```python
import torch

def _softmax(x, axis=-1):
    return torch.softmax(x, dim=axis)

def _gelu(x):
    return torch.nn.functional.gelu(x, approximate='tanh')

def _silu(x):
    return torch.nn.functional.silu(x)

def _sigmoid(x):
    return torch.sigmoid(x)

def _layernorm(x, axis=-1, eps=1e-05):
    m = x.mean(dim=axis, keepdim=True)
    v = x.var(dim=axis, keepdim=True, unbiased=False)
    return (x - m) / torch.sqrt(v + eps)

def _scatter_add(tgt, idx, src, axis=0):
    return tgt.clone().index_add_(axis, idx, src)

def _segment_sum(src, seg, n):
    out = torch.zeros((n,) + src.shape[1:], dtype=src.dtype)
    return out.index_add_(0, seg, src)

def _pad(x, pw):
    flat = tuple((v for pair in reversed(pw) for v in pair))
    return torch.nn.functional.pad(x, flat)
kernel_name = 'recurrent_scan__memory_aug_recurrent_mem_tr__moe_arch_mod__prompt'

def setup_inputs():

    _w = lambda a: (lambda t: t.to(torch.bfloat16) if t.is_floating_point() else t)(torch.as_tensor(a))

    def _A_setup():
        B, S, Dm = (1, 2048, 640)
        H, Dh = (32, 128)
        M, seg = (8, 32)
        seg = min(seg, S)
        S = S // seg * seg
        return {'x': _w((lambda *s: torch.randn(*s, dtype=torch.bfloat16) * 0.05)(B, S, Dm)), 'mem0': _w((lambda *s: torch.randn(*s, dtype=torch.bfloat16) * 0.2)(B, M, Dm)), 'Wq': _w((lambda *s: torch.randn(*s, dtype=torch.bfloat16) * 1.6)(Dm, H, Dh) * Dm ** (-0.5)), 'Wk': _w((lambda *s: torch.randn(*s, dtype=torch.bfloat16) * 1.6)(Dm, H, Dh) * Dm ** (-0.5)), 'Wv': _w((lambda *s: torch.randn(*s, dtype=torch.bfloat16) * 0.2)(Dm, H, Dh) * Dm ** (-0.5)), 'Wo': _w((lambda *s: torch.randn(*s, dtype=torch.bfloat16) * 0.2)(H, Dh, Dm) * (H * Dh) ** (-0.5)), 'seg_len': seg}
    _A_in = _A_setup()

    def _B_setup():
        B, S, D, F, C = (1, 2048, 640, 1728, 8)
        return {'x': _w((lambda *s: torch.randn(*s, dtype=torch.bfloat16) * 0.05)(B, S, D)), 'w_r': _w((lambda *s: torch.randn(*s, dtype=torch.bfloat16) * 0.2)(D)), 'w_gate': _w((lambda *s: torch.randn(*s, dtype=torch.bfloat16) * 0.1)(D, F)), 'w_up': _w((lambda *s: torch.randn(*s, dtype=torch.bfloat16) * 0.1)(D, F)), 'w_down': _w((lambda *s: torch.randn(*s, dtype=torch.bfloat16) * 0.1)(F, D))}
    _B_in = _B_setup()
    return {'A_x': _A_in['x'], 'A_mem0': _A_in['mem0'], 'A_Wq': _A_in['Wq'], 'A_Wk': _A_in['Wk'], 'A_Wv': _A_in['Wv'], 'A_Wo': _A_in['Wo'], 'A_seg_len': _A_in['seg_len'], 'B_x': _B_in['x'], 'B_w_r': _B_in['w_r'], 'B_w_gate': _B_in['w_gate'], 'B_w_up': _B_in['w_up'], 'B_w_down': _B_in['w_down']}

def reference(A_x, A_mem0, A_Wq, A_Wk, A_Wv, A_Wo, A_seg_len, B_x, B_w_r, B_w_gate, B_w_up, B_w_down):

    def _A_ref(x, mem0, Wq, Wk, Wv, Wo, seg_len):
        B, S, Dm = x.shape
        H, Dh = (Wq.shape[1], Wq.shape[2])
        M = mem0.shape[1]
        scale = Dh ** (-0.5)
        n_seg = S // seg_len
        L = M + seg_len
        idx = torch.arange(L)
        mask = (idx[:, None] < M) | (idx[:, None] >= idx[None, :])
        mem = mem0
        outs = []
        for s in range(n_seg):
            xs = x[:, s * seg_len:(s + 1) * seg_len, :].clone()
            h = torch.concatenate([mem, xs], axis=1)
            q = torch.einsum('btd,dhe->bhte', h, Wq)
            k = torch.einsum('btd,dhe->bhte', h, Wk)
            v = torch.einsum('btd,dhe->bhte', h, Wv)
            scores = torch.einsum('bhqe,bhke->bhqk', q, k) * scale
            scores = torch.where(mask[None, None], scores, -1000000000.0)
            p = _softmax(scores, axis=-1)
            o = torch.einsum('bhqk,bhke->bhqe', p, v)
            o = torch.einsum('bhte,hed->btd', o, Wo)
            mem = o[:, :M, :].clone()
            outs.append(o[:, M:, :])
        return torch.concatenate(outs, axis=1)

    def _B_ref(x, w_r, w_gate, w_up, w_down):
        B, S, D = x.shape
        C = 8
        r = x @ w_r
        idx = torch.argsort(-r, axis=-1)[:, :C]
        idx_e = (lambda x, n, axis: torch.repeat_interleave(x, n, dim=axis))(idx.reshape(B, C, 1), D, axis=2)
        x_sel = (lambda x, i, axis: torch.take_along_dim(x, i, dim=axis))(x, idx_e, axis=1)
        g = _silu(x_sel @ w_gate)
        u = x_sel @ w_up
        y = g * u @ w_down
        r_sel = _sigmoid((lambda x, i, axis: torch.take_along_dim(x, i, dim=axis))(r, idx, axis=1))
        y = y * r_sel.reshape(B, C, 1)
        b_off = (torch.arange(B) * S).reshape(B, 1)
        flat_idx = (idx + b_off).reshape(B * C)
        zero = (x * 0.0).reshape(B * S, D)
        upd = _scatter_add(zero, flat_idx, y.reshape(B * C, D), axis=0)
        return x + upd.reshape(B, S, D)
    x = A_x
    xn = _layernorm(x, axis=-1)
    s = _A_ref(xn, A_mem0, A_Wq, A_Wk, A_Wv, A_Wo, A_seg_len)
    g = _silu(_B_ref(xn, B_w_r, B_w_gate, B_w_up, B_w_down))
    return x + s * g
```

```asm
; @launch grid=(256,1,1) block=(256,1,1) lds=163840
.amdgcn_target "amdgcn-amd-amdhsa--gfx950"
.text
.globl recurrent_scan__memory_aug_recurrent_mem_tr__moe_arch_mod__prompt_kernel
.p2align 8
.type recurrent_scan__memory_aug_recurrent_mem_tr__moe_arch_mod__prompt_kernel,@function
recurrent_scan__memory_aug_recurrent_mem_tr__moe_arch_mod__prompt_kernel:
    s_cmp_ge_u32 s2, 256
    s_cbranch_scc1 L_exit_recurrent_scan__memory_aug_recurrent_mem_tr__moe_arch_mod__prompt_kernel
    s_load_dwordx2 s[4:5], s[0:1], 112
    s_mov_b32 s6, 0x10000000
    s_mov_b32 s7, 0x00020000
    s_load_dwordx2 s[20:21], s[0:1], 104
    s_mov_b32 s22, 0x100
    s_mov_b32 s23, 0x00020000
    v_lshrrev_b32 v1, 6, v0
    v_and_b32 v0, 63, v0
    v_readfirstlane_b32 s24, v1
    s_waitcnt lgkmcnt(0)
    s_getreg_b32 s73, hwreg(HW_REG_XCC_ID)
    s_and_b32 s73, s73, 7
    s_lshr_b32 s33, s2, 3
    s_lshl_b32 s25, s73, 5
    s_add_u32 s25, s25, s33
    s_mov_b32 s76, 1
    s_mov_b32 s77, 0
    s_lshl_b32 s26, s2, 8
    s_min_u32 s26, s26, 44800
    s_add_u32 s26, s26, 5373952
    v_lshlrev_b32 v1, 2, v0
    v_mov_b32 v2, 0
    s_cmp_lg_u32 s24, 0
    s_cbranch_scc1 L_recudsp_1
    buffer_store_dword v2, v1, s[4:7], s26 offen sc1
L_recudsp_1:
    s_mov_b32 s3, s25
    s_lshr_b32 s32, s25, 5
    s_and_b32 s33, s25, 31
    s_cmp_ge_u32 s25, 64
    s_cbranch_scc1 L_recuwk_2
    s_load_dwordx2 s[8:9], s[0:1], 16
    s_mov_b32 s10, 0x500000
    s_mov_b32 s11, 0x00020000
    s_load_dwordx2 s[12:13], s[0:1], 24
    s_mov_b32 s14, 0x500000
    s_mov_b32 s15, 0x00020000
    s_load_dwordx2 s[16:17], s[0:1], 32
    s_mov_b32 s18, 0x500000
    s_mov_b32 s19, 0x00020000
    s_load_dwordx2 s[52:53], s[0:1], 40
    s_mov_b32 s54, 0x500000
    s_mov_b32 s55, 0x00020000
    s_load_dwordx2 s[56:57], s[0:1], 8
    s_mov_b32 s58, 0x2800
    s_mov_b32 s59, 0x00020000
    v_bfe_u32 v14, v0, 4, 1
    v_lshrrev_b32 v15, 5, v0
    v_bfe_u32 v16, v0, 2, 2
    v_lshrrev_b32 v17, 1, v16
    v_and_b32 v18, 1, v16
    v_lshlrev_b32 v19, 1, v14
    v_and_b32 v20, 3, v0
    v_xor_b32 v19, v19, v20
    v_lshlrev_b32 v21, 4, v19
    s_and_b32 s31, s24, 1
    v_bfe_u32 v22, v0, 2, 1
    v_xor_b32 v22, v22, v14
    v_lshlrev_b32 v23, 1, v15
    v_xor_b32 v23, v23, v20
    v_lshlrev_b32 v23, 4, v23
    v_lshl_add_u32 v23, v22, 6, v23
    v_bfe_u32 v22, v0, 3, 2
    v_lshl_add_u32 v22, v15, 5, v22
    v_lshl_add_u32 v22, s31, 2, v22
    v_lshl_add_u32 v8, v22, 13, v23
    v_bfe_u32 v22, v0, 3, 1
    v_lshl_add_u32 v22, v15, 2, v22
    v_lshl_add_u32 v22, v14, 3, v22
    v_lshl_add_u32 v22, s31, 4, v22
    v_lshl_add_u32 v9, v22, 13, v23
    v_bfe_u32 v22, v0, 2, 3
    v_lshlrev_b32 v40, 7, v22
    v_bfe_u32 v22, v0, 3, 1
    v_xor_b32 v22, s31, v22
    v_lshl_add_u32 v40, v22, 6, v40
    v_lshl_add_u32 v40, v14, 5, v40
    v_lshl_add_u32 v40, v20, 3, v40
    v_mul_u32_u24 v22, 34816, v15
    v_add_u32 v40, v40, v22
    s_and_b32 s31, s24, 2
    s_mul_i32 s31, s31, 34816
    s_add_u32 s31, s31, 24576
    v_add_u32 v40, s31, v40
    v_xor_b32 v41, 32, v40
    v_lshl_add_u32 v22, v15, 2, v18
    v_lshl_add_u32 v22, v14, 4, v22
    v_lshl_add_u32 v22, v17, 5, v22
    v_mul_u32_u24 v10, 1280, v22
    v_lshrrev_b32 v23, 1, v19
    v_mul_u32_u24 v23, 81920, v23
    v_add_u32 v11, v10, v23
    v_and_b32 v23, 1, v19
    v_lshl_add_u32 v11, v23, 4, v11
    v_add_u32 v10, v10, v21
    s_mul_i32 s30, s24, 34816
    s_add_u32 s30, s30, 24576
    v_lshrrev_b32 v12, 2, v0
    v_lshlrev_b32 v12, 6, v12
    v_lshl_add_u32 v12, v20, 3, v12
    v_lshl_add_u32 v12, v14, 5, v12
    v_add_u32 v12, s30, v12
    v_xor_b32 v13, 32, v12
    v_lshl_add_u32 v1, v0, 4, s30
    s_lshl_b32 s26, s33, 8
    s_and_b32 s27, s24, 2
    s_lshl_b32 s27, s27, 6
    s_add_u32 s26, s26, s27
    s_mul_i32 s27, s32, 2621440
    s_add_u32 s60, s26, s27
    s_sub_u32 s27, 2621440, s27
    s_add_u32 s61, s26, s27
    s_mul_i32 s26, s33, 163840
    s_mul_i32 s27, s32, 640
    s_add_u32 s26, s26, s27
    s_lshl_b32 s27, s24, 7
    s_add_u32 s62, s26, s27
    s_lshl_b32 s27, s24, 5
    s_add_u32 s63, s26, s27
    s_add_u32 s63, s63, 512
    s_waitcnt lgkmcnt(0)
    v_and_b32 v22, 15, v0
    v_lshrrev_b32 v23, 4, v0
    v_bfe_u32 v24, v0, 1, 1
    v_lshl_add_u32 v25, v23, 1, v24
    v_lshlrev_b32 v2, 7, v25
    v_lshrrev_b32 v25, 2, v22
    v_lshl_add_u32 v2, v25, 5, v2
    v_and_b32 v26, 1, v0
    v_lshl_add_u32 v2, v26, 4, v2
    v_mov_b32 v7, 0x44444444
    v_mov_b32 v27, 0xeeeeeeee
    v_cmp_eq_u32 vcc, 1, v24
    s_nop 1
    v_cndmask_b32 v7, v7, v27, vcc
    v_xor_b32 v27, v23, v25
    v_lshlrev_b32 v3, 3, v27
    v_lshl_add_u32 v3, v20, 5, v3
    v_lshl_add_u32 v3, v25, 8, v3
    s_lshl_b32 s26, s24, 10
    s_add_u32 s26, s26, 18432
    v_add_u32 v3, s26, v3
    v_lshl_add_u32 v27, v23, 1, v26
    v_lshlrev_b32 v27, 4, v27
    s_lshl_b32 s26, s33, 7
    v_add_u32 v27, s26, v27
    v_lshrrev_b32 v28, 1, v22
    s_lshl_b32 s26, s24, 3
    v_add_u32 v28, s26, v28
    v_lshl_add_u32 v5, v28, 12, v27
    v_lshrrev_b32 v28, 3, v22
    s_lshl_b32 s26, s24, 1
    s_add_u32 s26, s26, 32
    v_add_u32 v28, s26, v28
    v_lshl_add_u32 v6, v28, 12, v27
    v_bfe_u32 v28, v0, 1, 2
    v_lshl_add_u32 v6, v28, 2, v6
    s_mul_i32 s35, s32, 524288
    s_add_u32 s35, s35, 6291456
    s_lshl_b32 s26, s24, 5
    s_add_u32 s43, s26, s33
    s_cmp_lt_u32 s43, 40
    s_cselect_b32 s42, 1, 0
    s_lshl_b32 s36, s43, 12
    s_add_u32 s36, s36, s35
    s_lshl_b32 s43, s43, 7
    s_and_b32 s28, s24, 1
    s_mul_i32 s28, s28, 3072
    s_cmp_lt_u32 s24, 2
    s_cselect_b32 s27, s43, s28
    s_cselect_b32 s66, 5120, 0
    s_add_u32 s66, s66, s28
    s_add_u32 s66, s66, 0
    s_lshl_b32 s37, s32, 16
    s_add_u32 s37, s37, 7340032
    s_add_u32 s37, s37, s27
    s_add_u32 s45, s37, 24576
    s_mul_i32 s26, s32, 5120
    s_add_u32 s48, s26, 8388608
    s_add_u32 s48, s48, s43
    s_sub_u32 s38, 8393728, s26
    s_add_u32 s38, s38, s28
    s_lshl_b32 s27, s33, 13
    s_lshl_b32 s26, s24, 11
    s_add_u32 s51, s26, 10240
    s_add_u32 s26, s26, s27
    s_add_u32 s39, s26, 33554432
    s_add_u32 s47, s26, 50331648
    s_lshl_b32 s26, s24, 24
    s_add_u32 s67, s26, s27
    s_add_u32 s67, s67, 33816576
    s_lshl_b32 s26, s24, 8
    s_add_u32 s72, s26, 22528
    s_lshl_b32 s27, s33, 12
    s_lshr_b32 s28, s27, 1
    s_lshl_b32 s26, s24, 10
    s_add_u32 s27, s27, s26
    s_lshl_b32 s26, s24, 9
    s_add_u32 s28, s28, s26
    s_add_u32 s27, s27, 83886080
    s_add_u32 s28, s28, 92274688
    s_cmp_eq_u32 s32, 0
    s_cselect_b32 s40, s27, s28
    s_lshr_b32 s29, 0x20000, s32
    s_lshl_b32 s27, s33, 8
    s_lshl_b32 s28, s32, 7
    s_add_u32 s41, s27, s28
    s_lshl_b32 s28, s24, 2
    s_add_u32 s41, s41, s28
    s_add_u32 s41, s41, 5406720
    s_add_u32 s46, s27, 5382144
    s_mov_b32 s44, 0
    s_mov_b32 s68, 0x3e0293ee
    s_mov_b32 s69, s68
    s_mov_b32 s31, s29
    s_lshr_b32 s27, s24, 1
    s_lshl_b32 s27, s27, 10
    s_and_b32 s28, s24, 1
    s_lshl_b32 s28, s28, 5
    s_add_u32 s49, s27, s28
    s_add_u32 s49, s49, 22528
    s_mov_b32 s34, 0
    s_mov_b32 s64, 0x33333333
    s_mov_b32 s65, s64
    s_mov_b32 s74, 0x00ff00ff
    s_mov_b32 s75, s74
    v_lshl_add_u32 v27, s24, 1, v15
    v_bfe_u32 v28, v0, 2, 3
    v_mul_u32_u24 v28, 1280, v28
    v_lshl_add_u32 v29, v20, 5, v28
    v_lshl_add_u32 v29, v27, 2, v29
    v_lshl_add_u32 v30, v20, 2, v28
    v_lshl_add_u32 v30, v27, 4, v30
    v_lshlrev_b32 v0, 4, v0
    v_mov_b32 v32, -1
    v_mov_b32 v33, -1
    v_mov_b32 v34, -1
    v_mov_b32 v35, -1
    s_mul_i32 s26, s31, 63
    s_add_u32 s26, s26, s40
    v_lshrrev_b32 v31, s32, v0
    s_cmp_lg_u32 s32, 0
    s_cbranch_scc1 L_recug1_3
    buffer_store_dwordx4 v[32:35], v31, s[4:7], s26 offen sc1
    s_add_u32 s26, s26, s31
    s_branch L_recug2_4
L_recug1_3:
    buffer_store_dwordx2 v[32:33], v31, s[4:7], s26 offen sc1
    s_add_u32 s26, s26, s31
L_recug2_4:
    s_cmp_eq_u32 s42, 0
    s_cbranch_scc1 L_recunc_5
    s_mov_b32 s26, s36
    s_add_u32 s27, s26, 262144
    buffer_store_dwordx4 v[32:35], v0, s[4:7], s26 offen offset:0 sc1
    buffer_store_dwordx4 v[32:35], v0, s[4:7], s26 offen offset:1024 sc1
    buffer_store_dwordx4 v[32:35], v0, s[4:7], s26 offen offset:2048 sc1
    buffer_store_dwordx4 v[32:35], v0, s[4:7], s26 offen offset:3072 sc1
    buffer_store_dwordx4 v[32:35], v0, s[4:7], s27 offen offset:0 sc1
    buffer_store_dwordx4 v[32:35], v0, s[4:7], s27 offen offset:1024 sc1
    buffer_store_dwordx4 v[32:35], v0, s[4:7], s27 offen offset:2048 sc1
    buffer_store_dwordx4 v[32:35], v0, s[4:7], s27 offen offset:3072 sc1
    s_mov_b32 s26, s37
    s_mov_b64 exec, 0xff
    buffer_store_dwordx4 v[32:35], v0, s[4:7], s26 offen sc1
    s_add_u32 s26, s26, 8192
    buffer_store_dwordx4 v[32:35], v0, s[4:7], s26 offen sc1
    s_add_u32 s26, s26, 8192
    buffer_store_dwordx4 v[32:35], v0, s[4:7], s26 offen sc1
    s_add_u32 s26, s26, 8192
    buffer_store_dwordx4 v[32:35], v0, s[4:7], s26 offen sc1
    s_add_u32 s26, s26, 8192
    s_mov_b64 exec, -1
L_recunc_5:
    s_lshl_b32 s26, s32, 5
    s_add_u32 s26, s26, s33
    s_mul_i32 s26, s26, 10240
    s_mul_i32 s27, s24, 2560
    s_add_u32 s26, s26, s27
    s_add_u32 s26, s26, 8388608
    buffer_store_dwordx4 v[32:35], v0, s[4:7], s26 offen offset:0 sc1
    buffer_store_dwordx4 v[32:35], v0, s[4:7], s26 offen offset:1024 sc1
    s_mov_b32 exec_hi, 0
    buffer_store_dwordx4 v[32:35], v0, s[4:7], s26 offen offset:2048 sc1
    s_mov_b32 exec_hi, -1
    s_mul_i32 s27, s32, 640
    s_sub_u32 s28, 640, s27
    s_lshl_b32 s29, s24, 8
    s_add_u32 m0, s29, 0
    s_add_u32 s26, s27, 0
    buffer_load_dword v29, s[56:59], s26 offen lds
    s_add_u32 m0, s29, 1024
    s_add_u32 s26, s27, 128
    buffer_load_dword v29, s[56:59], s26 offen lds
    s_add_u32 m0, s29, 2048
    s_add_u32 s26, s27, 256
    buffer_load_dword v29, s[56:59], s26 offen lds
    s_add_u32 m0, s29, 3072
    s_add_u32 s26, s27, 384
    buffer_load_dword v29, s[56:59], s26 offen lds
    s_add_u32 m0, s29, 4096
    s_add_u32 s26, s27, 512
    buffer_load_dword v30, s[56:59], s26 offen lds
    s_add_u32 m0, s29, 5120
    s_add_u32 s26, s28, 0
    buffer_load_dword v29, s[56:59], s26 offen lds
    s_add_u32 m0, s29, 6144
    s_add_u32 s26, s28, 128
    buffer_load_dword v29, s[56:59], s26 offen lds
    s_add_u32 m0, s29, 7168
    s_add_u32 s26, s28, 256
    buffer_load_dword v29, s[56:59], s26 offen lds
    s_add_u32 m0, s29, 8192
    s_add_u32 s26, s28, 384
    buffer_load_dword v29, s[56:59], s26 offen lds
    s_add_u32 m0, s29, 9216
    s_add_u32 s26, s28, 512
    buffer_load_dword v30, s[56:59], s26 offen lds
    s_add_u32 m0, s30, 0
    s_add_u32 s26, s60, 0
    buffer_load_dwordx4 v8, s[8:11], s26 offen lds
    s_add_u32 m0, s30, 1024
    s_add_u32 s26, s60, 131072
    buffer_load_dwordx4 v8, s[8:11], s26 offen lds
    s_add_u32 m0, s30, 2048
    s_add_u32 s26, s60, 65536
    buffer_load_dwordx4 v8, s[8:11], s26 offen lds
    s_add_u32 m0, s30, 3072
    s_add_u32 s26, s60, 196608
    buffer_load_dwordx4 v8, s[8:11], s26 offen lds
    s_add_u32 m0, s30, 4096
    s_add_u32 s26, s60, 0
    buffer_load_dwordx4 v8, s[16:19], s26 offen lds
    s_add_u32 m0, s30, 5120
    s_add_u32 s26, s60, 131072
    buffer_load_dwordx4 v8, s[16:19], s26 offen lds
    s_add_u32 m0, s30, 6144
    s_add_u32 s26, s60, 65536
    buffer_load_dwordx4 v8, s[16:19], s26 offen lds
    s_add_u32 m0, s30, 7168
    s_add_u32 s26, s60, 196608
    buffer_load_dwordx4 v8, s[16:19], s26 offen lds
    s_add_u32 m0, s30, 8192
    s_add_u32 s26, s60, 524288
    buffer_load_dwordx4 v8, s[8:11], s26 offen lds
    s_add_u32 m0, s30, 9216
    s_add_u32 s26, s60, 655360
    buffer_load_dwordx4 v8, s[8:11], s26 offen lds
    s_add_u32 m0, s30, 10240
    s_add_u32 s26, s60, 589824
    buffer_load_dwordx4 v8, s[8:11], s26 offen lds
    s_add_u32 m0, s30, 11264
    s_add_u32 s26, s60, 720896
    buffer_load_dwordx4 v8, s[8:11], s26 offen lds
    s_add_u32 m0, s30, 12288
    s_add_u32 s26, s60, 524288
    buffer_load_dwordx4 v8, s[16:19], s26 offen lds
    s_add_u32 m0, s30, 13312
    s_add_u32 s26, s60, 655360
    buffer_load_dwordx4 v8, s[16:19], s26 offen lds
    s_add_u32 m0, s30, 14336
    s_add_u32 s26, s60, 589824
    buffer_load_dwordx4 v8, s[16:19], s26 offen lds
    s_add_u32 m0, s30, 15360
    s_add_u32 s26, s60, 720896
    buffer_load_dwordx4 v8, s[16:19], s26 offen lds
    s_add_u32 m0, s30, 16384
    s_add_u32 s26, s60, 1048576
    buffer_load_dwordx4 v8, s[8:11], s26 offen lds
    s_add_u32 m0, s30, 17408
    s_add_u32 s26, s60, 1179648
    buffer_load_dwordx4 v8, s[8:11], s26 offen lds
    s_add_u32 m0, s30, 18432
    s_add_u32 s26, s60, 1114112
    buffer_load_dwordx4 v8, s[8:11], s26 offen lds
    s_add_u32 m0, s30, 19456
    s_add_u32 s26, s60, 1245184
    buffer_load_dwordx4 v8, s[8:11], s26 offen lds
    s_add_u32 m0, s30, 20480
    s_add_u32 s26, s60, 1048576
    buffer_load_dwordx4 v8, s[16:19], s26 offen lds
    s_add_u32 m0, s30, 21504
    s_add_u32 s26, s60, 1179648
    buffer_load_dwordx4 v8, s[16:19], s26 offen lds
    s_add_u32 m0, s30, 22528
    s_add_u32 s26, s60, 1114112
    buffer_load_dwordx4 v8, s[16:19], s26 offen lds
    s_add_u32 m0, s30, 23552
    s_add_u32 s26, s60, 1245184
    buffer_load_dwordx4 v8, s[16:19], s26 offen lds
    s_add_u32 m0, s30, 24576
    s_add_u32 s26, s60, 1572864
    buffer_load_dwordx4 v8, s[8:11], s26 offen lds
    s_add_u32 m0, s30, 25600
    s_add_u32 s26, s60, 1703936
    buffer_load_dwordx4 v8, s[8:11], s26 offen lds
    s_add_u32 m0, s30, 26624
    s_add_u32 s26, s60, 1638400
    buffer_load_dwordx4 v8, s[8:11], s26 offen lds
    s_add_u32 m0, s30, 27648
    s_add_u32 s26, s60, 1769472
    buffer_load_dwordx4 v8, s[8:11], s26 offen lds
    s_add_u32 m0, s30, 28672
    s_add_u32 s26, s60, 1572864
    buffer_load_dwordx4 v8, s[16:19], s26 offen lds
    s_add_u32 m0, s30, 29696
    s_add_u32 s26, s60, 1703936
    buffer_load_dwordx4 v8, s[16:19], s26 offen lds
    s_add_u32 m0, s30, 30720
    s_add_u32 s26, s60, 1638400
    buffer_load_dwordx4 v8, s[16:19], s26 offen lds
    s_add_u32 m0, s30, 31744
    s_add_u32 s26, s60, 1769472
    buffer_load_dwordx4 v8, s[16:19], s26 offen lds
    s_waitcnt vmcnt(28)
    s_barrier
    s_bitcmp1_b32 s77, 0
    s_cbranch_scc1 L_recuna_7
    s_or_b32 s77, s77, 1
    s_cmp_lg_u32 s24, 0
    s_cbranch_scc1 L_recuna_7
    s_lshr_b32 s26, s2, 3
    s_lshl_b32 s26, 1, s26
    s_lshl_b32 s27, s73, 3
    v_mov_b32 v36, s26
    v_mov_b32 v37, 0x100
    v_mov_b32 v38, 0
    s_mov_b64 exec, 1
    buffer_atomic_add_x2 v[36:37], v38, s[20:23], s27 offen offset:0 sc1
    s_mov_b64 exec, -1
L_recuna_7:
    v_mov_b32 v36, 0
    v_mov_b32 v37, 1
    s_lshl_b32 s26, s76, 2
    s_cmp_lg_u32 s24, 0
    s_cbranch_scc1 L_recunw_6
    s_mov_b64 exec, 1
    buffer_atomic_add v37, v36, s[20:23], s26 offen offset:136 sc1
    s_mov_b64 exec, -1
L_recunw_6:
    ds_read_b64_tr_b16 a[0:1], v40 offset:0
    ds_read_b64_tr_b16 a[2:3], v40 offset:1024
    ds_read_b64_tr_b16 a[4:5], v40 offset:2048
    ds_read_b64_tr_b16 a[6:7], v40 offset:3072
    ds_read_b64_tr_b16 a[8:9], v41 offset:0
    ds_read_b64_tr_b16 a[10:11], v41 offset:1024
    ds_read_b64_tr_b16 a[12:13], v41 offset:2048
    ds_read_b64_tr_b16 a[14:15], v41 offset:3072
    s_waitcnt lgkmcnt(0)
    s_waitcnt vmcnt(24)
    s_barrier
    s_add_u32 m0, s30, 0
    s_add_u32 s26, s60, 2097152
    buffer_load_dwordx4 v9, s[8:11], s26 offen lds
    s_add_u32 m0, s30, 1024
    s_add_u32 s26, s60, 2113536
    buffer_load_dwordx4 v9, s[8:11], s26 offen lds
    s_add_u32 m0, s30, 2048
    s_add_u32 s26, s60, 2359296
    buffer_load_dwordx4 v9, s[8:11], s26 offen lds
    s_add_u32 m0, s30, 3072
    s_add_u32 s26, s60, 2375680
    buffer_load_dwordx4 v9, s[8:11], s26 offen lds
    ds_read_b64_tr_b16 a[16:17], v40 offset:4096
    ds_read_b64_tr_b16 a[18:19], v40 offset:5120
    ds_read_b64_tr_b16 a[20:21], v40 offset:6144
    ds_read_b64_tr_b16 a[22:23], v40 offset:7168
    ds_read_b64_tr_b16 a[24:25], v41 offset:4096
    ds_read_b64_tr_b16 a[26:27], v41 offset:5120
    ds_read_b64_tr_b16 a[28:29], v41 offset:6144
    ds_read_b64_tr_b16 a[30:31], v41 offset:7168
    s_waitcnt lgkmcnt(0)
    s_waitcnt vmcnt(24)
    s_barrier
    s_add_u32 m0, s30, 4096
    s_add_u32 s26, s60, 2097152
    buffer_load_dwordx4 v9, s[16:19], s26 offen lds
    s_add_u32 m0, s30, 5120
    s_add_u32 s26, s60, 2113536
    buffer_load_dwordx4 v9, s[16:19], s26 offen lds
    s_add_u32 m0, s30, 6144
    s_add_u32 s26, s60, 2359296
    buffer_load_dwordx4 v9, s[16:19], s26 offen lds
    s_add_u32 m0, s30, 7168
    s_add_u32 s26, s60, 2375680
    buffer_load_dwordx4 v9, s[16:19], s26 offen lds
    ds_read_b64_tr_b16 a[32:33], v40 offset:8192
    ds_read_b64_tr_b16 a[34:35], v40 offset:9216
    ds_read_b64_tr_b16 a[36:37], v40 offset:10240
    ds_read_b64_tr_b16 a[38:39], v40 offset:11264
    ds_read_b64_tr_b16 a[40:41], v41 offset:8192
    ds_read_b64_tr_b16 a[42:43], v41 offset:9216
    ds_read_b64_tr_b16 a[44:45], v41 offset:10240
    ds_read_b64_tr_b16 a[46:47], v41 offset:11264
    s_waitcnt lgkmcnt(0)
    s_waitcnt vmcnt(24)
    s_barrier
    s_add_u32 m0, s30, 8192
    s_add_u32 s26, s61, 0
    buffer_load_dwordx4 v8, s[8:11], s26 offen lds
    s_add_u32 m0, s30, 9216
    s_add_u32 s26, s61, 131072
    buffer_load_dwordx4 v8, s[8:11], s26 offen lds
    s_add_u32 m0, s30, 10240
    s_add_u32 s26, s61, 65536
    buffer_load_dwordx4 v8, s[8:11], s26 offen lds
    s_add_u32 m0, s30, 11264
    s_add_u32 s26, s61, 196608
    buffer_load_dwordx4 v8, s[8:11], s26 offen lds
    ds_read_b64_tr_b16 a[48:49], v40 offset:12288
    ds_read_b64_tr_b16 a[50:51], v40 offset:13312
    ds_read_b64_tr_b16 a[52:53], v40 offset:14336
    ds_read_b64_tr_b16 a[54:55], v40 offset:15360
    ds_read_b64_tr_b16 a[56:57], v41 offset:12288
    ds_read_b64_tr_b16 a[58:59], v41 offset:13312
    ds_read_b64_tr_b16 a[60:61], v41 offset:14336
    ds_read_b64_tr_b16 a[62:63], v41 offset:15360
    s_waitcnt lgkmcnt(0)
    s_waitcnt vmcnt(24)
    s_barrier
    s_add_u32 m0, s30, 12288
    s_add_u32 s26, s61, 0
    buffer_load_dwordx4 v8, s[16:19], s26 offen lds
    s_add_u32 m0, s30, 13312
    s_add_u32 s26, s61, 131072
    buffer_load_dwordx4 v8, s[16:19], s26 offen lds
    s_add_u32 m0, s30, 14336
    s_add_u32 s26, s61, 65536
    buffer_load_dwordx4 v8, s[16:19], s26 offen lds
    s_add_u32 m0, s30, 15360
    s_add_u32 s26, s61, 196608
    buffer_load_dwordx4 v8, s[16:19], s26 offen lds
    ds_read_b64_tr_b16 a[64:65], v40 offset:16384
    ds_read_b64_tr_b16 a[66:67], v40 offset:17408
    ds_read_b64_tr_b16 a[68:69], v40 offset:18432
    ds_read_b64_tr_b16 a[70:71], v40 offset:19456
    ds_read_b64_tr_b16 a[72:73], v41 offset:16384
    ds_read_b64_tr_b16 a[74:75], v41 offset:17408
    ds_read_b64_tr_b16 a[76:77], v41 offset:18432
    ds_read_b64_tr_b16 a[78:79], v41 offset:19456
    s_waitcnt lgkmcnt(0)
    s_waitcnt vmcnt(24)
    s_barrier
    s_add_u32 m0, s30, 16384
    s_add_u32 s26, s61, 524288
    buffer_load_dwordx4 v8, s[8:11], s26 offen lds
    s_add_u32 m0, s30, 17408
    s_add_u32 s26, s61, 655360
    buffer_load_dwordx4 v8, s[8:11], s26 offen lds
    s_add_u32 m0, s30, 18432
    s_add_u32 s26, s61, 589824
    buffer_load_dwordx4 v8, s[8:11], s26 offen lds
    s_add_u32 m0, s30, 19456
    s_add_u32 s26, s61, 720896
    buffer_load_dwordx4 v8, s[8:11], s26 offen lds
    ds_read_b64_tr_b16 a[80:81], v40 offset:20480
    ds_read_b64_tr_b16 a[82:83], v40 offset:21504
    ds_read_b64_tr_b16 a[84:85], v40 offset:22528
    ds_read_b64_tr_b16 a[86:87], v40 offset:23552
    ds_read_b64_tr_b16 a[88:89], v41 offset:20480
    ds_read_b64_tr_b16 a[90:91], v41 offset:21504
    ds_read_b64_tr_b16 a[92:93], v41 offset:22528
    ds_read_b64_tr_b16 a[94:95], v41 offset:23552
    s_waitcnt lgkmcnt(0)
    s_waitcnt vmcnt(24)
    s_barrier
    s_add_u32 m0, s30, 20480
    s_add_u32 s26, s61, 524288
    buffer_load_dwordx4 v8, s[12:15], s26 offen lds
    s_add_u32 m0, s30, 21504
    s_add_u32 s26, s61, 655360
    buffer_load_dwordx4 v8, s[12:15], s26 offen lds
    s_add_u32 m0, s30, 22528
    s_add_u32 s26, s61, 589824
    buffer_load_dwordx4 v8, s[12:15], s26 offen lds
    s_add_u32 m0, s30, 23552
    s_add_u32 s26, s61, 720896
    buffer_load_dwordx4 v8, s[12:15], s26 offen lds
    ds_read_b64_tr_b16 a[96:97], v40 offset:24576
    ds_read_b64_tr_b16 a[98:99], v40 offset:25600
    ds_read_b64_tr_b16 a[100:101], v40 offset:26624
    ds_read_b64_tr_b16 a[102:103], v40 offset:27648
    ds_read_b64_tr_b16 a[104:105], v41 offset:24576
    ds_read_b64_tr_b16 a[106:107], v41 offset:25600
    ds_read_b64_tr_b16 a[108:109], v41 offset:26624
    ds_read_b64_tr_b16 a[110:111], v41 offset:27648
    s_waitcnt lgkmcnt(0)
    s_waitcnt vmcnt(24)
    s_barrier
    s_add_u32 m0, s30, 24576
    s_add_u32 s26, s61, 524288
    buffer_load_dwordx4 v8, s[16:19], s26 offen lds
    s_add_u32 m0, s30, 25600
    s_add_u32 s26, s61, 655360
    buffer_load_dwordx4 v8, s[16:19], s26 offen lds
    s_add_u32 m0, s30, 26624
    s_add_u32 s26, s61, 589824
    buffer_load_dwordx4 v8, s[16:19], s26 offen lds
    s_add_u32 m0, s30, 27648
    s_add_u32 s26, s61, 720896
    buffer_load_dwordx4 v8, s[16:19], s26 offen lds
    ds_read_b64_tr_b16 a[112:113], v40 offset:28672
    ds_read_b64_tr_b16 a[114:115], v40 offset:29696
    ds_read_b64_tr_b16 a[116:117], v40 offset:30720
    ds_read_b64_tr_b16 a[118:119], v40 offset:31744
    ds_read_b64_tr_b16 a[120:121], v41 offset:28672
    ds_read_b64_tr_b16 a[122:123], v41 offset:29696
    ds_read_b64_tr_b16 a[124:125], v41 offset:30720
    ds_read_b64_tr_b16 a[126:127], v41 offset:31744
    s_waitcnt lgkmcnt(0)
    s_waitcnt vmcnt(24)
    s_barrier
    s_add_u32 m0, s30, 28672
    s_add_u32 s26, s61, 1048576
    buffer_load_dwordx4 v8, s[8:11], s26 offen lds
    s_add_u32 m0, s30, 29696
    s_add_u32 s26, s61, 1179648
    buffer_load_dwordx4 v8, s[8:11], s26 offen lds
    s_add_u32 m0, s30, 30720
    s_add_u32 s26, s61, 1114112
    buffer_load_dwordx4 v8, s[8:11], s26 offen lds
    s_add_u32 m0, s30, 31744
    s_add_u32 s26, s61, 1245184
    buffer_load_dwordx4 v8, s[8:11], s26 offen lds
    ds_read_b64_tr_b16 a[128:129], v40 offset:0
    ds_read_b64_tr_b16 a[130:131], v40 offset:1024
    ds_read_b64_tr_b16 a[132:133], v40 offset:2048
    ds_read_b64_tr_b16 a[134:135], v40 offset:3072
    ds_read_b64_tr_b16 a[136:137], v41 offset:0
    ds_read_b64_tr_b16 a[138:139], v41 offset:1024
    ds_read_b64_tr_b16 a[140:141], v41 offset:2048
    ds_read_b64_tr_b16 a[142:143], v41 offset:3072
    s_waitcnt lgkmcnt(0)
    s_waitcnt vmcnt(24)
    s_barrier
    s_add_u32 m0, s30, 0
    s_add_u32 s26, s61, 1048576
    buffer_load_dwordx4 v8, s[12:15], s26 offen lds
    s_add_u32 m0, s30, 1024
    s_add_u32 s26, s61, 1179648
    buffer_load_dwordx4 v8, s[12:15], s26 offen lds
    s_add_u32 m0, s30, 2048
    s_add_u32 s26, s61, 1114112
    buffer_load_dwordx4 v8, s[12:15], s26 offen lds
    s_add_u32 m0, s30, 3072
    s_add_u32 s26, s61, 1245184
    buffer_load_dwordx4 v8, s[12:15], s26 offen lds
    ds_read_b64_tr_b16 a[144:145], v40 offset:4096
    ds_read_b64_tr_b16 a[146:147], v40 offset:5120
    ds_read_b64_tr_b16 a[148:149], v40 offset:6144
    ds_read_b64_tr_b16 a[150:151], v40 offset:7168
    ds_read_b64_tr_b16 a[152:153], v41 offset:4096
    ds_read_b64_tr_b16 a[154:155], v41 offset:5120
    ds_read_b64_tr_b16 a[156:157], v41 offset:6144
    ds_read_b64_tr_b16 a[158:159], v41 offset:7168
    s_waitcnt lgkmcnt(0)
    s_waitcnt vmcnt(24)
    s_barrier
    s_add_u32 m0, s30, 4096
    s_add_u32 s26, s61, 1048576
    buffer_load_dwordx4 v8, s[16:19], s26 offen lds
    s_add_u32 m0, s30, 5120
    s_add_u32 s26, s61, 1179648
    buffer_load_dwordx4 v8, s[16:19], s26 offen lds
    s_add_u32 m0, s30, 6144
    s_add_u32 s26, s61, 1114112
    buffer_load_dwordx4 v8, s[16:19], s26 offen lds
    s_add_u32 m0, s30, 7168
    s_add_u32 s26, s61, 1245184
    buffer_load_dwordx4 v8, s[16:19], s26 offen lds
    ds_read_b64_tr_b16 a[160:161], v40 offset:8192
    ds_read_b64_tr_b16 a[162:163], v40 offset:9216
    ds_read_b64_tr_b16 a[164:165], v40 offset:10240
    ds_read_b64_tr_b16 a[166:167], v40 offset:11264
    ds_read_b64_tr_b16 a[168:169], v41 offset:8192
    ds_read_b64_tr_b16 a[170:171], v41 offset:9216
    ds_read_b64_tr_b16 a[172:173], v41 offset:10240
    ds_read_b64_tr_b16 a[174:175], v41 offset:11264
    s_waitcnt lgkmcnt(0)
    s_waitcnt vmcnt(24)
    s_barrier
    s_add_u32 m0, s30, 8192
    s_add_u32 s26, s61, 1572864
    buffer_load_dwordx4 v8, s[8:11], s26 offen lds
    s_add_u32 m0, s30, 9216
    s_add_u32 s26, s61, 1703936
    buffer_load_dwordx4 v8, s[8:11], s26 offen lds
    s_add_u32 m0, s30, 10240
    s_add_u32 s26, s61, 1638400
    buffer_load_dwordx4 v8, s[8:11], s26 offen lds
    s_add_u32 m0, s30, 11264
    s_add_u32 s26, s61, 1769472
    buffer_load_dwordx4 v8, s[8:11], s26 offen lds
    ds_read_b64_tr_b16 a[176:177], v40 offset:12288
    ds_read_b64_tr_b16 a[178:179], v40 offset:13312
    ds_read_b64_tr_b16 a[180:181], v40 offset:14336
    ds_read_b64_tr_b16 a[182:183], v40 offset:15360
    ds_read_b64_tr_b16 a[184:185], v41 offset:12288
    ds_read_b64_tr_b16 a[186:187], v41 offset:13312
    ds_read_b64_tr_b16 a[188:189], v41 offset:14336
    ds_read_b64_tr_b16 a[190:191], v41 offset:15360
    s_waitcnt lgkmcnt(0)
    s_waitcnt vmcnt(24)
    s_barrier
    s_add_u32 m0, s30, 12288
    s_add_u32 s26, s61, 1572864
    buffer_load_dwordx4 v8, s[12:15], s26 offen lds
    s_add_u32 m0, s30, 13312
    s_add_u32 s26, s61, 1703936
    buffer_load_dwordx4 v8, s[12:15], s26 offen lds
    s_add_u32 m0, s30, 14336
    s_add_u32 s26, s61, 1638400
    buffer_load_dwordx4 v8, s[12:15], s26 offen lds
    s_add_u32 m0, s30, 15360
    s_add_u32 s26, s61, 1769472
    buffer_load_dwordx4 v8, s[12:15], s26 offen lds
    ds_read_b64_tr_b16 a[192:193], v40 offset:16384
    ds_read_b64_tr_b16 a[194:195], v40 offset:17408
    ds_read_b64_tr_b16 a[196:197], v40 offset:18432
    ds_read_b64_tr_b16 a[198:199], v40 offset:19456
    ds_read_b64_tr_b16 a[200:201], v41 offset:16384
    ds_read_b64_tr_b16 a[202:203], v41 offset:17408
    ds_read_b64_tr_b16 a[204:205], v41 offset:18432
    ds_read_b64_tr_b16 a[206:207], v41 offset:19456
    s_waitcnt lgkmcnt(0)
    s_waitcnt vmcnt(24)
    s_barrier
    s_add_u32 m0, s30, 16384
    s_add_u32 s26, s61, 1572864
    buffer_load_dwordx4 v8, s[16:19], s26 offen lds
    s_add_u32 m0, s30, 17408
    s_add_u32 s26, s61, 1703936
    buffer_load_dwordx4 v8, s[16:19], s26 offen lds
    s_add_u32 m0, s30, 18432
    s_add_u32 s26, s61, 1638400
    buffer_load_dwordx4 v8, s[16:19], s26 offen lds
    s_add_u32 m0, s30, 19456
    s_add_u32 s26, s61, 1769472
    buffer_load_dwordx4 v8, s[16:19], s26 offen lds
    ds_read_b64_tr_b16 v[72:73], v40 offset:20480
    ds_read_b64_tr_b16 v[74:75], v40 offset:21504
    ds_read_b64_tr_b16 v[76:77], v40 offset:22528
    ds_read_b64_tr_b16 v[78:79], v40 offset:23552
    ds_read_b64_tr_b16 a[208:209], v41 offset:20480
    ds_read_b64_tr_b16 a[210:211], v41 offset:21504
    ds_read_b64_tr_b16 a[212:213], v41 offset:22528
    ds_read_b64_tr_b16 a[214:215], v41 offset:23552
    s_waitcnt lgkmcnt(0)
    s_waitcnt vmcnt(24)
    s_barrier
    ds_write_b128 v1, v[72:75] offset:32768
    ds_write_b128 v1, v[76:79] offset:33792
    s_add_u32 m0, s30, 20480
    s_add_u32 s26, s61, 2097152
    buffer_load_dwordx4 v9, s[8:11], s26 offen lds
    s_add_u32 m0, s30, 21504
    s_add_u32 s26, s61, 2113536
    buffer_load_dwordx4 v9, s[8:11], s26 offen lds
    s_add_u32 m0, s30, 22528
    s_add_u32 s26, s61, 2359296
    buffer_load_dwordx4 v9, s[8:11], s26 offen lds
    s_add_u32 m0, s30, 23552
    s_add_u32 s26, s61, 2375680
    buffer_load_dwordx4 v9, s[8:11], s26 offen lds
    ds_read_b64_tr_b16 a[216:217], v40 offset:24576
    ds_read_b64_tr_b16 a[218:219], v40 offset:25600
    ds_read_b64_tr_b16 a[220:221], v40 offset:26624
    ds_read_b64_tr_b16 a[222:223], v40 offset:27648
    ds_read_b64_tr_b16 a[224:225], v41 offset:24576
    ds_read_b64_tr_b16 a[226:227], v41 offset:25600
    ds_read_b64_tr_b16 a[228:229], v41 offset:26624
    ds_read_b64_tr_b16 a[230:231], v41 offset:27648
    s_waitcnt lgkmcnt(0)
    s_waitcnt vmcnt(24)
    s_barrier
    s_add_u32 m0, s30, 24576
    s_add_u32 s26, s61, 2097152
    buffer_load_dwordx4 v9, s[12:15], s26 offen lds
    s_add_u32 m0, s30, 25600
    s_add_u32 s26, s61, 2113536
    buffer_load_dwordx4 v9, s[12:15], s26 offen lds
    s_add_u32 m0, s30, 26624
    s_add_u32 s26, s61, 2359296
    buffer_load_dwordx4 v9, s[12:15], s26 offen lds
    s_add_u32 m0, s30, 27648
    s_add_u32 s26, s61, 2375680
    buffer_load_dwordx4 v9, s[12:15], s26 offen lds
    ds_read_b64_tr_b16 a[232:233], v40 offset:28672
    ds_read_b64_tr_b16 a[234:235], v40 offset:29696
    ds_read_b64_tr_b16 a[236:237], v40 offset:30720
    ds_read_b64_tr_b16 a[238:239], v40 offset:31744
    ds_read_b64_tr_b16 a[240:241], v41 offset:28672
    ds_read_b64_tr_b16 a[242:243], v41 offset:29696
    ds_read_b64_tr_b16 a[244:245], v41 offset:30720
    ds_read_b64_tr_b16 a[246:247], v41 offset:31744
    s_waitcnt lgkmcnt(0)
    s_waitcnt vmcnt(24)
    s_barrier
    s_add_u32 m0, s30, 28672
    s_add_u32 s26, s61, 2097152
    buffer_load_dwordx4 v9, s[16:19], s26 offen lds
    s_add_u32 m0, s30, 29696
    s_add_u32 s26, s61, 2113536
    buffer_load_dwordx4 v9, s[16:19], s26 offen lds
    s_add_u32 m0, s30, 30720
    s_add_u32 s26, s61, 2359296
    buffer_load_dwordx4 v9, s[16:19], s26 offen lds
    s_add_u32 m0, s30, 31744
    s_add_u32 s26, s61, 2375680
    buffer_load_dwordx4 v9, s[16:19], s26 offen lds
    ds_read_b64_tr_b16 a[248:249], v40 offset:0
    ds_read_b64_tr_b16 a[250:251], v40 offset:1024
    ds_read_b64_tr_b16 a[252:253], v40 offset:2048
    ds_read_b64_tr_b16 a[254:255], v40 offset:3072
    ds_read_b64_tr_b16 v[88:89], v41 offset:0
    ds_read_b64_tr_b16 v[90:91], v41 offset:1024
    ds_read_b64_tr_b16 v[92:93], v41 offset:2048
    ds_read_b64_tr_b16 v[94:95], v41 offset:3072
    s_waitcnt lgkmcnt(0)
    s_waitcnt vmcnt(24)
    s_barrier
    s_add_u32 m0, s30, 0
    s_add_u32 s26, s62, 0
    buffer_load_dwordx4 v10, s[52:55], s26 offen lds
    s_add_u32 m0, s30, 1024
    s_add_u32 s26, s62, 2560
    buffer_load_dwordx4 v10, s[52:55], s26 offen lds
    s_add_u32 m0, s30, 2048
    s_add_u32 s26, s62, 10240
    buffer_load_dwordx4 v10, s[52:55], s26 offen lds
    s_add_u32 m0, s30, 3072
    s_add_u32 s26, s62, 12800
    buffer_load_dwordx4 v10, s[52:55], s26 offen lds
    ds_read_b64_tr_b16 v[96:97], v40 offset:4096
    ds_read_b64_tr_b16 v[98:99], v40 offset:5120
    ds_read_b64_tr_b16 v[100:101], v40 offset:6144
    ds_read_b64_tr_b16 v[102:103], v40 offset:7168
    ds_read_b64_tr_b16 v[104:105], v41 offset:4096
    ds_read_b64_tr_b16 v[106:107], v41 offset:5120
    ds_read_b64_tr_b16 v[108:109], v41 offset:6144
    ds_read_b64_tr_b16 v[110:111], v41 offset:7168
    s_waitcnt lgkmcnt(0)
    s_waitcnt vmcnt(24)
    s_barrier
    s_add_u32 m0, s30, 4096
    s_add_u32 s26, s62, 64
    buffer_load_dwordx4 v10, s[52:55], s26 offen lds
    s_add_u32 m0, s30, 5120
    s_add_u32 s26, s62, 2624
    buffer_load_dwordx4 v10, s[52:55], s26 offen lds
    s_add_u32 m0, s30, 6144
    s_add_u32 s26, s62, 10304
    buffer_load_dwordx4 v10, s[52:55], s26 offen lds
    s_add_u32 m0, s30, 7168
    s_add_u32 s26, s62, 12864
    buffer_load_dwordx4 v10, s[52:55], s26 offen lds
    ds_read_b64_tr_b16 v[112:113], v40 offset:8192
    ds_read_b64_tr_b16 v[114:115], v40 offset:9216
    ds_read_b64_tr_b16 v[116:117], v40 offset:10240
    ds_read_b64_tr_b16 v[118:119], v40 offset:11264
    ds_read_b64_tr_b16 v[120:121], v41 offset:8192
    ds_read_b64_tr_b16 v[122:123], v41 offset:9216
    ds_read_b64_tr_b16 v[124:125], v41 offset:10240
    ds_read_b64_tr_b16 v[126:127], v41 offset:11264
    s_waitcnt lgkmcnt(0)
    s_waitcnt vmcnt(24)
    s_barrier
    s_add_u32 m0, s30, 8192
    s_add_u32 s26, s62, 81920
    buffer_load_dwordx4 v10, s[52:55], s26 offen lds
    s_add_u32 m0, s30, 9216
    s_add_u32 s26, s62, 84480
    buffer_load_dwordx4 v10, s[52:55], s26 offen lds
    s_add_u32 m0, s30, 10240
    s_add_u32 s26, s62, 92160
    buffer_load_dwordx4 v10, s[52:55], s26 offen lds
    s_add_u32 m0, s30, 11264
    s_add_u32 s26, s62, 94720
    buffer_load_dwordx4 v10, s[52:55], s26 offen lds
    ds_read_b64_tr_b16 v[128:129], v40 offset:12288
    ds_read_b64_tr_b16 v[130:131], v40 offset:13312
    ds_read_b64_tr_b16 v[132:133], v40 offset:14336
    ds_read_b64_tr_b16 v[134:135], v40 offset:15360
    ds_read_b64_tr_b16 v[136:137], v41 offset:12288
    ds_read_b64_tr_b16 v[138:139], v41 offset:13312
    ds_read_b64_tr_b16 v[140:141], v41 offset:14336
    ds_read_b64_tr_b16 v[142:143], v41 offset:15360
    s_waitcnt lgkmcnt(0)
    s_waitcnt vmcnt(24)
    s_barrier
    s_add_u32 m0, s30, 12288
    s_add_u32 s26, s60, 0
    buffer_load_dwordx4 v8, s[12:15], s26 offen lds
    s_add_u32 m0, s30, 13312
    s_add_u32 s26, s60, 131072
    buffer_load_dwordx4 v8, s[12:15], s26 offen lds
    s_add_u32 m0, s30, 14336
    s_add_u32 s26, s60, 65536
    buffer_load_dwordx4 v8, s[12:15], s26 offen lds
    s_add_u32 m0, s30, 15360
    s_add_u32 s26, s60, 196608
    buffer_load_dwordx4 v8, s[12:15], s26 offen lds
    ds_read_b64_tr_b16 v[144:145], v40 offset:16384
    ds_read_b64_tr_b16 v[146:147], v40 offset:17408
    ds_read_b64_tr_b16 v[148:149], v40 offset:18432
    ds_read_b64_tr_b16 v[150:151], v40 offset:19456
    ds_read_b64_tr_b16 v[152:153], v41 offset:16384
    ds_read_b64_tr_b16 v[154:155], v41 offset:17408
    ds_read_b64_tr_b16 v[156:157], v41 offset:18432
    ds_read_b64_tr_b16 v[158:159], v41 offset:19456
    s_waitcnt lgkmcnt(0)
    s_waitcnt vmcnt(24)
    s_barrier
    s_add_u32 m0, s30, 16384
    s_add_u32 s26, s60, 524288
    buffer_load_dwordx4 v8, s[12:15], s26 offen lds
    s_add_u32 m0, s30, 17408
    s_add_u32 s26, s60, 655360
    buffer_load_dwordx4 v8, s[12:15], s26 offen lds
    s_add_u32 m0, s30, 18432
    s_add_u32 s26, s60, 589824
    buffer_load_dwordx4 v8, s[12:15], s26 offen lds
    s_add_u32 m0, s30, 19456
    s_add_u32 s26, s60, 720896
    buffer_load_dwordx4 v8, s[12:15], s26 offen lds
    ds_read_b64_tr_b16 v[160:161], v40 offset:20480
    ds_read_b64_tr_b16 v[162:163], v40 offset:21504
    ds_read_b64_tr_b16 v[164:165], v40 offset:22528
    ds_read_b64_tr_b16 v[166:167], v40 offset:23552
    ds_read_b64_tr_b16 v[168:169], v41 offset:20480
    ds_read_b64_tr_b16 v[170:171], v41 offset:21504
    ds_read_b64_tr_b16 v[172:173], v41 offset:22528
    ds_read_b64_tr_b16 v[174:175], v41 offset:23552
    s_waitcnt lgkmcnt(0)
    s_waitcnt vmcnt(24)
    s_barrier
    s_add_u32 m0, s30, 20480
    s_add_u32 s26, s60, 1048576
    buffer_load_dwordx4 v8, s[12:15], s26 offen lds
    s_add_u32 m0, s30, 21504
    s_add_u32 s26, s60, 1179648
    buffer_load_dwordx4 v8, s[12:15], s26 offen lds
    s_add_u32 m0, s30, 22528
    s_add_u32 s26, s60, 1114112
    buffer_load_dwordx4 v8, s[12:15], s26 offen lds
    s_add_u32 m0, s30, 23552
    s_add_u32 s26, s60, 1245184
    buffer_load_dwordx4 v8, s[12:15], s26 offen lds
    ds_read_b64_tr_b16 v[176:177], v40 offset:24576
    ds_read_b64_tr_b16 v[178:179], v40 offset:25600
    ds_read_b64_tr_b16 v[180:181], v40 offset:26624
    ds_read_b64_tr_b16 v[182:183], v40 offset:27648
    ds_read_b64_tr_b16 v[184:185], v41 offset:24576
    ds_read_b64_tr_b16 v[186:187], v41 offset:25600
    ds_read_b64_tr_b16 v[188:189], v41 offset:26624
    ds_read_b64_tr_b16 v[190:191], v41 offset:27648
    s_waitcnt lgkmcnt(0)
    s_waitcnt vmcnt(24)
    s_barrier
    s_add_u32 m0, s30, 24576
    s_add_u32 s26, s60, 1572864
    buffer_load_dwordx4 v8, s[12:15], s26 offen lds
    s_add_u32 m0, s30, 25600
    s_add_u32 s26, s60, 1703936
    buffer_load_dwordx4 v8, s[12:15], s26 offen lds
    s_add_u32 m0, s30, 26624
    s_add_u32 s26, s60, 1638400
    buffer_load_dwordx4 v8, s[12:15], s26 offen lds
    s_add_u32 m0, s30, 27648
    s_add_u32 s26, s60, 1769472
    buffer_load_dwordx4 v8, s[12:15], s26 offen lds
    ds_read_b64_tr_b16 v[192:193], v40 offset:28672
    ds_read_b64_tr_b16 v[194:195], v40 offset:29696
    ds_read_b64_tr_b16 v[196:197], v40 offset:30720
    ds_read_b64_tr_b16 v[198:199], v40 offset:31744
    ds_read_b64_tr_b16 v[200:201], v41 offset:28672
    ds_read_b64_tr_b16 v[202:203], v41 offset:29696
    ds_read_b64_tr_b16 v[204:205], v41 offset:30720
    ds_read_b64_tr_b16 v[206:207], v41 offset:31744
    s_waitcnt lgkmcnt(0)
    s_waitcnt vmcnt(24)
    s_barrier
    v_lshrrev_b32 v20, 2, v0
    v_and_b32 v20, 60, v20
    buffer_load_dword v21, v20, s[20:23], 0 offen offset:0 sc1
    s_add_u32 m0, s30, 28672
    s_add_u32 s26, s60, 2097152
    buffer_load_dwordx4 v9, s[12:15], s26 offen lds
    s_add_u32 m0, s30, 29696
    s_add_u32 s26, s60, 2113536
    buffer_load_dwordx4 v9, s[12:15], s26 offen lds
    s_add_u32 m0, s30, 30720
    s_add_u32 s26, s60, 2359296
    buffer_load_dwordx4 v9, s[12:15], s26 offen lds
    s_add_u32 m0, s30, 31744
    s_add_u32 s26, s60, 2375680
    buffer_load_dwordx4 v9, s[12:15], s26 offen lds
    ds_read_b64_tr_b16 v[208:209], v12 offset:0
    ds_read_b64_tr_b16 v[210:211], v12 offset:1024
    ds_read_b64_tr_b16 v[212:213], v12 offset:2048
    ds_read_b64_tr_b16 v[214:215], v12 offset:3072
    ds_read_b64_tr_b16 v[216:217], v13 offset:0
    ds_read_b64_tr_b16 v[218:219], v13 offset:1024
    ds_read_b64_tr_b16 v[220:221], v13 offset:2048
    ds_read_b64_tr_b16 v[222:223], v13 offset:3072
    s_waitcnt lgkmcnt(0)
    s_waitcnt vmcnt(24)
    s_barrier
    s_add_u32 m0, s30, 0
    s_add_u32 s26, s61, 0
    buffer_load_dwordx4 v8, s[12:15], s26 offen lds
    s_add_u32 m0, s30, 1024
    s_add_u32 s26, s61, 131072
    buffer_load_dwordx4 v8, s[12:15], s26 offen lds
    s_add_u32 m0, s30, 2048
    s_add_u32 s26, s61, 65536
    buffer_load_dwordx4 v8, s[12:15], s26 offen lds
    s_add_u32 m0, s30, 3072
    s_add_u32 s26, s61, 196608
    buffer_load_dwordx4 v8, s[12:15], s26 offen lds
    ds_read_b64_tr_b16 v[224:225], v12 offset:4096
    ds_read_b64_tr_b16 v[226:227], v12 offset:5120
    ds_read_b64_tr_b16 v[228:229], v12 offset:6144
    ds_read_b64_tr_b16 v[230:231], v12 offset:7168
    ds_read_b64_tr_b16 v[232:233], v13 offset:4096
    ds_read_b64_tr_b16 v[234:235], v13 offset:5120
    ds_read_b64_tr_b16 v[236:237], v13 offset:6144
    ds_read_b64_tr_b16 v[238:239], v13 offset:7168
    s_waitcnt lgkmcnt(0)
    s_waitcnt vmcnt(24)
    s_barrier
    s_add_u32 m0, s30, 4096
    s_add_u32 s26, s62, 81984
    buffer_load_dwordx4 v10, s[52:55], s26 offen lds
    s_add_u32 m0, s30, 5120
    s_add_u32 s26, s62, 84544
    buffer_load_dwordx4 v10, s[52:55], s26 offen lds
    s_add_u32 m0, s30, 6144
    s_add_u32 s26, s62, 92224
    buffer_load_dwordx4 v10, s[52:55], s26 offen lds
    s_add_u32 m0, s30, 7168
    s_add_u32 s26, s62, 94784
    buffer_load_dwordx4 v10, s[52:55], s26 offen lds
    ds_read_b64_tr_b16 v[240:241], v12 offset:8192
    ds_read_b64_tr_b16 v[242:243], v12 offset:9216
    ds_read_b64_tr_b16 v[244:245], v12 offset:10240
    ds_read_b64_tr_b16 v[246:247], v12 offset:11264
    ds_read_b64_tr_b16 v[248:249], v13 offset:8192
    ds_read_b64_tr_b16 v[250:251], v13 offset:9216
    ds_read_b64_tr_b16 v[252:253], v13 offset:10240
    ds_read_b64_tr_b16 v[254:255], v13 offset:11264
    s_waitcnt lgkmcnt(0)
    s_waitcnt vmcnt(24)
    s_barrier
    s_add_u32 m0, s30, 8192
    s_add_u32 s26, s63, 0
    buffer_load_dwordx4 v11, s[52:55], s26 offen lds
    s_add_u32 m0, s30, 9216
    s_add_u32 s26, s63, 2560
    buffer_load_dwordx4 v11, s[52:55], s26 offen lds
    s_add_u32 m0, s30, 10240
    s_add_u32 s26, s63, 10240
    buffer_load_dwordx4 v11, s[52:55], s26 offen lds
    s_add_u32 m0, s30, 11264
    s_add_u32 s26, s63, 12800
    buffer_load_dwordx4 v11, s[52:55], s26 offen lds
    ds_read_b64_tr_b16 v[72:73], v40 offset:12288
    ds_read_b64_tr_b16 v[74:75], v40 offset:13312
    ds_read_b64_tr_b16 v[76:77], v40 offset:14336
    ds_read_b64_tr_b16 v[78:79], v40 offset:15360
    ds_read_b64_tr_b16 v[80:81], v41 offset:12288
    ds_read_b64_tr_b16 v[82:83], v41 offset:13312
    ds_read_b64_tr_b16 v[84:85], v41 offset:14336
    ds_read_b64_tr_b16 v[86:87], v41 offset:15360
    s_waitcnt lgkmcnt(0)
    s_waitcnt vmcnt(24)
    s_barrier
    ds_write_b128 v1, v[72:75] offset:12288
    ds_write_b128 v1, v[76:79] offset:13312
    ds_write_b128 v1, v[80:83] offset:14336
    ds_write_b128 v1, v[84:87] offset:15360
    ds_read_b64_tr_b16 v[56:57], v40 offset:16384
    ds_read_b64_tr_b16 v[58:59], v40 offset:17408
    ds_read_b64_tr_b16 v[60:61], v40 offset:18432
    ds_read_b64_tr_b16 v[62:63], v40 offset:19456
    ds_read_b64_tr_b16 v[64:65], v41 offset:16384
    ds_read_b64_tr_b16 v[66:67], v41 offset:17408
    ds_read_b64_tr_b16 v[68:69], v41 offset:18432
    ds_read_b64_tr_b16 v[70:71], v41 offset:19456
    s_waitcnt lgkmcnt(0)
    s_waitcnt vmcnt(20)
    s_barrier
    ds_write_b128 v1, v[56:59] offset:16384
    ds_write_b128 v1, v[60:63] offset:17408
    ds_write_b128 v1, v[64:67] offset:18432
    ds_write_b128 v1, v[68:71] offset:19456
    ds_read_b64_tr_b16 v[72:73], v40 offset:20480
    ds_read_b64_tr_b16 v[74:75], v40 offset:21504
    ds_read_b64_tr_b16 v[76:77], v40 offset:22528
    ds_read_b64_tr_b16 v[78:79], v40 offset:23552
    ds_read_b64_tr_b16 v[80:81], v41 offset:20480
    ds_read_b64_tr_b16 v[82:83], v41 offset:21504
    ds_read_b64_tr_b16 v[84:85], v41 offset:22528
    ds_read_b64_tr_b16 v[86:87], v41 offset:23552
    s_waitcnt lgkmcnt(0)
    s_waitcnt vmcnt(16)
    s_barrier
    ds_write_b128 v1, v[72:75] offset:20480
    ds_write_b128 v1, v[76:79] offset:21504
    ds_write_b128 v1, v[80:83] offset:22528
    ds_write_b128 v1, v[84:87] offset:23552
    ds_read_b64_tr_b16 v[56:57], v40 offset:24576
    ds_read_b64_tr_b16 v[58:59], v40 offset:25600
    ds_read_b64_tr_b16 v[60:61], v40 offset:26624
    ds_read_b64_tr_b16 v[62:63], v40 offset:27648
    ds_read_b64_tr_b16 v[64:65], v41 offset:24576
    ds_read_b64_tr_b16 v[66:67], v41 offset:25600
    ds_read_b64_tr_b16 v[68:69], v41 offset:26624
    ds_read_b64_tr_b16 v[70:71], v41 offset:27648
    s_waitcnt lgkmcnt(0)
    s_waitcnt vmcnt(12)
    s_barrier
    ds_write_b128 v1, v[56:59] offset:24576
    ds_write_b128 v1, v[60:63] offset:25600
    ds_write_b128 v1, v[64:67] offset:26624
    ds_write_b128 v1, v[68:71] offset:27648
    v_mov_b32 v14, 0
    s_lshl_b32 s26, s76, 2
    buffer_load_dword v15, v14, s[20:23], s26 offen offset:136 sc1
    v_bfe_u32 v16, v0, 6, 1
    v_lshlrev_b32 v16, 13, v16
    v_bfe_u32 v17, v0, 4, 2
    v_lshl_add_u32 v16, v17, 2, v16
    v_bfe_u32 v18, v0, 7, 1
    v_lshl_add_u32 v16, v18, 7, v16
    buffer_load_dword v17, v16, s[4:7], s46 offen sc1
    ds_read_b64_tr_b16 v[72:73], v40 offset:28672
    ds_read_b64_tr_b16 v[74:75], v40 offset:29696
    ds_read_b64_tr_b16 v[76:77], v40 offset:30720
    ds_read_b64_tr_b16 v[78:79], v40 offset:31744
    ds_read_b64_tr_b16 v[80:81], v41 offset:28672
    ds_read_b64_tr_b16 v[82:83], v41 offset:29696
    ds_read_b64_tr_b16 v[84:85], v41 offset:30720
    ds_read_b64_tr_b16 v[86:87], v41 offset:31744
    s_waitcnt lgkmcnt(0)
    s_waitcnt vmcnt(8)
    s_barrier
    ds_write_b128 v1, v[72:75] offset:28672
    ds_write_b128 v1, v[76:79] offset:29696
    ds_write_b128 v1, v[80:83] offset:30720
    ds_write_b128 v1, v[84:87] offset:31744
    ds_read_b64_tr_b16 v[56:57], v40 offset:0
    ds_read_b64_tr_b16 v[58:59], v40 offset:1024
    ds_read_b64_tr_b16 v[60:61], v40 offset:2048
    ds_read_b64_tr_b16 v[62:63], v40 offset:3072
    ds_read_b64_tr_b16 v[64:65], v41 offset:0
    ds_read_b64_tr_b16 v[66:67], v41 offset:1024
    ds_read_b64_tr_b16 v[68:69], v41 offset:2048
    ds_read_b64_tr_b16 v[70:71], v41 offset:3072
    s_waitcnt lgkmcnt(0)
    s_waitcnt vmcnt(4)
    s_barrier
    ds_write_b128 v1, v[56:59] offset:0
    ds_write_b128 v1, v[60:63] offset:1024
    ds_write_b128 v1, v[64:67] offset:2048
    ds_write_b128 v1, v[68:71] offset:3072
    ds_read_b64_tr_b16 v[72:73], v12 offset:4096
    ds_read_b64_tr_b16 v[74:75], v12 offset:5120
    ds_read_b64_tr_b16 v[76:77], v12 offset:6144
    ds_read_b64_tr_b16 v[78:79], v12 offset:7168
    ds_read_b64_tr_b16 v[80:81], v13 offset:4096
    ds_read_b64_tr_b16 v[82:83], v13 offset:5120
    ds_read_b64_tr_b16 v[84:85], v13 offset:6144
    ds_read_b64_tr_b16 v[86:87], v13 offset:7168
    s_waitcnt lgkmcnt(0)
    s_waitcnt vmcnt(0)
    s_barrier
    ds_write_b128 v1, v[72:75] offset:4096
    ds_write_b128 v1, v[76:79] offset:5120
    ds_write_b128 v1, v[80:83] offset:6144
    ds_write_b128 v1, v[84:87] offset:7168
    ds_read_b64_tr_b16 v[56:57], v12 offset:8192
    ds_read_b64_tr_b16 v[58:59], v12 offset:9216
    ds_read_b64_tr_b16 v[60:61], v12 offset:10240
    ds_read_b64_tr_b16 v[62:63], v12 offset:11264
    ds_read_b64_tr_b16 v[64:65], v13 offset:8192
    ds_read_b64_tr_b16 v[66:67], v13 offset:9216
    ds_read_b64_tr_b16 v[68:69], v13 offset:10240
    ds_read_b64_tr_b16 v[70:71], v13 offset:11264
    s_waitcnt lgkmcnt(0)
    s_barrier
    ds_write_b128 v1, v[56:59] offset:8192
    ds_write_b128 v1, v[60:63] offset:9216
    ds_write_b128 v1, v[64:67] offset:10240
    ds_write_b128 v1, v[68:71] offset:11264
    s_waitcnt lgkmcnt(0)
    s_bitcmp1_b32 s77, 1
    s_cbranch_scc1 L_recuvtr_11
    s_mov_b32 s72, 0
    s_branch L_recuvok_9
L_recuvf_8:
    buffer_load_dword v21, v20, s[20:23], 0 offen offset:0 sc1
L_recuvok_9:
    s_waitcnt vmcnt(0)
    v_lshrrev_b32 v22, 8, v21
    s_nop 1
    v_add_u32_dpp v22, v22, v22 quad_perm:[2,3,0,1] row_mask:0xf bank_mask:0xf
    s_nop 1
    v_add_u32_dpp v22, v22, v22 row_ror:4 row_mask:0xf bank_mask:0xf
    s_nop 1
    v_add_u32_dpp v22, v22, v22 row_ror:8 row_mask:0xf bank_mask:0xf
    s_nop 0
    v_readlane_b32 s70, v22, 1
    s_cmp_ge_u32 s70, 0x100
    s_cbranch_scc1 L_recuvfu_10
    s_add_u32 s72, s72, 1
    s_cmp_lt_u32 s72, 400000
    s_cbranch_scc1 L_recuvf_8
    s_branch L_exit_recurrent_scan__memory_aug_recurrent_mem_tr__moe_arch_mod__prompt_kernel
L_recuvfu_10:
    s_cmp_gt_u32 s70, 0x100
    s_cbranch_scc1 L_exit_recurrent_scan__memory_aug_recurrent_mem_tr__moe_arch_mod__prompt_kernel
    v_mov_b32 v22, 0x2000
    v_bfe_u32 v20, v20, 2, 1
    v_cmp_eq_u32 vcc, 1, v20
    s_nop 1
    v_cndmask_b32 v22, -1, v22, vcc
    v_cmp_ne_u32 vcc, v21, v22
    s_cbranch_vccnz L_gen_recurrent_scan__memory_aug_recurrent_mem_tr__moe_arch_mod__prompt_kernel
    s_or_b32 s77, s77, 2
L_recuvtr_11:
    s_waitcnt vmcnt(0)
    s_cmp_eq_u32 s72, 0
    s_cbranch_scc1 L_recukf_12
    buffer_load_dword v17, v16, s[4:7], s46 offen sc1
L_recukf_12:
    s_branch L_recukg_13
    s_nop 0
    s_nop 0
    s_nop 0
    s_nop 0
    s_nop 0
    s_nop 0
    s_nop 0
    s_nop 0
    s_nop 0
    s_nop 0
    s_nop 0
L_recukg_13:
    s_lshl_b32 s26, s76, 2
    s_mov_b32 s50, 0
    s_branch L_recucrdyp_16
L_recucrdy_14:
    buffer_load_dword v15, v14, s[20:23], s26 offen offset:136 sc1
L_recucrdyp_16:
    s_waitcnt vmcnt(0)
    v_cmp_gt_u32 vcc, 64, v15
    s_cbranch_vccz L_recucrdyok_15
    s_add_u32 s50, s50, 1
    s_cmp_lt_u32 s50, 400000
    s_cbranch_scc0 L_exit_recurrent_scan__memory_aug_recurrent_mem_tr__moe_arch_mod__prompt_kernel
    s_sleep 2
    s_branch L_recucrdy_14
L_recucrdyok_15:
    s_mov_b32 s70, 0x3f803f80
    s_mov_b32 s71, s70
    s_mov_b32 s73, s31
    s_lshl_b32 s26, s24, 8
    s_add_u32 s72, s26, 22528
    s_lshl_b32 s26, s33, 12
    s_lshl_b32 s27, s24, 10
    s_add_u32 s26, s26, s27
    s_add_u32 s26, s26, s35
    s_add_u32 s60, s26, 262144
    s_add_u32 s61, s60, 131072
    s_cmp_lt_u32 s33, 8
    s_cselect_b64 s[62:63], -1, 0
    s_cmp_eq_u32 s76, 2
    s_cbranch_scc1 L_recugen_17
    s_mov_b32 s26, 1
    s_cmp_gt_u32 s44, s26
    s_cbranch_scc1 L_recuf0_18
    s_mov_b32 s50, 0
    s_branch L_recuf0sp_21
L_recuf0s_19:
    buffer_load_dword v17, v16, s[4:7], s46 offen sc1
L_recuf0sp_21:
    s_waitcnt vmcnt(0)
    v_lshl_add_u32 v17, v17, 1, v18
    v_cmp_ge_u32 vcc, s26, v17
    s_cbranch_vccz L_recuf0sok_20
    s_add_u32 s50, s50, 1
    s_cmp_lt_u32 s50, 400000
    s_cbranch_scc0 L_exit_recurrent_scan__memory_aug_recurrent_mem_tr__moe_arch_mod__prompt_kernel
    s_sleep 2
    s_branch L_recuf0s_19
L_recuf0sok_20:
    v_min_u32_dpp v17, v17, v17 quad_perm:[1,0,3,2] row_mask:0xf bank_mask:0xf
    s_nop 1
    v_min_u32_dpp v17, v17, v17 quad_perm:[2,3,0,1] row_mask:0xf bank_mask:0xf
    s_nop 1
    v_min_u32_dpp v17, v17, v17 row_half_mirror row_mask:0xf bank_mask:0xf
    s_nop 1
    v_min_u32_dpp v17, v17, v17 row_mirror row_mask:0xf bank_mask:0xf
    s_nop 0
    v_readfirstlane_b32 s44, v17
L_recuf0_18:
    s_mov_b32 m0, s51
    s_nop 0
    buffer_load_dwordx4 v0, s[4:7], s39 offen lds
    buffer_load_dwordx4 v0, s[4:7], s39 offen offset:1024 lds
    s_add_u32 s39, s39, 262144
    v_mov_b64 v[24:25], 0
    v_mov_b64 v[26:27], 0
    v_mov_b64 v[28:29], 0
    v_mov_b64 v[30:31], 0
    v_mov_b64 v[32:33], 0
    v_mov_b64 v[34:35], 0
    v_mov_b64 v[36:37], 0
    v_mov_b64 v[38:39], 0
    v_mov_b64 v[40:41], 0
    v_mov_b64 v[42:43], 0
    v_mov_b64 v[44:45], 0
    v_mov_b64 v[46:47], 0
    ds_read_b128 v[56:59], v1 offset:12288
    ds_read_b128 v[60:63], v1 offset:13312
    ds_read_b128 v[64:67], v1 offset:14336
    ds_read_b128 v[68:71], v1 offset:15360
    ds_read_b128 v[72:75], v1 offset:16384
    ds_read_b128 v[76:79], v1 offset:17408
    ds_read_b128 v[80:83], v1 offset:18432
    ds_read_b128 v[84:87], v1 offset:19456
    v_bfe_u32 v4, v0, 7, 2
    v_lshl_add_u32 v4, v4, 2, v0
    s_waitcnt lgkmcnt(0)
    s_mov_b64 s[8:9], 0
    s_mov_b32 s30, s38
    s_mov_b32 m0, s66
    s_mov_b32 s19, 0
    s_lshl_b32 s26, s32, 2
    s_add_u32 s26, s26, s24
    s_cmp_eq_u32 s26, 1
    s_cbranch_scc1 L_recub_23
    s_cmp_eq_u32 s26, 2
    s_cbranch_scc1 L_recub_24
    s_cmp_eq_u32 s26, 3
    s_cbranch_scc1 L_recub_25
    s_cmp_eq_u32 s26, 4
    s_cbranch_scc1 L_recub_26
    s_cmp_eq_u32 s26, 5
    s_cbranch_scc1 L_recub_27
    s_cmp_eq_u32 s26, 6
    s_cbranch_scc1 L_recub_28
    s_cmp_eq_u32 s26, 7
    s_cbranch_scc1 L_recub_29
L_recub_22:
L_recucl_30:
    s_barrier
    ds_read_b128 v[12:15], v2 offset:0
    ds_read_b128 v[16:19], v2 offset:1024
    ds_read_b128 v[20:23], v2 offset:2048
    s_mov_b64 exec, s[8:9]
    buffer_load_dwordx4 v0, s[4:7], s30 offen offset:0 sc1 lds
    buffer_load_dwordx4 v0, s[4:7], s30 offen offset:1024 sc1 lds
    buffer_load_dwordx4 v0, s[4:7], s30 offen offset:2048 sc1 lds
    s_mov_b64 exec, -1
    s_waitcnt lgkmcnt(2)
    v_smfmac_f32_16x16x64_bf16 v[24:27], v[12:15], a[0:7], v7
    v_mov_b32 v8, s34
    v_smfmac_f32_16x16x64_bf16 v[28:31], v[12:15], v[56:63], v7
    ds_read_b128 v[56:59], v1 offset:20480
    v_smfmac_f32_16x16x64_bf16 v[32:35], v[12:15], a[8:15], v7
    ds_read_b128 v[60:63], v1 offset:21504
    v_smfmac_f32_16x16x64_bf16 v[36:39], v[12:15], v[64:71], v7
    ds_read_b128 v[64:67], v1 offset:22528
    v_smfmac_f32_16x16x64_bf16 v[40:43], v[12:15], a[16:23], v7
    ds_read_b128 v[68:71], v1 offset:23552
    v_smfmac_f32_16x16x64_bf16 v[44:47], v[12:15], a[24:31], v7
    buffer_load_dwordx4 v[48:51], v0, s[4:7], s47 offen offset:0
    ds_read_b128 v[12:15], v2 offset:3072
    s_waitcnt lgkmcnt(6)
    v_smfmac_f32_16x16x64_bf16 v[24:27], v[16:19], a[32:39], v7
    buffer_load_dwordx4 v[52:55], v0, s[4:7], s47 offen offset:1024
    v_smfmac_f32_16x16x64_bf16 v[28:31], v[16:19], v[72:79], v7
    ds_read_b128 v[72:75], v1 offset:24576
    v_smfmac_f32_16x16x64_bf16 v[32:35], v[16:19], a[40:47], v7
    ds_read_b128 v[76:79], v1 offset:25600
    buffer_store_dword v8, off, s[4:7], s41 sc1
    v_smfmac_f32_16x16x64_bf16 v[36:39], v[16:19], v[80:87], v7
    ds_read_b128 v[80:83], v1 offset:26624
    v_smfmac_f32_16x16x64_bf16 v[40:43], v[16:19], a[48:55], v7
    ds_read_b128 v[84:87], v1 offset:27648
    v_smfmac_f32_16x16x64_bf16 v[44:47], v[16:19], a[56:63], v7
    ds_read_b128 v[16:19], v2 offset:4096
    s_waitcnt lgkmcnt(10)
    v_smfmac_f32_16x16x64_bf16 v[24:27], v[20:23], a[64:71], v7
    s_waitcnt lgkmcnt(8)
    v_smfmac_f32_16x16x64_bf16 v[28:31], v[20:23], v[56:63], v7
    ds_read_b128 v[56:59], v1 offset:28672
    v_smfmac_f32_16x16x64_bf16 v[32:35], v[20:23], a[72:79], v7
    ds_read_b128 v[60:63], v1 offset:29696
    s_waitcnt lgkmcnt(8)
    v_smfmac_f32_16x16x64_bf16 v[36:39], v[20:23], v[64:71], v7
    ds_read_b128 v[64:67], v1 offset:30720
    v_smfmac_f32_16x16x64_bf16 v[40:43], v[20:23], a[80:87], v7
    ds_read_b128 v[68:71], v1 offset:31744
    v_smfmac_f32_16x16x64_bf16 v[44:47], v[20:23], a[88:95], v7
    s_waitcnt lgkmcnt(9)
    v_smfmac_f32_16x16x64_bf16 v[24:27], v[12:15], a[96:103], v7
    s_waitcnt lgkmcnt(7)
    v_smfmac_f32_16x16x64_bf16 v[28:31], v[12:15], v[72:79], v7
    ds_read_b128 v[72:75], v1 offset:0
    v_smfmac_f32_16x16x64_bf16 v[32:35], v[12:15], a[104:111], v7
    ds_read_b128 v[76:79], v1 offset:1024
    s_waitcnt lgkmcnt(7)
    v_smfmac_f32_16x16x64_bf16 v[36:39], v[12:15], v[80:87], v7
    ds_read_b128 v[80:83], v1 offset:2048
    s_waitcnt vmcnt(3)
    ds_read2st64_b32 v[8:9], v4 offset0:20 offset1:24
    ds_read_b32 v10, v4 offset:7168
    s_waitcnt lgkmcnt(9)
    v_smfmac_f32_16x16x64_bf16 v[24:27], v[16:19], a[128:135], v7
    ds_read_b128 v[84:87], v1 offset:3072
    s_waitcnt lgkmcnt(8)
    v_smfmac_f32_16x16x64_bf16 v[28:31], v[16:19], v[56:63], v7
    ds_read_b128 v[56:59], v1 offset:32768
    v_smfmac_f32_16x16x64_bf16 v[32:35], v[16:19], a[136:143], v7
    ds_read_b128 v[60:63], v1 offset:33792
    s_waitcnt lgkmcnt(3)
    v_max3_u32 v8, v8, v9, v10
    v_smfmac_f32_16x16x64_bf16 v[36:39], v[16:19], v[64:71], v7
    v_cmp_eq_u32 vcc, -1, v8
    s_cbranch_vccnz L_recurt_32
L_recurb_33:
    s_barrier
    ds_read_b128 v[20:23], v2 offset:5120
    v_smfmac_f32_16x16x64_bf16 v[40:43], v[12:15], a[112:119], v7
    v_smfmac_f32_16x16x64_bf16 v[44:47], v[12:15], a[120:127], v7
    ds_read_b128 v[12:15], v2 offset:6144
    v_smfmac_f32_16x16x64_bf16 v[40:43], v[16:19], a[144:151], v7
    v_smfmac_f32_16x16x64_bf16 v[44:47], v[16:19], a[152:159], v7
    ds_read_b128 v[16:19], v2 offset:7168
    s_waitcnt lgkmcnt(2)
    v_smfmac_f32_16x16x64_bf16 v[24:27], v[20:23], a[160:167], v7
    v_smfmac_f32_16x16x64_bf16 v[28:31], v[20:23], v[72:79], v7
    v_smfmac_f32_16x16x64_bf16 v[32:35], v[20:23], a[168:175], v7
    v_smfmac_f32_16x16x64_bf16 v[36:39], v[20:23], v[80:87], v7
    ds_read_b128 v[20:23], v2 offset:8192
    s_waitcnt lgkmcnt(2)
    v_smfmac_f32_16x16x64_bf16 v[24:27], v[12:15], a[192:199], v7
    v_smfmac_f32_16x16x64_bf16 v[28:31], v[12:15], v[56:63], v7
    ds_read_b128 v[72:75], v0 offset:10240
    v_smfmac_f32_16x16x64_bf16 v[32:35], v[12:15], a[200:207], v7
    v_lshlrev_b32 v4, 3, v0
    v_smfmac_f32_16x16x64_bf16 v[36:39], v[12:15], a[208:215], v7
    buffer_load_dword v4, v4, s[4:7], s67 offen
    ds_read_b128 v[76:79], v0 offset:11264
    ds_read_b128 v[12:15], v2 offset:9216
    s_waitcnt lgkmcnt(4)
    v_smfmac_f32_16x16x64_bf16 v[24:27], v[16:19], a[232:239], v7
    v_lshrrev_b32 v71, 9, v0
    v_smfmac_f32_16x16x64_bf16 v[28:31], v[16:19], a[248:255], v7
    ds_read_b128 v[80:83], v0 offset:12288
    v_smfmac_f32_16x16x64_bf16 v[32:35], v[16:19], a[240:247], v7
    v_lshlrev_b32 v71, 3, v71
    v_smfmac_f32_16x16x64_bf16 v[36:39], v[16:19], v[88:95], v7
    ds_read_b128 v[84:87], v0 offset:13312
    s_waitcnt lgkmcnt(5)
    v_smfmac_f32_16x16x64_bf16 v[24:27], v[20:23], v[112:119], v7
    v_lshrrev_b32 v70, 1, v0
    v_smfmac_f32_16x16x64_bf16 v[28:31], v[20:23], v[128:135], v7
    v_xor_b32 v70, v71, v70
    v_smfmac_f32_16x16x64_bf16 v[32:35], v[20:23], v[120:127], v7
    v_xor_b32 v71, 16, v70
    v_smfmac_f32_16x16x64_bf16 v[36:39], v[20:23], v[136:143], v7
    s_waitcnt lgkmcnt(2)
    v_smfmac_f32_16x16x64_bf16 v[24:27], v[12:15], v[160:167], v7
    v_smfmac_f32_16x16x64_bf16 v[28:31], v[12:15], v[176:183], v7
    v_smfmac_f32_16x16x64_bf16 v[32:35], v[12:15], v[168:175], v7
    v_add_f32 v24, v24, v26
    v_smfmac_f32_16x16x64_bf16 v[36:39], v[12:15], v[184:191], v7
    v_add_f32 v25, v25, v27
    v_add_f32 v28, v28, v30
    v_cvt_pk_bf16_f32 v8, v24, v25
    v_add_f32 v29, v29, v31
    v_add_f32 v32, v32, v34
    v_cvt_pk_bf16_f32 v9, v28, v29
    v_add_f32 v33, v33, v35
    ds_write_b64 v3, v[8:9]
    v_pk_add_f32 v[36:37], v[36:37], v[38:39]
    v_cvt_pk_bf16_f32 v10, v32, v33
    v_cvt_pk_bf16_f32 v11, v36, v37
    ds_write_b64 v3, v[10:11] offset:128
    v_smfmac_f32_16x16x64_bf16 v[40:43], v[12:15], v[192:199], v7
    v_smfmac_f32_16x16x64_bf16 v[44:47], v[12:15], v[200:207], v7
    ds_read_b128 v[12:15], v2 offset:6144
    v_smfmac_f32_16x16x64_bf16 v[40:43], v[20:23], v[144:151], v7
    v_smfmac_f32_16x16x64_bf16 v[44:47], v[20:23], v[152:159], v7
    ds_read_b128 v[20:23], v2 offset:5120
    v_smfmac_f32_16x16x64_bf16 v[40:43], v[16:19], v[96:103], v7
    s_waitcnt lgkmcnt(2)
    s_barrier
    ds_read_b64_tr_b16 v[56:57], v70 offset:18432
    ds_read_b64_tr_b16 v[58:59], v71 offset:18944
    v_smfmac_f32_16x16x64_bf16 v[44:47], v[16:19], v[104:111], v7
    ds_read_b64_tr_b16 v[60:61], v70 offset:19456
    ds_read_b64_tr_b16 v[62:63], v71 offset:19968
    s_waitcnt lgkmcnt(5)
    v_smfmac_f32_16x16x64_bf16 v[40:43], v[12:15], a[216:223], v7
    ds_read_b64_tr_b16 v[64:65], v70 offset:20480
    ds_read_b64_tr_b16 v[66:67], v71 offset:20992
    v_smfmac_f32_16x16x64_bf16 v[44:47], v[12:15], a[224:231], v7
    ds_read_b64_tr_b16 v[68:69], v70 offset:21504
    ds_read_b64_tr_b16 v[70:71], v71 offset:22016
    s_waitcnt lgkmcnt(8)
    v_smfmac_f32_16x16x64_bf16 v[40:43], v[20:23], a[176:183], v7
    v_smfmac_f32_16x16x64_bf16 v[44:47], v[20:23], a[184:191], v7
    s_waitcnt lgkmcnt(6)
    v_mfma_f32_16x16x32_bf16 v[28:31], v[72:75], v[56:59], 0
    ds_read_b128 v[72:75], v0 offset:14336
    s_waitcnt lgkmcnt(5)
    v_mfma_f32_16x16x32_bf16 v[28:31], v[76:79], v[60:63], v[28:31]
    ds_read_b128 v[76:79], v0 offset:15360
    s_waitcnt lgkmcnt(4)
    v_mfma_f32_16x16x32_bf16 v[28:31], v[80:83], v[64:67], v[28:31]
    ds_read_b128 v[80:83], v0 offset:16384
    v_add_f32 v40, v40, v42
    s_waitcnt lgkmcnt(3)
    v_mfma_f32_16x16x32_bf16 v[28:31], v[84:87], v[68:71], v[28:31]
    ds_read_b128 v[84:87], v0 offset:17408
    v_add_f32 v44, v44, v46
    v_mfma_f32_16x16x32_bf16 v[24:27], v[56:59], v[56:59], 0
    v_add_f32 v41, v41, v43
    v_add_f32 v45, v45, v47
    v_mfma_f32_16x16x32_bf16 v[24:27], v[60:63], v[60:63], v[24:27]
    v_cvt_pk_bf16_f32 v46, v40, v41
    v_cvt_pk_bf16_f32 v47, v44, v45
    v_mfma_f32_16x16x32_bf16 v[24:27], v[64:67], v[64:67], v[24:27]
    s_cmp_eq_u32 s34, 63
    buffer_store_dwordx4 v[56:59], v0, s[4:7], s40 offen sc1
    s_cbranch_scc1 L_recufin_31
    v_max3_f32 v8, v28, v29, v30
    v_mfma_f32_16x16x32_bf16 v[24:27], v[68:71], v[68:71], v[24:27]
    v_mov_b64 v[12:13], s[70:71]
    v_mov_b64 v[14:15], s[70:71]
    s_waitcnt lgkmcnt(3)
    v_mfma_f32_16x16x32_bf16 v[32:35], v[72:75], v[56:59], 0
    v_add_u32 v10, s49, v0
    v_mov_b64 v[36:37], 0
    s_waitcnt lgkmcnt(2)
    v_mfma_f32_16x16x32_bf16 v[32:35], v[76:79], v[60:63], v[32:35]
    v_max3_f32 v8, v8, v31, v26
    v_mov_b64 v[38:39], 0
    s_waitcnt lgkmcnt(1)
    v_mfma_f32_16x16x32_bf16 v[32:35], v[80:83], v[64:67], v[32:35]
    v_max_f32 v8, v8, v27
    ds_read_b128 v[72:75], v1 offset:8192
    ds_read_b128 v[76:79], v1 offset:9216
    s_waitcnt lgkmcnt(2)
    v_mfma_f32_16x16x32_bf16 v[32:35], v[84:87], v[68:71], v[32:35]
    ds_read_b128 v[80:83], v1 offset:4096
    ds_read_b128 v[84:87], v1 offset:5120
    v_mov_b32 v69, 0
    v_mov_b32 v70, 0
    v_mov_b64 v[40:41], 0
    v_mov_b64 v[42:43], 0
    s_nop 1
    v_max3_f32 v8, v8, v32, v33
    v_max3_f32 v9, v8, v34, v35
    v_max3_f32 v8, v8, v34, v35
    s_nop 1
    v_permlane32_swap_b32 v9, v8
    v_max_f32 v11, v8, v9
    v_max_f32 v8, v8, v9
    s_nop 1
    v_permlane16_swap_b32 v11, v8
    v_max_f32 v8, v8, v11
    v_mul_f32 v8, 0xbe0293ee, v8
    v_pk_fma_f32 v[26:27], v[26:27], s[68:69], v[8:9] op_sel_hi:[1,1,0]
    v_pk_fma_f32 v[28:29], v[28:29], s[68:69], v[8:9] op_sel_hi:[1,1,0]
    v_exp_f32 v26, v26
    v_exp_f32 v27, v27
    v_pk_fma_f32 v[30:31], v[30:31], s[68:69], v[8:9] op_sel_hi:[1,1,0]
    v_exp_f32 v28, v28
    v_pk_fma_f32 v[32:33], v[32:33], s[68:69], v[8:9] op_sel_hi:[1,1,0]
    v_exp_f32 v29, v29
    v_cvt_pk_bf16_f32 v68, v26, v27
    v_pk_fma_f32 v[34:35], v[34:35], s[68:69], v[8:9] op_sel_hi:[1,1,0]
    v_cvt_pk_bf16_f32 v71, v26, v27
    v_exp_f32 v30, v30
    v_mfma_f32_16x16x16_bf16 v[16:19], v[12:13], v[68:69], 0
    v_exp_f32 v31, v31
    v_cvt_pk_bf16_f32 v64, v28, v29
    v_mfma_f32_16x16x16_bf16 v[56:59], v[46:47], v[68:69], 0
    v_exp_f32 v32, v32
    v_exp_f32 v33, v33
    v_mfma_f32_16x16x16_bf16 v[60:63], v[46:47], v[70:71], 0
    v_cvt_pk_bf16_f32 v65, v30, v31
    v_exp_f32 v34, v34
    v_exp_f32 v35, v35
    v_cvt_pk_bf16_f32 v66, v32, v33
    s_waitcnt vmcnt(2)
    v_cvt_pk_bf16_f32 v67, v34, v35
    v_mov_b64 v[24:25], 0
    s_nop 0
    v_mfma_f32_16x16x32_bf16 v[16:19], v[12:15], v[64:67], v[16:19]
    v_mov_b64 v[26:27], 0
    v_mov_b64 v[28:29], 0
    v_mfma_f32_16x16x32_bf16 v[56:59], v[48:51], v[64:67], v[56:59]
    v_mov_b64 v[30:31], 0
    v_mov_b64 v[32:33], 0
    v_mfma_f32_16x16x32_bf16 v[60:63], v[52:55], v[64:67], v[60:63]
    v_mov_b64 v[34:35], 0
    v_rcp_f32 v8, v16
    s_nop 1
    v_pk_mul_f32 v[56:57], v[56:57], v[8:9] op_sel_hi:[1,0]
    v_pk_mul_f32 v[58:59], v[58:59], v[8:9] op_sel_hi:[1,0]
    v_cvt_pk_bf16_f32 v20, v56, v57
    v_cvt_pk_bf16_f32 v21, v58, v59
    v_pk_mul_f32 v[60:61], v[60:61], v[8:9] op_sel_hi:[1,0]
    v_pk_mul_f32 v[62:63], v[62:63], v[8:9] op_sel_hi:[1,0]
    v_cvt_pk_bf16_f32 v22, v60, v61
    v_cvt_pk_bf16_f32 v23, v62, v63
    s_mov_b64 exec, s[64:65]
    ds_write_b128 v10, v[20:23]
    s_mov_b64 exec, -1
    ds_read_b128 v[56:59], v1 offset:6144
    ds_read_b128 v[60:63], v1 offset:7168
    ds_read_b128 v[64:67], v1 offset:10240
    ds_read_b128 v[68:71], v1 offset:11264
    s_waitcnt lgkmcnt(4)
    s_barrier
    ds_read_b128 v[12:15], v0 offset:22528
    ds_read_b128 v[16:19], v0 offset:23552
    s_mov_b32 m0, s51
    s_nop 0
    buffer_load_dwordx4 v0, s[4:7], s39 offen lds
    buffer_load_dwordx4 v0, s[4:7], s39 offen offset:1024 lds
    s_waitcnt lgkmcnt(1)
    v_smfmac_f32_16x16x64_bf16 v[40:43], v[12:15], v[72:79], v7
    s_waitcnt lgkmcnt(0)
    v_smfmac_f32_16x16x64_bf16 v[40:43], v[16:19], v[64:71], v7
    v_smfmac_f32_16x16x64_bf16 v[24:27], v[12:15], v[208:215], v7
    v_smfmac_f32_16x16x64_bf16 v[24:27], v[16:19], v[240:247], v7
    v_add_f32 v40, v40, v42
    v_smfmac_f32_16x16x64_bf16 v[28:31], v[12:15], v[216:223], v7
    v_add_f32 v41, v41, v43
    v_smfmac_f32_16x16x64_bf16 v[28:31], v[16:19], v[248:255], v7
    v_cvt_pk_bf16_f32 v20, v40, v41
    v_smfmac_f32_16x16x64_bf16 v[32:35], v[12:15], v[224:231], v7
    v_bfi_b32 v20, 1, s19, v20
    v_smfmac_f32_16x16x64_bf16 v[32:35], v[16:19], v[80:87], v7
    buffer_store_dword v20, v6, s[4:7], s35 offen
    v_add_f32 v24, v24, v26
    v_smfmac_f32_16x16x64_bf16 v[36:39], v[12:15], v[232:239], v7
    v_add_f32 v25, v25, v27
    v_smfmac_f32_16x16x64_bf16 v[36:39], v[16:19], v[56:63], v7
    v_add_f32 v28, v28, v30
    v_add_f32 v29, v29, v31
    v_cvt_pk_bf16_f32 v8, v24, v25
    v_add_f32 v32, v32, v34
    v_cvt_pk_bf16_f32 v9, v28, v29
    v_add_f32 v33, v33, v35
    v_bfi_b32 v8, 1, s19, v8
    v_cvt_pk_bf16_f32 v10, v32, v33
    v_pk_add_f32 v[36:37], v[36:37], v[38:39]
    v_cvt_pk_bf16_f32 v11, v36, v37
    buffer_store_dwordx4 v[8:11], v5, s[4:7], s35 offen
    s_add_u32 s39, s39, 262144
    s_add_u32 s47, s47, 262144
    s_xor_b32 s35, s35, 262144
    s_add_u32 s40, s40, 131072
    s_cmp_eq_u32 s42, 0
    s_cbranch_scc1 L_recunred_34
    v_bfe_u32 v8, v0, 4, 1
    v_lshlrev_b32 v21, 4, v8
    v_mov_b32 v10, 0x3f80
    v_lshlrev_b32 v10, v21, v10
    v_bfe_u32 v11, v0, 5, 3
    v_cmp_eq_u32 s[52:53], 0, v11
    v_cmp_eq_u32 s[54:55], 1, v11
    v_cmp_eq_u32 s[56:57], 2, v11
    v_cmp_eq_u32 s[58:59], 3, v11
    v_cndmask_b32 v12, 0, v10, s[52:53]
    v_cndmask_b32 v13, 0, v10, s[54:55]
    v_cndmask_b32 v14, 0, v10, s[56:57]
    v_cndmask_b32 v15, 0, v10, s[58:59]
    v_and_b32 v11, 3, v11
    v_lshl_add_u32 v21, v11, 2, v21
    v_bfe_u32 v11, v0, 8, 1
    v_lshl_add_u32 v21, v11, 6, v21
    v_lshrrev_b32 v11, 9, v0
    v_lshl_add_u32 v21, v11, 5, v21
    v_mov_b64 v[24:25], 0
    v_mov_b64 v[26:27], 0
    v_mov_b64 v[28:29], 0
    v_mov_b64 v[30:31], 0
    v_mov_b64 v[32:33], 0
    v_mov_b64 v[34:35], 0
    v_mov_b64 v[36:37], 0
    v_mov_b64 v[38:39], 0
    v_mov_b64 v[40:41], 0
    v_mov_b64 v[42:43], 0
    v_mov_b64 v[44:45], 0
    v_mov_b64 v[46:47], 0
    s_mov_b32 s50, 3200000
    s_nop 15
    s_nop 15
    s_nop 11
    buffer_load_dwordx4 v[56:59], v0, s[4:7], s36 offen offset:0 sc1
    buffer_load_dwordx4 v[60:63], v0, s[4:7], s36 offen offset:1024 sc1
    buffer_load_dwordx4 v[64:67], v0, s[4:7], s36 offen offset:2048 sc1
    buffer_load_dwordx4 v[68:71], v0, s[4:7], s36 offen offset:3072 sc1
    s_nop 15
    s_nop 3
    buffer_load_dwordx4 v[56:59], v0, s[4:7], s36 offen offset:0 sc1
    buffer_load_dwordx4 v[60:63], v0, s[4:7], s36 offen offset:1024 sc1
    buffer_load_dwordx4 v[64:67], v0, s[4:7], s36 offen offset:2048 sc1
    buffer_load_dwordx4 v[68:71], v0, s[4:7], s36 offen offset:3072 sc1
L_recursl_37:
    s_waitcnt vmcnt(7)
    v_xor_b32 v8, s19, v56
    v_mfma_f32_16x16x32_bf16 v[16:19], v[56:59], v[12:15], 0
    buffer_load_dwordx4 v[56:59], v0, s[4:7], s36 offen offset:0 sc1
    s_waitcnt vmcnt(7)
    v_bitop3_b32 v8, v8, v60, s19 bitop3:0xf6
    v_mfma_f32_16x16x32_bf16 v[16:19], v[60:63], v[12:15], v[16:19]
    buffer_load_dwordx4 v[60:63], v0, s[4:7], s36 offen offset:1024 sc1
    s_waitcnt vmcnt(7)
    v_bitop3_b32 v8, v8, v64, s19 bitop3:0xf6
    v_mfma_f32_16x16x32_bf16 v[16:19], v[64:67], v[12:15], v[16:19]
    buffer_load_dwordx4 v[64:67], v0, s[4:7], s36 offen offset:2048 sc1
    s_waitcnt vmcnt(7)
    v_bitop3_b32 v8, v8, v68, s19 bitop3:0xf6
    v_mfma_f32_16x16x32_bf16 v[16:19], v[68:71], v[12:15], v[16:19]
    buffer_load_dwordx4 v[68:71], v0, s[4:7], s36 offen offset:3072 sc1
    v_and_b32 v8, 1, v8
    v_cmp_ne_u32 vcc, 0, v8
    s_cbranch_vccz L_recursok_36
    s_waitcnt vmcnt(7)
    v_xor_b32 v8, s19, v56
    v_mfma_f32_16x16x32_bf16 v[16:19], v[56:59], v[12:15], 0
    buffer_load_dwordx4 v[56:59], v0, s[4:7], s36 offen offset:0 sc1
    s_waitcnt vmcnt(7)
    v_bitop3_b32 v8, v8, v60, s19 bitop3:0xf6
    v_mfma_f32_16x16x32_bf16 v[16:19], v[60:63], v[12:15], v[16:19]
    buffer_load_dwordx4 v[60:63], v0, s[4:7], s36 offen offset:1024 sc1
    s_waitcnt vmcnt(7)
    v_bitop3_b32 v8, v8, v64, s19 bitop3:0xf6
    v_mfma_f32_16x16x32_bf16 v[16:19], v[64:67], v[12:15], v[16:19]
    buffer_load_dwordx4 v[64:67], v0, s[4:7], s36 offen offset:2048 sc1
    s_waitcnt vmcnt(7)
    v_bitop3_b32 v8, v8, v68, s19 bitop3:0xf6
    v_mfma_f32_16x16x32_bf16 v[16:19], v[68:71], v[12:15], v[16:19]
    buffer_load_dwordx4 v[68:71], v0, s[4:7], s36 offen offset:3072 sc1
    v_and_b32 v8, 1, v8
    v_cmp_ne_u32 vcc, 0, v8
    s_cbranch_vccz L_recursok_36
    s_sub_u32 s50, s50, 1
    s_cbranch_scc0 L_recursl_37
    s_branch L_exit_recurrent_scan__memory_aug_recurrent_mem_tr__moe_arch_mod__prompt_kernel
L_recursok_36:
    s_nop 1
    v_permlane32_swap_b32 v16, v18
    v_permlane32_swap_b32 v17, v19
    v_pk_add_f32 v[16:17], v[16:17], v[18:19]
    v_cvt_pk_bf16_f32 v16, v16, v17
    s_mov_b64 exec, s[74:75]
    buffer_store_dword v16, v21, s[4:7], s48 offen sc1
    buffer_store_dword v16, v21, s[4:7], s37 offen
    s_mov_b64 exec, -1
    s_barrier
    v_mov_b64 v[8:9], -1
    v_mov_b64 v[10:11], -1
    s_mov_b64 exec, 0xff
    buffer_store_dwordx4 v[8:11], v0, s[4:7], s45 offen
    s_mov_b64 exec, -1
    s_xor_b32 s36, s36, 262144
    s_mov_b32 s45, s37
    s_add_u32 s37, s37, 8192
    s_andn2_b32 s37, s37, 0x8000
    s_add_u32 s48, s48, 10240
    s_waitcnt vmcnt(3)
    s_branch L_recun2_35
L_recunred_34:
    v_mov_b64 v[24:25], 0
    v_mov_b64 v[26:27], 0
    v_mov_b64 v[28:29], 0
    v_mov_b64 v[30:31], 0
    v_mov_b64 v[32:33], 0
    v_mov_b64 v[34:35], 0
    v_mov_b64 v[36:37], 0
    v_mov_b64 v[38:39], 0
    v_mov_b64 v[40:41], 0
    v_mov_b64 v[42:43], 0
    v_mov_b64 v[44:45], 0
    v_mov_b64 v[46:47], 0
    s_barrier
    s_waitcnt vmcnt(0)
L_recun2_35:
    v_bfe_u32 v4, v0, 7, 2
    v_lshl_add_u32 v4, v4, 2, v0
    s_add_u32 s34, s34, 1
    ds_read_b128 v[56:59], v1 offset:12288
    ds_read_b128 v[60:63], v1 offset:13312
    ds_read_b128 v[64:67], v1 offset:14336
    ds_read_b128 v[68:71], v1 offset:15360
    ds_read_b128 v[72:75], v1 offset:16384
    ds_read_b128 v[76:79], v1 offset:17408
    ds_read_b128 v[80:83], v1 offset:18432
    ds_read_b128 v[84:87], v1 offset:19456
    s_add_u32 s26, s34, 1
    s_min_u32 s26, s26, 63
    s_cmp_gt_u32 s44, s26
    s_cbranch_scc1 L_recuf_38
    v_bfe_u32 v8, v0, 6, 1
    v_lshlrev_b32 v8, 13, v8
    v_bfe_u32 v9, v0, 4, 2
    v_lshl_add_u32 v8, v9, 2, v8
    v_bfe_u32 v10, v0, 7, 1
    v_lshl_add_u32 v8, v10, 7, v8
    s_mov_b32 s50, 0
L_recufs_39:
    buffer_load_dword v9, v8, s[4:7], s46 offen sc1
    s_waitcnt vmcnt(0)
    v_lshl_add_u32 v9, v9, 1, v10
    v_cmp_ge_u32 vcc, s26, v9
    s_cbranch_vccz L_recufsok_40
    s_add_u32 s50, s50, 1
    s_cmp_lt_u32 s50, 400000
    s_cbranch_scc0 L_exit_recurrent_scan__memory_aug_recurrent_mem_tr__moe_arch_mod__prompt_kernel
    s_sleep 2
    s_branch L_recufs_39
L_recufsok_40:
    v_min_u32_dpp v9, v9, v9 quad_perm:[1,0,3,2] row_mask:0xf bank_mask:0xf
    s_nop 1
    v_min_u32_dpp v9, v9, v9 quad_perm:[2,3,0,1] row_mask:0xf bank_mask:0xf
    s_nop 1
    v_min_u32_dpp v9, v9, v9 row_half_mirror row_mask:0xf bank_mask:0xf
    s_nop 1
    v_min_u32_dpp v9, v9, v9 row_mirror row_mask:0xf bank_mask:0xf
    s_nop 0
    v_readfirstlane_b32 s44, v9
L_recuf_38:
    s_mov_b32 m0, s66
    s_mov_b32 s30, s38
    s_mov_b64 s[8:9], -1
    s_add_u32 s67, s67, 262144
    s_add_u32 s38, s38, 10240
    s_waitcnt lgkmcnt(0)
    s_bfe_u32 s19, s34, 0x10001
    s_branch L_recucl_30
L_recurt_32:
    s_cmp_eq_u32 s34, 0
    s_cbranch_scc1 L_recurb_33
    s_mov_b32 s50, 0
    s_mov_b32 m0, s66
    ds_read2st64_b32 v[8:9], v4 offset0:20 offset1:24
    ds_read_b32 v10, v4 offset:7168
    s_waitcnt lgkmcnt(0)
    v_cmp_eq_u32 s[52:53], -1, v8
    v_cmp_eq_u32 s[54:55], -1, v9
    v_cmp_eq_u32 s[56:57], -1, v10
    s_or_b64 s[58:59], s[52:53], s[54:55]
    s_or_b64 s[58:59], s[58:59], s[56:57]
    s_cbranch_scc0 L_recurb_33
    s_mov_b64 exec, s[52:53]
    buffer_load_dwordx4 v0, s[4:7], s30 offen offset:0 sc1 lds
    s_mov_b64 exec, s[54:55]
    buffer_load_dwordx4 v0, s[4:7], s30 offen offset:1024 sc1 lds
    s_mov_b64 exec, s[56:57]
    buffer_load_dwordx4 v0, s[4:7], s30 offen offset:2048 sc1 lds
    s_mov_b64 exec, -1
    s_nop 15
    s_nop 15
L_recur2_42:
    s_mov_b64 exec, s[52:53]
    buffer_load_dwordx4 v0, s[4:7], s30 offen offset:0 sc1 lds
    s_mov_b64 exec, s[54:55]
    buffer_load_dwordx4 v0, s[4:7], s30 offen offset:1024 sc1 lds
    s_mov_b64 exec, s[56:57]
    buffer_load_dwordx4 v0, s[4:7], s30 offen offset:2048 sc1 lds
    s_mov_b64 exec, -1
    s_waitcnt vmcnt(3)
    ds_read2st64_b32 v[8:9], v4 offset0:20 offset1:24
    ds_read_b32 v10, v4 offset:7168
    s_waitcnt lgkmcnt(0)
    v_cmp_eq_u32 s[52:53], -1, v8
    v_cmp_eq_u32 s[54:55], -1, v9
    v_cmp_eq_u32 s[56:57], -1, v10
    s_or_b64 s[58:59], s[52:53], s[54:55]
    s_or_b64 s[58:59], s[58:59], s[56:57]
    s_cbranch_scc0 L_recurb_33
    s_add_u32 s50, s50, 1
    s_cmp_lt_u32 s50, 3200000
    s_cbranch_scc0 L_exit_recurrent_scan__memory_aug_recurrent_mem_tr__moe_arch_mod__prompt_kernel
    s_branch L_recur2_42
L_recufin_31:
    s_waitcnt lgkmcnt(0)
    s_nop 7
    s_waitcnt vmcnt(0)
    v_mov_b32 v9, 64
    buffer_store_dword v9, off, s[4:7], s41 sc1
    s_waitcnt vmcnt(0)
    s_branch L_exit_recurrent_scan__memory_aug_recurrent_mem_tr__moe_arch_mod__prompt_kernel
L_recub_23:
L_recucl_43:
    s_barrier
    ds_read_b128 v[12:15], v2 offset:0
    ds_read_b128 v[16:19], v2 offset:1024
    ds_read_b128 v[20:23], v2 offset:2048
    s_mov_b64 exec, s[8:9]
    buffer_load_dwordx4 v0, s[4:7], s30 offen offset:0 sc1 lds
    buffer_load_dwordx4 v0, s[4:7], s30 offen offset:1024 sc1 lds
    s_mov_b64 exec, -1
    s_waitcnt lgkmcnt(2)
    v_smfmac_f32_16x16x64_bf16 v[24:27], v[12:15], a[0:7], v7
    v_mov_b32 v8, s34
    v_smfmac_f32_16x16x64_bf16 v[28:31], v[12:15], v[56:63], v7
    ds_read_b128 v[56:59], v1 offset:20480
    v_smfmac_f32_16x16x64_bf16 v[32:35], v[12:15], a[8:15], v7
    ds_read_b128 v[60:63], v1 offset:21504
    v_smfmac_f32_16x16x64_bf16 v[36:39], v[12:15], v[64:71], v7
    ds_read_b128 v[64:67], v1 offset:22528
    v_smfmac_f32_16x16x64_bf16 v[40:43], v[12:15], a[16:23], v7
    ds_read_b128 v[68:71], v1 offset:23552
    v_smfmac_f32_16x16x64_bf16 v[44:47], v[12:15], a[24:31], v7
    buffer_load_dwordx4 v[48:51], v0, s[4:7], s47 offen offset:0
    ds_read_b128 v[12:15], v2 offset:3072
    s_waitcnt lgkmcnt(6)
    v_smfmac_f32_16x16x64_bf16 v[24:27], v[16:19], a[32:39], v7
    buffer_load_dwordx4 v[52:55], v0, s[4:7], s47 offen offset:1024
    v_smfmac_f32_16x16x64_bf16 v[28:31], v[16:19], v[72:79], v7
    ds_read_b128 v[72:75], v1 offset:24576
    v_smfmac_f32_16x16x64_bf16 v[32:35], v[16:19], a[40:47], v7
    ds_read_b128 v[76:79], v1 offset:25600
    buffer_store_dword v8, off, s[4:7], s41 sc1
    v_smfmac_f32_16x16x64_bf16 v[36:39], v[16:19], v[80:87], v7
    ds_read_b128 v[80:83], v1 offset:26624
    v_smfmac_f32_16x16x64_bf16 v[40:43], v[16:19], a[48:55], v7
    ds_read_b128 v[84:87], v1 offset:27648
    v_smfmac_f32_16x16x64_bf16 v[44:47], v[16:19], a[56:63], v7
    ds_read_b128 v[16:19], v2 offset:4096
    s_waitcnt lgkmcnt(10)
    v_smfmac_f32_16x16x64_bf16 v[24:27], v[20:23], a[64:71], v7
    s_waitcnt lgkmcnt(8)
    v_smfmac_f32_16x16x64_bf16 v[28:31], v[20:23], v[56:63], v7
    ds_read_b128 v[56:59], v1 offset:28672
    v_smfmac_f32_16x16x64_bf16 v[32:35], v[20:23], a[72:79], v7
    ds_read_b128 v[60:63], v1 offset:29696
    s_waitcnt lgkmcnt(8)
    v_smfmac_f32_16x16x64_bf16 v[36:39], v[20:23], v[64:71], v7
    ds_read_b128 v[64:67], v1 offset:30720
    v_smfmac_f32_16x16x64_bf16 v[40:43], v[20:23], a[80:87], v7
    ds_read_b128 v[68:71], v1 offset:31744
    v_smfmac_f32_16x16x64_bf16 v[44:47], v[20:23], a[88:95], v7
    s_waitcnt lgkmcnt(9)
    v_smfmac_f32_16x16x64_bf16 v[24:27], v[12:15], a[96:103], v7
    s_waitcnt lgkmcnt(7)
    v_smfmac_f32_16x16x64_bf16 v[28:31], v[12:15], v[72:79], v7
    ds_read_b128 v[72:75], v1 offset:0
    v_smfmac_f32_16x16x64_bf16 v[32:35], v[12:15], a[104:111], v7
    ds_read_b128 v[76:79], v1 offset:1024
    s_waitcnt lgkmcnt(7)
    v_smfmac_f32_16x16x64_bf16 v[36:39], v[12:15], v[80:87], v7
    ds_read_b128 v[80:83], v1 offset:2048
    s_waitcnt vmcnt(3)
    ds_read2st64_b32 v[8:9], v4 offset0:32 offset1:36
    s_waitcnt lgkmcnt(8)
    v_smfmac_f32_16x16x64_bf16 v[24:27], v[16:19], a[128:135], v7
    ds_read_b128 v[84:87], v1 offset:3072
    s_waitcnt lgkmcnt(7)
    v_smfmac_f32_16x16x64_bf16 v[28:31], v[16:19], v[56:63], v7
    ds_read_b128 v[56:59], v1 offset:32768
    v_smfmac_f32_16x16x64_bf16 v[32:35], v[16:19], a[136:143], v7
    ds_read_b128 v[60:63], v1 offset:33792
    s_waitcnt lgkmcnt(3)
    v_max_u32 v8, v8, v9
    v_smfmac_f32_16x16x64_bf16 v[36:39], v[16:19], v[64:71], v7
    v_cmp_eq_u32 vcc, -1, v8
    s_cbranch_vccnz L_recurt_45
L_recurb_46:
    s_barrier
    ds_read_b128 v[20:23], v2 offset:5120
    v_smfmac_f32_16x16x64_bf16 v[40:43], v[12:15], a[112:119], v7
    v_smfmac_f32_16x16x64_bf16 v[44:47], v[12:15], a[120:127], v7
    ds_read_b128 v[12:15], v2 offset:6144
    v_smfmac_f32_16x16x64_bf16 v[40:43], v[16:19], a[144:151], v7
    v_smfmac_f32_16x16x64_bf16 v[44:47], v[16:19], a[152:159], v7
    ds_read_b128 v[16:19], v2 offset:7168
    s_waitcnt lgkmcnt(2)
    v_smfmac_f32_16x16x64_bf16 v[24:27], v[20:23], a[160:167], v7
    v_smfmac_f32_16x16x64_bf16 v[28:31], v[20:23], v[72:79], v7
    v_smfmac_f32_16x16x64_bf16 v[32:35], v[20:23], a[168:175], v7
    v_smfmac_f32_16x16x64_bf16 v[36:39], v[20:23], v[80:87], v7
    ds_read_b128 v[20:23], v2 offset:8192
    s_waitcnt lgkmcnt(2)
    v_smfmac_f32_16x16x64_bf16 v[24:27], v[12:15], a[192:199], v7
    v_smfmac_f32_16x16x64_bf16 v[28:31], v[12:15], v[56:63], v7
    ds_read_b128 v[72:75], v0 offset:10240
    v_smfmac_f32_16x16x64_bf16 v[32:35], v[12:15], a[200:207], v7
    v_lshlrev_b32 v4, 3, v0
    v_smfmac_f32_16x16x64_bf16 v[36:39], v[12:15], a[208:215], v7
    buffer_load_dword v4, v4, s[4:7], s67 offen
    ds_read_b128 v[76:79], v0 offset:11264
    ds_read_b128 v[12:15], v2 offset:9216
    s_waitcnt lgkmcnt(4)
    v_smfmac_f32_16x16x64_bf16 v[24:27], v[16:19], a[232:239], v7
    v_lshrrev_b32 v71, 9, v0
    v_smfmac_f32_16x16x64_bf16 v[28:31], v[16:19], a[248:255], v7
    ds_read_b128 v[80:83], v0 offset:12288
    v_smfmac_f32_16x16x64_bf16 v[32:35], v[16:19], a[240:247], v7
    v_lshlrev_b32 v71, 3, v71
    v_smfmac_f32_16x16x64_bf16 v[36:39], v[16:19], v[88:95], v7
    ds_read_b128 v[84:87], v0 offset:13312
    s_waitcnt lgkmcnt(5)
    v_smfmac_f32_16x16x64_bf16 v[24:27], v[20:23], v[112:119], v7
    v_lshrrev_b32 v70, 1, v0
    v_smfmac_f32_16x16x64_bf16 v[28:31], v[20:23], v[128:135], v7
    v_xor_b32 v70, v71, v70
    v_smfmac_f32_16x16x64_bf16 v[32:35], v[20:23], v[120:127], v7
    v_xor_b32 v71, 16, v70
    v_smfmac_f32_16x16x64_bf16 v[36:39], v[20:23], v[136:143], v7
    s_waitcnt lgkmcnt(2)
    v_smfmac_f32_16x16x64_bf16 v[24:27], v[12:15], v[160:167], v7
    v_smfmac_f32_16x16x64_bf16 v[28:31], v[12:15], v[176:183], v7
    v_smfmac_f32_16x16x64_bf16 v[32:35], v[12:15], v[168:175], v7
    v_add_f32 v24, v24, v26
    v_smfmac_f32_16x16x64_bf16 v[36:39], v[12:15], v[184:191], v7
    v_add_f32 v25, v25, v27
    v_add_f32 v28, v28, v30
    v_cvt_pk_bf16_f32 v8, v24, v25
    v_add_f32 v29, v29, v31
    v_add_f32 v32, v32, v34
    v_cvt_pk_bf16_f32 v9, v28, v29
    v_add_f32 v33, v33, v35
    ds_write_b64 v3, v[8:9]
    v_pk_add_f32 v[36:37], v[36:37], v[38:39]
    v_cvt_pk_bf16_f32 v10, v32, v33
    v_cvt_pk_bf16_f32 v11, v36, v37
    ds_write_b64 v3, v[10:11] offset:128
    v_smfmac_f32_16x16x64_bf16 v[40:43], v[12:15], v[192:199], v7
    v_smfmac_f32_16x16x64_bf16 v[44:47], v[12:15], v[200:207], v7
    ds_read_b128 v[12:15], v2 offset:6144
    v_smfmac_f32_16x16x64_bf16 v[40:43], v[20:23], v[144:151], v7
    v_smfmac_f32_16x16x64_bf16 v[44:47], v[20:23], v[152:159], v7
    ds_read_b128 v[20:23], v2 offset:5120
    v_smfmac_f32_16x16x64_bf16 v[40:43], v[16:19], v[96:103], v7
    s_waitcnt lgkmcnt(2)
    s_barrier
    ds_read_b64_tr_b16 v[56:57], v70 offset:18432
    ds_read_b64_tr_b16 v[58:59], v71 offset:18944
    v_smfmac_f32_16x16x64_bf16 v[44:47], v[16:19], v[104:111], v7
    ds_read_b64_tr_b16 v[60:61], v70 offset:19456
    ds_read_b64_tr_b16 v[62:63], v71 offset:19968
    s_waitcnt lgkmcnt(5)
    v_smfmac_f32_16x16x64_bf16 v[40:43], v[12:15], a[216:223], v7
    ds_read_b64_tr_b16 v[64:65], v70 offset:20480
    ds_read_b64_tr_b16 v[66:67], v71 offset:20992
    v_smfmac_f32_16x16x64_bf16 v[44:47], v[12:15], a[224:231], v7
    ds_read_b64_tr_b16 v[68:69], v70 offset:21504
    ds_read_b64_tr_b16 v[70:71], v71 offset:22016
    s_waitcnt lgkmcnt(8)
    v_smfmac_f32_16x16x64_bf16 v[40:43], v[20:23], a[176:183], v7
    v_smfmac_f32_16x16x64_bf16 v[44:47], v[20:23], a[184:191], v7
    s_waitcnt lgkmcnt(6)
    v_mfma_f32_16x16x32_bf16 v[28:31], v[72:75], v[56:59], 0
    ds_read_b128 v[72:75], v0 offset:14336
    s_waitcnt lgkmcnt(5)
    v_mfma_f32_16x16x32_bf16 v[28:31], v[76:79], v[60:63], v[28:31]
    ds_read_b128 v[76:79], v0 offset:15360
    s_waitcnt lgkmcnt(4)
    v_mfma_f32_16x16x32_bf16 v[28:31], v[80:83], v[64:67], v[28:31]
    ds_read_b128 v[80:83], v0 offset:16384
    v_add_f32 v40, v40, v42
    s_waitcnt lgkmcnt(3)
    v_mfma_f32_16x16x32_bf16 v[28:31], v[84:87], v[68:71], v[28:31]
    ds_read_b128 v[84:87], v0 offset:17408
    v_add_f32 v44, v44, v46
    v_mfma_f32_16x16x32_bf16 v[24:27], v[56:59], v[56:59], 0
    v_add_f32 v41, v41, v43
    v_add_f32 v45, v45, v47
    v_mfma_f32_16x16x32_bf16 v[24:27], v[60:63], v[60:63], v[24:27]
    v_cvt_pk_bf16_f32 v46, v40, v41
    v_cvt_pk_bf16_f32 v47, v44, v45
    v_mfma_f32_16x16x32_bf16 v[24:27], v[64:67], v[64:67], v[24:27]
    s_cmp_eq_u32 s34, 63
    buffer_store_dwordx4 v[60:63], v0, s[4:7], s40 offen sc1
    s_cbranch_scc1 L_recufin_44
    v_max3_f32 v8, v28, v29, v30
    v_mfma_f32_16x16x32_bf16 v[24:27], v[68:71], v[68:71], v[24:27]
    v_mov_b64 v[12:13], s[70:71]
    v_mov_b64 v[14:15], s[70:71]
    s_waitcnt lgkmcnt(3)
    v_mfma_f32_16x16x32_bf16 v[32:35], v[72:75], v[56:59], 0
    v_add_u32 v10, s49, v0
    v_mov_b64 v[36:37], 0
    s_waitcnt lgkmcnt(2)
    v_mfma_f32_16x16x32_bf16 v[32:35], v[76:79], v[60:63], v[32:35]
    v_max3_f32 v8, v8, v31, v26
    v_mov_b64 v[38:39], 0
    s_waitcnt lgkmcnt(1)
    v_mfma_f32_16x16x32_bf16 v[32:35], v[80:83], v[64:67], v[32:35]
    v_max_f32 v8, v8, v27
    ds_read_b128 v[72:75], v1 offset:8192
    ds_read_b128 v[76:79], v1 offset:9216
    s_waitcnt lgkmcnt(2)
    v_mfma_f32_16x16x32_bf16 v[32:35], v[84:87], v[68:71], v[32:35]
    ds_read_b128 v[80:83], v1 offset:4096
    ds_read_b128 v[84:87], v1 offset:5120
    v_mov_b32 v69, 0
    v_mov_b32 v70, 0
    v_mov_b64 v[40:41], 0
    v_mov_b64 v[42:43], 0
    s_nop 1
    v_max3_f32 v8, v8, v32, v33
    v_max3_f32 v9, v8, v34, v35
    v_max3_f32 v8, v8, v34, v35
    s_nop 1
    v_permlane32_swap_b32 v9, v8
    v_max_f32 v11, v8, v9
    v_max_f32 v8, v8, v9
    s_nop 1
    v_permlane16_swap_b32 v11, v8
    v_max_f32 v8, v8, v11
    v_mul_f32 v8, 0xbe0293ee, v8
    v_pk_fma_f32 v[26:27], v[26:27], s[68:69], v[8:9] op_sel_hi:[1,1,0]
    v_pk_fma_f32 v[28:29], v[28:29], s[68:69], v[8:9] op_sel_hi:[1,1,0]
    v_exp_f32 v26, v26
    v_exp_f32 v27, v27
    v_pk_fma_f32 v[30:31], v[30:31], s[68:69], v[8:9] op_sel_hi:[1,1,0]
    v_exp_f32 v28, v28
    v_pk_fma_f32 v[32:33], v[32:33], s[68:69], v[8:9] op_sel_hi:[1,1,0]
    v_exp_f32 v29, v29
    v_cvt_pk_bf16_f32 v68, v26, v27
    v_pk_fma_f32 v[34:35], v[34:35], s[68:69], v[8:9] op_sel_hi:[1,1,0]
    v_cvt_pk_bf16_f32 v71, v26, v27
    v_exp_f32 v30, v30
    v_mfma_f32_16x16x16_bf16 v[16:19], v[12:13], v[68:69], 0
    v_exp_f32 v31, v31
    v_cvt_pk_bf16_f32 v64, v28, v29
    v_mfma_f32_16x16x16_bf16 v[56:59], v[46:47], v[68:69], 0
    v_exp_f32 v32, v32
    v_exp_f32 v33, v33
    v_mfma_f32_16x16x16_bf16 v[60:63], v[46:47], v[70:71], 0
    v_cvt_pk_bf16_f32 v65, v30, v31
    v_exp_f32 v34, v34
    v_exp_f32 v35, v35
    v_cvt_pk_bf16_f32 v66, v32, v33
    s_waitcnt vmcnt(2)
    v_cvt_pk_bf16_f32 v67, v34, v35
    v_mov_b64 v[24:25], 0
    s_nop 0
    v_mfma_f32_16x16x32_bf16 v[16:19], v[12:15], v[64:67], v[16:19]
    v_mov_b64 v[26:27], 0
    v_mov_b64 v[28:29], 0
    v_mfma_f32_16x16x32_bf16 v[56:59], v[48:51], v[64:67], v[56:59]
    v_mov_b64 v[30:31], 0
    v_mov_b64 v[32:33], 0
    v_mfma_f32_16x16x32_bf16 v[60:63], v[52:55], v[64:67], v[60:63]
    v_mov_b64 v[34:35], 0
    v_rcp_f32 v8, v16
    s_nop 1
    v_pk_mul_f32 v[56:57], v[56:57], v[8:9] op_sel_hi:[1,0]
    v_pk_mul_f32 v[58:59], v[58:59], v[8:9] op_sel_hi:[1,0]
    v_cvt_pk_bf16_f32 v20, v56, v57
    v_cvt_pk_bf16_f32 v21, v58, v59
    v_pk_mul_f32 v[60:61], v[60:61], v[8:9] op_sel_hi:[1,0]
    v_pk_mul_f32 v[62:63], v[62:63], v[8:9] op_sel_hi:[1,0]
    v_cvt_pk_bf16_f32 v22, v60, v61
    v_cvt_pk_bf16_f32 v23, v62, v63
    s_mov_b64 exec, s[64:65]
    ds_write_b128 v10, v[20:23]
    s_mov_b64 exec, -1
    ds_read_b128 v[56:59], v1 offset:6144
    ds_read_b128 v[60:63], v1 offset:7168
    ds_read_b128 v[64:67], v1 offset:10240
    ds_read_b128 v[68:71], v1 offset:11264
    s_waitcnt lgkmcnt(4)
    s_barrier
    ds_read_b128 v[12:15], v0 offset:22528
    ds_read_b128 v[16:19], v0 offset:23552
    s_mov_b32 m0, s51
    s_nop 0
    buffer_load_dwordx4 v0, s[4:7], s39 offen lds
    buffer_load_dwordx4 v0, s[4:7], s39 offen offset:1024 lds
    s_waitcnt lgkmcnt(1)
    v_smfmac_f32_16x16x64_bf16 v[40:43], v[12:15], v[72:79], v7
    s_waitcnt lgkmcnt(0)
    v_smfmac_f32_16x16x64_bf16 v[40:43], v[16:19], v[64:71], v7
    v_smfmac_f32_16x16x64_bf16 v[24:27], v[12:15], v[208:215], v7
    v_smfmac_f32_16x16x64_bf16 v[24:27], v[16:19], v[240:247], v7
    v_add_f32 v40, v40, v42
    v_smfmac_f32_16x16x64_bf16 v[28:31], v[12:15], v[216:223], v7
    v_add_f32 v41, v41, v43
    v_smfmac_f32_16x16x64_bf16 v[28:31], v[16:19], v[248:255], v7
    v_cvt_pk_bf16_f32 v20, v40, v41
    v_smfmac_f32_16x16x64_bf16 v[32:35], v[12:15], v[224:231], v7
    v_bfi_b32 v20, 1, s19, v20
    v_smfmac_f32_16x16x64_bf16 v[32:35], v[16:19], v[80:87], v7
    buffer_store_dword v20, v6, s[4:7], s35 offen
    v_add_f32 v24, v24, v26
    v_smfmac_f32_16x16x64_bf16 v[36:39], v[12:15], v[232:239], v7
    v_add_f32 v25, v25, v27
    v_smfmac_f32_16x16x64_bf16 v[36:39], v[16:19], v[56:63], v7
    v_add_f32 v28, v28, v30
    v_add_f32 v29, v29, v31
    v_cvt_pk_bf16_f32 v8, v24, v25
    v_add_f32 v32, v32, v34
    v_cvt_pk_bf16_f32 v9, v28, v29
    v_add_f32 v33, v33, v35
    v_bfi_b32 v8, 1, s19, v8
    v_cvt_pk_bf16_f32 v10, v32, v33
    v_pk_add_f32 v[36:37], v[36:37], v[38:39]
    v_cvt_pk_bf16_f32 v11, v36, v37
    buffer_store_dwordx4 v[8:11], v5, s[4:7], s35 offen
    s_add_u32 s39, s39, 262144
    s_add_u32 s47, s47, 262144
    s_xor_b32 s35, s35, 262144
    s_add_u32 s40, s40, 131072
    s_cmp_eq_u32 s42, 0
    s_cbranch_scc1 L_recunred_47
    v_bfe_u32 v8, v0, 4, 1
    v_lshlrev_b32 v21, 4, v8
    v_mov_b32 v10, 0x3f80
    v_lshlrev_b32 v10, v21, v10
    v_bfe_u32 v11, v0, 5, 3
    v_cmp_eq_u32 s[52:53], 0, v11
    v_cmp_eq_u32 s[54:55], 1, v11
    v_cmp_eq_u32 s[56:57], 2, v11
    v_cmp_eq_u32 s[58:59], 3, v11
    v_cndmask_b32 v12, 0, v10, s[52:53]
    v_cndmask_b32 v13, 0, v10, s[54:55]
    v_cndmask_b32 v14, 0, v10, s[56:57]
    v_cndmask_b32 v15, 0, v10, s[58:59]
    v_and_b32 v11, 3, v11
    v_lshl_add_u32 v21, v11, 2, v21
    v_bfe_u32 v11, v0, 8, 1
    v_lshl_add_u32 v21, v11, 6, v21
    v_lshrrev_b32 v11, 9, v0
    v_lshl_add_u32 v21, v11, 5, v21
    v_mov_b64 v[24:25], 0
    v_mov_b64 v[26:27], 0
    v_mov_b64 v[28:29], 0
    v_mov_b64 v[30:31], 0
    v_mov_b64 v[32:33], 0
    v_mov_b64 v[34:35], 0
    v_mov_b64 v[36:37], 0
    v_mov_b64 v[38:39], 0
    v_mov_b64 v[40:41], 0
    v_mov_b64 v[42:43], 0
    v_mov_b64 v[44:45], 0
    v_mov_b64 v[46:47], 0
    s_mov_b32 s50, 3200000
    s_nop 15
    s_nop 15
    s_nop 11
    buffer_load_dwordx4 v[56:59], v0, s[4:7], s36 offen offset:0 sc1
    buffer_load_dwordx4 v[60:63], v0, s[4:7], s36 offen offset:1024 sc1
    buffer_load_dwordx4 v[64:67], v0, s[4:7], s36 offen offset:2048 sc1
    buffer_load_dwordx4 v[68:71], v0, s[4:7], s36 offen offset:3072 sc1
    s_nop 15
    s_nop 3
    buffer_load_dwordx4 v[56:59], v0, s[4:7], s36 offen offset:0 sc1
    buffer_load_dwordx4 v[60:63], v0, s[4:7], s36 offen offset:1024 sc1
    buffer_load_dwordx4 v[64:67], v0, s[4:7], s36 offen offset:2048 sc1
    buffer_load_dwordx4 v[68:71], v0, s[4:7], s36 offen offset:3072 sc1
L_recursl_50:
    s_waitcnt vmcnt(7)
    v_xor_b32 v8, s19, v56
    v_mfma_f32_16x16x32_bf16 v[16:19], v[56:59], v[12:15], 0
    buffer_load_dwordx4 v[56:59], v0, s[4:7], s36 offen offset:0 sc1
    s_waitcnt vmcnt(7)
    v_bitop3_b32 v8, v8, v60, s19 bitop3:0xf6
    v_mfma_f32_16x16x32_bf16 v[16:19], v[60:63], v[12:15], v[16:19]
    buffer_load_dwordx4 v[60:63], v0, s[4:7], s36 offen offset:1024 sc1
    s_waitcnt vmcnt(7)
    v_bitop3_b32 v8, v8, v64, s19 bitop3:0xf6
    v_mfma_f32_16x16x32_bf16 v[16:19], v[64:67], v[12:15], v[16:19]
    buffer_load_dwordx4 v[64:67], v0, s[4:7], s36 offen offset:2048 sc1
    s_waitcnt vmcnt(7)
    v_bitop3_b32 v8, v8, v68, s19 bitop3:0xf6
    v_mfma_f32_16x16x32_bf16 v[16:19], v[68:71], v[12:15], v[16:19]
    buffer_load_dwordx4 v[68:71], v0, s[4:7], s36 offen offset:3072 sc1
    v_and_b32 v8, 1, v8
    v_cmp_ne_u32 vcc, 0, v8
    s_cbranch_vccz L_recursok_49
    s_waitcnt vmcnt(7)
    v_xor_b32 v8, s19, v56
    v_mfma_f32_16x16x32_bf16 v[16:19], v[56:59], v[12:15], 0
    buffer_load_dwordx4 v[56:59], v0, s[4:7], s36 offen offset:0 sc1
    s_waitcnt vmcnt(7)
    v_bitop3_b32 v8, v8, v60, s19 bitop3:0xf6
    v_mfma_f32_16x16x32_bf16 v[16:19], v[60:63], v[12:15], v[16:19]
    buffer_load_dwordx4 v[60:63], v0, s[4:7], s36 offen offset:1024 sc1
    s_waitcnt vmcnt(7)
    v_bitop3_b32 v8, v8, v64, s19 bitop3:0xf6
    v_mfma_f32_16x16x32_bf16 v[16:19], v[64:67], v[12:15], v[16:19]
    buffer_load_dwordx4 v[64:67], v0, s[4:7], s36 offen offset:2048 sc1
    s_waitcnt vmcnt(7)
    v_bitop3_b32 v8, v8, v68, s19 bitop3:0xf6
    v_mfma_f32_16x16x32_bf16 v[16:19], v[68:71], v[12:15], v[16:19]
    buffer_load_dwordx4 v[68:71], v0, s[4:7], s36 offen offset:3072 sc1
    v_and_b32 v8, 1, v8
    v_cmp_ne_u32 vcc, 0, v8
    s_cbranch_vccz L_recursok_49
    s_sub_u32 s50, s50, 1
    s_cbranch_scc0 L_recursl_50
    s_branch L_exit_recurrent_scan__memory_aug_recurrent_mem_tr__moe_arch_mod__prompt_kernel
L_recursok_49:
    s_nop 1
    v_permlane32_swap_b32 v16, v18
    v_permlane32_swap_b32 v17, v19
    v_pk_add_f32 v[16:17], v[16:17], v[18:19]
    v_cvt_pk_bf16_f32 v16, v16, v17
    s_mov_b64 exec, s[74:75]
    buffer_store_dword v16, v21, s[4:7], s48 offen sc1
    buffer_store_dword v16, v21, s[4:7], s37 offen
    s_mov_b64 exec, -1
    s_barrier
    v_mov_b64 v[8:9], -1
    v_mov_b64 v[10:11], -1
    s_mov_b64 exec, 0xff
    buffer_store_dwordx4 v[8:11], v0, s[4:7], s45 offen
    s_mov_b64 exec, -1
    s_xor_b32 s36, s36, 262144
    s_mov_b32 s45, s37
    s_add_u32 s37, s37, 8192
    s_andn2_b32 s37, s37, 0x8000
    s_add_u32 s48, s48, 10240
    s_waitcnt vmcnt(3)
    s_branch L_recun2_48
L_recunred_47:
    v_mov_b64 v[24:25], 0
    v_mov_b64 v[26:27], 0
    v_mov_b64 v[28:29], 0
    v_mov_b64 v[30:31], 0
    v_mov_b64 v[32:33], 0
    v_mov_b64 v[34:35], 0
    v_mov_b64 v[36:37], 0
    v_mov_b64 v[38:39], 0
    v_mov_b64 v[40:41], 0
    v_mov_b64 v[42:43], 0
    v_mov_b64 v[44:45], 0
    v_mov_b64 v[46:47], 0
    s_barrier
    s_waitcnt vmcnt(0)
L_recun2_48:
    v_bfe_u32 v4, v0, 7, 2
    v_lshl_add_u32 v4, v4, 2, v0
    s_add_u32 s34, s34, 1
    ds_read_b128 v[56:59], v1 offset:12288
    ds_read_b128 v[60:63], v1 offset:13312
    ds_read_b128 v[64:67], v1 offset:14336
    ds_read_b128 v[68:71], v1 offset:15360
    ds_read_b128 v[72:75], v1 offset:16384
    ds_read_b128 v[76:79], v1 offset:17408
    ds_read_b128 v[80:83], v1 offset:18432
    ds_read_b128 v[84:87], v1 offset:19456
    s_add_u32 s26, s34, 1
    s_min_u32 s26, s26, 63
    s_cmp_gt_u32 s44, s26
    s_cbranch_scc1 L_recuf_51
    v_bfe_u32 v8, v0, 6, 1
    v_lshlrev_b32 v8, 13, v8
    v_bfe_u32 v9, v0, 4, 2
    v_lshl_add_u32 v8, v9, 2, v8
    v_bfe_u32 v10, v0, 7, 1
    v_lshl_add_u32 v8, v10, 7, v8
    s_mov_b32 s50, 0
L_recufs_52:
    buffer_load_dword v9, v8, s[4:7], s46 offen sc1
    s_waitcnt vmcnt(0)
    v_lshl_add_u32 v9, v9, 1, v10
    v_cmp_ge_u32 vcc, s26, v9
    s_cbranch_vccz L_recufsok_53
    s_add_u32 s50, s50, 1
    s_cmp_lt_u32 s50, 400000
    s_cbranch_scc0 L_exit_recurrent_scan__memory_aug_recurrent_mem_tr__moe_arch_mod__prompt_kernel
    s_sleep 2
    s_branch L_recufs_52
L_recufsok_53:
    v_min_u32_dpp v9, v9, v9 quad_perm:[1,0,3,2] row_mask:0xf bank_mask:0xf
    s_nop 1
    v_min_u32_dpp v9, v9, v9 quad_perm:[2,3,0,1] row_mask:0xf bank_mask:0xf
    s_nop 1
    v_min_u32_dpp v9, v9, v9 row_half_mirror row_mask:0xf bank_mask:0xf
    s_nop 1
    v_min_u32_dpp v9, v9, v9 row_mirror row_mask:0xf bank_mask:0xf
    s_nop 0
    v_readfirstlane_b32 s44, v9
L_recuf_51:
    s_mov_b32 m0, s66
    s_mov_b32 s30, s38
    s_mov_b64 s[8:9], -1
    s_add_u32 s67, s67, 262144
    s_add_u32 s38, s38, 10240
    s_waitcnt lgkmcnt(0)
    s_bfe_u32 s19, s34, 0x10001
    s_branch L_recucl_43
L_recurt_45:
    s_cmp_eq_u32 s34, 0
    s_cbranch_scc1 L_recurb_46
    s_mov_b32 s50, 0
    s_mov_b32 m0, s66
    ds_read2st64_b32 v[8:9], v4 offset0:32 offset1:36
    s_waitcnt lgkmcnt(0)
    v_cmp_eq_u32 s[52:53], -1, v8
    v_cmp_eq_u32 s[54:55], -1, v9
    s_or_b64 s[58:59], s[52:53], s[54:55]
    s_cbranch_scc0 L_recurb_46
    s_mov_b64 exec, s[52:53]
    buffer_load_dwordx4 v0, s[4:7], s30 offen offset:0 sc1 lds
    s_mov_b64 exec, s[54:55]
    buffer_load_dwordx4 v0, s[4:7], s30 offen offset:1024 sc1 lds
    s_mov_b64 exec, -1
    s_nop 15
    s_nop 15
L_recur2_55:
    s_mov_b64 exec, s[52:53]
    buffer_load_dwordx4 v0, s[4:7], s30 offen offset:0 sc1 lds
    s_mov_b64 exec, s[54:55]
    buffer_load_dwordx4 v0, s[4:7], s30 offen offset:1024 sc1 lds
    s_mov_b64 exec, -1
    s_waitcnt vmcnt(2)
    ds_read2st64_b32 v[8:9], v4 offset0:32 offset1:36
    s_waitcnt lgkmcnt(0)
    v_cmp_eq_u32 s[52:53], -1, v8
    v_cmp_eq_u32 s[54:55], -1, v9
    s_or_b64 s[58:59], s[52:53], s[54:55]
    s_cbranch_scc0 L_recurb_46
    s_add_u32 s50, s50, 1
    s_cmp_lt_u32 s50, 3200000
    s_cbranch_scc0 L_exit_recurrent_scan__memory_aug_recurrent_mem_tr__moe_arch_mod__prompt_kernel
    s_branch L_recur2_55
L_recufin_44:
    s_waitcnt lgkmcnt(0)
    s_nop 7
    s_waitcnt vmcnt(0)
    v_mov_b32 v9, 64
    buffer_store_dword v9, off, s[4:7], s41 sc1
    s_waitcnt vmcnt(0)
    s_branch L_exit_recurrent_scan__memory_aug_recurrent_mem_tr__moe_arch_mod__prompt_kernel
L_recub_24:
L_recucl_56:
    s_barrier
    ds_read_b128 v[12:15], v2 offset:0
    ds_read_b128 v[16:19], v2 offset:1024
    ds_read_b128 v[20:23], v2 offset:2048
    s_waitcnt lgkmcnt(2)
    v_smfmac_f32_16x16x64_bf16 v[24:27], v[12:15], a[0:7], v7
    v_mov_b32 v8, s34
    v_smfmac_f32_16x16x64_bf16 v[28:31], v[12:15], v[56:63], v7
    ds_read_b128 v[56:59], v1 offset:20480
    v_smfmac_f32_16x16x64_bf16 v[32:35], v[12:15], a[8:15], v7
    ds_read_b128 v[60:63], v1 offset:21504
    v_smfmac_f32_16x16x64_bf16 v[36:39], v[12:15], v[64:71], v7
    ds_read_b128 v[64:67], v1 offset:22528
    v_smfmac_f32_16x16x64_bf16 v[40:43], v[12:15], a[16:23], v7
    ds_read_b128 v[68:71], v1 offset:23552
    v_smfmac_f32_16x16x64_bf16 v[44:47], v[12:15], a[24:31], v7
    buffer_load_dwordx4 v[48:51], v0, s[4:7], s47 offen offset:0
    ds_read_b128 v[12:15], v2 offset:3072
    s_waitcnt lgkmcnt(6)
    v_smfmac_f32_16x16x64_bf16 v[24:27], v[16:19], a[32:39], v7
    buffer_load_dwordx4 v[52:55], v0, s[4:7], s47 offen offset:1024
    v_smfmac_f32_16x16x64_bf16 v[28:31], v[16:19], v[72:79], v7
    ds_read_b128 v[72:75], v1 offset:24576
    v_smfmac_f32_16x16x64_bf16 v[32:35], v[16:19], a[40:47], v7
    ds_read_b128 v[76:79], v1 offset:25600
    buffer_store_dword v8, off, s[4:7], s41 sc1
    v_smfmac_f32_16x16x64_bf16 v[36:39], v[16:19], v[80:87], v7
    ds_read_b128 v[80:83], v1 offset:26624
    v_smfmac_f32_16x16x64_bf16 v[40:43], v[16:19], a[48:55], v7
    ds_read_b128 v[84:87], v1 offset:27648
    v_smfmac_f32_16x16x64_bf16 v[44:47], v[16:19], a[56:63], v7
    ds_read_b128 v[16:19], v2 offset:4096
    s_waitcnt lgkmcnt(10)
    v_smfmac_f32_16x16x64_bf16 v[24:27], v[20:23], a[64:71], v7
    s_waitcnt lgkmcnt(8)
    v_smfmac_f32_16x16x64_bf16 v[28:31], v[20:23], v[56:63], v7
    ds_read_b128 v[56:59], v1 offset:28672
    v_smfmac_f32_16x16x64_bf16 v[32:35], v[20:23], a[72:79], v7
    ds_read_b128 v[60:63], v1 offset:29696
    s_waitcnt lgkmcnt(8)
    v_smfmac_f32_16x16x64_bf16 v[36:39], v[20:23], v[64:71], v7
    ds_read_b128 v[64:67], v1 offset:30720
    v_smfmac_f32_16x16x64_bf16 v[40:43], v[20:23], a[80:87], v7
    ds_read_b128 v[68:71], v1 offset:31744
    v_smfmac_f32_16x16x64_bf16 v[44:47], v[20:23], a[88:95], v7
    s_waitcnt lgkmcnt(9)
    v_smfmac_f32_16x16x64_bf16 v[24:27], v[12:15], a[96:103], v7
    s_waitcnt lgkmcnt(7)
    v_smfmac_f32_16x16x64_bf16 v[28:31], v[12:15], v[72:79], v7
    ds_read_b128 v[72:75], v1 offset:0
    v_smfmac_f32_16x16x64_bf16 v[32:35], v[12:15], a[104:111], v7
    ds_read_b128 v[76:79], v1 offset:1024
    s_waitcnt lgkmcnt(7)
    v_smfmac_f32_16x16x64_bf16 v[36:39], v[12:15], v[80:87], v7
    ds_read_b128 v[80:83], v1 offset:2048
    s_waitcnt lgkmcnt(7)
    v_smfmac_f32_16x16x64_bf16 v[24:27], v[16:19], a[128:135], v7
    ds_read_b128 v[84:87], v1 offset:3072
    s_waitcnt lgkmcnt(6)
    v_smfmac_f32_16x16x64_bf16 v[28:31], v[16:19], v[56:63], v7
    ds_read_b128 v[56:59], v1 offset:32768
    v_smfmac_f32_16x16x64_bf16 v[32:35], v[16:19], a[136:143], v7
    ds_read_b128 v[60:63], v1 offset:33792
    s_waitcnt lgkmcnt(6)
    v_smfmac_f32_16x16x64_bf16 v[36:39], v[16:19], v[64:71], v7
    s_waitcnt vmcnt(3)
    s_barrier
    ds_read_b128 v[20:23], v2 offset:5120
    v_smfmac_f32_16x16x64_bf16 v[40:43], v[12:15], a[112:119], v7
    v_smfmac_f32_16x16x64_bf16 v[44:47], v[12:15], a[120:127], v7
    ds_read_b128 v[12:15], v2 offset:6144
    v_smfmac_f32_16x16x64_bf16 v[40:43], v[16:19], a[144:151], v7
    v_smfmac_f32_16x16x64_bf16 v[44:47], v[16:19], a[152:159], v7
    ds_read_b128 v[16:19], v2 offset:7168
    s_waitcnt lgkmcnt(2)
    v_smfmac_f32_16x16x64_bf16 v[24:27], v[20:23], a[160:167], v7
    v_smfmac_f32_16x16x64_bf16 v[28:31], v[20:23], v[72:79], v7
    v_smfmac_f32_16x16x64_bf16 v[32:35], v[20:23], a[168:175], v7
    v_smfmac_f32_16x16x64_bf16 v[36:39], v[20:23], v[80:87], v7
    ds_read_b128 v[20:23], v2 offset:8192
    s_waitcnt lgkmcnt(2)
    v_smfmac_f32_16x16x64_bf16 v[24:27], v[12:15], a[192:199], v7
    v_smfmac_f32_16x16x64_bf16 v[28:31], v[12:15], v[56:63], v7
    ds_read_b128 v[72:75], v0 offset:10240
    v_smfmac_f32_16x16x64_bf16 v[32:35], v[12:15], a[200:207], v7
    v_smfmac_f32_16x16x64_bf16 v[36:39], v[12:15], a[208:215], v7
    ds_read_b128 v[76:79], v0 offset:11264
    ds_read_b128 v[12:15], v2 offset:9216
    s_waitcnt lgkmcnt(4)
    v_smfmac_f32_16x16x64_bf16 v[24:27], v[16:19], a[232:239], v7
    v_lshrrev_b32 v71, 9, v0
    v_smfmac_f32_16x16x64_bf16 v[28:31], v[16:19], a[248:255], v7
    ds_read_b128 v[80:83], v0 offset:12288
    v_smfmac_f32_16x16x64_bf16 v[32:35], v[16:19], a[240:247], v7
    v_lshlrev_b32 v71, 3, v71
    v_smfmac_f32_16x16x64_bf16 v[36:39], v[16:19], v[88:95], v7
    ds_read_b128 v[84:87], v0 offset:13312
    s_waitcnt lgkmcnt(5)
    v_smfmac_f32_16x16x64_bf16 v[24:27], v[20:23], v[112:119], v7
    v_lshrrev_b32 v70, 1, v0
    v_smfmac_f32_16x16x64_bf16 v[28:31], v[20:23], v[128:135], v7
    v_xor_b32 v70, v71, v70
    v_smfmac_f32_16x16x64_bf16 v[32:35], v[20:23], v[120:127], v7
    v_xor_b32 v71, 16, v70
    v_smfmac_f32_16x16x64_bf16 v[36:39], v[20:23], v[136:143], v7
    s_waitcnt lgkmcnt(2)
    v_smfmac_f32_16x16x64_bf16 v[24:27], v[12:15], v[160:167], v7
    v_smfmac_f32_16x16x64_bf16 v[28:31], v[12:15], v[176:183], v7
    v_smfmac_f32_16x16x64_bf16 v[32:35], v[12:15], v[168:175], v7
    v_add_f32 v24, v24, v26
    v_smfmac_f32_16x16x64_bf16 v[36:39], v[12:15], v[184:191], v7
    v_add_f32 v25, v25, v27
    v_add_f32 v28, v28, v30
    v_cvt_pk_bf16_f32 v8, v24, v25
    v_add_f32 v29, v29, v31
    v_add_f32 v32, v32, v34
    v_cvt_pk_bf16_f32 v9, v28, v29
    v_add_f32 v33, v33, v35
    ds_write_b64 v3, v[8:9]
    v_pk_add_f32 v[36:37], v[36:37], v[38:39]
    v_cvt_pk_bf16_f32 v10, v32, v33
    v_cvt_pk_bf16_f32 v11, v36, v37
    ds_write_b64 v3, v[10:11] offset:128
    v_smfmac_f32_16x16x64_bf16 v[40:43], v[12:15], v[192:199], v7
    v_smfmac_f32_16x16x64_bf16 v[44:47], v[12:15], v[200:207], v7
    ds_read_b128 v[12:15], v2 offset:6144
    v_smfmac_f32_16x16x64_bf16 v[40:43], v[20:23], v[144:151], v7
    v_smfmac_f32_16x16x64_bf16 v[44:47], v[20:23], v[152:159], v7
    ds_read_b128 v[20:23], v2 offset:5120
    v_smfmac_f32_16x16x64_bf16 v[40:43], v[16:19], v[96:103], v7
    s_waitcnt lgkmcnt(2)
    s_barrier
    ds_read_b64_tr_b16 v[56:57], v70 offset:18432
    ds_read_b64_tr_b16 v[58:59], v71 offset:18944
    v_smfmac_f32_16x16x64_bf16 v[44:47], v[16:19], v[104:111], v7
    ds_read_b64_tr_b16 v[60:61], v70 offset:19456
    ds_read_b64_tr_b16 v[62:63], v71 offset:19968
    s_waitcnt lgkmcnt(5)
    v_smfmac_f32_16x16x64_bf16 v[40:43], v[12:15], a[216:223], v7
    ds_read_b64_tr_b16 v[64:65], v70 offset:20480
    ds_read_b64_tr_b16 v[66:67], v71 offset:20992
    v_smfmac_f32_16x16x64_bf16 v[44:47], v[12:15], a[224:231], v7
    ds_read_b64_tr_b16 v[68:69], v70 offset:21504
    ds_read_b64_tr_b16 v[70:71], v71 offset:22016
    s_waitcnt lgkmcnt(8)
    v_smfmac_f32_16x16x64_bf16 v[40:43], v[20:23], a[176:183], v7
    v_smfmac_f32_16x16x64_bf16 v[44:47], v[20:23], a[184:191], v7
    s_waitcnt lgkmcnt(6)
    v_mfma_f32_16x16x32_bf16 v[28:31], v[72:75], v[56:59], 0
    ds_read_b128 v[72:75], v0 offset:14336
    s_waitcnt lgkmcnt(5)
    v_mfma_f32_16x16x32_bf16 v[28:31], v[76:79], v[60:63], v[28:31]
    ds_read_b128 v[76:79], v0 offset:15360
    s_waitcnt lgkmcnt(4)
    v_mfma_f32_16x16x32_bf16 v[28:31], v[80:83], v[64:67], v[28:31]
    ds_read_b128 v[80:83], v0 offset:16384
    v_add_f32 v40, v40, v42
    s_waitcnt lgkmcnt(3)
    v_mfma_f32_16x16x32_bf16 v[28:31], v[84:87], v[68:71], v[28:31]
    ds_read_b128 v[84:87], v0 offset:17408
    v_add_f32 v44, v44, v46
    v_mfma_f32_16x16x32_bf16 v[24:27], v[56:59], v[56:59], 0
    v_add_f32 v41, v41, v43
    v_add_f32 v45, v45, v47
    v_mfma_f32_16x16x32_bf16 v[24:27], v[60:63], v[60:63], v[24:27]
    v_cvt_pk_bf16_f32 v46, v40, v41
    v_cvt_pk_bf16_f32 v47, v44, v45
    v_mfma_f32_16x16x32_bf16 v[24:27], v[64:67], v[64:67], v[24:27]
    s_cmp_eq_u32 s34, 63
    buffer_store_dwordx4 v[64:67], v0, s[4:7], s40 offen sc1
    s_cbranch_scc1 L_recufin_57
    v_max3_f32 v8, v28, v29, v30
    v_mfma_f32_16x16x32_bf16 v[24:27], v[68:71], v[68:71], v[24:27]
    v_mov_b64 v[12:13], s[70:71]
    v_mov_b64 v[14:15], s[70:71]
    s_waitcnt lgkmcnt(3)
    v_mfma_f32_16x16x32_bf16 v[32:35], v[72:75], v[56:59], 0
    v_add_u32 v10, s49, v0
    v_mov_b64 v[36:37], 0
    s_waitcnt lgkmcnt(2)
    v_mfma_f32_16x16x32_bf16 v[32:35], v[76:79], v[60:63], v[32:35]
    v_max3_f32 v8, v8, v31, v26
    v_mov_b64 v[38:39], 0
    s_waitcnt lgkmcnt(1)
    v_mfma_f32_16x16x32_bf16 v[32:35], v[80:83], v[64:67], v[32:35]
    v_max_f32 v8, v8, v27
    ds_read_b128 v[72:75], v1 offset:8192
    ds_read_b128 v[76:79], v1 offset:9216
    s_waitcnt lgkmcnt(2)
    v_mfma_f32_16x16x32_bf16 v[32:35], v[84:87], v[68:71], v[32:35]
    ds_read_b128 v[80:83], v1 offset:4096
    ds_read_b128 v[84:87], v1 offset:5120
    v_mov_b32 v69, 0
    v_mov_b32 v70, 0
    v_mov_b64 v[40:41], 0
    v_mov_b64 v[42:43], 0
    s_nop 1
    v_max3_f32 v8, v8, v32, v33
    v_max3_f32 v9, v8, v34, v35
    v_max3_f32 v8, v8, v34, v35
    s_nop 1
    v_permlane32_swap_b32 v9, v8
    v_max_f32 v11, v8, v9
    v_max_f32 v8, v8, v9
    s_nop 1
    v_permlane16_swap_b32 v11, v8
    v_max_f32 v8, v8, v11
    v_mul_f32 v8, 0xbe0293ee, v8
    v_pk_fma_f32 v[26:27], v[26:27], s[68:69], v[8:9] op_sel_hi:[1,1,0]
    v_pk_fma_f32 v[28:29], v[28:29], s[68:69], v[8:9] op_sel_hi:[1,1,0]
    v_exp_f32 v26, v26
    v_exp_f32 v27, v27
    v_pk_fma_f32 v[30:31], v[30:31], s[68:69], v[8:9] op_sel_hi:[1,1,0]
    v_exp_f32 v28, v28
    v_pk_fma_f32 v[32:33], v[32:33], s[68:69], v[8:9] op_sel_hi:[1,1,0]
    v_exp_f32 v29, v29
    v_cvt_pk_bf16_f32 v68, v26, v27
    v_pk_fma_f32 v[34:35], v[34:35], s[68:69], v[8:9] op_sel_hi:[1,1,0]
    v_cvt_pk_bf16_f32 v71, v26, v27
    v_exp_f32 v30, v30
    v_mfma_f32_16x16x16_bf16 v[16:19], v[12:13], v[68:69], 0
    v_exp_f32 v31, v31
    v_cvt_pk_bf16_f32 v64, v28, v29
    v_mfma_f32_16x16x16_bf16 v[56:59], v[46:47], v[68:69], 0
    v_exp_f32 v32, v32
    v_exp_f32 v33, v33
    v_mfma_f32_16x16x16_bf16 v[60:63], v[46:47], v[70:71], 0
    v_cvt_pk_bf16_f32 v65, v30, v31
    v_exp_f32 v34, v34
    v_exp_f32 v35, v35
    v_cvt_pk_bf16_f32 v66, v32, v33
    s_waitcnt vmcnt(1)
    v_cvt_pk_bf16_f32 v67, v34, v35
    v_mov_b64 v[24:25], 0
    s_nop 0
    v_mfma_f32_16x16x32_bf16 v[16:19], v[12:15], v[64:67], v[16:19]
    v_mov_b64 v[26:27], 0
    v_mov_b64 v[28:29], 0
    v_mfma_f32_16x16x32_bf16 v[56:59], v[48:51], v[64:67], v[56:59]
    v_mov_b64 v[30:31], 0
    v_mov_b64 v[32:33], 0
    v_mfma_f32_16x16x32_bf16 v[60:63], v[52:55], v[64:67], v[60:63]
    v_mov_b64 v[34:35], 0
    v_rcp_f32 v8, v16
    s_nop 1
    v_pk_mul_f32 v[56:57], v[56:57], v[8:9] op_sel_hi:[1,0]
    v_pk_mul_f32 v[58:59], v[58:59], v[8:9] op_sel_hi:[1,0]
    v_cvt_pk_bf16_f32 v20, v56, v57
    v_cvt_pk_bf16_f32 v21, v58, v59
    v_pk_mul_f32 v[60:61], v[60:61], v[8:9] op_sel_hi:[1,0]
    v_pk_mul_f32 v[62:63], v[62:63], v[8:9] op_sel_hi:[1,0]
    v_cvt_pk_bf16_f32 v22, v60, v61
    v_cvt_pk_bf16_f32 v23, v62, v63
    s_mov_b64 exec, s[64:65]
    ds_write_b128 v10, v[20:23]
    s_mov_b64 exec, -1
    ds_read_b128 v[56:59], v1 offset:6144
    ds_read_b128 v[60:63], v1 offset:7168
    ds_read_b128 v[64:67], v1 offset:10240
    ds_read_b128 v[68:71], v1 offset:11264
    s_waitcnt lgkmcnt(4)
    s_barrier
    ds_read_b128 v[12:15], v0 offset:22528
    ds_read_b128 v[16:19], v0 offset:23552
    s_mov_b32 m0, s51
    s_nop 0
    buffer_load_dwordx4 v0, s[4:7], s39 offen lds
    buffer_load_dwordx4 v0, s[4:7], s39 offen offset:1024 lds
    s_waitcnt lgkmcnt(1)
    v_smfmac_f32_16x16x64_bf16 v[40:43], v[12:15], v[72:79], v7
    s_waitcnt lgkmcnt(0)
    v_smfmac_f32_16x16x64_bf16 v[40:43], v[16:19], v[64:71], v7
    v_smfmac_f32_16x16x64_bf16 v[24:27], v[12:15], v[208:215], v7
    v_smfmac_f32_16x16x64_bf16 v[24:27], v[16:19], v[240:247], v7
    v_add_f32 v40, v40, v42
    v_smfmac_f32_16x16x64_bf16 v[28:31], v[12:15], v[216:223], v7
    v_add_f32 v41, v41, v43
    v_smfmac_f32_16x16x64_bf16 v[28:31], v[16:19], v[248:255], v7
    v_cvt_pk_bf16_f32 v20, v40, v41
    v_smfmac_f32_16x16x64_bf16 v[32:35], v[12:15], v[224:231], v7
    v_bfi_b32 v20, 1, s19, v20
    v_smfmac_f32_16x16x64_bf16 v[32:35], v[16:19], v[80:87], v7
    buffer_store_dword v20, v6, s[4:7], s35 offen
    v_add_f32 v24, v24, v26
    v_smfmac_f32_16x16x64_bf16 v[36:39], v[12:15], v[232:239], v7
    v_add_f32 v25, v25, v27
    v_smfmac_f32_16x16x64_bf16 v[36:39], v[16:19], v[56:63], v7
    v_add_f32 v28, v28, v30
    v_add_f32 v29, v29, v31
    v_cvt_pk_bf16_f32 v8, v24, v25
    v_add_f32 v32, v32, v34
    v_cvt_pk_bf16_f32 v9, v28, v29
    v_add_f32 v33, v33, v35
    v_bfi_b32 v8, 1, s19, v8
    v_cvt_pk_bf16_f32 v10, v32, v33
    v_pk_add_f32 v[36:37], v[36:37], v[38:39]
    v_cvt_pk_bf16_f32 v11, v36, v37
    buffer_store_dwordx4 v[8:11], v5, s[4:7], s35 offen
    s_add_u32 s39, s39, 262144
    s_add_u32 s47, s47, 262144
    s_xor_b32 s35, s35, 262144
    s_add_u32 s40, s40, 131072
    v_mov_b64 v[24:25], 0
    v_mov_b64 v[26:27], 0
    v_mov_b64 v[28:29], 0
    v_mov_b64 v[30:31], 0
    v_mov_b64 v[32:33], 0
    v_mov_b64 v[34:35], 0
    v_mov_b64 v[36:37], 0
    v_mov_b64 v[38:39], 0
    v_mov_b64 v[40:41], 0
    v_mov_b64 v[42:43], 0
    v_mov_b64 v[44:45], 0
    v_mov_b64 v[46:47], 0
    ds_read_b128 v[56:59], v1 offset:12288
    ds_read_b128 v[60:63], v1 offset:13312
    ds_read_b128 v[64:67], v1 offset:14336
    ds_read_b128 v[68:71], v1 offset:15360
    ds_read_b128 v[72:75], v1 offset:16384
    ds_read_b128 v[76:79], v1 offset:17408
    ds_read_b128 v[80:83], v1 offset:18432
    ds_read_b128 v[84:87], v1 offset:19456
    s_mov_b32 m0, s66
    s_add_u32 s34, s34, 1
    s_bfe_u32 s19, s34, 0x10001
    s_mov_b32 s50, 3200000
    s_mov_b32 s30, s37
    s_add_u32 s37, s37, 8192
    s_andn2_b32 s37, s37, 0x8000
    s_waitcnt lgkmcnt(0)
    s_barrier
    s_nop 15
    s_nop 15
    s_nop 15
    s_nop 15
    s_nop 15
    buffer_load_dwordx4 v0, s[4:7], s30 offen offset:0 sc1 lds
    buffer_load_dwordx4 v0, s[4:7], s30 offen offset:1024 sc1 lds
    buffer_load_dwordx4 v0, s[4:7], s30 offen offset:2048 sc1 lds
    s_nop 15
    s_nop 15
    s_nop 11
    buffer_load_dwordx4 v0, s[4:7], s30 offen offset:0 sc1 lds
    buffer_load_dwordx4 v0, s[4:7], s30 offen offset:1024 sc1 lds
    buffer_load_dwordx4 v0, s[4:7], s30 offen offset:2048 sc1 lds
L_recuagl_60:
    s_waitcnt vmcnt(3)
    ds_read2st64_b32 v[8:9], v4 offset0:0 offset1:4
    ds_read_b32 v10, v4 offset:2048
    buffer_load_dwordx4 v0, s[4:7], s30 offen offset:0 sc1 lds
    buffer_load_dwordx4 v0, s[4:7], s30 offen offset:1024 sc1 lds
    buffer_load_dwordx4 v0, s[4:7], s30 offen offset:2048 sc1 lds
    s_waitcnt lgkmcnt(0)
    v_max3_u32 v8, v8, v9, v10
    v_cmp_eq_u32 vcc, -1, v8
    s_cbranch_vccz L_recucl_56
    s_waitcnt vmcnt(3)
    ds_read2st64_b32 v[8:9], v4 offset0:0 offset1:4
    ds_read_b32 v10, v4 offset:2048
    buffer_load_dwordx4 v0, s[4:7], s30 offen offset:0 sc1 lds
    buffer_load_dwordx4 v0, s[4:7], s30 offen offset:1024 sc1 lds
    buffer_load_dwordx4 v0, s[4:7], s30 offen offset:2048 sc1 lds
    s_waitcnt lgkmcnt(0)
    v_max3_u32 v8, v8, v9, v10
    v_cmp_eq_u32 vcc, -1, v8
    s_cbranch_vccz L_recucl_56
    s_sub_u32 s50, s50, 1
    s_cbranch_scc0 L_recuagl_60
    s_branch L_exit_recurrent_scan__memory_aug_recurrent_mem_tr__moe_arch_mod__prompt_kernel
    s_branch L_recucl_56
L_recufin_57:
    s_waitcnt lgkmcnt(0)
    s_nop 7
    s_waitcnt vmcnt(0)
    v_mov_b32 v9, 64
    buffer_store_dword v9, off, s[4:7], s41 sc1
    s_waitcnt vmcnt(0)
    s_branch L_exit_recurrent_scan__memory_aug_recurrent_mem_tr__moe_arch_mod__prompt_kernel
L_recub_25:
L_recucl_61:
    s_barrier
    ds_read_b128 v[12:15], v2 offset:0
    ds_read_b128 v[16:19], v2 offset:1024
    ds_read_b128 v[20:23], v2 offset:2048
    s_waitcnt lgkmcnt(2)
    v_smfmac_f32_16x16x64_bf16 v[24:27], v[12:15], a[0:7], v7
    v_mov_b32 v8, s34
    v_smfmac_f32_16x16x64_bf16 v[28:31], v[12:15], v[56:63], v7
    ds_read_b128 v[56:59], v1 offset:20480
    v_smfmac_f32_16x16x64_bf16 v[32:35], v[12:15], a[8:15], v7
    ds_read_b128 v[60:63], v1 offset:21504
    v_smfmac_f32_16x16x64_bf16 v[36:39], v[12:15], v[64:71], v7
    ds_read_b128 v[64:67], v1 offset:22528
    v_smfmac_f32_16x16x64_bf16 v[40:43], v[12:15], a[16:23], v7
    ds_read_b128 v[68:71], v1 offset:23552
    v_smfmac_f32_16x16x64_bf16 v[44:47], v[12:15], a[24:31], v7
    buffer_load_dwordx4 v[48:51], v0, s[4:7], s47 offen offset:0
    ds_read_b128 v[12:15], v2 offset:3072
    s_waitcnt lgkmcnt(6)
    v_smfmac_f32_16x16x64_bf16 v[24:27], v[16:19], a[32:39], v7
    buffer_load_dwordx4 v[52:55], v0, s[4:7], s47 offen offset:1024
    v_smfmac_f32_16x16x64_bf16 v[28:31], v[16:19], v[72:79], v7
    ds_read_b128 v[72:75], v1 offset:24576
    v_smfmac_f32_16x16x64_bf16 v[32:35], v[16:19], a[40:47], v7
    ds_read_b128 v[76:79], v1 offset:25600
    buffer_store_dword v8, off, s[4:7], s41 sc1
    v_smfmac_f32_16x16x64_bf16 v[36:39], v[16:19], v[80:87], v7
    ds_read_b128 v[80:83], v1 offset:26624
    v_smfmac_f32_16x16x64_bf16 v[40:43], v[16:19], a[48:55], v7
    ds_read_b128 v[84:87], v1 offset:27648
    v_smfmac_f32_16x16x64_bf16 v[44:47], v[16:19], a[56:63], v7
    ds_read_b128 v[16:19], v2 offset:4096
    s_waitcnt lgkmcnt(10)
    v_smfmac_f32_16x16x64_bf16 v[24:27], v[20:23], a[64:71], v7
    s_waitcnt lgkmcnt(8)
    v_smfmac_f32_16x16x64_bf16 v[28:31], v[20:23], v[56:63], v7
    ds_read_b128 v[56:59], v1 offset:28672
    v_smfmac_f32_16x16x64_bf16 v[32:35], v[20:23], a[72:79], v7
    ds_read_b128 v[60:63], v1 offset:29696
    s_waitcnt lgkmcnt(8)
    v_smfmac_f32_16x16x64_bf16 v[36:39], v[20:23], v[64:71], v7
    ds_read_b128 v[64:67], v1 offset:30720
    v_smfmac_f32_16x16x64_bf16 v[40:43], v[20:23], a[80:87], v7
    ds_read_b128 v[68:71], v1 offset:31744
    v_smfmac_f32_16x16x64_bf16 v[44:47], v[20:23], a[88:95], v7
    s_waitcnt lgkmcnt(9)
    v_smfmac_f32_16x16x64_bf16 v[24:27], v[12:15], a[96:103], v7
    s_waitcnt lgkmcnt(7)
    v_smfmac_f32_16x16x64_bf16 v[28:31], v[12:15], v[72:79], v7
    ds_read_b128 v[72:75], v1 offset:0
    v_smfmac_f32_16x16x64_bf16 v[32:35], v[12:15], a[104:111], v7
    ds_read_b128 v[76:79], v1 offset:1024
    s_waitcnt lgkmcnt(7)
    v_smfmac_f32_16x16x64_bf16 v[36:39], v[12:15], v[80:87], v7
    ds_read_b128 v[80:83], v1 offset:2048
    s_waitcnt lgkmcnt(7)
    v_smfmac_f32_16x16x64_bf16 v[24:27], v[16:19], a[128:135], v7
    ds_read_b128 v[84:87], v1 offset:3072
    s_waitcnt lgkmcnt(6)
    v_smfmac_f32_16x16x64_bf16 v[28:31], v[16:19], v[56:63], v7
    ds_read_b128 v[56:59], v1 offset:32768
    v_smfmac_f32_16x16x64_bf16 v[32:35], v[16:19], a[136:143], v7
    ds_read_b128 v[60:63], v1 offset:33792
    s_waitcnt lgkmcnt(6)
    v_smfmac_f32_16x16x64_bf16 v[36:39], v[16:19], v[64:71], v7
    s_waitcnt vmcnt(3)
    s_barrier
    ds_read_b128 v[20:23], v2 offset:5120
    v_smfmac_f32_16x16x64_bf16 v[40:43], v[12:15], a[112:119], v7
    v_smfmac_f32_16x16x64_bf16 v[44:47], v[12:15], a[120:127], v7
    ds_read_b128 v[12:15], v2 offset:6144
    v_smfmac_f32_16x16x64_bf16 v[40:43], v[16:19], a[144:151], v7
    v_smfmac_f32_16x16x64_bf16 v[44:47], v[16:19], a[152:159], v7
    ds_read_b128 v[16:19], v2 offset:7168
    s_waitcnt lgkmcnt(2)
    v_smfmac_f32_16x16x64_bf16 v[24:27], v[20:23], a[160:167], v7
    v_smfmac_f32_16x16x64_bf16 v[28:31], v[20:23], v[72:79], v7
    v_smfmac_f32_16x16x64_bf16 v[32:35], v[20:23], a[168:175], v7
    v_smfmac_f32_16x16x64_bf16 v[36:39], v[20:23], v[80:87], v7
    ds_read_b128 v[20:23], v2 offset:8192
    s_waitcnt lgkmcnt(2)
    v_smfmac_f32_16x16x64_bf16 v[24:27], v[12:15], a[192:199], v7
    v_smfmac_f32_16x16x64_bf16 v[28:31], v[12:15], v[56:63], v7
    ds_read_b128 v[72:75], v0 offset:10240
    v_smfmac_f32_16x16x64_bf16 v[32:35], v[12:15], a[200:207], v7
    v_smfmac_f32_16x16x64_bf16 v[36:39], v[12:15], a[208:215], v7
    ds_read_b128 v[76:79], v0 offset:11264
    ds_read_b128 v[12:15], v2 offset:9216
    s_waitcnt lgkmcnt(4)
    v_smfmac_f32_16x16x64_bf16 v[24:27], v[16:19], a[232:239], v7
    v_lshrrev_b32 v71, 9, v0
    v_smfmac_f32_16x16x64_bf16 v[28:31], v[16:19], a[248:255], v7
    ds_read_b128 v[80:83], v0 offset:12288
    v_smfmac_f32_16x16x64_bf16 v[32:35], v[16:19], a[240:247], v7
    v_lshlrev_b32 v71, 3, v71
    v_smfmac_f32_16x16x64_bf16 v[36:39], v[16:19], v[88:95], v7
    ds_read_b128 v[84:87], v0 offset:13312
    s_waitcnt lgkmcnt(5)
    v_smfmac_f32_16x16x64_bf16 v[24:27], v[20:23], v[112:119], v7
    v_lshrrev_b32 v70, 1, v0
    v_smfmac_f32_16x16x64_bf16 v[28:31], v[20:23], v[128:135], v7
    v_xor_b32 v70, v71, v70
    v_smfmac_f32_16x16x64_bf16 v[32:35], v[20:23], v[120:127], v7
    v_xor_b32 v71, 16, v70
    v_smfmac_f32_16x16x64_bf16 v[36:39], v[20:23], v[136:143], v7
    s_waitcnt lgkmcnt(2)
    v_smfmac_f32_16x16x64_bf16 v[24:27], v[12:15], v[160:167], v7
    v_smfmac_f32_16x16x64_bf16 v[28:31], v[12:15], v[176:183], v7
    v_smfmac_f32_16x16x64_bf16 v[32:35], v[12:15], v[168:175], v7
    v_add_f32 v24, v24, v26
    v_smfmac_f32_16x16x64_bf16 v[36:39], v[12:15], v[184:191], v7
    v_add_f32 v25, v25, v27
    v_add_f32 v28, v28, v30
    v_cvt_pk_bf16_f32 v8, v24, v25
    v_add_f32 v29, v29, v31
    v_add_f32 v32, v32, v34
    v_cvt_pk_bf16_f32 v9, v28, v29
    v_add_f32 v33, v33, v35
    ds_write_b64 v3, v[8:9]
    v_pk_add_f32 v[36:37], v[36:37], v[38:39]
    v_cvt_pk_bf16_f32 v10, v32, v33
    v_cvt_pk_bf16_f32 v11, v36, v37
    ds_write_b64 v3, v[10:11] offset:128
    v_smfmac_f32_16x16x64_bf16 v[40:43], v[12:15], v[192:199], v7
    v_smfmac_f32_16x16x64_bf16 v[44:47], v[12:15], v[200:207], v7
    ds_read_b128 v[12:15], v2 offset:6144
    v_smfmac_f32_16x16x64_bf16 v[40:43], v[20:23], v[144:151], v7
    v_smfmac_f32_16x16x64_bf16 v[44:47], v[20:23], v[152:159], v7
    ds_read_b128 v[20:23], v2 offset:5120
    v_smfmac_f32_16x16x64_bf16 v[40:43], v[16:19], v[96:103], v7
    s_waitcnt lgkmcnt(2)
    s_barrier
    ds_read_b64_tr_b16 v[56:57], v70 offset:18432
    ds_read_b64_tr_b16 v[58:59], v71 offset:18944
    v_smfmac_f32_16x16x64_bf16 v[44:47], v[16:19], v[104:111], v7
    ds_read_b64_tr_b16 v[60:61], v70 offset:19456
    ds_read_b64_tr_b16 v[62:63], v71 offset:19968
    s_waitcnt lgkmcnt(5)
    v_smfmac_f32_16x16x64_bf16 v[40:43], v[12:15], a[216:223], v7
    ds_read_b64_tr_b16 v[64:65], v70 offset:20480
    ds_read_b64_tr_b16 v[66:67], v71 offset:20992
    v_smfmac_f32_16x16x64_bf16 v[44:47], v[12:15], a[224:231], v7
    ds_read_b64_tr_b16 v[68:69], v70 offset:21504
    ds_read_b64_tr_b16 v[70:71], v71 offset:22016
    s_waitcnt lgkmcnt(8)
    v_smfmac_f32_16x16x64_bf16 v[40:43], v[20:23], a[176:183], v7
    v_smfmac_f32_16x16x64_bf16 v[44:47], v[20:23], a[184:191], v7
    s_waitcnt lgkmcnt(6)
    v_mfma_f32_16x16x32_bf16 v[28:31], v[72:75], v[56:59], 0
    ds_read_b128 v[72:75], v0 offset:14336
    s_waitcnt lgkmcnt(5)
    v_mfma_f32_16x16x32_bf16 v[28:31], v[76:79], v[60:63], v[28:31]
    ds_read_b128 v[76:79], v0 offset:15360
    s_waitcnt lgkmcnt(4)
    v_mfma_f32_16x16x32_bf16 v[28:31], v[80:83], v[64:67], v[28:31]
    ds_read_b128 v[80:83], v0 offset:16384
    v_add_f32 v40, v40, v42
    s_waitcnt lgkmcnt(3)
    v_mfma_f32_16x16x32_bf16 v[28:31], v[84:87], v[68:71], v[28:31]
    ds_read_b128 v[84:87], v0 offset:17408
    v_add_f32 v44, v44, v46
    v_mfma_f32_16x16x32_bf16 v[24:27], v[56:59], v[56:59], 0
    v_add_f32 v41, v41, v43
    v_add_f32 v45, v45, v47
    v_mfma_f32_16x16x32_bf16 v[24:27], v[60:63], v[60:63], v[24:27]
    v_cvt_pk_bf16_f32 v46, v40, v41
    v_cvt_pk_bf16_f32 v47, v44, v45
    v_mfma_f32_16x16x32_bf16 v[24:27], v[64:67], v[64:67], v[24:27]
    s_cmp_eq_u32 s34, 63
    buffer_store_dwordx4 v[68:71], v0, s[4:7], s40 offen sc1
    s_cbranch_scc1 L_recufin_62
    v_max3_f32 v8, v28, v29, v30
    v_mfma_f32_16x16x32_bf16 v[24:27], v[68:71], v[68:71], v[24:27]
    v_mov_b64 v[12:13], s[70:71]
    v_mov_b64 v[14:15], s[70:71]
    s_waitcnt lgkmcnt(3)
    v_mfma_f32_16x16x32_bf16 v[32:35], v[72:75], v[56:59], 0
    v_add_u32 v10, s49, v0
    v_mov_b64 v[36:37], 0
    s_waitcnt lgkmcnt(2)
    v_mfma_f32_16x16x32_bf16 v[32:35], v[76:79], v[60:63], v[32:35]
    v_max3_f32 v8, v8, v31, v26
    v_mov_b64 v[38:39], 0
    s_waitcnt lgkmcnt(1)
    v_mfma_f32_16x16x32_bf16 v[32:35], v[80:83], v[64:67], v[32:35]
    v_max_f32 v8, v8, v27
    ds_read_b128 v[72:75], v1 offset:8192
    ds_read_b128 v[76:79], v1 offset:9216
    s_waitcnt lgkmcnt(2)
    v_mfma_f32_16x16x32_bf16 v[32:35], v[84:87], v[68:71], v[32:35]
    ds_read_b128 v[80:83], v1 offset:4096
    ds_read_b128 v[84:87], v1 offset:5120
    v_mov_b32 v69, 0
    v_mov_b32 v70, 0
    v_mov_b64 v[40:41], 0
    v_mov_b64 v[42:43], 0
    s_nop 1
    v_max3_f32 v8, v8, v32, v33
    v_max3_f32 v9, v8, v34, v35
    v_max3_f32 v8, v8, v34, v35
    s_nop 1
    v_permlane32_swap_b32 v9, v8
    v_max_f32 v11, v8, v9
    v_max_f32 v8, v8, v9
    s_nop 1
    v_permlane16_swap_b32 v11, v8
    v_max_f32 v8, v8, v11
    v_mul_f32 v8, 0xbe0293ee, v8
    v_pk_fma_f32 v[26:27], v[26:27], s[68:69], v[8:9] op_sel_hi:[1,1,0]
    v_pk_fma_f32 v[28:29], v[28:29], s[68:69], v[8:9] op_sel_hi:[1,1,0]
    v_exp_f32 v26, v26
    v_exp_f32 v27, v27
    v_pk_fma_f32 v[30:31], v[30:31], s[68:69], v[8:9] op_sel_hi:[1,1,0]
    v_exp_f32 v28, v28
    v_pk_fma_f32 v[32:33], v[32:33], s[68:69], v[8:9] op_sel_hi:[1,1,0]
    v_exp_f32 v29, v29
    v_cvt_pk_bf16_f32 v68, v26, v27
    v_pk_fma_f32 v[34:35], v[34:35], s[68:69], v[8:9] op_sel_hi:[1,1,0]
    v_cvt_pk_bf16_f32 v71, v26, v27
    v_exp_f32 v30, v30
    v_mfma_f32_16x16x16_bf16 v[16:19], v[12:13], v[68:69], 0
    v_exp_f32 v31, v31
    v_cvt_pk_bf16_f32 v64, v28, v29
    v_mfma_f32_16x16x16_bf16 v[56:59], v[46:47], v[68:69], 0
    v_exp_f32 v32, v32
    v_exp_f32 v33, v33
    v_mfma_f32_16x16x16_bf16 v[60:63], v[46:47], v[70:71], 0
    v_cvt_pk_bf16_f32 v65, v30, v31
    v_exp_f32 v34, v34
    v_exp_f32 v35, v35
    v_cvt_pk_bf16_f32 v66, v32, v33
    s_waitcnt vmcnt(1)
    v_cvt_pk_bf16_f32 v67, v34, v35
    v_mov_b64 v[24:25], 0
    s_nop 0
    v_mfma_f32_16x16x32_bf16 v[16:19], v[12:15], v[64:67], v[16:19]
    v_mov_b64 v[26:27], 0
    v_mov_b64 v[28:29], 0
    v_mfma_f32_16x16x32_bf16 v[56:59], v[48:51], v[64:67], v[56:59]
    v_mov_b64 v[30:31], 0
    v_mov_b64 v[32:33], 0
    v_mfma_f32_16x16x32_bf16 v[60:63], v[52:55], v[64:67], v[60:63]
    v_mov_b64 v[34:35], 0
    v_rcp_f32 v8, v16
    s_nop 1
    v_pk_mul_f32 v[56:57], v[56:57], v[8:9] op_sel_hi:[1,0]
    v_pk_mul_f32 v[58:59], v[58:59], v[8:9] op_sel_hi:[1,0]
    v_cvt_pk_bf16_f32 v20, v56, v57
    v_cvt_pk_bf16_f32 v21, v58, v59
    v_pk_mul_f32 v[60:61], v[60:61], v[8:9] op_sel_hi:[1,0]
    v_pk_mul_f32 v[62:63], v[62:63], v[8:9] op_sel_hi:[1,0]
    v_cvt_pk_bf16_f32 v22, v60, v61
    v_cvt_pk_bf16_f32 v23, v62, v63
    s_mov_b64 exec, s[64:65]
    ds_write_b128 v10, v[20:23]
    s_mov_b64 exec, -1
    ds_read_b128 v[56:59], v1 offset:6144
    ds_read_b128 v[60:63], v1 offset:7168
    ds_read_b128 v[64:67], v1 offset:10240
    ds_read_b128 v[68:71], v1 offset:11264
    s_waitcnt lgkmcnt(4)
    s_barrier
    ds_read_b128 v[12:15], v0 offset:22528
    ds_read_b128 v[16:19], v0 offset:23552
    s_mov_b32 m0, s51
    s_nop 0
    buffer_load_dwordx4 v0, s[4:7], s39 offen lds
    buffer_load_dwordx4 v0, s[4:7], s39 offen offset:1024 lds
    s_waitcnt lgkmcnt(1)
    v_smfmac_f32_16x16x64_bf16 v[40:43], v[12:15], v[72:79], v7
    s_waitcnt lgkmcnt(0)
    v_smfmac_f32_16x16x64_bf16 v[40:43], v[16:19], v[64:71], v7
    v_smfmac_f32_16x16x64_bf16 v[24:27], v[12:15], v[208:215], v7
    v_smfmac_f32_16x16x64_bf16 v[24:27], v[16:19], v[240:247], v7
    v_add_f32 v40, v40, v42
    v_smfmac_f32_16x16x64_bf16 v[28:31], v[12:15], v[216:223], v7
    v_add_f32 v41, v41, v43
    v_smfmac_f32_16x16x64_bf16 v[28:31], v[16:19], v[248:255], v7
    v_cvt_pk_bf16_f32 v20, v40, v41
    v_smfmac_f32_16x16x64_bf16 v[32:35], v[12:15], v[224:231], v7
    v_bfi_b32 v20, 1, s19, v20
    v_smfmac_f32_16x16x64_bf16 v[32:35], v[16:19], v[80:87], v7
    buffer_store_dword v20, v6, s[4:7], s35 offen
    v_add_f32 v24, v24, v26
    v_smfmac_f32_16x16x64_bf16 v[36:39], v[12:15], v[232:239], v7
    v_add_f32 v25, v25, v27
    v_smfmac_f32_16x16x64_bf16 v[36:39], v[16:19], v[56:63], v7
    v_add_f32 v28, v28, v30
    v_add_f32 v29, v29, v31
    v_cvt_pk_bf16_f32 v8, v24, v25
    v_add_f32 v32, v32, v34
    v_cvt_pk_bf16_f32 v9, v28, v29
    v_add_f32 v33, v33, v35
    v_bfi_b32 v8, 1, s19, v8
    v_cvt_pk_bf16_f32 v10, v32, v33
    v_pk_add_f32 v[36:37], v[36:37], v[38:39]
    v_cvt_pk_bf16_f32 v11, v36, v37
    buffer_store_dwordx4 v[8:11], v5, s[4:7], s35 offen
    s_add_u32 s39, s39, 262144
    s_add_u32 s47, s47, 262144
    s_xor_b32 s35, s35, 262144
    s_add_u32 s40, s40, 131072
    v_mov_b64 v[24:25], 0
    v_mov_b64 v[26:27], 0
    v_mov_b64 v[28:29], 0
    v_mov_b64 v[30:31], 0
    v_mov_b64 v[32:33], 0
    v_mov_b64 v[34:35], 0
    v_mov_b64 v[36:37], 0
    v_mov_b64 v[38:39], 0
    v_mov_b64 v[40:41], 0
    v_mov_b64 v[42:43], 0
    v_mov_b64 v[44:45], 0
    v_mov_b64 v[46:47], 0
    ds_read_b128 v[56:59], v1 offset:12288
    ds_read_b128 v[60:63], v1 offset:13312
    ds_read_b128 v[64:67], v1 offset:14336
    ds_read_b128 v[68:71], v1 offset:15360
    ds_read_b128 v[72:75], v1 offset:16384
    ds_read_b128 v[76:79], v1 offset:17408
    ds_read_b128 v[80:83], v1 offset:18432
    ds_read_b128 v[84:87], v1 offset:19456
    s_mov_b32 m0, s66
    s_add_u32 s34, s34, 1
    s_bfe_u32 s19, s34, 0x10001
    s_mov_b32 s50, 3200000
    s_mov_b32 s30, s37
    s_add_u32 s37, s37, 8192
    s_andn2_b32 s37, s37, 0x8000
    s_waitcnt lgkmcnt(0)
    s_barrier
    s_nop 15
    s_nop 15
    s_nop 15
    s_nop 15
    s_nop 15
    buffer_load_dwordx4 v0, s[4:7], s30 offen offset:0 sc1 lds
    buffer_load_dwordx4 v0, s[4:7], s30 offen offset:1024 sc1 lds
    s_nop 15
    s_nop 15
    s_nop 11
    buffer_load_dwordx4 v0, s[4:7], s30 offen offset:0 sc1 lds
    buffer_load_dwordx4 v0, s[4:7], s30 offen offset:1024 sc1 lds
L_recuagl_65:
    s_waitcnt vmcnt(2)
    ds_read2st64_b32 v[8:9], v4 offset0:12 offset1:16
    buffer_load_dwordx4 v0, s[4:7], s30 offen offset:0 sc1 lds
    buffer_load_dwordx4 v0, s[4:7], s30 offen offset:1024 sc1 lds
    s_waitcnt lgkmcnt(0)
    v_max_u32 v8, v8, v9
    v_cmp_eq_u32 vcc, -1, v8
    s_cbranch_vccz L_recucl_61
    s_waitcnt vmcnt(2)
    ds_read2st64_b32 v[8:9], v4 offset0:12 offset1:16
    buffer_load_dwordx4 v0, s[4:7], s30 offen offset:0 sc1 lds
    buffer_load_dwordx4 v0, s[4:7], s30 offen offset:1024 sc1 lds
    s_waitcnt lgkmcnt(0)
    v_max_u32 v8, v8, v9
    v_cmp_eq_u32 vcc, -1, v8
    s_cbranch_vccz L_recucl_61
    s_sub_u32 s50, s50, 1
    s_cbranch_scc0 L_recuagl_65
    s_branch L_exit_recurrent_scan__memory_aug_recurrent_mem_tr__moe_arch_mod__prompt_kernel
    s_branch L_recucl_61
L_recufin_62:
    s_waitcnt lgkmcnt(0)
    s_nop 7
    s_waitcnt vmcnt(0)
    v_mov_b32 v9, 64
    buffer_store_dword v9, off, s[4:7], s41 sc1
    s_waitcnt vmcnt(0)
    s_branch L_exit_recurrent_scan__memory_aug_recurrent_mem_tr__moe_arch_mod__prompt_kernel
L_recub_26:
L_recucl_66:
    s_barrier
    ds_read_b128 v[12:15], v2 offset:0
    ds_read_b128 v[16:19], v2 offset:1024
    ds_read_b128 v[20:23], v2 offset:2048
    s_mov_b64 exec, s[8:9]
    buffer_load_dwordx4 v0, s[4:7], s30 offen offset:0 sc1 lds
    buffer_load_dwordx4 v0, s[4:7], s30 offen offset:1024 sc1 lds
    buffer_load_dwordx4 v0, s[4:7], s30 offen offset:2048 sc1 lds
    s_mov_b64 exec, -1
    s_waitcnt lgkmcnt(2)
    v_smfmac_f32_16x16x64_bf16 v[24:27], v[12:15], a[0:7], v7
    v_mov_b32 v8, s34
    v_smfmac_f32_16x16x64_bf16 v[28:31], v[12:15], v[56:63], v7
    ds_read_b128 v[56:59], v1 offset:20480
    v_smfmac_f32_16x16x64_bf16 v[32:35], v[12:15], a[8:15], v7
    ds_read_b128 v[60:63], v1 offset:21504
    v_smfmac_f32_16x16x64_bf16 v[36:39], v[12:15], v[64:71], v7
    ds_read_b128 v[64:67], v1 offset:22528
    v_smfmac_f32_16x16x64_bf16 v[40:43], v[12:15], a[16:23], v7
    ds_read_b128 v[68:71], v1 offset:23552
    v_smfmac_f32_16x16x64_bf16 v[44:47], v[12:15], a[24:31], v7
    buffer_load_dwordx4 v[48:51], v0, s[4:7], s47 offen offset:0
    ds_read_b128 v[12:15], v2 offset:3072
    s_waitcnt lgkmcnt(6)
    v_smfmac_f32_16x16x64_bf16 v[24:27], v[16:19], a[32:39], v7
    buffer_load_dwordx4 v[52:55], v0, s[4:7], s47 offen offset:1024
    v_smfmac_f32_16x16x64_bf16 v[28:31], v[16:19], v[72:79], v7
    ds_read_b128 v[72:75], v1 offset:24576
    v_smfmac_f32_16x16x64_bf16 v[32:35], v[16:19], a[40:47], v7
    ds_read_b128 v[76:79], v1 offset:25600
    buffer_store_dword v8, off, s[4:7], s41 sc1
    v_smfmac_f32_16x16x64_bf16 v[36:39], v[16:19], v[80:87], v7
    ds_read_b128 v[80:83], v1 offset:26624
    v_smfmac_f32_16x16x64_bf16 v[40:43], v[16:19], a[48:55], v7
    ds_read_b128 v[84:87], v1 offset:27648
    v_smfmac_f32_16x16x64_bf16 v[44:47], v[16:19], a[56:63], v7
    ds_read_b128 v[16:19], v2 offset:4096
    s_waitcnt lgkmcnt(10)
    v_smfmac_f32_16x16x64_bf16 v[24:27], v[20:23], a[64:71], v7
    s_waitcnt lgkmcnt(8)
    v_smfmac_f32_16x16x64_bf16 v[28:31], v[20:23], v[56:63], v7
    ds_read_b128 v[56:59], v1 offset:28672
    v_smfmac_f32_16x16x64_bf16 v[32:35], v[20:23], a[72:79], v7
    ds_read_b128 v[60:63], v1 offset:29696
    s_waitcnt lgkmcnt(8)
    v_smfmac_f32_16x16x64_bf16 v[36:39], v[20:23], v[64:71], v7
    ds_read_b128 v[64:67], v1 offset:30720
    v_smfmac_f32_16x16x64_bf16 v[40:43], v[20:23], a[80:87], v7
    ds_read_b128 v[68:71], v1 offset:31744
    v_smfmac_f32_16x16x64_bf16 v[44:47], v[20:23], a[88:95], v7
    s_waitcnt lgkmcnt(9)
    v_smfmac_f32_16x16x64_bf16 v[24:27], v[12:15], a[96:103], v7
    s_waitcnt lgkmcnt(7)
    v_smfmac_f32_16x16x64_bf16 v[28:31], v[12:15], v[72:79], v7
    ds_read_b128 v[72:75], v1 offset:0
    v_smfmac_f32_16x16x64_bf16 v[32:35], v[12:15], a[104:111], v7
    ds_read_b128 v[76:79], v1 offset:1024
    s_waitcnt lgkmcnt(7)
    v_smfmac_f32_16x16x64_bf16 v[36:39], v[12:15], v[80:87], v7
    ds_read_b128 v[80:83], v1 offset:2048
    s_waitcnt vmcnt(3)
    ds_read2st64_b32 v[8:9], v4 offset0:20 offset1:24
    ds_read_b32 v10, v4 offset:7168
    s_waitcnt lgkmcnt(9)
    v_smfmac_f32_16x16x64_bf16 v[24:27], v[16:19], a[128:135], v7
    ds_read_b128 v[84:87], v1 offset:3072
    s_waitcnt lgkmcnt(8)
    v_smfmac_f32_16x16x64_bf16 v[28:31], v[16:19], v[56:63], v7
    ds_read_b128 v[56:59], v1 offset:32768
    v_smfmac_f32_16x16x64_bf16 v[32:35], v[16:19], a[136:143], v7
    ds_read_b128 v[60:63], v1 offset:33792
    s_waitcnt lgkmcnt(3)
    v_max3_u32 v8, v8, v9, v10
    v_smfmac_f32_16x16x64_bf16 v[36:39], v[16:19], v[64:71], v7
    v_cmp_eq_u32 vcc, -1, v8
    s_cbranch_vccnz L_recurt_68
L_recurb_69:
    s_barrier
    ds_read_b128 v[20:23], v2 offset:5120
    v_smfmac_f32_16x16x64_bf16 v[40:43], v[12:15], a[112:119], v7
    v_smfmac_f32_16x16x64_bf16 v[44:47], v[12:15], a[120:127], v7
    ds_read_b128 v[12:15], v2 offset:6144
    v_smfmac_f32_16x16x64_bf16 v[40:43], v[16:19], a[144:151], v7
    v_smfmac_f32_16x16x64_bf16 v[44:47], v[16:19], a[152:159], v7
    ds_read_b128 v[16:19], v2 offset:7168
    s_waitcnt lgkmcnt(2)
    v_smfmac_f32_16x16x64_bf16 v[24:27], v[20:23], a[160:167], v7
    v_smfmac_f32_16x16x64_bf16 v[28:31], v[20:23], v[72:79], v7
    v_smfmac_f32_16x16x64_bf16 v[32:35], v[20:23], a[168:175], v7
    v_smfmac_f32_16x16x64_bf16 v[36:39], v[20:23], v[80:87], v7
    ds_read_b128 v[20:23], v2 offset:8192
    s_waitcnt lgkmcnt(2)
    v_smfmac_f32_16x16x64_bf16 v[24:27], v[12:15], a[192:199], v7
    v_smfmac_f32_16x16x64_bf16 v[28:31], v[12:15], v[56:63], v7
    ds_read_b128 v[72:75], v0 offset:10240
    v_smfmac_f32_16x16x64_bf16 v[32:35], v[12:15], a[200:207], v7
    v_lshlrev_b32 v4, 3, v0
    v_smfmac_f32_16x16x64_bf16 v[36:39], v[12:15], a[208:215], v7
    buffer_load_dword v4, v4, s[4:7], s67 offen
    ds_read_b128 v[76:79], v0 offset:11264
    ds_read_b128 v[12:15], v2 offset:9216
    s_waitcnt lgkmcnt(4)
    v_smfmac_f32_16x16x64_bf16 v[24:27], v[16:19], a[232:239], v7
    v_lshrrev_b32 v71, 9, v0
    v_smfmac_f32_16x16x64_bf16 v[28:31], v[16:19], a[248:255], v7
    ds_read_b128 v[80:83], v0 offset:12288
    v_smfmac_f32_16x16x64_bf16 v[32:35], v[16:19], a[240:247], v7
    v_lshlrev_b32 v71, 3, v71
    v_smfmac_f32_16x16x64_bf16 v[36:39], v[16:19], v[88:95], v7
    ds_read_b128 v[84:87], v0 offset:13312
    s_waitcnt lgkmcnt(5)
    v_smfmac_f32_16x16x64_bf16 v[24:27], v[20:23], v[112:119], v7
    v_lshrrev_b32 v70, 1, v0
    v_smfmac_f32_16x16x64_bf16 v[28:31], v[20:23], v[128:135], v7
    v_xor_b32 v70, v71, v70
    v_smfmac_f32_16x16x64_bf16 v[32:35], v[20:23], v[120:127], v7
    v_xor_b32 v71, 16, v70
    v_smfmac_f32_16x16x64_bf16 v[36:39], v[20:23], v[136:143], v7
    s_waitcnt lgkmcnt(2)
    v_smfmac_f32_16x16x64_bf16 v[24:27], v[12:15], v[160:167], v7
    v_smfmac_f32_16x16x64_bf16 v[28:31], v[12:15], v[176:183], v7
    v_smfmac_f32_16x16x64_bf16 v[32:35], v[12:15], v[168:175], v7
    v_add_f32 v24, v24, v26
    v_smfmac_f32_16x16x64_bf16 v[36:39], v[12:15], v[184:191], v7
    v_add_f32 v25, v25, v27
    v_add_f32 v28, v28, v30
    v_cvt_pk_bf16_f32 v8, v24, v25
    v_add_f32 v29, v29, v31
    v_add_f32 v32, v32, v34
    v_cvt_pk_bf16_f32 v9, v28, v29
    v_add_f32 v33, v33, v35
    ds_write_b64 v3, v[8:9]
    v_pk_add_f32 v[36:37], v[36:37], v[38:39]
    v_cvt_pk_bf16_f32 v10, v32, v33
    v_cvt_pk_bf16_f32 v11, v36, v37
    ds_write_b64 v3, v[10:11] offset:128
    v_smfmac_f32_16x16x64_bf16 v[40:43], v[12:15], v[192:199], v7
    v_smfmac_f32_16x16x64_bf16 v[44:47], v[12:15], v[200:207], v7
    ds_read_b128 v[12:15], v2 offset:6144
    v_smfmac_f32_16x16x64_bf16 v[40:43], v[20:23], v[144:151], v7
    v_smfmac_f32_16x16x64_bf16 v[44:47], v[20:23], v[152:159], v7
    ds_read_b128 v[20:23], v2 offset:5120
    v_smfmac_f32_16x16x64_bf16 v[40:43], v[16:19], v[96:103], v7
    s_waitcnt lgkmcnt(2)
    s_barrier
    ds_read_b64_tr_b16 v[56:57], v70 offset:18432
    ds_read_b64_tr_b16 v[58:59], v71 offset:18944
    v_smfmac_f32_16x16x64_bf16 v[44:47], v[16:19], v[104:111], v7
    ds_read_b64_tr_b16 v[60:61], v70 offset:19456
    ds_read_b64_tr_b16 v[62:63], v71 offset:19968
    s_waitcnt lgkmcnt(5)
    v_smfmac_f32_16x16x64_bf16 v[40:43], v[12:15], a[216:223], v7
    ds_read_b64_tr_b16 v[64:65], v70 offset:20480
    ds_read_b64_tr_b16 v[66:67], v71 offset:20992
    v_smfmac_f32_16x16x64_bf16 v[44:47], v[12:15], a[224:231], v7
    ds_read_b64_tr_b16 v[68:69], v70 offset:21504
    ds_read_b64_tr_b16 v[70:71], v71 offset:22016
    s_waitcnt lgkmcnt(8)
    v_smfmac_f32_16x16x64_bf16 v[40:43], v[20:23], a[176:183], v7
    v_smfmac_f32_16x16x64_bf16 v[44:47], v[20:23], a[184:191], v7
    s_waitcnt lgkmcnt(6)
    v_mfma_f32_16x16x32_bf16 v[28:31], v[72:75], v[56:59], 0
    ds_read_b128 v[72:75], v0 offset:14336
    s_waitcnt lgkmcnt(5)
    v_mfma_f32_16x16x32_bf16 v[28:31], v[76:79], v[60:63], v[28:31]
    ds_read_b128 v[76:79], v0 offset:15360
    s_waitcnt lgkmcnt(4)
    v_mfma_f32_16x16x32_bf16 v[28:31], v[80:83], v[64:67], v[28:31]
    ds_read_b128 v[80:83], v0 offset:16384
    v_add_f32 v40, v40, v42
    s_waitcnt lgkmcnt(3)
    v_mfma_f32_16x16x32_bf16 v[28:31], v[84:87], v[68:71], v[28:31]
    ds_read_b128 v[84:87], v0 offset:17408
    v_add_f32 v44, v44, v46
    v_mfma_f32_16x16x32_bf16 v[24:27], v[56:59], v[56:59], 0
    v_add_f32 v41, v41, v43
    v_add_f32 v45, v45, v47
    v_mfma_f32_16x16x32_bf16 v[24:27], v[60:63], v[60:63], v[24:27]
    v_cvt_pk_bf16_f32 v46, v40, v41
    v_cvt_pk_bf16_f32 v47, v44, v45
    v_mfma_f32_16x16x32_bf16 v[24:27], v[64:67], v[64:67], v[24:27]
    v_lshrrev_b32 v11, 1, v0
    s_cmp_eq_u32 s34, 63
    buffer_store_dwordx2 v[46:47], v11, s[4:7], s40 offen sc1
    s_cbranch_scc1 L_recufin_67
    v_max3_f32 v8, v28, v29, v30
    v_mfma_f32_16x16x32_bf16 v[24:27], v[68:71], v[68:71], v[24:27]
    v_mov_b64 v[12:13], s[70:71]
    v_mov_b64 v[14:15], s[70:71]
    s_waitcnt lgkmcnt(3)
    v_mfma_f32_16x16x32_bf16 v[32:35], v[72:75], v[56:59], 0
    v_add_u32 v10, s49, v0
    v_mov_b64 v[36:37], 0
    s_waitcnt lgkmcnt(2)
    v_mfma_f32_16x16x32_bf16 v[32:35], v[76:79], v[60:63], v[32:35]
    v_max3_f32 v8, v8, v31, v26
    v_mov_b64 v[38:39], 0
    s_waitcnt lgkmcnt(1)
    v_mfma_f32_16x16x32_bf16 v[32:35], v[80:83], v[64:67], v[32:35]
    v_max_f32 v8, v8, v27
    ds_read_b128 v[72:75], v1 offset:8192
    ds_read_b128 v[76:79], v1 offset:9216
    s_waitcnt lgkmcnt(2)
    v_mfma_f32_16x16x32_bf16 v[32:35], v[84:87], v[68:71], v[32:35]
    ds_read_b128 v[80:83], v1 offset:4096
    ds_read_b128 v[84:87], v1 offset:5120
    v_mov_b32 v69, 0
    v_mov_b32 v70, 0
    v_mov_b64 v[40:41], 0
    v_mov_b64 v[42:43], 0
    s_nop 1
    v_max3_f32 v8, v8, v32, v33
    v_max3_f32 v9, v8, v34, v35
    v_max3_f32 v8, v8, v34, v35
    s_nop 1
    v_permlane32_swap_b32 v9, v8
    v_max_f32 v11, v8, v9
    v_max_f32 v8, v8, v9
    s_nop 1
    v_permlane16_swap_b32 v11, v8
    v_max_f32 v8, v8, v11
    v_mul_f32 v8, 0xbe0293ee, v8
    v_pk_fma_f32 v[26:27], v[26:27], s[68:69], v[8:9] op_sel_hi:[1,1,0]
    v_pk_fma_f32 v[28:29], v[28:29], s[68:69], v[8:9] op_sel_hi:[1,1,0]
    v_exp_f32 v26, v26
    v_exp_f32 v27, v27
    v_pk_fma_f32 v[30:31], v[30:31], s[68:69], v[8:9] op_sel_hi:[1,1,0]
    v_exp_f32 v28, v28
    v_pk_fma_f32 v[32:33], v[32:33], s[68:69], v[8:9] op_sel_hi:[1,1,0]
    v_exp_f32 v29, v29
    v_cvt_pk_bf16_f32 v68, v26, v27
    v_pk_fma_f32 v[34:35], v[34:35], s[68:69], v[8:9] op_sel_hi:[1,1,0]
    v_cvt_pk_bf16_f32 v71, v26, v27
    v_exp_f32 v30, v30
    v_mfma_f32_16x16x16_bf16 v[16:19], v[12:13], v[68:69], 0
    v_exp_f32 v31, v31
    v_cvt_pk_bf16_f32 v64, v28, v29
    v_mfma_f32_16x16x16_bf16 v[56:59], v[46:47], v[68:69], 0
    v_exp_f32 v32, v32
    v_exp_f32 v33, v33
    v_mfma_f32_16x16x16_bf16 v[60:63], v[46:47], v[70:71], 0
    v_cvt_pk_bf16_f32 v65, v30, v31
    v_exp_f32 v34, v34
    v_exp_f32 v35, v35
    v_cvt_pk_bf16_f32 v66, v32, v33
    s_waitcnt vmcnt(2)
    v_cvt_pk_bf16_f32 v67, v34, v35
    v_mov_b64 v[24:25], 0
    s_nop 0
    v_mfma_f32_16x16x32_bf16 v[16:19], v[12:15], v[64:67], v[16:19]
    v_mov_b64 v[26:27], 0
    v_mov_b64 v[28:29], 0
    v_mfma_f32_16x16x32_bf16 v[56:59], v[48:51], v[64:67], v[56:59]
    v_mov_b64 v[30:31], 0
    v_mov_b64 v[32:33], 0
    v_mfma_f32_16x16x32_bf16 v[60:63], v[52:55], v[64:67], v[60:63]
    v_mov_b64 v[34:35], 0
    v_rcp_f32 v8, v16
    s_nop 1
    v_pk_mul_f32 v[56:57], v[56:57], v[8:9] op_sel_hi:[1,0]
    v_pk_mul_f32 v[58:59], v[58:59], v[8:9] op_sel_hi:[1,0]
    v_cvt_pk_bf16_f32 v20, v56, v57
    v_cvt_pk_bf16_f32 v21, v58, v59
    v_pk_mul_f32 v[60:61], v[60:61], v[8:9] op_sel_hi:[1,0]
    v_pk_mul_f32 v[62:63], v[62:63], v[8:9] op_sel_hi:[1,0]
    v_cvt_pk_bf16_f32 v22, v60, v61
    v_cvt_pk_bf16_f32 v23, v62, v63
    s_mov_b64 exec, s[64:65]
    ds_write_b128 v10, v[20:23]
    s_mov_b64 exec, -1
    ds_read_b128 v[56:59], v1 offset:6144
    ds_read_b128 v[60:63], v1 offset:7168
    ds_read_b128 v[64:67], v1 offset:10240
    ds_read_b128 v[68:71], v1 offset:11264
    s_waitcnt lgkmcnt(4)
    s_barrier
    ds_read_b128 v[12:15], v0 offset:22528
    ds_read_b128 v[16:19], v0 offset:23552
    s_mov_b32 m0, s51
    s_nop 0
    buffer_load_dwordx4 v0, s[4:7], s39 offen lds
    buffer_load_dwordx4 v0, s[4:7], s39 offen offset:1024 lds
    s_waitcnt lgkmcnt(1)
    v_smfmac_f32_16x16x64_bf16 v[40:43], v[12:15], v[72:79], v7
    s_waitcnt lgkmcnt(0)
    v_smfmac_f32_16x16x64_bf16 v[40:43], v[16:19], v[64:71], v7
    v_smfmac_f32_16x16x64_bf16 v[24:27], v[12:15], v[208:215], v7
    v_smfmac_f32_16x16x64_bf16 v[24:27], v[16:19], v[240:247], v7
    v_add_f32 v40, v40, v42
    v_smfmac_f32_16x16x64_bf16 v[28:31], v[12:15], v[216:223], v7
    v_add_f32 v41, v41, v43
    v_smfmac_f32_16x16x64_bf16 v[28:31], v[16:19], v[248:255], v7
    v_cvt_pk_bf16_f32 v20, v40, v41
    v_smfmac_f32_16x16x64_bf16 v[32:35], v[12:15], v[224:231], v7
    v_bfi_b32 v20, 1, s19, v20
    v_smfmac_f32_16x16x64_bf16 v[32:35], v[16:19], v[80:87], v7
    buffer_store_dword v20, v6, s[4:7], s35 offen
    v_add_f32 v24, v24, v26
    v_smfmac_f32_16x16x64_bf16 v[36:39], v[12:15], v[232:239], v7
    v_add_f32 v25, v25, v27
    v_smfmac_f32_16x16x64_bf16 v[36:39], v[16:19], v[56:63], v7
    v_add_f32 v28, v28, v30
    v_add_f32 v29, v29, v31
    v_cvt_pk_bf16_f32 v8, v24, v25
    v_add_f32 v32, v32, v34
    v_cvt_pk_bf16_f32 v9, v28, v29
    v_add_f32 v33, v33, v35
    v_bfi_b32 v8, 1, s19, v8
    v_cvt_pk_bf16_f32 v10, v32, v33
    v_pk_add_f32 v[36:37], v[36:37], v[38:39]
    v_cvt_pk_bf16_f32 v11, v36, v37
    buffer_store_dwordx4 v[8:11], v5, s[4:7], s35 offen
    s_add_u32 s39, s39, 262144
    s_add_u32 s47, s47, 262144
    s_xor_b32 s35, s35, 262144
    s_add_u32 s40, s40, 65536
    s_cmp_eq_u32 s42, 0
    s_cbranch_scc1 L_recunred_70
    v_bfe_u32 v8, v0, 4, 1
    v_lshlrev_b32 v21, 4, v8
    v_mov_b32 v10, 0x3f80
    v_lshlrev_b32 v10, v21, v10
    v_bfe_u32 v11, v0, 5, 3
    v_cmp_eq_u32 s[52:53], 0, v11
    v_cmp_eq_u32 s[54:55], 1, v11
    v_cmp_eq_u32 s[56:57], 2, v11
    v_cmp_eq_u32 s[58:59], 3, v11
    v_cndmask_b32 v12, 0, v10, s[52:53]
    v_cndmask_b32 v13, 0, v10, s[54:55]
    v_cndmask_b32 v14, 0, v10, s[56:57]
    v_cndmask_b32 v15, 0, v10, s[58:59]
    v_and_b32 v11, 3, v11
    v_lshl_add_u32 v21, v11, 2, v21
    v_bfe_u32 v11, v0, 8, 1
    v_lshl_add_u32 v21, v11, 6, v21
    v_lshrrev_b32 v11, 9, v0
    v_lshl_add_u32 v21, v11, 5, v21
    v_mov_b64 v[24:25], 0
    v_mov_b64 v[26:27], 0
    v_mov_b64 v[28:29], 0
    v_mov_b64 v[30:31], 0
    v_mov_b64 v[32:33], 0
    v_mov_b64 v[34:35], 0
    v_mov_b64 v[36:37], 0
    v_mov_b64 v[38:39], 0
    v_mov_b64 v[40:41], 0
    v_mov_b64 v[42:43], 0
    v_mov_b64 v[44:45], 0
    v_mov_b64 v[46:47], 0
    s_mov_b32 s50, 3200000
    s_nop 15
    s_nop 15
    s_nop 11
    buffer_load_dwordx4 v[56:59], v0, s[4:7], s36 offen offset:0 sc1
    buffer_load_dwordx4 v[60:63], v0, s[4:7], s36 offen offset:1024 sc1
    buffer_load_dwordx4 v[64:67], v0, s[4:7], s36 offen offset:2048 sc1
    buffer_load_dwordx4 v[68:71], v0, s[4:7], s36 offen offset:3072 sc1
    s_nop 15
    s_nop 3
    buffer_load_dwordx4 v[56:59], v0, s[4:7], s36 offen offset:0 sc1
    buffer_load_dwordx4 v[60:63], v0, s[4:7], s36 offen offset:1024 sc1
    buffer_load_dwordx4 v[64:67], v0, s[4:7], s36 offen offset:2048 sc1
    buffer_load_dwordx4 v[68:71], v0, s[4:7], s36 offen offset:3072 sc1
L_recursl_73:
    s_waitcnt vmcnt(7)
    v_xor_b32 v8, s19, v56
    v_mfma_f32_16x16x32_bf16 v[16:19], v[56:59], v[12:15], 0
    buffer_load_dwordx4 v[56:59], v0, s[4:7], s36 offen offset:0 sc1
    s_waitcnt vmcnt(7)
    v_bitop3_b32 v8, v8, v60, s19 bitop3:0xf6
    v_mfma_f32_16x16x32_bf16 v[16:19], v[60:63], v[12:15], v[16:19]
    buffer_load_dwordx4 v[60:63], v0, s[4:7], s36 offen offset:1024 sc1
    s_waitcnt vmcnt(7)
    v_bitop3_b32 v8, v8, v64, s19 bitop3:0xf6
    v_mfma_f32_16x16x32_bf16 v[16:19], v[64:67], v[12:15], v[16:19]
    buffer_load_dwordx4 v[64:67], v0, s[4:7], s36 offen offset:2048 sc1
    s_waitcnt vmcnt(7)
    v_bitop3_b32 v8, v8, v68, s19 bitop3:0xf6
    v_mfma_f32_16x16x32_bf16 v[16:19], v[68:71], v[12:15], v[16:19]
    buffer_load_dwordx4 v[68:71], v0, s[4:7], s36 offen offset:3072 sc1
    v_and_b32 v8, 1, v8
    v_cmp_ne_u32 vcc, 0, v8
    s_cbranch_vccz L_recursok_72
    s_waitcnt vmcnt(7)
    v_xor_b32 v8, s19, v56
    v_mfma_f32_16x16x32_bf16 v[16:19], v[56:59], v[12:15], 0
    buffer_load_dwordx4 v[56:59], v0, s[4:7], s36 offen offset:0 sc1
    s_waitcnt vmcnt(7)
    v_bitop3_b32 v8, v8, v60, s19 bitop3:0xf6
    v_mfma_f32_16x16x32_bf16 v[16:19], v[60:63], v[12:15], v[16:19]
    buffer_load_dwordx4 v[60:63], v0, s[4:7], s36 offen offset:1024 sc1
    s_waitcnt vmcnt(7)
    v_bitop3_b32 v8, v8, v64, s19 bitop3:0xf6
    v_mfma_f32_16x16x32_bf16 v[16:19], v[64:67], v[12:15], v[16:19]
    buffer_load_dwordx4 v[64:67], v0, s[4:7], s36 offen offset:2048 sc1
    s_waitcnt vmcnt(7)
    v_bitop3_b32 v8, v8, v68, s19 bitop3:0xf6
    v_mfma_f32_16x16x32_bf16 v[16:19], v[68:71], v[12:15], v[16:19]
    buffer_load_dwordx4 v[68:71], v0, s[4:7], s36 offen offset:3072 sc1
    v_and_b32 v8, 1, v8
    v_cmp_ne_u32 vcc, 0, v8
    s_cbranch_vccz L_recursok_72
    s_sub_u32 s50, s50, 1
    s_cbranch_scc0 L_recursl_73
    s_branch L_exit_recurrent_scan__memory_aug_recurrent_mem_tr__moe_arch_mod__prompt_kernel
L_recursok_72:
    s_nop 1
    v_permlane32_swap_b32 v16, v18
    v_permlane32_swap_b32 v17, v19
    v_pk_add_f32 v[16:17], v[16:17], v[18:19]
    v_cvt_pk_bf16_f32 v16, v16, v17
    s_mov_b64 exec, s[74:75]
    buffer_store_dword v16, v21, s[4:7], s48 offen sc1
    buffer_store_dword v16, v21, s[4:7], s37 offen
    s_mov_b64 exec, -1
    s_barrier
    v_mov_b64 v[8:9], -1
    v_mov_b64 v[10:11], -1
    s_mov_b64 exec, 0xff
    buffer_store_dwordx4 v[8:11], v0, s[4:7], s45 offen
    s_mov_b64 exec, -1
    s_xor_b32 s36, s36, 262144
    s_mov_b32 s45, s37
    s_add_u32 s37, s37, 8192
    s_andn2_b32 s37, s37, 0x8000
    s_add_u32 s48, s48, 10240
    s_waitcnt vmcnt(3)
    s_branch L_recun2_71
L_recunred_70:
    v_mov_b64 v[24:25], 0
    v_mov_b64 v[26:27], 0
    v_mov_b64 v[28:29], 0
    v_mov_b64 v[30:31], 0
    v_mov_b64 v[32:33], 0
    v_mov_b64 v[34:35], 0
    v_mov_b64 v[36:37], 0
    v_mov_b64 v[38:39], 0
    v_mov_b64 v[40:41], 0
    v_mov_b64 v[42:43], 0
    v_mov_b64 v[44:45], 0
    v_mov_b64 v[46:47], 0
    s_barrier
    s_waitcnt vmcnt(0)
L_recun2_71:
    v_bfe_u32 v4, v0, 7, 2
    v_lshl_add_u32 v4, v4, 2, v0
    s_add_u32 s34, s34, 1
    ds_read_b128 v[56:59], v1 offset:12288
    ds_read_b128 v[60:63], v1 offset:13312
    ds_read_b128 v[64:67], v1 offset:14336
    ds_read_b128 v[68:71], v1 offset:15360
    ds_read_b128 v[72:75], v1 offset:16384
    ds_read_b128 v[76:79], v1 offset:17408
    ds_read_b128 v[80:83], v1 offset:18432
    ds_read_b128 v[84:87], v1 offset:19456
    s_add_u32 s26, s34, 1
    s_min_u32 s26, s26, 63
    s_cmp_gt_u32 s44, s26
    s_cbranch_scc1 L_recuf_74
    v_bfe_u32 v8, v0, 6, 1
    v_lshlrev_b32 v8, 13, v8
    v_bfe_u32 v9, v0, 4, 2
    v_lshl_add_u32 v8, v9, 2, v8
    v_bfe_u32 v10, v0, 7, 1
    v_lshl_add_u32 v8, v10, 7, v8
    s_mov_b32 s50, 0
L_recufs_75:
    buffer_load_dword v9, v8, s[4:7], s46 offen sc1
    s_waitcnt vmcnt(0)
    v_lshl_add_u32 v9, v9, 1, v10
    v_cmp_ge_u32 vcc, s26, v9
    s_cbranch_vccz L_recufsok_76
    s_add_u32 s50, s50, 1
    s_cmp_lt_u32 s50, 400000
    s_cbranch_scc0 L_exit_recurrent_scan__memory_aug_recurrent_mem_tr__moe_arch_mod__prompt_kernel
    s_sleep 2
    s_branch L_recufs_75
L_recufsok_76:
    v_min_u32_dpp v9, v9, v9 quad_perm:[1,0,3,2] row_mask:0xf bank_mask:0xf
    s_nop 1
    v_min_u32_dpp v9, v9, v9 quad_perm:[2,3,0,1] row_mask:0xf bank_mask:0xf
    s_nop 1
    v_min_u32_dpp v9, v9, v9 row_half_mirror row_mask:0xf bank_mask:0xf
    s_nop 1
    v_min_u32_dpp v9, v9, v9 row_mirror row_mask:0xf bank_mask:0xf
    s_nop 0
    v_readfirstlane_b32 s44, v9
L_recuf_74:
    s_mov_b32 m0, s66
    s_mov_b32 s30, s38
    s_mov_b64 s[8:9], -1
    s_add_u32 s67, s67, 262144
    s_add_u32 s38, s38, 10240
    s_waitcnt lgkmcnt(0)
    s_bfe_u32 s19, s34, 0x10001
    s_branch L_recucl_66
L_recurt_68:
    s_cmp_eq_u32 s34, 0
    s_cbranch_scc1 L_recurb_69
    s_mov_b32 s50, 0
    s_mov_b32 m0, s66
    ds_read2st64_b32 v[8:9], v4 offset0:20 offset1:24
    ds_read_b32 v10, v4 offset:7168
    s_waitcnt lgkmcnt(0)
    v_cmp_eq_u32 s[52:53], -1, v8
    v_cmp_eq_u32 s[54:55], -1, v9
    v_cmp_eq_u32 s[56:57], -1, v10
    s_or_b64 s[58:59], s[52:53], s[54:55]
    s_or_b64 s[58:59], s[58:59], s[56:57]
    s_cbranch_scc0 L_recurb_69
    s_mov_b64 exec, s[52:53]
    buffer_load_dwordx4 v0, s[4:7], s30 offen offset:0 sc1 lds
    s_mov_b64 exec, s[54:55]
    buffer_load_dwordx4 v0, s[4:7], s30 offen offset:1024 sc1 lds
    s_mov_b64 exec, s[56:57]
    buffer_load_dwordx4 v0, s[4:7], s30 offen offset:2048 sc1 lds
    s_mov_b64 exec, -1
    s_nop 15
    s_nop 15
L_recur2_78:
    s_mov_b64 exec, s[52:53]
    buffer_load_dwordx4 v0, s[4:7], s30 offen offset:0 sc1 lds
    s_mov_b64 exec, s[54:55]
    buffer_load_dwordx4 v0, s[4:7], s30 offen offset:1024 sc1 lds
    s_mov_b64 exec, s[56:57]
    buffer_load_dwordx4 v0, s[4:7], s30 offen offset:2048 sc1 lds
    s_mov_b64 exec, -1
    s_waitcnt vmcnt(3)
    ds_read2st64_b32 v[8:9], v4 offset0:20 offset1:24
    ds_read_b32 v10, v4 offset:7168
    s_waitcnt lgkmcnt(0)
    v_cmp_eq_u32 s[52:53], -1, v8
    v_cmp_eq_u32 s[54:55], -1, v9
    v_cmp_eq_u32 s[56:57], -1, v10
    s_or_b64 s[58:59], s[52:53], s[54:55]
    s_or_b64 s[58:59], s[58:59], s[56:57]
    s_cbranch_scc0 L_recurb_69
    s_add_u32 s50, s50, 1
    s_cmp_lt_u32 s50, 3200000
    s_cbranch_scc0 L_exit_recurrent_scan__memory_aug_recurrent_mem_tr__moe_arch_mod__prompt_kernel
    s_branch L_recur2_78
L_recufin_67:
    s_waitcnt lgkmcnt(0)
    s_nop 7
    s_waitcnt vmcnt(0)
    v_mov_b32 v9, 64
    buffer_store_dword v9, off, s[4:7], s41 sc1
    s_waitcnt vmcnt(0)
    s_branch L_exit_recurrent_scan__memory_aug_recurrent_mem_tr__moe_arch_mod__prompt_kernel
L_recub_27:
L_recucl_79:
    s_barrier
    ds_read_b128 v[12:15], v2 offset:0
    ds_read_b128 v[16:19], v2 offset:1024
    ds_read_b128 v[20:23], v2 offset:2048
    s_mov_b64 exec, s[8:9]
    buffer_load_dwordx4 v0, s[4:7], s30 offen offset:0 sc1 lds
    buffer_load_dwordx4 v0, s[4:7], s30 offen offset:1024 sc1 lds
    s_mov_b64 exec, -1
    s_waitcnt lgkmcnt(2)
    v_smfmac_f32_16x16x64_bf16 v[24:27], v[12:15], a[0:7], v7
    v_mov_b32 v8, s34
    v_smfmac_f32_16x16x64_bf16 v[28:31], v[12:15], v[56:63], v7
    ds_read_b128 v[56:59], v1 offset:20480
    v_smfmac_f32_16x16x64_bf16 v[32:35], v[12:15], a[8:15], v7
    ds_read_b128 v[60:63], v1 offset:21504
    v_smfmac_f32_16x16x64_bf16 v[36:39], v[12:15], v[64:71], v7
    ds_read_b128 v[64:67], v1 offset:22528
    v_smfmac_f32_16x16x64_bf16 v[40:43], v[12:15], a[16:23], v7
    ds_read_b128 v[68:71], v1 offset:23552
    v_smfmac_f32_16x16x64_bf16 v[44:47], v[12:15], a[24:31], v7
    buffer_load_dwordx4 v[48:51], v0, s[4:7], s47 offen offset:0
    ds_read_b128 v[12:15], v2 offset:3072
    s_waitcnt lgkmcnt(6)
    v_smfmac_f32_16x16x64_bf16 v[24:27], v[16:19], a[32:39], v7
    buffer_load_dwordx4 v[52:55], v0, s[4:7], s47 offen offset:1024
    v_smfmac_f32_16x16x64_bf16 v[28:31], v[16:19], v[72:79], v7
    ds_read_b128 v[72:75], v1 offset:24576
    v_smfmac_f32_16x16x64_bf16 v[32:35], v[16:19], a[40:47], v7
    ds_read_b128 v[76:79], v1 offset:25600
    buffer_store_dword v8, off, s[4:7], s41 sc1
    v_smfmac_f32_16x16x64_bf16 v[36:39], v[16:19], v[80:87], v7
    ds_read_b128 v[80:83], v1 offset:26624
    v_smfmac_f32_16x16x64_bf16 v[40:43], v[16:19], a[48:55], v7
    ds_read_b128 v[84:87], v1 offset:27648
    v_smfmac_f32_16x16x64_bf16 v[44:47], v[16:19], a[56:63], v7
    ds_read_b128 v[16:19], v2 offset:4096
    s_waitcnt lgkmcnt(10)
    v_smfmac_f32_16x16x64_bf16 v[24:27], v[20:23], a[64:71], v7
    s_waitcnt lgkmcnt(8)
    v_smfmac_f32_16x16x64_bf16 v[28:31], v[20:23], v[56:63], v7
    ds_read_b128 v[56:59], v1 offset:28672
    v_smfmac_f32_16x16x64_bf16 v[32:35], v[20:23], a[72:79], v7
    ds_read_b128 v[60:63], v1 offset:29696
    s_waitcnt lgkmcnt(8)
    v_smfmac_f32_16x16x64_bf16 v[36:39], v[20:23], v[64:71], v7
    ds_read_b128 v[64:67], v1 offset:30720
    v_smfmac_f32_16x16x64_bf16 v[40:43], v[20:23], a[80:87], v7
    ds_read_b128 v[68:71], v1 offset:31744
    v_smfmac_f32_16x16x64_bf16 v[44:47], v[20:23], a[88:95], v7
    s_waitcnt lgkmcnt(9)
    v_smfmac_f32_16x16x64_bf16 v[24:27], v[12:15], a[96:103], v7
    s_waitcnt lgkmcnt(7)
    v_smfmac_f32_16x16x64_bf16 v[28:31], v[12:15], v[72:79], v7
    ds_read_b128 v[72:75], v1 offset:0
    v_smfmac_f32_16x16x64_bf16 v[32:35], v[12:15], a[104:111], v7
    ds_read_b128 v[76:79], v1 offset:1024
    s_waitcnt lgkmcnt(7)
    v_smfmac_f32_16x16x64_bf16 v[36:39], v[12:15], v[80:87], v7
    ds_read_b128 v[80:83], v1 offset:2048
    s_waitcnt vmcnt(3)
    ds_read2st64_b32 v[8:9], v4 offset0:32 offset1:36
    s_waitcnt lgkmcnt(8)
    v_smfmac_f32_16x16x64_bf16 v[24:27], v[16:19], a[128:135], v7
    ds_read_b128 v[84:87], v1 offset:3072
    s_waitcnt lgkmcnt(7)
    v_smfmac_f32_16x16x64_bf16 v[28:31], v[16:19], v[56:63], v7
    ds_read_b128 v[56:59], v1 offset:32768
    v_smfmac_f32_16x16x64_bf16 v[32:35], v[16:19], a[136:143], v7
    ds_read_b128 v[60:63], v1 offset:33792
    s_waitcnt lgkmcnt(3)
    v_max_u32 v8, v8, v9
    v_smfmac_f32_16x16x64_bf16 v[36:39], v[16:19], v[64:71], v7
    v_cmp_eq_u32 vcc, -1, v8
    s_cbranch_vccnz L_recurt_81
L_recurb_82:
    s_barrier
    ds_read_b128 v[20:23], v2 offset:5120
    v_smfmac_f32_16x16x64_bf16 v[40:43], v[12:15], a[112:119], v7
    v_smfmac_f32_16x16x64_bf16 v[44:47], v[12:15], a[120:127], v7
    ds_read_b128 v[12:15], v2 offset:6144
    v_smfmac_f32_16x16x64_bf16 v[40:43], v[16:19], a[144:151], v7
    v_smfmac_f32_16x16x64_bf16 v[44:47], v[16:19], a[152:159], v7
    ds_read_b128 v[16:19], v2 offset:7168
    s_waitcnt lgkmcnt(2)
    v_smfmac_f32_16x16x64_bf16 v[24:27], v[20:23], a[160:167], v7
    v_smfmac_f32_16x16x64_bf16 v[28:31], v[20:23], v[72:79], v7
    v_smfmac_f32_16x16x64_bf16 v[32:35], v[20:23], a[168:175], v7
    v_smfmac_f32_16x16x64_bf16 v[36:39], v[20:23], v[80:87], v7
    ds_read_b128 v[20:23], v2 offset:8192
    s_waitcnt lgkmcnt(2)
    v_smfmac_f32_16x16x64_bf16 v[24:27], v[12:15], a[192:199], v7
    v_smfmac_f32_16x16x64_bf16 v[28:31], v[12:15], v[56:63], v7
    ds_read_b128 v[72:75], v0 offset:10240
    v_smfmac_f32_16x16x64_bf16 v[32:35], v[12:15], a[200:207], v7
    v_lshlrev_b32 v4, 3, v0
    v_smfmac_f32_16x16x64_bf16 v[36:39], v[12:15], a[208:215], v7
    buffer_load_dword v4, v4, s[4:7], s67 offen
    ds_read_b128 v[76:79], v0 offset:11264
    ds_read_b128 v[12:15], v2 offset:9216
    s_waitcnt lgkmcnt(4)
    v_smfmac_f32_16x16x64_bf16 v[24:27], v[16:19], a[232:239], v7
    v_lshrrev_b32 v71, 9, v0
    v_smfmac_f32_16x16x64_bf16 v[28:31], v[16:19], a[248:255], v7
    ds_read_b128 v[80:83], v0 offset:12288
    v_smfmac_f32_16x16x64_bf16 v[32:35], v[16:19], a[240:247], v7
    v_lshlrev_b32 v71, 3, v71
    v_smfmac_f32_16x16x64_bf16 v[36:39], v[16:19], v[88:95], v7
    ds_read_b128 v[84:87], v0 offset:13312
    s_waitcnt lgkmcnt(5)
    v_smfmac_f32_16x16x64_bf16 v[24:27], v[20:23], v[112:119], v7
    v_lshrrev_b32 v70, 1, v0
    v_smfmac_f32_16x16x64_bf16 v[28:31], v[20:23], v[128:135], v7
    v_xor_b32 v70, v71, v70
    v_smfmac_f32_16x16x64_bf16 v[32:35], v[20:23], v[120:127], v7
    v_xor_b32 v71, 16, v70
    v_smfmac_f32_16x16x64_bf16 v[36:39], v[20:23], v[136:143], v7
    s_waitcnt lgkmcnt(2)
    v_smfmac_f32_16x16x64_bf16 v[24:27], v[12:15], v[160:167], v7
    v_smfmac_f32_16x16x64_bf16 v[28:31], v[12:15], v[176:183], v7
    v_smfmac_f32_16x16x64_bf16 v[32:35], v[12:15], v[168:175], v7
    v_add_f32 v24, v24, v26
    v_smfmac_f32_16x16x64_bf16 v[36:39], v[12:15], v[184:191], v7
    v_add_f32 v25, v25, v27
    v_add_f32 v28, v28, v30
    v_cvt_pk_bf16_f32 v8, v24, v25
    v_add_f32 v29, v29, v31
    v_add_f32 v32, v32, v34
    v_cvt_pk_bf16_f32 v9, v28, v29
    v_add_f32 v33, v33, v35
    ds_write_b64 v3, v[8:9]
    v_pk_add_f32 v[36:37], v[36:37], v[38:39]
    v_cvt_pk_bf16_f32 v10, v32, v33
    v_cvt_pk_bf16_f32 v11, v36, v37
    ds_write_b64 v3, v[10:11] offset:128
    v_smfmac_f32_16x16x64_bf16 v[40:43], v[12:15], v[192:199], v7
    v_smfmac_f32_16x16x64_bf16 v[44:47], v[12:15], v[200:207], v7
    ds_read_b128 v[12:15], v2 offset:6144
    v_smfmac_f32_16x16x64_bf16 v[40:43], v[20:23], v[144:151], v7
    v_smfmac_f32_16x16x64_bf16 v[44:47], v[20:23], v[152:159], v7
    ds_read_b128 v[20:23], v2 offset:5120
    v_smfmac_f32_16x16x64_bf16 v[40:43], v[16:19], v[96:103], v7
    s_waitcnt lgkmcnt(2)
    s_barrier
    ds_read_b64_tr_b16 v[56:57], v70 offset:18432
    ds_read_b64_tr_b16 v[58:59], v71 offset:18944
    v_smfmac_f32_16x16x64_bf16 v[44:47], v[16:19], v[104:111], v7
    ds_read_b64_tr_b16 v[60:61], v70 offset:19456
    ds_read_b64_tr_b16 v[62:63], v71 offset:19968
    s_waitcnt lgkmcnt(5)
    v_smfmac_f32_16x16x64_bf16 v[40:43], v[12:15], a[216:223], v7
    ds_read_b64_tr_b16 v[64:65], v70 offset:20480
    ds_read_b64_tr_b16 v[66:67], v71 offset:20992
    v_smfmac_f32_16x16x64_bf16 v[44:47], v[12:15], a[224:231], v7
    ds_read_b64_tr_b16 v[68:69], v70 offset:21504
    ds_read_b64_tr_b16 v[70:71], v71 offset:22016
    s_waitcnt lgkmcnt(8)
    v_smfmac_f32_16x16x64_bf16 v[40:43], v[20:23], a[176:183], v7
    v_smfmac_f32_16x16x64_bf16 v[44:47], v[20:23], a[184:191], v7
    s_waitcnt lgkmcnt(6)
    v_mfma_f32_16x16x32_bf16 v[28:31], v[72:75], v[56:59], 0
    ds_read_b128 v[72:75], v0 offset:14336
    s_waitcnt lgkmcnt(5)
    v_mfma_f32_16x16x32_bf16 v[28:31], v[76:79], v[60:63], v[28:31]
    ds_read_b128 v[76:79], v0 offset:15360
    s_waitcnt lgkmcnt(4)
    v_mfma_f32_16x16x32_bf16 v[28:31], v[80:83], v[64:67], v[28:31]
    ds_read_b128 v[80:83], v0 offset:16384
    v_add_f32 v40, v40, v42
    s_waitcnt lgkmcnt(3)
    v_mfma_f32_16x16x32_bf16 v[28:31], v[84:87], v[68:71], v[28:31]
    ds_read_b128 v[84:87], v0 offset:17408
    v_add_f32 v44, v44, v46
    v_mfma_f32_16x16x32_bf16 v[24:27], v[56:59], v[56:59], 0
    v_add_f32 v41, v41, v43
    v_add_f32 v45, v45, v47
    v_mfma_f32_16x16x32_bf16 v[24:27], v[60:63], v[60:63], v[24:27]
    v_cvt_pk_bf16_f32 v46, v40, v41
    v_cvt_pk_bf16_f32 v47, v44, v45
    v_mfma_f32_16x16x32_bf16 v[24:27], v[64:67], v[64:67], v[24:27]
    v_lshrrev_b32 v11, 1, v0
    s_cmp_eq_u32 s34, 63
    buffer_store_dwordx2 v[46:47], v11, s[4:7], s40 offen sc1
    s_cbranch_scc1 L_recufin_80
    v_max3_f32 v8, v28, v29, v30
    v_mfma_f32_16x16x32_bf16 v[24:27], v[68:71], v[68:71], v[24:27]
    v_mov_b64 v[12:13], s[70:71]
    v_mov_b64 v[14:15], s[70:71]
    s_waitcnt lgkmcnt(3)
    v_mfma_f32_16x16x32_bf16 v[32:35], v[72:75], v[56:59], 0
    v_add_u32 v10, s49, v0
    v_mov_b64 v[36:37], 0
    s_waitcnt lgkmcnt(2)
    v_mfma_f32_16x16x32_bf16 v[32:35], v[76:79], v[60:63], v[32:35]
    v_max3_f32 v8, v8, v31, v26
    v_mov_b64 v[38:39], 0
    s_waitcnt lgkmcnt(1)
    v_mfma_f32_16x16x32_bf16 v[32:35], v[80:83], v[64:67], v[32:35]
    v_max_f32 v8, v8, v27
    ds_read_b128 v[72:75], v1 offset:8192
    ds_read_b128 v[76:79], v1 offset:9216
    s_waitcnt lgkmcnt(2)
    v_mfma_f32_16x16x32_bf16 v[32:35], v[84:87], v[68:71], v[32:35]
    ds_read_b128 v[80:83], v1 offset:4096
    ds_read_b128 v[84:87], v1 offset:5120
    v_mov_b32 v69, 0
    v_mov_b32 v70, 0
    v_mov_b64 v[40:41], 0
    v_mov_b64 v[42:43], 0
    s_nop 1
    v_max3_f32 v8, v8, v32, v33
    v_max3_f32 v9, v8, v34, v35
    v_max3_f32 v8, v8, v34, v35
    s_nop 1
    v_permlane32_swap_b32 v9, v8
    v_max_f32 v11, v8, v9
    v_max_f32 v8, v8, v9
    s_nop 1
    v_permlane16_swap_b32 v11, v8
    v_max_f32 v8, v8, v11
    v_mul_f32 v8, 0xbe0293ee, v8
    v_pk_fma_f32 v[26:27], v[26:27], s[68:69], v[8:9] op_sel_hi:[1,1,0]
    v_pk_fma_f32 v[28:29], v[28:29], s[68:69], v[8:9] op_sel_hi:[1,1,0]
    v_exp_f32 v26, v26
    v_exp_f32 v27, v27
    v_pk_fma_f32 v[30:31], v[30:31], s[68:69], v[8:9] op_sel_hi:[1,1,0]
    v_exp_f32 v28, v28
    v_pk_fma_f32 v[32:33], v[32:33], s[68:69], v[8:9] op_sel_hi:[1,1,0]
    v_exp_f32 v29, v29
    v_cvt_pk_bf16_f32 v68, v26, v27
    v_pk_fma_f32 v[34:35], v[34:35], s[68:69], v[8:9] op_sel_hi:[1,1,0]
    v_cvt_pk_bf16_f32 v71, v26, v27
    v_exp_f32 v30, v30
    v_mfma_f32_16x16x16_bf16 v[16:19], v[12:13], v[68:69], 0
    v_exp_f32 v31, v31
    v_cvt_pk_bf16_f32 v64, v28, v29
    v_mfma_f32_16x16x16_bf16 v[56:59], v[46:47], v[68:69], 0
    v_exp_f32 v32, v32
    v_exp_f32 v33, v33
    v_mfma_f32_16x16x16_bf16 v[60:63], v[46:47], v[70:71], 0
    v_cvt_pk_bf16_f32 v65, v30, v31
    v_exp_f32 v34, v34
    v_exp_f32 v35, v35
    v_cvt_pk_bf16_f32 v66, v32, v33
    s_waitcnt vmcnt(2)
    v_cvt_pk_bf16_f32 v67, v34, v35
    v_mov_b64 v[24:25], 0
    s_nop 0
    v_mfma_f32_16x16x32_bf16 v[16:19], v[12:15], v[64:67], v[16:19]
    v_mov_b64 v[26:27], 0
    v_mov_b64 v[28:29], 0
    v_mfma_f32_16x16x32_bf16 v[56:59], v[48:51], v[64:67], v[56:59]
    v_mov_b64 v[30:31], 0
    v_mov_b64 v[32:33], 0
    v_mfma_f32_16x16x32_bf16 v[60:63], v[52:55], v[64:67], v[60:63]
    v_mov_b64 v[34:35], 0
    v_rcp_f32 v8, v16
    s_nop 1
    v_pk_mul_f32 v[56:57], v[56:57], v[8:9] op_sel_hi:[1,0]
    v_pk_mul_f32 v[58:59], v[58:59], v[8:9] op_sel_hi:[1,0]
    v_cvt_pk_bf16_f32 v20, v56, v57
    v_cvt_pk_bf16_f32 v21, v58, v59
    v_pk_mul_f32 v[60:61], v[60:61], v[8:9] op_sel_hi:[1,0]
    v_pk_mul_f32 v[62:63], v[62:63], v[8:9] op_sel_hi:[1,0]
    v_cvt_pk_bf16_f32 v22, v60, v61
    v_cvt_pk_bf16_f32 v23, v62, v63
    s_mov_b64 exec, s[64:65]
    ds_write_b128 v10, v[20:23]
    s_mov_b64 exec, -1
    ds_read_b128 v[56:59], v1 offset:6144
    ds_read_b128 v[60:63], v1 offset:7168
    ds_read_b128 v[64:67], v1 offset:10240
    ds_read_b128 v[68:71], v1 offset:11264
    s_waitcnt lgkmcnt(4)
    s_barrier
    ds_read_b128 v[12:15], v0 offset:22528
    ds_read_b128 v[16:19], v0 offset:23552
    s_mov_b32 m0, s51
    s_nop 0
    buffer_load_dwordx4 v0, s[4:7], s39 offen lds
    buffer_load_dwordx4 v0, s[4:7], s39 offen offset:1024 lds
    s_waitcnt lgkmcnt(1)
    v_smfmac_f32_16x16x64_bf16 v[40:43], v[12:15], v[72:79], v7
    s_waitcnt lgkmcnt(0)
    v_smfmac_f32_16x16x64_bf16 v[40:43], v[16:19], v[64:71], v7
    v_smfmac_f32_16x16x64_bf16 v[24:27], v[12:15], v[208:215], v7
    v_smfmac_f32_16x16x64_bf16 v[24:27], v[16:19], v[240:247], v7
    v_add_f32 v40, v40, v42
    v_smfmac_f32_16x16x64_bf16 v[28:31], v[12:15], v[216:223], v7
    v_add_f32 v41, v41, v43
    v_smfmac_f32_16x16x64_bf16 v[28:31], v[16:19], v[248:255], v7
    v_cvt_pk_bf16_f32 v20, v40, v41
    v_smfmac_f32_16x16x64_bf16 v[32:35], v[12:15], v[224:231], v7
    v_bfi_b32 v20, 1, s19, v20
    v_smfmac_f32_16x16x64_bf16 v[32:35], v[16:19], v[80:87], v7
    buffer_store_dword v20, v6, s[4:7], s35 offen
    v_add_f32 v24, v24, v26
    v_smfmac_f32_16x16x64_bf16 v[36:39], v[12:15], v[232:239], v7
    v_add_f32 v25, v25, v27
    v_smfmac_f32_16x16x64_bf16 v[36:39], v[16:19], v[56:63], v7
    v_add_f32 v28, v28, v30
    v_add_f32 v29, v29, v31
    v_cvt_pk_bf16_f32 v8, v24, v25
    v_add_f32 v32, v32, v34
    v_cvt_pk_bf16_f32 v9, v28, v29
    v_add_f32 v33, v33, v35
    v_bfi_b32 v8, 1, s19, v8
    v_cvt_pk_bf16_f32 v10, v32, v33
    v_pk_add_f32 v[36:37], v[36:37], v[38:39]
    v_cvt_pk_bf16_f32 v11, v36, v37
    buffer_store_dwordx4 v[8:11], v5, s[4:7], s35 offen
    s_add_u32 s39, s39, 262144
    s_add_u32 s47, s47, 262144
    s_xor_b32 s35, s35, 262144
    s_add_u32 s40, s40, 65536
    s_cmp_eq_u32 s42, 0
    s_cbranch_scc1 L_recunred_83
    v_bfe_u32 v8, v0, 4, 1
    v_lshlrev_b32 v21, 4, v8
    v_mov_b32 v10, 0x3f80
    v_lshlrev_b32 v10, v21, v10
    v_bfe_u32 v11, v0, 5, 3
    v_cmp_eq_u32 s[52:53], 0, v11
    v_cmp_eq_u32 s[54:55], 1, v11
    v_cmp_eq_u32 s[56:57], 2, v11
    v_cmp_eq_u32 s[58:59], 3, v11
    v_cndmask_b32 v12, 0, v10, s[52:53]
    v_cndmask_b32 v13, 0, v10, s[54:55]
    v_cndmask_b32 v14, 0, v10, s[56:57]
    v_cndmask_b32 v15, 0, v10, s[58:59]
    v_and_b32 v11, 3, v11
    v_lshl_add_u32 v21, v11, 2, v21
    v_bfe_u32 v11, v0, 8, 1
    v_lshl_add_u32 v21, v11, 6, v21
    v_lshrrev_b32 v11, 9, v0
    v_lshl_add_u32 v21, v11, 5, v21
    v_mov_b64 v[24:25], 0
    v_mov_b64 v[26:27], 0
    v_mov_b64 v[28:29], 0
    v_mov_b64 v[30:31], 0
    v_mov_b64 v[32:33], 0
    v_mov_b64 v[34:35], 0
    v_mov_b64 v[36:37], 0
    v_mov_b64 v[38:39], 0
    v_mov_b64 v[40:41], 0
    v_mov_b64 v[42:43], 0
    v_mov_b64 v[44:45], 0
    v_mov_b64 v[46:47], 0
    s_mov_b32 s50, 3200000
    s_nop 15
    s_nop 15
    s_nop 11
    buffer_load_dwordx4 v[56:59], v0, s[4:7], s36 offen offset:0 sc1
    buffer_load_dwordx4 v[60:63], v0, s[4:7], s36 offen offset:1024 sc1
    buffer_load_dwordx4 v[64:67], v0, s[4:7], s36 offen offset:2048 sc1
    buffer_load_dwordx4 v[68:71], v0, s[4:7], s36 offen offset:3072 sc1
    s_nop 15
    s_nop 3
    buffer_load_dwordx4 v[56:59], v0, s[4:7], s36 offen offset:0 sc1
    buffer_load_dwordx4 v[60:63], v0, s[4:7], s36 offen offset:1024 sc1
    buffer_load_dwordx4 v[64:67], v0, s[4:7], s36 offen offset:2048 sc1
    buffer_load_dwordx4 v[68:71], v0, s[4:7], s36 offen offset:3072 sc1
L_recursl_86:
    s_waitcnt vmcnt(7)
    v_xor_b32 v8, s19, v56
    v_mfma_f32_16x16x32_bf16 v[16:19], v[56:59], v[12:15], 0
    buffer_load_dwordx4 v[56:59], v0, s[4:7], s36 offen offset:0 sc1
    s_waitcnt vmcnt(7)
    v_bitop3_b32 v8, v8, v60, s19 bitop3:0xf6
    v_mfma_f32_16x16x32_bf16 v[16:19], v[60:63], v[12:15], v[16:19]
    buffer_load_dwordx4 v[60:63], v0, s[4:7], s36 offen offset:1024 sc1
    s_waitcnt vmcnt(7)
    v_bitop3_b32 v8, v8, v64, s19 bitop3:0xf6
    v_mfma_f32_16x16x32_bf16 v[16:19], v[64:67], v[12:15], v[16:19]
    buffer_load_dwordx4 v[64:67], v0, s[4:7], s36 offen offset:2048 sc1
    s_waitcnt vmcnt(7)
    v_bitop3_b32 v8, v8, v68, s19 bitop3:0xf6
    v_mfma_f32_16x16x32_bf16 v[16:19], v[68:71], v[12:15], v[16:19]
    buffer_load_dwordx4 v[68:71], v0, s[4:7], s36 offen offset:3072 sc1
    v_and_b32 v8, 1, v8
    v_cmp_ne_u32 vcc, 0, v8
    s_cbranch_vccz L_recursok_85
    s_waitcnt vmcnt(7)
    v_xor_b32 v8, s19, v56
    v_mfma_f32_16x16x32_bf16 v[16:19], v[56:59], v[12:15], 0
    buffer_load_dwordx4 v[56:59], v0, s[4:7], s36 offen offset:0 sc1
    s_waitcnt vmcnt(7)
    v_bitop3_b32 v8, v8, v60, s19 bitop3:0xf6
    v_mfma_f32_16x16x32_bf16 v[16:19], v[60:63], v[12:15], v[16:19]
    buffer_load_dwordx4 v[60:63], v0, s[4:7], s36 offen offset:1024 sc1
    s_waitcnt vmcnt(7)
    v_bitop3_b32 v8, v8, v64, s19 bitop3:0xf6
    v_mfma_f32_16x16x32_bf16 v[16:19], v[64:67], v[12:15], v[16:19]
    buffer_load_dwordx4 v[64:67], v0, s[4:7], s36 offen offset:2048 sc1
    s_waitcnt vmcnt(7)
    v_bitop3_b32 v8, v8, v68, s19 bitop3:0xf6
    v_mfma_f32_16x16x32_bf16 v[16:19], v[68:71], v[12:15], v[16:19]
    buffer_load_dwordx4 v[68:71], v0, s[4:7], s36 offen offset:3072 sc1
    v_and_b32 v8, 1, v8
    v_cmp_ne_u32 vcc, 0, v8
    s_cbranch_vccz L_recursok_85
    s_sub_u32 s50, s50, 1
    s_cbranch_scc0 L_recursl_86
    s_branch L_exit_recurrent_scan__memory_aug_recurrent_mem_tr__moe_arch_mod__prompt_kernel
L_recursok_85:
    s_nop 1
    v_permlane32_swap_b32 v16, v18
    v_permlane32_swap_b32 v17, v19
    v_pk_add_f32 v[16:17], v[16:17], v[18:19]
    v_cvt_pk_bf16_f32 v16, v16, v17
    s_mov_b64 exec, s[74:75]
    buffer_store_dword v16, v21, s[4:7], s48 offen sc1
    buffer_store_dword v16, v21, s[4:7], s37 offen
    s_mov_b64 exec, -1
    s_barrier
    v_mov_b64 v[8:9], -1
    v_mov_b64 v[10:11], -1
    s_mov_b64 exec, 0xff
    buffer_store_dwordx4 v[8:11], v0, s[4:7], s45 offen
    s_mov_b64 exec, -1
    s_xor_b32 s36, s36, 262144
    s_mov_b32 s45, s37
    s_add_u32 s37, s37, 8192
    s_andn2_b32 s37, s37, 0x8000
    s_add_u32 s48, s48, 10240
    s_waitcnt vmcnt(3)
    s_branch L_recun2_84
L_recunred_83:
    v_mov_b64 v[24:25], 0
    v_mov_b64 v[26:27], 0
    v_mov_b64 v[28:29], 0
    v_mov_b64 v[30:31], 0
    v_mov_b64 v[32:33], 0
    v_mov_b64 v[34:35], 0
    v_mov_b64 v[36:37], 0
    v_mov_b64 v[38:39], 0
    v_mov_b64 v[40:41], 0
    v_mov_b64 v[42:43], 0
    v_mov_b64 v[44:45], 0
    v_mov_b64 v[46:47], 0
    s_barrier
    s_waitcnt vmcnt(0)
L_recun2_84:
    v_bfe_u32 v4, v0, 7, 2
    v_lshl_add_u32 v4, v4, 2, v0
    s_add_u32 s34, s34, 1
    ds_read_b128 v[56:59], v1 offset:12288
    ds_read_b128 v[60:63], v1 offset:13312
    ds_read_b128 v[64:67], v1 offset:14336
    ds_read_b128 v[68:71], v1 offset:15360
    ds_read_b128 v[72:75], v1 offset:16384
    ds_read_b128 v[76:79], v1 offset:17408
    ds_read_b128 v[80:83], v1 offset:18432
    ds_read_b128 v[84:87], v1 offset:19456
    s_add_u32 s26, s34, 1
    s_min_u32 s26, s26, 63
    s_cmp_gt_u32 s44, s26
    s_cbranch_scc1 L_recuf_87
    v_bfe_u32 v8, v0, 6, 1
    v_lshlrev_b32 v8, 13, v8
    v_bfe_u32 v9, v0, 4, 2
    v_lshl_add_u32 v8, v9, 2, v8
    v_bfe_u32 v10, v0, 7, 1
    v_lshl_add_u32 v8, v10, 7, v8
    s_mov_b32 s50, 0
L_recufs_88:
    buffer_load_dword v9, v8, s[4:7], s46 offen sc1
    s_waitcnt vmcnt(0)
    v_lshl_add_u32 v9, v9, 1, v10
    v_cmp_ge_u32 vcc, s26, v9
    s_cbranch_vccz L_recufsok_89
    s_add_u32 s50, s50, 1
    s_cmp_lt_u32 s50, 400000
    s_cbranch_scc0 L_exit_recurrent_scan__memory_aug_recurrent_mem_tr__moe_arch_mod__prompt_kernel
    s_sleep 2
    s_branch L_recufs_88
L_recufsok_89:
    v_min_u32_dpp v9, v9, v9 quad_perm:[1,0,3,2] row_mask:0xf bank_mask:0xf
    s_nop 1
    v_min_u32_dpp v9, v9, v9 quad_perm:[2,3,0,1] row_mask:0xf bank_mask:0xf
    s_nop 1
    v_min_u32_dpp v9, v9, v9 row_half_mirror row_mask:0xf bank_mask:0xf
    s_nop 1
    v_min_u32_dpp v9, v9, v9 row_mirror row_mask:0xf bank_mask:0xf
    s_nop 0
    v_readfirstlane_b32 s44, v9
L_recuf_87:
    s_mov_b32 m0, s66
    s_mov_b32 s30, s38
    s_mov_b64 s[8:9], -1
    s_add_u32 s67, s67, 262144
    s_add_u32 s38, s38, 10240
    s_waitcnt lgkmcnt(0)
    s_bfe_u32 s19, s34, 0x10001
    s_branch L_recucl_79
L_recurt_81:
    s_cmp_eq_u32 s34, 0
    s_cbranch_scc1 L_recurb_82
    s_mov_b32 s50, 0
    s_mov_b32 m0, s66
    ds_read2st64_b32 v[8:9], v4 offset0:32 offset1:36
    s_waitcnt lgkmcnt(0)
    v_cmp_eq_u32 s[52:53], -1, v8
    v_cmp_eq_u32 s[54:55], -1, v9
    s_or_b64 s[58:59], s[52:53], s[54:55]
    s_cbranch_scc0 L_recurb_82
    s_mov_b64 exec, s[52:53]
    buffer_load_dwordx4 v0, s[4:7], s30 offen offset:0 sc1 lds
    s_mov_b64 exec, s[54:55]
    buffer_load_dwordx4 v0, s[4:7], s30 offen offset:1024 sc1 lds
    s_mov_b64 exec, -1
    s_nop 15
    s_nop 15
L_recur2_91:
    s_mov_b64 exec, s[52:53]
    buffer_load_dwordx4 v0, s[4:7], s30 offen offset:0 sc1 lds
    s_mov_b64 exec, s[54:55]
    buffer_load_dwordx4 v0, s[4:7], s30 offen offset:1024 sc1 lds
    s_mov_b64 exec, -1
    s_waitcnt vmcnt(2)
    ds_read2st64_b32 v[8:9], v4 offset0:32 offset1:36
    s_waitcnt lgkmcnt(0)
    v_cmp_eq_u32 s[52:53], -1, v8
    v_cmp_eq_u32 s[54:55], -1, v9
    s_or_b64 s[58:59], s[52:53], s[54:55]
    s_cbranch_scc0 L_recurb_82
    s_add_u32 s50, s50, 1
    s_cmp_lt_u32 s50, 3200000
    s_cbranch_scc0 L_exit_recurrent_scan__memory_aug_recurrent_mem_tr__moe_arch_mod__prompt_kernel
    s_branch L_recur2_91
L_recufin_80:
    s_waitcnt lgkmcnt(0)
    s_nop 7
    s_waitcnt vmcnt(0)
    v_mov_b32 v9, 64
    buffer_store_dword v9, off, s[4:7], s41 sc1
    s_waitcnt vmcnt(0)
    s_branch L_exit_recurrent_scan__memory_aug_recurrent_mem_tr__moe_arch_mod__prompt_kernel
L_recub_28:
L_recucl_92:
    s_barrier
    ds_read_b128 v[12:15], v2 offset:0
    ds_read_b128 v[16:19], v2 offset:1024
    ds_read_b128 v[20:23], v2 offset:2048
    s_waitcnt lgkmcnt(2)
    v_smfmac_f32_16x16x64_bf16 v[24:27], v[12:15], a[0:7], v7
    v_mov_b32 v8, s34
    v_smfmac_f32_16x16x64_bf16 v[28:31], v[12:15], v[56:63], v7
    ds_read_b128 v[56:59], v1 offset:20480
    v_smfmac_f32_16x16x64_bf16 v[32:35], v[12:15], a[8:15], v7
    ds_read_b128 v[60:63], v1 offset:21504
    v_smfmac_f32_16x16x64_bf16 v[36:39], v[12:15], v[64:71], v7
    ds_read_b128 v[64:67], v1 offset:22528
    v_smfmac_f32_16x16x64_bf16 v[40:43], v[12:15], a[16:23], v7
    ds_read_b128 v[68:71], v1 offset:23552
    v_smfmac_f32_16x16x64_bf16 v[44:47], v[12:15], a[24:31], v7
    buffer_load_dwordx4 v[48:51], v0, s[4:7], s47 offen offset:0
    ds_read_b128 v[12:15], v2 offset:3072
    s_waitcnt lgkmcnt(6)
    v_smfmac_f32_16x16x64_bf16 v[24:27], v[16:19], a[32:39], v7
    buffer_load_dwordx4 v[52:55], v0, s[4:7], s47 offen offset:1024
    v_smfmac_f32_16x16x64_bf16 v[28:31], v[16:19], v[72:79], v7
    ds_read_b128 v[72:75], v1 offset:24576
    v_smfmac_f32_16x16x64_bf16 v[32:35], v[16:19], a[40:47], v7
    ds_read_b128 v[76:79], v1 offset:25600
    buffer_store_dword v8, off, s[4:7], s41 sc1
    v_smfmac_f32_16x16x64_bf16 v[36:39], v[16:19], v[80:87], v7
    ds_read_b128 v[80:83], v1 offset:26624
    v_smfmac_f32_16x16x64_bf16 v[40:43], v[16:19], a[48:55], v7
    ds_read_b128 v[84:87], v1 offset:27648
    v_smfmac_f32_16x16x64_bf16 v[44:47], v[16:19], a[56:63], v7
    ds_read_b128 v[16:19], v2 offset:4096
    s_waitcnt lgkmcnt(10)
    v_smfmac_f32_16x16x64_bf16 v[24:27], v[20:23], a[64:71], v7
    s_waitcnt lgkmcnt(8)
    v_smfmac_f32_16x16x64_bf16 v[28:31], v[20:23], v[56:63], v7
    ds_read_b128 v[56:59], v1 offset:28672
    v_smfmac_f32_16x16x64_bf16 v[32:35], v[20:23], a[72:79], v7
    ds_read_b128 v[60:63], v1 offset:29696
    s_waitcnt lgkmcnt(8)
    v_smfmac_f32_16x16x64_bf16 v[36:39], v[20:23], v[64:71], v7
    ds_read_b128 v[64:67], v1 offset:30720
    v_smfmac_f32_16x16x64_bf16 v[40:43], v[20:23], a[80:87], v7
    ds_read_b128 v[68:71], v1 offset:31744
    v_smfmac_f32_16x16x64_bf16 v[44:47], v[20:23], a[88:95], v7
    s_waitcnt lgkmcnt(9)
    v_smfmac_f32_16x16x64_bf16 v[24:27], v[12:15], a[96:103], v7
    s_waitcnt lgkmcnt(7)
    v_smfmac_f32_16x16x64_bf16 v[28:31], v[12:15], v[72:79], v7
    ds_read_b128 v[72:75], v1 offset:0
    v_smfmac_f32_16x16x64_bf16 v[32:35], v[12:15], a[104:111], v7
    ds_read_b128 v[76:79], v1 offset:1024
    s_waitcnt lgkmcnt(7)
    v_smfmac_f32_16x16x64_bf16 v[36:39], v[12:15], v[80:87], v7
    ds_read_b128 v[80:83], v1 offset:2048
    s_waitcnt lgkmcnt(7)
    v_smfmac_f32_16x16x64_bf16 v[24:27], v[16:19], a[128:135], v7
    ds_read_b128 v[84:87], v1 offset:3072
    s_waitcnt lgkmcnt(6)
    v_smfmac_f32_16x16x64_bf16 v[28:31], v[16:19], v[56:63], v7
    ds_read_b128 v[56:59], v1 offset:32768
    v_smfmac_f32_16x16x64_bf16 v[32:35], v[16:19], a[136:143], v7
    ds_read_b128 v[60:63], v1 offset:33792
    s_waitcnt lgkmcnt(6)
    v_smfmac_f32_16x16x64_bf16 v[36:39], v[16:19], v[64:71], v7
    s_waitcnt vmcnt(3)
    s_barrier
    ds_read_b128 v[20:23], v2 offset:5120
    v_smfmac_f32_16x16x64_bf16 v[40:43], v[12:15], a[112:119], v7
    v_smfmac_f32_16x16x64_bf16 v[44:47], v[12:15], a[120:127], v7
    ds_read_b128 v[12:15], v2 offset:6144
    v_smfmac_f32_16x16x64_bf16 v[40:43], v[16:19], a[144:151], v7
    v_smfmac_f32_16x16x64_bf16 v[44:47], v[16:19], a[152:159], v7
    ds_read_b128 v[16:19], v2 offset:7168
    s_waitcnt lgkmcnt(2)
    v_smfmac_f32_16x16x64_bf16 v[24:27], v[20:23], a[160:167], v7
    v_smfmac_f32_16x16x64_bf16 v[28:31], v[20:23], v[72:79], v7
    v_smfmac_f32_16x16x64_bf16 v[32:35], v[20:23], a[168:175], v7
    v_smfmac_f32_16x16x64_bf16 v[36:39], v[20:23], v[80:87], v7
    ds_read_b128 v[20:23], v2 offset:8192
    s_waitcnt lgkmcnt(2)
    v_smfmac_f32_16x16x64_bf16 v[24:27], v[12:15], a[192:199], v7
    v_smfmac_f32_16x16x64_bf16 v[28:31], v[12:15], v[56:63], v7
    ds_read_b128 v[72:75], v0 offset:10240
    v_smfmac_f32_16x16x64_bf16 v[32:35], v[12:15], a[200:207], v7
    v_smfmac_f32_16x16x64_bf16 v[36:39], v[12:15], a[208:215], v7
    ds_read_b128 v[76:79], v0 offset:11264
    ds_read_b128 v[12:15], v2 offset:9216
    s_waitcnt lgkmcnt(4)
    v_smfmac_f32_16x16x64_bf16 v[24:27], v[16:19], a[232:239], v7
    v_lshrrev_b32 v71, 9, v0
    v_smfmac_f32_16x16x64_bf16 v[28:31], v[16:19], a[248:255], v7
    ds_read_b128 v[80:83], v0 offset:12288
    v_smfmac_f32_16x16x64_bf16 v[32:35], v[16:19], a[240:247], v7
    v_lshlrev_b32 v71, 3, v71
    v_smfmac_f32_16x16x64_bf16 v[36:39], v[16:19], v[88:95], v7
    ds_read_b128 v[84:87], v0 offset:13312
    s_waitcnt lgkmcnt(5)
    v_smfmac_f32_16x16x64_bf16 v[24:27], v[20:23], v[112:119], v7
    v_lshrrev_b32 v70, 1, v0
    v_smfmac_f32_16x16x64_bf16 v[28:31], v[20:23], v[128:135], v7
    v_xor_b32 v70, v71, v70
    v_smfmac_f32_16x16x64_bf16 v[32:35], v[20:23], v[120:127], v7
    v_xor_b32 v71, 16, v70
    v_smfmac_f32_16x16x64_bf16 v[36:39], v[20:23], v[136:143], v7
    s_waitcnt lgkmcnt(2)
    v_smfmac_f32_16x16x64_bf16 v[24:27], v[12:15], v[160:167], v7
    v_smfmac_f32_16x16x64_bf16 v[28:31], v[12:15], v[176:183], v7
    v_smfmac_f32_16x16x64_bf16 v[32:35], v[12:15], v[168:175], v7
    v_add_f32 v24, v24, v26
    v_smfmac_f32_16x16x64_bf16 v[36:39], v[12:15], v[184:191], v7
    v_add_f32 v25, v25, v27
    v_add_f32 v28, v28, v30
    v_cvt_pk_bf16_f32 v8, v24, v25
    v_add_f32 v29, v29, v31
    v_add_f32 v32, v32, v34
    v_cvt_pk_bf16_f32 v9, v28, v29
    v_add_f32 v33, v33, v35
    ds_write_b64 v3, v[8:9]
    v_pk_add_f32 v[36:37], v[36:37], v[38:39]
    v_cvt_pk_bf16_f32 v10, v32, v33
    v_cvt_pk_bf16_f32 v11, v36, v37
    ds_write_b64 v3, v[10:11] offset:128
    v_smfmac_f32_16x16x64_bf16 v[40:43], v[12:15], v[192:199], v7
    v_smfmac_f32_16x16x64_bf16 v[44:47], v[12:15], v[200:207], v7
    ds_read_b128 v[12:15], v2 offset:6144
    v_smfmac_f32_16x16x64_bf16 v[40:43], v[20:23], v[144:151], v7
    v_smfmac_f32_16x16x64_bf16 v[44:47], v[20:23], v[152:159], v7
    ds_read_b128 v[20:23], v2 offset:5120
    v_smfmac_f32_16x16x64_bf16 v[40:43], v[16:19], v[96:103], v7
    s_waitcnt lgkmcnt(2)
    s_barrier
    ds_read_b64_tr_b16 v[56:57], v70 offset:18432
    ds_read_b64_tr_b16 v[58:59], v71 offset:18944
    v_smfmac_f32_16x16x64_bf16 v[44:47], v[16:19], v[104:111], v7
    ds_read_b64_tr_b16 v[60:61], v70 offset:19456
    ds_read_b64_tr_b16 v[62:63], v71 offset:19968
    s_waitcnt lgkmcnt(5)
    v_smfmac_f32_16x16x64_bf16 v[40:43], v[12:15], a[216:223], v7
    ds_read_b64_tr_b16 v[64:65], v70 offset:20480
    ds_read_b64_tr_b16 v[66:67], v71 offset:20992
    v_smfmac_f32_16x16x64_bf16 v[44:47], v[12:15], a[224:231], v7
    ds_read_b64_tr_b16 v[68:69], v70 offset:21504
    ds_read_b64_tr_b16 v[70:71], v71 offset:22016
    s_waitcnt lgkmcnt(8)
    v_smfmac_f32_16x16x64_bf16 v[40:43], v[20:23], a[176:183], v7
    v_smfmac_f32_16x16x64_bf16 v[44:47], v[20:23], a[184:191], v7
    s_waitcnt lgkmcnt(6)
    v_mfma_f32_16x16x32_bf16 v[28:31], v[72:75], v[56:59], 0
    ds_read_b128 v[72:75], v0 offset:14336
    s_waitcnt lgkmcnt(5)
    v_mfma_f32_16x16x32_bf16 v[28:31], v[76:79], v[60:63], v[28:31]
    ds_read_b128 v[76:79], v0 offset:15360
    s_waitcnt lgkmcnt(4)
    v_mfma_f32_16x16x32_bf16 v[28:31], v[80:83], v[64:67], v[28:31]
    ds_read_b128 v[80:83], v0 offset:16384
    v_add_f32 v40, v40, v42
    s_waitcnt lgkmcnt(3)
    v_mfma_f32_16x16x32_bf16 v[28:31], v[84:87], v[68:71], v[28:31]
    ds_read_b128 v[84:87], v0 offset:17408
    v_add_f32 v44, v44, v46
    v_mfma_f32_16x16x32_bf16 v[24:27], v[56:59], v[56:59], 0
    v_add_f32 v41, v41, v43
    v_add_f32 v45, v45, v47
    v_mfma_f32_16x16x32_bf16 v[24:27], v[60:63], v[60:63], v[24:27]
    v_cvt_pk_bf16_f32 v46, v40, v41
    v_cvt_pk_bf16_f32 v47, v44, v45
    v_mfma_f32_16x16x32_bf16 v[24:27], v[64:67], v[64:67], v[24:27]
    v_lshrrev_b32 v11, 1, v0
    s_cmp_eq_u32 s34, 63
    buffer_store_dwordx2 v[46:47], v11, s[4:7], s40 offen sc1
    s_cbranch_scc1 L_recufin_93
    v_max3_f32 v8, v28, v29, v30
    v_mfma_f32_16x16x32_bf16 v[24:27], v[68:71], v[68:71], v[24:27]
    v_mov_b64 v[12:13], s[70:71]
    v_mov_b64 v[14:15], s[70:71]
    s_waitcnt lgkmcnt(3)
    v_mfma_f32_16x16x32_bf16 v[32:35], v[72:75], v[56:59], 0
    v_add_u32 v10, s49, v0
    v_mov_b64 v[36:37], 0
    s_waitcnt lgkmcnt(2)
    v_mfma_f32_16x16x32_bf16 v[32:35], v[76:79], v[60:63], v[32:35]
    v_max3_f32 v8, v8, v31, v26
    v_mov_b64 v[38:39], 0
    s_waitcnt lgkmcnt(1)
    v_mfma_f32_16x16x32_bf16 v[32:35], v[80:83], v[64:67], v[32:35]
    v_max_f32 v8, v8, v27
    ds_read_b128 v[72:75], v1 offset:8192
    ds_read_b128 v[76:79], v1 offset:9216
    s_waitcnt lgkmcnt(2)
    v_mfma_f32_16x16x32_bf16 v[32:35], v[84:87], v[68:71], v[32:35]
    ds_read_b128 v[80:83], v1 offset:4096
    ds_read_b128 v[84:87], v1 offset:5120
    v_mov_b32 v69, 0
    v_mov_b32 v70, 0
    v_mov_b64 v[40:41], 0
    v_mov_b64 v[42:43], 0
    s_nop 1
    v_max3_f32 v8, v8, v32, v33
    v_max3_f32 v9, v8, v34, v35
    v_max3_f32 v8, v8, v34, v35
    s_nop 1
    v_permlane32_swap_b32 v9, v8
    v_max_f32 v11, v8, v9
    v_max_f32 v8, v8, v9
    s_nop 1
    v_permlane16_swap_b32 v11, v8
    v_max_f32 v8, v8, v11
    v_mul_f32 v8, 0xbe0293ee, v8
    v_pk_fma_f32 v[26:27], v[26:27], s[68:69], v[8:9] op_sel_hi:[1,1,0]
    v_pk_fma_f32 v[28:29], v[28:29], s[68:69], v[8:9] op_sel_hi:[1,1,0]
    v_exp_f32 v26, v26
    v_exp_f32 v27, v27
    v_pk_fma_f32 v[30:31], v[30:31], s[68:69], v[8:9] op_sel_hi:[1,1,0]
    v_exp_f32 v28, v28
    v_pk_fma_f32 v[32:33], v[32:33], s[68:69], v[8:9] op_sel_hi:[1,1,0]
    v_exp_f32 v29, v29
    v_cvt_pk_bf16_f32 v68, v26, v27
    v_pk_fma_f32 v[34:35], v[34:35], s[68:69], v[8:9] op_sel_hi:[1,1,0]
    v_cvt_pk_bf16_f32 v71, v26, v27
    v_exp_f32 v30, v30
    v_mfma_f32_16x16x16_bf16 v[16:19], v[12:13], v[68:69], 0
    v_exp_f32 v31, v31
    v_cvt_pk_bf16_f32 v64, v28, v29
    v_mfma_f32_16x16x16_bf16 v[56:59], v[46:47], v[68:69], 0
    v_exp_f32 v32, v32
    v_exp_f32 v33, v33
    v_mfma_f32_16x16x16_bf16 v[60:63], v[46:47], v[70:71], 0
    v_cvt_pk_bf16_f32 v65, v30, v31
    v_exp_f32 v34, v34
    v_exp_f32 v35, v35
    v_cvt_pk_bf16_f32 v66, v32, v33
    s_waitcnt vmcnt(1)
    v_cvt_pk_bf16_f32 v67, v34, v35
    v_mov_b64 v[24:25], 0
    s_nop 0
    v_mfma_f32_16x16x32_bf16 v[16:19], v[12:15], v[64:67], v[16:19]
    v_mov_b64 v[26:27], 0
    v_mov_b64 v[28:29], 0
    v_mfma_f32_16x16x32_bf16 v[56:59], v[48:51], v[64:67], v[56:59]
    v_mov_b64 v[30:31], 0
    v_mov_b64 v[32:33], 0
    v_mfma_f32_16x16x32_bf16 v[60:63], v[52:55], v[64:67], v[60:63]
    v_mov_b64 v[34:35], 0
    v_rcp_f32 v8, v16
    s_nop 1
    v_pk_mul_f32 v[56:57], v[56:57], v[8:9] op_sel_hi:[1,0]
    v_pk_mul_f32 v[58:59], v[58:59], v[8:9] op_sel_hi:[1,0]
    v_cvt_pk_bf16_f32 v20, v56, v57
    v_cvt_pk_bf16_f32 v21, v58, v59
    v_pk_mul_f32 v[60:61], v[60:61], v[8:9] op_sel_hi:[1,0]
    v_pk_mul_f32 v[62:63], v[62:63], v[8:9] op_sel_hi:[1,0]
    v_cvt_pk_bf16_f32 v22, v60, v61
    v_cvt_pk_bf16_f32 v23, v62, v63
    s_mov_b64 exec, s[64:65]
    ds_write_b128 v10, v[20:23]
    s_mov_b64 exec, -1
    ds_read_b128 v[56:59], v1 offset:6144
    ds_read_b128 v[60:63], v1 offset:7168
    ds_read_b128 v[64:67], v1 offset:10240
    ds_read_b128 v[68:71], v1 offset:11264
    s_waitcnt lgkmcnt(4)
    s_barrier
    ds_read_b128 v[12:15], v0 offset:22528
    ds_read_b128 v[16:19], v0 offset:23552
    s_mov_b32 m0, s51
    s_nop 0
    buffer_load_dwordx4 v0, s[4:7], s39 offen lds
    buffer_load_dwordx4 v0, s[4:7], s39 offen offset:1024 lds
    s_waitcnt lgkmcnt(1)
    v_smfmac_f32_16x16x64_bf16 v[40:43], v[12:15], v[72:79], v7
    s_waitcnt lgkmcnt(0)
    v_smfmac_f32_16x16x64_bf16 v[40:43], v[16:19], v[64:71], v7
    v_smfmac_f32_16x16x64_bf16 v[24:27], v[12:15], v[208:215], v7
    v_smfmac_f32_16x16x64_bf16 v[24:27], v[16:19], v[240:247], v7
    v_add_f32 v40, v40, v42
    v_smfmac_f32_16x16x64_bf16 v[28:31], v[12:15], v[216:223], v7
    v_add_f32 v41, v41, v43
    v_smfmac_f32_16x16x64_bf16 v[28:31], v[16:19], v[248:255], v7
    v_cvt_pk_bf16_f32 v20, v40, v41
    v_smfmac_f32_16x16x64_bf16 v[32:35], v[12:15], v[224:231], v7
    v_bfi_b32 v20, 1, s19, v20
    v_smfmac_f32_16x16x64_bf16 v[32:35], v[16:19], v[80:87], v7
    buffer_store_dword v20, v6, s[4:7], s35 offen
    v_add_f32 v24, v24, v26
    v_smfmac_f32_16x16x64_bf16 v[36:39], v[12:15], v[232:239], v7
    v_add_f32 v25, v25, v27
    v_smfmac_f32_16x16x64_bf16 v[36:39], v[16:19], v[56:63], v7
    v_add_f32 v28, v28, v30
    v_add_f32 v29, v29, v31
    v_cvt_pk_bf16_f32 v8, v24, v25
    v_add_f32 v32, v32, v34
    v_cvt_pk_bf16_f32 v9, v28, v29
    v_add_f32 v33, v33, v35
    v_bfi_b32 v8, 1, s19, v8
    v_cvt_pk_bf16_f32 v10, v32, v33
    v_pk_add_f32 v[36:37], v[36:37], v[38:39]
    v_cvt_pk_bf16_f32 v11, v36, v37
    buffer_store_dwordx4 v[8:11], v5, s[4:7], s35 offen
    s_add_u32 s39, s39, 262144
    s_add_u32 s47, s47, 262144
    s_xor_b32 s35, s35, 262144
    s_add_u32 s40, s40, 65536
    v_mov_b64 v[24:25], 0
    v_mov_b64 v[26:27], 0
    v_mov_b64 v[28:29], 0
    v_mov_b64 v[30:31], 0
    v_mov_b64 v[32:33], 0
    v_mov_b64 v[34:35], 0
    v_mov_b64 v[36:37], 0
    v_mov_b64 v[38:39], 0
    v_mov_b64 v[40:41], 0
    v_mov_b64 v[42:43], 0
    v_mov_b64 v[44:45], 0
    v_mov_b64 v[46:47], 0
    ds_read_b128 v[56:59], v1 offset:12288
    ds_read_b128 v[60:63], v1 offset:13312
    ds_read_b128 v[64:67], v1 offset:14336
    ds_read_b128 v[68:71], v1 offset:15360
    ds_read_b128 v[72:75], v1 offset:16384
    ds_read_b128 v[76:79], v1 offset:17408
    ds_read_b128 v[80:83], v1 offset:18432
    ds_read_b128 v[84:87], v1 offset:19456
    s_mov_b32 m0, s66
    s_add_u32 s34, s34, 1
    s_bfe_u32 s19, s34, 0x10001
    s_mov_b32 s50, 3200000
    s_mov_b32 s30, s37
    s_add_u32 s37, s37, 8192
    s_andn2_b32 s37, s37, 0x8000
    s_waitcnt lgkmcnt(0)
    s_barrier
    s_nop 15
    s_nop 15
    s_nop 15
    s_nop 15
    s_nop 15
    buffer_load_dwordx4 v0, s[4:7], s30 offen offset:0 sc1 lds
    buffer_load_dwordx4 v0, s[4:7], s30 offen offset:1024 sc1 lds
    buffer_load_dwordx4 v0, s[4:7], s30 offen offset:2048 sc1 lds
    s_nop 15
    s_nop 15
    s_nop 11
    buffer_load_dwordx4 v0, s[4:7], s30 offen offset:0 sc1 lds
    buffer_load_dwordx4 v0, s[4:7], s30 offen offset:1024 sc1 lds
    buffer_load_dwordx4 v0, s[4:7], s30 offen offset:2048 sc1 lds
L_recuagl_96:
    s_waitcnt vmcnt(3)
    ds_read2st64_b32 v[8:9], v4 offset0:0 offset1:4
    ds_read_b32 v10, v4 offset:2048
    buffer_load_dwordx4 v0, s[4:7], s30 offen offset:0 sc1 lds
    buffer_load_dwordx4 v0, s[4:7], s30 offen offset:1024 sc1 lds
    buffer_load_dwordx4 v0, s[4:7], s30 offen offset:2048 sc1 lds
    s_waitcnt lgkmcnt(0)
    v_max3_u32 v8, v8, v9, v10
    v_cmp_eq_u32 vcc, -1, v8
    s_cbranch_vccz L_recucl_92
    s_waitcnt vmcnt(3)
    ds_read2st64_b32 v[8:9], v4 offset0:0 offset1:4
    ds_read_b32 v10, v4 offset:2048
    buffer_load_dwordx4 v0, s[4:7], s30 offen offset:0 sc1 lds
    buffer_load_dwordx4 v0, s[4:7], s30 offen offset:1024 sc1 lds
    buffer_load_dwordx4 v0, s[4:7], s30 offen offset:2048 sc1 lds
    s_waitcnt lgkmcnt(0)
    v_max3_u32 v8, v8, v9, v10
    v_cmp_eq_u32 vcc, -1, v8
    s_cbranch_vccz L_recucl_92
    s_sub_u32 s50, s50, 1
    s_cbranch_scc0 L_recuagl_96
    s_branch L_exit_recurrent_scan__memory_aug_recurrent_mem_tr__moe_arch_mod__prompt_kernel
    s_branch L_recucl_92
L_recufin_93:
    s_waitcnt lgkmcnt(0)
    s_nop 7
    s_waitcnt vmcnt(0)
    v_mov_b32 v9, 64
    buffer_store_dword v9, off, s[4:7], s41 sc1
    s_waitcnt vmcnt(0)
    s_branch L_exit_recurrent_scan__memory_aug_recurrent_mem_tr__moe_arch_mod__prompt_kernel
L_recub_29:
L_recucl_97:
    s_barrier
    ds_read_b128 v[12:15], v2 offset:0
    ds_read_b128 v[16:19], v2 offset:1024
    ds_read_b128 v[20:23], v2 offset:2048
    s_waitcnt lgkmcnt(2)
    v_smfmac_f32_16x16x64_bf16 v[24:27], v[12:15], a[0:7], v7
    v_mov_b32 v8, s34
    v_smfmac_f32_16x16x64_bf16 v[28:31], v[12:15], v[56:63], v7
    ds_read_b128 v[56:59], v1 offset:20480
    v_smfmac_f32_16x16x64_bf16 v[32:35], v[12:15], a[8:15], v7
    ds_read_b128 v[60:63], v1 offset:21504
    v_smfmac_f32_16x16x64_bf16 v[36:39], v[12:15], v[64:71], v7
    ds_read_b128 v[64:67], v1 offset:22528
    v_smfmac_f32_16x16x64_bf16 v[40:43], v[12:15], a[16:23], v7
    ds_read_b128 v[68:71], v1 offset:23552
    v_smfmac_f32_16x16x64_bf16 v[44:47], v[12:15], a[24:31], v7
    buffer_load_dwordx4 v[48:51], v0, s[4:7], s47 offen offset:0
    ds_read_b128 v[12:15], v2 offset:3072
    s_waitcnt lgkmcnt(6)
    v_smfmac_f32_16x16x64_bf16 v[24:27], v[16:19], a[32:39], v7
    buffer_load_dwordx4 v[52:55], v0, s[4:7], s47 offen offset:1024
    v_smfmac_f32_16x16x64_bf16 v[28:31], v[16:19], v[72:79], v7
    ds_read_b128 v[72:75], v1 offset:24576
    v_smfmac_f32_16x16x64_bf16 v[32:35], v[16:19], a[40:47], v7
    ds_read_b128 v[76:79], v1 offset:25600
    buffer_store_dword v8, off, s[4:7], s41 sc1
    v_smfmac_f32_16x16x64_bf16 v[36:39], v[16:19], v[80:87], v7
    ds_read_b128 v[80:83], v1 offset:26624
    v_smfmac_f32_16x16x64_bf16 v[40:43], v[16:19], a[48:55], v7
    ds_read_b128 v[84:87], v1 offset:27648
    v_smfmac_f32_16x16x64_bf16 v[44:47], v[16:19], a[56:63], v7
    ds_read_b128 v[16:19], v2 offset:4096
    s_waitcnt lgkmcnt(10)
    v_smfmac_f32_16x16x64_bf16 v[24:27], v[20:23], a[64:71], v7
    s_waitcnt lgkmcnt(8)
    v_smfmac_f32_16x16x64_bf16 v[28:31], v[20:23], v[56:63], v7
    ds_read_b128 v[56:59], v1 offset:28672
    v_smfmac_f32_16x16x64_bf16 v[32:35], v[20:23], a[72:79], v7
    ds_read_b128 v[60:63], v1 offset:29696
    s_waitcnt lgkmcnt(8)
    v_smfmac_f32_16x16x64_bf16 v[36:39], v[20:23], v[64:71], v7
    ds_read_b128 v[64:67], v1 offset:30720
    v_smfmac_f32_16x16x64_bf16 v[40:43], v[20:23], a[80:87], v7
    ds_read_b128 v[68:71], v1 offset:31744
    v_smfmac_f32_16x16x64_bf16 v[44:47], v[20:23], a[88:95], v7
    s_waitcnt lgkmcnt(9)
    v_smfmac_f32_16x16x64_bf16 v[24:27], v[12:15], a[96:103], v7
    s_waitcnt lgkmcnt(7)
    v_smfmac_f32_16x16x64_bf16 v[28:31], v[12:15], v[72:79], v7
    ds_read_b128 v[72:75], v1 offset:0
    v_smfmac_f32_16x16x64_bf16 v[32:35], v[12:15], a[104:111], v7
    ds_read_b128 v[76:79], v1 offset:1024
    s_waitcnt lgkmcnt(7)
    v_smfmac_f32_16x16x64_bf16 v[36:39], v[12:15], v[80:87], v7
    ds_read_b128 v[80:83], v1 offset:2048
    s_waitcnt lgkmcnt(7)
    v_smfmac_f32_16x16x64_bf16 v[24:27], v[16:19], a[128:135], v7
    ds_read_b128 v[84:87], v1 offset:3072
    s_waitcnt lgkmcnt(6)
    v_smfmac_f32_16x16x64_bf16 v[28:31], v[16:19], v[56:63], v7
    ds_read_b128 v[56:59], v1 offset:32768
    v_smfmac_f32_16x16x64_bf16 v[32:35], v[16:19], a[136:143], v7
    ds_read_b128 v[60:63], v1 offset:33792
    s_waitcnt lgkmcnt(6)
    v_smfmac_f32_16x16x64_bf16 v[36:39], v[16:19], v[64:71], v7
    s_waitcnt vmcnt(3)
    s_barrier
    ds_read_b128 v[20:23], v2 offset:5120
    v_smfmac_f32_16x16x64_bf16 v[40:43], v[12:15], a[112:119], v7
    v_smfmac_f32_16x16x64_bf16 v[44:47], v[12:15], a[120:127], v7
    ds_read_b128 v[12:15], v2 offset:6144
    v_smfmac_f32_16x16x64_bf16 v[40:43], v[16:19], a[144:151], v7
    v_smfmac_f32_16x16x64_bf16 v[44:47], v[16:19], a[152:159], v7
    ds_read_b128 v[16:19], v2 offset:7168
    s_waitcnt lgkmcnt(2)
    v_smfmac_f32_16x16x64_bf16 v[24:27], v[20:23], a[160:167], v7
    v_smfmac_f32_16x16x64_bf16 v[28:31], v[20:23], v[72:79], v7
    v_smfmac_f32_16x16x64_bf16 v[32:35], v[20:23], a[168:175], v7
    v_smfmac_f32_16x16x64_bf16 v[36:39], v[20:23], v[80:87], v7
    ds_read_b128 v[20:23], v2 offset:8192
    s_waitcnt lgkmcnt(2)
    v_smfmac_f32_16x16x64_bf16 v[24:27], v[12:15], a[192:199], v7
    v_smfmac_f32_16x16x64_bf16 v[28:31], v[12:15], v[56:63], v7
    ds_read_b128 v[72:75], v0 offset:10240
    v_smfmac_f32_16x16x64_bf16 v[32:35], v[12:15], a[200:207], v7
    v_smfmac_f32_16x16x64_bf16 v[36:39], v[12:15], a[208:215], v7
    ds_read_b128 v[76:79], v0 offset:11264
    ds_read_b128 v[12:15], v2 offset:9216
    s_waitcnt lgkmcnt(4)
    v_smfmac_f32_16x16x64_bf16 v[24:27], v[16:19], a[232:239], v7
    v_lshrrev_b32 v71, 9, v0
    v_smfmac_f32_16x16x64_bf16 v[28:31], v[16:19], a[248:255], v7
    ds_read_b128 v[80:83], v0 offset:12288
    v_smfmac_f32_16x16x64_bf16 v[32:35], v[16:19], a[240:247], v7
    v_lshlrev_b32 v71, 3, v71
    v_smfmac_f32_16x16x64_bf16 v[36:39], v[16:19], v[88:95], v7
    ds_read_b128 v[84:87], v0 offset:13312
    s_waitcnt lgkmcnt(5)
    v_smfmac_f32_16x16x64_bf16 v[24:27], v[20:23], v[112:119], v7
    v_lshrrev_b32 v70, 1, v0
    v_smfmac_f32_16x16x64_bf16 v[28:31], v[20:23], v[128:135], v7
    v_xor_b32 v70, v71, v70
    v_smfmac_f32_16x16x64_bf16 v[32:35], v[20:23], v[120:127], v7
    v_xor_b32 v71, 16, v70
    v_smfmac_f32_16x16x64_bf16 v[36:39], v[20:23], v[136:143], v7
    s_waitcnt lgkmcnt(2)
    v_smfmac_f32_16x16x64_bf16 v[24:27], v[12:15], v[160:167], v7
    v_smfmac_f32_16x16x64_bf16 v[28:31], v[12:15], v[176:183], v7
    v_smfmac_f32_16x16x64_bf16 v[32:35], v[12:15], v[168:175], v7
    v_add_f32 v24, v24, v26
    v_smfmac_f32_16x16x64_bf16 v[36:39], v[12:15], v[184:191], v7
    v_add_f32 v25, v25, v27
    v_add_f32 v28, v28, v30
    v_cvt_pk_bf16_f32 v8, v24, v25
    v_add_f32 v29, v29, v31
    v_add_f32 v32, v32, v34
    v_cvt_pk_bf16_f32 v9, v28, v29
    v_add_f32 v33, v33, v35
    ds_write_b64 v3, v[8:9]
    v_pk_add_f32 v[36:37], v[36:37], v[38:39]
    v_cvt_pk_bf16_f32 v10, v32, v33
    v_cvt_pk_bf16_f32 v11, v36, v37
    ds_write_b64 v3, v[10:11] offset:128
    v_smfmac_f32_16x16x64_bf16 v[40:43], v[12:15], v[192:199], v7
    v_smfmac_f32_16x16x64_bf16 v[44:47], v[12:15], v[200:207], v7
    ds_read_b128 v[12:15], v2 offset:6144
    v_smfmac_f32_16x16x64_bf16 v[40:43], v[20:23], v[144:151], v7
    v_smfmac_f32_16x16x64_bf16 v[44:47], v[20:23], v[152:159], v7
    ds_read_b128 v[20:23], v2 offset:5120
    v_smfmac_f32_16x16x64_bf16 v[40:43], v[16:19], v[96:103], v7
    s_waitcnt lgkmcnt(2)
    s_barrier
    ds_read_b64_tr_b16 v[56:57], v70 offset:18432
    ds_read_b64_tr_b16 v[58:59], v71 offset:18944
    v_smfmac_f32_16x16x64_bf16 v[44:47], v[16:19], v[104:111], v7
    ds_read_b64_tr_b16 v[60:61], v70 offset:19456
    ds_read_b64_tr_b16 v[62:63], v71 offset:19968
    s_waitcnt lgkmcnt(5)
    v_smfmac_f32_16x16x64_bf16 v[40:43], v[12:15], a[216:223], v7
    ds_read_b64_tr_b16 v[64:65], v70 offset:20480
    ds_read_b64_tr_b16 v[66:67], v71 offset:20992
    v_smfmac_f32_16x16x64_bf16 v[44:47], v[12:15], a[224:231], v7
    ds_read_b64_tr_b16 v[68:69], v70 offset:21504
    ds_read_b64_tr_b16 v[70:71], v71 offset:22016
    s_waitcnt lgkmcnt(8)
    v_smfmac_f32_16x16x64_bf16 v[40:43], v[20:23], a[176:183], v7
    v_smfmac_f32_16x16x64_bf16 v[44:47], v[20:23], a[184:191], v7
    s_waitcnt lgkmcnt(6)
    v_mfma_f32_16x16x32_bf16 v[28:31], v[72:75], v[56:59], 0
    ds_read_b128 v[72:75], v0 offset:14336
    s_waitcnt lgkmcnt(5)
    v_mfma_f32_16x16x32_bf16 v[28:31], v[76:79], v[60:63], v[28:31]
    ds_read_b128 v[76:79], v0 offset:15360
    s_waitcnt lgkmcnt(4)
    v_mfma_f32_16x16x32_bf16 v[28:31], v[80:83], v[64:67], v[28:31]
    ds_read_b128 v[80:83], v0 offset:16384
    v_add_f32 v40, v40, v42
    s_waitcnt lgkmcnt(3)
    v_mfma_f32_16x16x32_bf16 v[28:31], v[84:87], v[68:71], v[28:31]
    ds_read_b128 v[84:87], v0 offset:17408
    v_add_f32 v44, v44, v46
    v_mfma_f32_16x16x32_bf16 v[24:27], v[56:59], v[56:59], 0
    v_add_f32 v41, v41, v43
    v_add_f32 v45, v45, v47
    v_mfma_f32_16x16x32_bf16 v[24:27], v[60:63], v[60:63], v[24:27]
    v_cvt_pk_bf16_f32 v46, v40, v41
    v_cvt_pk_bf16_f32 v47, v44, v45
    v_mfma_f32_16x16x32_bf16 v[24:27], v[64:67], v[64:67], v[24:27]
    v_lshrrev_b32 v11, 1, v0
    s_cmp_eq_u32 s34, 63
    buffer_store_dwordx2 v[46:47], v11, s[4:7], s40 offen sc1
    s_cbranch_scc1 L_recufin_98
    v_max3_f32 v8, v28, v29, v30
    v_mfma_f32_16x16x32_bf16 v[24:27], v[68:71], v[68:71], v[24:27]
    v_mov_b64 v[12:13], s[70:71]
    v_mov_b64 v[14:15], s[70:71]
    s_waitcnt lgkmcnt(3)
    v_mfma_f32_16x16x32_bf16 v[32:35], v[72:75], v[56:59], 0
    v_add_u32 v10, s49, v0
    v_mov_b64 v[36:37], 0
    s_waitcnt lgkmcnt(2)
    v_mfma_f32_16x16x32_bf16 v[32:35], v[76:79], v[60:63], v[32:35]
    v_max3_f32 v8, v8, v31, v26
    v_mov_b64 v[38:39], 0
    s_waitcnt lgkmcnt(1)
    v_mfma_f32_16x16x32_bf16 v[32:35], v[80:83], v[64:67], v[32:35]
    v_max_f32 v8, v8, v27
    ds_read_b128 v[72:75], v1 offset:8192
    ds_read_b128 v[76:79], v1 offset:9216
    s_waitcnt lgkmcnt(2)
    v_mfma_f32_16x16x32_bf16 v[32:35], v[84:87], v[68:71], v[32:35]
    ds_read_b128 v[80:83], v1 offset:4096
    ds_read_b128 v[84:87], v1 offset:5120
    v_mov_b32 v69, 0
    v_mov_b32 v70, 0
    v_mov_b64 v[40:41], 0
    v_mov_b64 v[42:43], 0
    s_nop 1
    v_max3_f32 v8, v8, v32, v33
    v_max3_f32 v9, v8, v34, v35
    v_max3_f32 v8, v8, v34, v35
    s_nop 1
    v_permlane32_swap_b32 v9, v8
    v_max_f32 v11, v8, v9
    v_max_f32 v8, v8, v9
    s_nop 1
    v_permlane16_swap_b32 v11, v8
    v_max_f32 v8, v8, v11
    v_mul_f32 v8, 0xbe0293ee, v8
    v_pk_fma_f32 v[26:27], v[26:27], s[68:69], v[8:9] op_sel_hi:[1,1,0]
    v_pk_fma_f32 v[28:29], v[28:29], s[68:69], v[8:9] op_sel_hi:[1,1,0]
    v_exp_f32 v26, v26
    v_exp_f32 v27, v27
    v_pk_fma_f32 v[30:31], v[30:31], s[68:69], v[8:9] op_sel_hi:[1,1,0]
    v_exp_f32 v28, v28
    v_pk_fma_f32 v[32:33], v[32:33], s[68:69], v[8:9] op_sel_hi:[1,1,0]
    v_exp_f32 v29, v29
    v_cvt_pk_bf16_f32 v68, v26, v27
    v_pk_fma_f32 v[34:35], v[34:35], s[68:69], v[8:9] op_sel_hi:[1,1,0]
    v_cvt_pk_bf16_f32 v71, v26, v27
    v_exp_f32 v30, v30
    v_mfma_f32_16x16x16_bf16 v[16:19], v[12:13], v[68:69], 0
    v_exp_f32 v31, v31
    v_cvt_pk_bf16_f32 v64, v28, v29
    v_mfma_f32_16x16x16_bf16 v[56:59], v[46:47], v[68:69], 0
    v_exp_f32 v32, v32
    v_exp_f32 v33, v33
    v_mfma_f32_16x16x16_bf16 v[60:63], v[46:47], v[70:71], 0
    v_cvt_pk_bf16_f32 v65, v30, v31
    v_exp_f32 v34, v34
    v_exp_f32 v35, v35
    v_cvt_pk_bf16_f32 v66, v32, v33
    s_waitcnt vmcnt(1)
    v_cvt_pk_bf16_f32 v67, v34, v35
    v_mov_b64 v[24:25], 0
    s_nop 0
    v_mfma_f32_16x16x32_bf16 v[16:19], v[12:15], v[64:67], v[16:19]
    v_mov_b64 v[26:27], 0
    v_mov_b64 v[28:29], 0
    v_mfma_f32_16x16x32_bf16 v[56:59], v[48:51], v[64:67], v[56:59]
    v_mov_b64 v[30:31], 0
    v_mov_b64 v[32:33], 0
    v_mfma_f32_16x16x32_bf16 v[60:63], v[52:55], v[64:67], v[60:63]
    v_mov_b64 v[34:35], 0
    v_rcp_f32 v8, v16
    s_nop 1
    v_pk_mul_f32 v[56:57], v[56:57], v[8:9] op_sel_hi:[1,0]
    v_pk_mul_f32 v[58:59], v[58:59], v[8:9] op_sel_hi:[1,0]
    v_cvt_pk_bf16_f32 v20, v56, v57
    v_cvt_pk_bf16_f32 v21, v58, v59
    v_pk_mul_f32 v[60:61], v[60:61], v[8:9] op_sel_hi:[1,0]
    v_pk_mul_f32 v[62:63], v[62:63], v[8:9] op_sel_hi:[1,0]
    v_cvt_pk_bf16_f32 v22, v60, v61
    v_cvt_pk_bf16_f32 v23, v62, v63
    s_mov_b64 exec, s[64:65]
    ds_write_b128 v10, v[20:23]
    s_mov_b64 exec, -1
    ds_read_b128 v[56:59], v1 offset:6144
    ds_read_b128 v[60:63], v1 offset:7168
    ds_read_b128 v[64:67], v1 offset:10240
    ds_read_b128 v[68:71], v1 offset:11264
    s_waitcnt lgkmcnt(4)
    s_barrier
    ds_read_b128 v[12:15], v0 offset:22528
    ds_read_b128 v[16:19], v0 offset:23552
    s_mov_b32 m0, s51
    s_nop 0
    buffer_load_dwordx4 v0, s[4:7], s39 offen lds
    buffer_load_dwordx4 v0, s[4:7], s39 offen offset:1024 lds
    s_waitcnt lgkmcnt(1)
    v_smfmac_f32_16x16x64_bf16 v[40:43], v[12:15], v[72:79], v7
    s_waitcnt lgkmcnt(0)
    v_smfmac_f32_16x16x64_bf16 v[40:43], v[16:19], v[64:71], v7
    v_smfmac_f32_16x16x64_bf16 v[24:27], v[12:15], v[208:215], v7
    v_smfmac_f32_16x16x64_bf16 v[24:27], v[16:19], v[240:247], v7
    v_add_f32 v40, v40, v42
    v_smfmac_f32_16x16x64_bf16 v[28:31], v[12:15], v[216:223], v7
    v_add_f32 v41, v41, v43
    v_smfmac_f32_16x16x64_bf16 v[28:31], v[16:19], v[248:255], v7
    v_cvt_pk_bf16_f32 v20, v40, v41
    v_smfmac_f32_16x16x64_bf16 v[32:35], v[12:15], v[224:231], v7
    v_bfi_b32 v20, 1, s19, v20
    v_smfmac_f32_16x16x64_bf16 v[32:35], v[16:19], v[80:87], v7
    buffer_store_dword v20, v6, s[4:7], s35 offen
    v_add_f32 v24, v24, v26
    v_smfmac_f32_16x16x64_bf16 v[36:39], v[12:15], v[232:239], v7
    v_add_f32 v25, v25, v27
    v_smfmac_f32_16x16x64_bf16 v[36:39], v[16:19], v[56:63], v7
    v_add_f32 v28, v28, v30
    v_add_f32 v29, v29, v31
    v_cvt_pk_bf16_f32 v8, v24, v25
    v_add_f32 v32, v32, v34
    v_cvt_pk_bf16_f32 v9, v28, v29
    v_add_f32 v33, v33, v35
    v_bfi_b32 v8, 1, s19, v8
    v_cvt_pk_bf16_f32 v10, v32, v33
    v_pk_add_f32 v[36:37], v[36:37], v[38:39]
    v_cvt_pk_bf16_f32 v11, v36, v37
    buffer_store_dwordx4 v[8:11], v5, s[4:7], s35 offen
    s_add_u32 s39, s39, 262144
    s_add_u32 s47, s47, 262144
    s_xor_b32 s35, s35, 262144
    s_add_u32 s40, s40, 65536
    v_mov_b64 v[24:25], 0
    v_mov_b64 v[26:27], 0
    v_mov_b64 v[28:29], 0
    v_mov_b64 v[30:31], 0
    v_mov_b64 v[32:33], 0
    v_mov_b64 v[34:35], 0
    v_mov_b64 v[36:37], 0
    v_mov_b64 v[38:39], 0
    v_mov_b64 v[40:41], 0
    v_mov_b64 v[42:43], 0
    v_mov_b64 v[44:45], 0
    v_mov_b64 v[46:47], 0
    ds_read_b128 v[56:59], v1 offset:12288
    ds_read_b128 v[60:63], v1 offset:13312
    ds_read_b128 v[64:67], v1 offset:14336
    ds_read_b128 v[68:71], v1 offset:15360
    ds_read_b128 v[72:75], v1 offset:16384
    ds_read_b128 v[76:79], v1 offset:17408
    ds_read_b128 v[80:83], v1 offset:18432
    ds_read_b128 v[84:87], v1 offset:19456
    s_mov_b32 m0, s66
    s_add_u32 s34, s34, 1
    s_bfe_u32 s19, s34, 0x10001
    s_mov_b32 s50, 3200000
    s_mov_b32 s30, s37
    s_add_u32 s37, s37, 8192
    s_andn2_b32 s37, s37, 0x8000
    s_waitcnt lgkmcnt(0)
    s_barrier
    s_nop 15
    s_nop 15
    s_nop 15
    s_nop 15
    s_nop 15
    buffer_load_dwordx4 v0, s[4:7], s30 offen offset:0 sc1 lds
    buffer_load_dwordx4 v0, s[4:7], s30 offen offset:1024 sc1 lds
    s_nop 15
    s_nop 15
    s_nop 11
    buffer_load_dwordx4 v0, s[4:7], s30 offen offset:0 sc1 lds
    buffer_load_dwordx4 v0, s[4:7], s30 offen offset:1024 sc1 lds
L_recuagl_101:
    s_waitcnt vmcnt(2)
    ds_read2st64_b32 v[8:9], v4 offset0:12 offset1:16
    buffer_load_dwordx4 v0, s[4:7], s30 offen offset:0 sc1 lds
    buffer_load_dwordx4 v0, s[4:7], s30 offen offset:1024 sc1 lds
    s_waitcnt lgkmcnt(0)
    v_max_u32 v8, v8, v9
    v_cmp_eq_u32 vcc, -1, v8
    s_cbranch_vccz L_recucl_97
    s_waitcnt vmcnt(2)
    ds_read2st64_b32 v[8:9], v4 offset0:12 offset1:16
    buffer_load_dwordx4 v0, s[4:7], s30 offen offset:0 sc1 lds
    buffer_load_dwordx4 v0, s[4:7], s30 offen offset:1024 sc1 lds
    s_waitcnt lgkmcnt(0)
    v_max_u32 v8, v8, v9
    v_cmp_eq_u32 vcc, -1, v8
    s_cbranch_vccz L_recucl_97
    s_sub_u32 s50, s50, 1
    s_cbranch_scc0 L_recuagl_101
    s_branch L_exit_recurrent_scan__memory_aug_recurrent_mem_tr__moe_arch_mod__prompt_kernel
    s_branch L_recucl_97
L_recufin_98:
    s_waitcnt lgkmcnt(0)
    s_nop 7
    s_waitcnt vmcnt(0)
    v_mov_b32 v9, 64
    buffer_store_dword v9, off, s[4:7], s41 sc1
    s_waitcnt vmcnt(0)
    s_branch L_exit_recurrent_scan__memory_aug_recurrent_mem_tr__moe_arch_mod__prompt_kernel
    s_branch L_exit_recurrent_scan__memory_aug_recurrent_mem_tr__moe_arch_mod__prompt_kernel
L_recugen_17:
    s_mov_b32 s26, 1
    s_cmp_gt_u32 s44, s26
    s_cbranch_scc1 L_recuf0_102
    s_mov_b32 s50, 0
    s_branch L_recuf0sp_105
L_recuf0s_103:
    buffer_load_dword v17, v16, s[4:7], s46 offen sc1
L_recuf0sp_105:
    s_waitcnt vmcnt(0)
    v_lshl_add_u32 v17, v17, 1, v18
    v_cmp_ge_u32 vcc, s26, v17
    s_cbranch_vccz L_recuf0sok_104
    s_add_u32 s50, s50, 1
    s_cmp_lt_u32 s50, 400000
    s_cbranch_scc0 L_exit_recurrent_scan__memory_aug_recurrent_mem_tr__moe_arch_mod__prompt_kernel
    s_sleep 2
    s_branch L_recuf0s_103
L_recuf0sok_104:
    v_min_u32_dpp v17, v17, v17 quad_perm:[1,0,3,2] row_mask:0xf bank_mask:0xf
    s_nop 1
    v_min_u32_dpp v17, v17, v17 quad_perm:[2,3,0,1] row_mask:0xf bank_mask:0xf
    s_nop 1
    v_min_u32_dpp v17, v17, v17 row_half_mirror row_mask:0xf bank_mask:0xf
    s_nop 1
    v_min_u32_dpp v17, v17, v17 row_mirror row_mask:0xf bank_mask:0xf
    s_nop 0
    v_readfirstlane_b32 s44, v17
L_recuf0_102:
    s_mov_b32 m0, s51
    s_nop 0
    buffer_load_dwordx4 v0, s[4:7], s39 offen lds
    buffer_load_dwordx4 v0, s[4:7], s39 offen offset:1024 lds
    s_add_u32 s39, s39, 262144
    v_mov_b64 v[24:25], 0
    v_mov_b64 v[26:27], 0
    v_mov_b64 v[28:29], 0
    v_mov_b64 v[30:31], 0
    v_mov_b64 v[32:33], 0
    v_mov_b64 v[34:35], 0
    v_mov_b64 v[36:37], 0
    v_mov_b64 v[38:39], 0
    v_mov_b64 v[40:41], 0
    v_mov_b64 v[42:43], 0
    v_mov_b64 v[44:45], 0
    v_mov_b64 v[46:47], 0
    ds_read_b128 v[56:59], v1 offset:12288
    ds_read_b128 v[60:63], v1 offset:13312
    ds_read_b128 v[64:67], v1 offset:14336
    ds_read_b128 v[68:71], v1 offset:15360
    ds_read_b128 v[72:75], v1 offset:16384
    ds_read_b128 v[76:79], v1 offset:17408
    ds_read_b128 v[80:83], v1 offset:18432
    ds_read_b128 v[84:87], v1 offset:19456
    v_bfe_u32 v4, v0, 7, 2
    v_lshl_add_u32 v4, v4, 2, v0
    s_waitcnt lgkmcnt(0)
    s_mov_b64 s[8:9], 0
    s_mov_b32 s30, s38
    s_mov_b32 m0, s66
    s_mov_b32 s19, 0
    s_lshl_b32 s26, s32, 2
    s_add_u32 s26, s26, s24
    s_cmp_eq_u32 s26, 1
    s_cbranch_scc1 L_recub_107
    s_cmp_eq_u32 s26, 2
    s_cbranch_scc1 L_recub_108
    s_cmp_eq_u32 s26, 3
    s_cbranch_scc1 L_recub_109
    s_cmp_eq_u32 s26, 4
    s_cbranch_scc1 L_recub_110
    s_cmp_eq_u32 s26, 5
    s_cbranch_scc1 L_recub_111
    s_cmp_eq_u32 s26, 6
    s_cbranch_scc1 L_recub_112
    s_cmp_eq_u32 s26, 7
    s_cbranch_scc1 L_recub_113
L_recub_106:
L_recucl_114:
    s_barrier
    ds_read_b128 v[12:15], v2 offset:0
    ds_read_b128 v[16:19], v2 offset:1024
    ds_read_b128 v[20:23], v2 offset:2048
    s_mov_b64 exec, s[8:9]
    buffer_load_dwordx4 v0, s[4:7], s30 offen offset:0 sc1 lds
    buffer_load_dwordx4 v0, s[4:7], s30 offen offset:1024 sc1 lds
    buffer_load_dwordx4 v0, s[4:7], s30 offen offset:2048 sc1 lds
    s_mov_b64 exec, -1
    s_waitcnt lgkmcnt(2)
    v_smfmac_f32_16x16x64_bf16 v[24:27], v[12:15], a[0:7], v7
    v_mov_b32 v8, s34
    v_smfmac_f32_16x16x64_bf16 v[28:31], v[12:15], v[56:63], v7
    ds_read_b128 v[56:59], v1 offset:20480
    v_smfmac_f32_16x16x64_bf16 v[32:35], v[12:15], a[8:15], v7
    ds_read_b128 v[60:63], v1 offset:21504
    v_smfmac_f32_16x16x64_bf16 v[36:39], v[12:15], v[64:71], v7
    ds_read_b128 v[64:67], v1 offset:22528
    v_smfmac_f32_16x16x64_bf16 v[40:43], v[12:15], a[16:23], v7
    ds_read_b128 v[68:71], v1 offset:23552
    v_smfmac_f32_16x16x64_bf16 v[44:47], v[12:15], a[24:31], v7
    buffer_load_dwordx4 v[48:51], v0, s[4:7], s47 offen offset:0
    ds_read_b128 v[12:15], v2 offset:3072
    s_waitcnt lgkmcnt(6)
    v_smfmac_f32_16x16x64_bf16 v[24:27], v[16:19], a[32:39], v7
    buffer_load_dwordx4 v[52:55], v0, s[4:7], s47 offen offset:1024
    v_smfmac_f32_16x16x64_bf16 v[28:31], v[16:19], v[72:79], v7
    ds_read_b128 v[72:75], v1 offset:24576
    v_smfmac_f32_16x16x64_bf16 v[32:35], v[16:19], a[40:47], v7
    ds_read_b128 v[76:79], v1 offset:25600
    buffer_store_dword v8, off, s[4:7], s41 sc1
    v_smfmac_f32_16x16x64_bf16 v[36:39], v[16:19], v[80:87], v7
    ds_read_b128 v[80:83], v1 offset:26624
    v_smfmac_f32_16x16x64_bf16 v[40:43], v[16:19], a[48:55], v7
    ds_read_b128 v[84:87], v1 offset:27648
    v_smfmac_f32_16x16x64_bf16 v[44:47], v[16:19], a[56:63], v7
    ds_read_b128 v[16:19], v2 offset:4096
    s_waitcnt lgkmcnt(10)
    v_smfmac_f32_16x16x64_bf16 v[24:27], v[20:23], a[64:71], v7
    s_waitcnt lgkmcnt(8)
    v_smfmac_f32_16x16x64_bf16 v[28:31], v[20:23], v[56:63], v7
    ds_read_b128 v[56:59], v1 offset:28672
    v_smfmac_f32_16x16x64_bf16 v[32:35], v[20:23], a[72:79], v7
    ds_read_b128 v[60:63], v1 offset:29696
    s_waitcnt lgkmcnt(8)
    v_smfmac_f32_16x16x64_bf16 v[36:39], v[20:23], v[64:71], v7
    ds_read_b128 v[64:67], v1 offset:30720
    v_smfmac_f32_16x16x64_bf16 v[40:43], v[20:23], a[80:87], v7
    ds_read_b128 v[68:71], v1 offset:31744
    v_smfmac_f32_16x16x64_bf16 v[44:47], v[20:23], a[88:95], v7
    s_waitcnt lgkmcnt(9)
    v_smfmac_f32_16x16x64_bf16 v[24:27], v[12:15], a[96:103], v7
    s_waitcnt lgkmcnt(7)
    v_smfmac_f32_16x16x64_bf16 v[28:31], v[12:15], v[72:79], v7
    ds_read_b128 v[72:75], v1 offset:0
    v_smfmac_f32_16x16x64_bf16 v[32:35], v[12:15], a[104:111], v7
    ds_read_b128 v[76:79], v1 offset:1024
    s_waitcnt lgkmcnt(7)
    v_smfmac_f32_16x16x64_bf16 v[36:39], v[12:15], v[80:87], v7
    ds_read_b128 v[80:83], v1 offset:2048
    s_waitcnt vmcnt(3)
    ds_read2st64_b32 v[8:9], v4 offset0:20 offset1:24
    ds_read_b32 v10, v4 offset:7168
    s_waitcnt lgkmcnt(9)
    v_smfmac_f32_16x16x64_bf16 v[24:27], v[16:19], a[128:135], v7
    ds_read_b128 v[84:87], v1 offset:3072
    s_waitcnt lgkmcnt(8)
    v_smfmac_f32_16x16x64_bf16 v[28:31], v[16:19], v[56:63], v7
    ds_read_b128 v[56:59], v1 offset:32768
    v_smfmac_f32_16x16x64_bf16 v[32:35], v[16:19], a[136:143], v7
    ds_read_b128 v[60:63], v1 offset:33792
    s_waitcnt lgkmcnt(3)
    v_max3_u32 v8, v8, v9, v10
    v_smfmac_f32_16x16x64_bf16 v[36:39], v[16:19], v[64:71], v7
    v_cmp_eq_u32 vcc, -1, v8
    s_cbranch_vccnz L_recurt_116
L_recurb_117:
    s_barrier
    ds_read_b128 v[20:23], v2 offset:5120
    v_smfmac_f32_16x16x64_bf16 v[40:43], v[12:15], a[112:119], v7
    v_smfmac_f32_16x16x64_bf16 v[44:47], v[12:15], a[120:127], v7
    ds_read_b128 v[12:15], v2 offset:6144
    v_smfmac_f32_16x16x64_bf16 v[40:43], v[16:19], a[144:151], v7
    v_smfmac_f32_16x16x64_bf16 v[44:47], v[16:19], a[152:159], v7
    ds_read_b128 v[16:19], v2 offset:7168
    s_waitcnt lgkmcnt(2)
    v_smfmac_f32_16x16x64_bf16 v[24:27], v[20:23], a[160:167], v7
    v_smfmac_f32_16x16x64_bf16 v[28:31], v[20:23], v[72:79], v7
    v_smfmac_f32_16x16x64_bf16 v[32:35], v[20:23], a[168:175], v7
    v_smfmac_f32_16x16x64_bf16 v[36:39], v[20:23], v[80:87], v7
    ds_read_b128 v[20:23], v2 offset:8192
    s_waitcnt lgkmcnt(2)
    v_smfmac_f32_16x16x64_bf16 v[24:27], v[12:15], a[192:199], v7
    v_smfmac_f32_16x16x64_bf16 v[28:31], v[12:15], v[56:63], v7
    ds_read_b128 v[72:75], v0 offset:10240
    v_smfmac_f32_16x16x64_bf16 v[32:35], v[12:15], a[200:207], v7
    v_lshlrev_b32 v4, 3, v0
    v_smfmac_f32_16x16x64_bf16 v[36:39], v[12:15], a[208:215], v7
    buffer_load_dword v4, v4, s[4:7], s67 offen
    ds_read_b128 v[76:79], v0 offset:11264
    ds_read_b128 v[12:15], v2 offset:9216
    s_waitcnt lgkmcnt(4)
    v_smfmac_f32_16x16x64_bf16 v[24:27], v[16:19], a[232:239], v7
    v_lshrrev_b32 v71, 9, v0
    v_smfmac_f32_16x16x64_bf16 v[28:31], v[16:19], a[248:255], v7
    ds_read_b128 v[80:83], v0 offset:12288
    v_smfmac_f32_16x16x64_bf16 v[32:35], v[16:19], a[240:247], v7
    v_lshlrev_b32 v71, 3, v71
    v_smfmac_f32_16x16x64_bf16 v[36:39], v[16:19], v[88:95], v7
    ds_read_b128 v[84:87], v0 offset:13312
    s_waitcnt lgkmcnt(5)
    v_smfmac_f32_16x16x64_bf16 v[24:27], v[20:23], v[112:119], v7
    v_lshrrev_b32 v70, 1, v0
    v_smfmac_f32_16x16x64_bf16 v[28:31], v[20:23], v[128:135], v7
    v_xor_b32 v70, v71, v70
    v_smfmac_f32_16x16x64_bf16 v[32:35], v[20:23], v[120:127], v7
    v_xor_b32 v71, 16, v70
    v_smfmac_f32_16x16x64_bf16 v[36:39], v[20:23], v[136:143], v7
    s_waitcnt lgkmcnt(2)
    v_smfmac_f32_16x16x64_bf16 v[24:27], v[12:15], v[160:167], v7
    v_smfmac_f32_16x16x64_bf16 v[28:31], v[12:15], v[176:183], v7
    v_smfmac_f32_16x16x64_bf16 v[32:35], v[12:15], v[168:175], v7
    v_add_f32 v24, v24, v26
    v_smfmac_f32_16x16x64_bf16 v[36:39], v[12:15], v[184:191], v7
    v_add_f32 v25, v25, v27
    v_add_f32 v28, v28, v30
    v_cvt_pk_bf16_f32 v8, v24, v25
    v_add_f32 v29, v29, v31
    v_add_f32 v32, v32, v34
    v_cvt_pk_bf16_f32 v9, v28, v29
    v_add_f32 v33, v33, v35
    ds_write_b64 v3, v[8:9]
    v_pk_add_f32 v[36:37], v[36:37], v[38:39]
    v_cvt_pk_bf16_f32 v10, v32, v33
    v_cvt_pk_bf16_f32 v11, v36, v37
    ds_write_b64 v3, v[10:11] offset:128
    v_smfmac_f32_16x16x64_bf16 v[40:43], v[12:15], v[192:199], v7
    v_smfmac_f32_16x16x64_bf16 v[44:47], v[12:15], v[200:207], v7
    ds_read_b128 v[12:15], v2 offset:6144
    v_smfmac_f32_16x16x64_bf16 v[40:43], v[20:23], v[144:151], v7
    v_smfmac_f32_16x16x64_bf16 v[44:47], v[20:23], v[152:159], v7
    ds_read_b128 v[20:23], v2 offset:5120
    v_smfmac_f32_16x16x64_bf16 v[40:43], v[16:19], v[96:103], v7
    s_waitcnt lgkmcnt(2)
    s_barrier
    ds_read_b64_tr_b16 v[56:57], v70 offset:18432
    ds_read_b64_tr_b16 v[58:59], v71 offset:18944
    v_smfmac_f32_16x16x64_bf16 v[44:47], v[16:19], v[104:111], v7
    ds_read_b64_tr_b16 v[60:61], v70 offset:19456
    ds_read_b64_tr_b16 v[62:63], v71 offset:19968
    s_waitcnt lgkmcnt(5)
    v_smfmac_f32_16x16x64_bf16 v[40:43], v[12:15], a[216:223], v7
    ds_read_b64_tr_b16 v[64:65], v70 offset:20480
    ds_read_b64_tr_b16 v[66:67], v71 offset:20992
    v_smfmac_f32_16x16x64_bf16 v[44:47], v[12:15], a[224:231], v7
    ds_read_b64_tr_b16 v[68:69], v70 offset:21504
    ds_read_b64_tr_b16 v[70:71], v71 offset:22016
    s_waitcnt lgkmcnt(8)
    v_smfmac_f32_16x16x64_bf16 v[40:43], v[20:23], a[176:183], v7
    v_smfmac_f32_16x16x64_bf16 v[44:47], v[20:23], a[184:191], v7
    s_waitcnt lgkmcnt(6)
    v_mfma_f32_16x16x32_bf16 v[28:31], v[72:75], v[56:59], 0
    ds_read_b128 v[72:75], v0 offset:14336
    s_waitcnt lgkmcnt(5)
    v_mfma_f32_16x16x32_bf16 v[28:31], v[76:79], v[60:63], v[28:31]
    ds_read_b128 v[76:79], v0 offset:15360
    s_waitcnt lgkmcnt(4)
    v_mfma_f32_16x16x32_bf16 v[28:31], v[80:83], v[64:67], v[28:31]
    ds_read_b128 v[80:83], v0 offset:16384
    v_add_f32 v40, v40, v42
    s_waitcnt lgkmcnt(3)
    v_mfma_f32_16x16x32_bf16 v[28:31], v[84:87], v[68:71], v[28:31]
    ds_read_b128 v[84:87], v0 offset:17408
    v_add_f32 v44, v44, v46
    v_mfma_f32_16x16x32_bf16 v[24:27], v[56:59], v[56:59], 0
    v_add_f32 v41, v41, v43
    v_add_f32 v45, v45, v47
    v_mfma_f32_16x16x32_bf16 v[24:27], v[60:63], v[60:63], v[24:27]
    v_cvt_pk_bf16_f32 v46, v40, v41
    v_cvt_pk_bf16_f32 v47, v44, v45
    v_mfma_f32_16x16x32_bf16 v[24:27], v[64:67], v[64:67], v[24:27]
    s_cmp_eq_u32 s34, 63
    buffer_store_dwordx4 v[56:59], v0, s[4:7], s40 offen sc1
    s_cbranch_scc1 L_recufin_115
    v_max3_f32 v8, v28, v29, v30
    v_mfma_f32_16x16x32_bf16 v[24:27], v[68:71], v[68:71], v[24:27]
    v_mov_b64 v[12:13], s[70:71]
    v_mov_b64 v[14:15], s[70:71]
    s_waitcnt lgkmcnt(3)
    v_mfma_f32_16x16x32_bf16 v[32:35], v[72:75], v[56:59], 0
    v_add_u32 v10, s49, v0
    v_mov_b64 v[36:37], 0
    s_waitcnt lgkmcnt(2)
    v_mfma_f32_16x16x32_bf16 v[32:35], v[76:79], v[60:63], v[32:35]
    v_max3_f32 v8, v8, v31, v26
    v_mov_b64 v[38:39], 0
    s_waitcnt lgkmcnt(1)
    v_mfma_f32_16x16x32_bf16 v[32:35], v[80:83], v[64:67], v[32:35]
    v_max_f32 v8, v8, v27
    ds_read_b128 v[72:75], v1 offset:8192
    ds_read_b128 v[76:79], v1 offset:9216
    s_waitcnt lgkmcnt(2)
    v_mfma_f32_16x16x32_bf16 v[32:35], v[84:87], v[68:71], v[32:35]
    ds_read_b128 v[80:83], v1 offset:4096
    ds_read_b128 v[84:87], v1 offset:5120
    v_mov_b32 v69, 0
    v_mov_b32 v70, 0
    v_mov_b64 v[40:41], 0
    v_mov_b64 v[42:43], 0
    s_nop 1
    v_max3_f32 v8, v8, v32, v33
    v_max3_f32 v9, v8, v34, v35
    v_max3_f32 v8, v8, v34, v35
    s_nop 1
    v_permlane32_swap_b32 v9, v8
    v_max_f32 v11, v8, v9
    v_max_f32 v8, v8, v9
    s_nop 1
    v_permlane16_swap_b32 v11, v8
    v_max_f32 v8, v8, v11
    v_mul_f32 v8, 0xbe0293ee, v8
    v_pk_fma_f32 v[26:27], v[26:27], s[68:69], v[8:9] op_sel_hi:[1,1,0]
    v_pk_fma_f32 v[28:29], v[28:29], s[68:69], v[8:9] op_sel_hi:[1,1,0]
    v_exp_f32 v26, v26
    v_exp_f32 v27, v27
    v_pk_fma_f32 v[30:31], v[30:31], s[68:69], v[8:9] op_sel_hi:[1,1,0]
    v_exp_f32 v28, v28
    v_pk_fma_f32 v[32:33], v[32:33], s[68:69], v[8:9] op_sel_hi:[1,1,0]
    v_exp_f32 v29, v29
    v_cvt_pk_bf16_f32 v68, v26, v27
    v_pk_fma_f32 v[34:35], v[34:35], s[68:69], v[8:9] op_sel_hi:[1,1,0]
    v_cvt_pk_bf16_f32 v71, v26, v27
    v_exp_f32 v30, v30
    v_mfma_f32_16x16x16_bf16 v[16:19], v[12:13], v[68:69], 0
    v_exp_f32 v31, v31
    v_cvt_pk_bf16_f32 v64, v28, v29
    v_mfma_f32_16x16x16_bf16 v[56:59], v[46:47], v[68:69], 0
    v_exp_f32 v32, v32
    v_exp_f32 v33, v33
    v_mfma_f32_16x16x16_bf16 v[60:63], v[46:47], v[70:71], 0
    v_cvt_pk_bf16_f32 v65, v30, v31
    v_exp_f32 v34, v34
    v_exp_f32 v35, v35
    v_cvt_pk_bf16_f32 v66, v32, v33
    s_waitcnt vmcnt(2)
    v_cvt_pk_bf16_f32 v67, v34, v35
    v_mov_b64 v[24:25], 0
    s_nop 0
    v_mfma_f32_16x16x32_bf16 v[16:19], v[12:15], v[64:67], v[16:19]
    v_mov_b64 v[26:27], 0
    v_mov_b64 v[28:29], 0
    v_mfma_f32_16x16x32_bf16 v[56:59], v[48:51], v[64:67], v[56:59]
    v_mov_b64 v[30:31], 0
    v_mov_b64 v[32:33], 0
    v_mfma_f32_16x16x32_bf16 v[60:63], v[52:55], v[64:67], v[60:63]
    v_mov_b64 v[34:35], 0
    v_rcp_f32 v8, v16
    s_nop 1
    v_pk_mul_f32 v[56:57], v[56:57], v[8:9] op_sel_hi:[1,0]
    v_pk_mul_f32 v[58:59], v[58:59], v[8:9] op_sel_hi:[1,0]
    v_cvt_pk_bf16_f32 v20, v56, v57
    v_cvt_pk_bf16_f32 v21, v58, v59
    v_pk_mul_f32 v[60:61], v[60:61], v[8:9] op_sel_hi:[1,0]
    v_pk_mul_f32 v[62:63], v[62:63], v[8:9] op_sel_hi:[1,0]
    v_cvt_pk_bf16_f32 v22, v60, v61
    v_cvt_pk_bf16_f32 v23, v62, v63
    s_mov_b64 exec, s[64:65]
    ds_write_b128 v10, v[20:23]
    s_mov_b64 exec, -1
    ds_read_b128 v[56:59], v1 offset:6144
    ds_read_b128 v[60:63], v1 offset:7168
    ds_read_b128 v[64:67], v1 offset:10240
    ds_read_b128 v[68:71], v1 offset:11264
    s_waitcnt lgkmcnt(4)
    s_barrier
    ds_read_b128 v[12:15], v0 offset:22528
    ds_read_b128 v[16:19], v0 offset:23552
    s_mov_b32 m0, s51
    s_nop 0
    buffer_load_dwordx4 v0, s[4:7], s39 offen lds
    buffer_load_dwordx4 v0, s[4:7], s39 offen offset:1024 lds
    s_waitcnt lgkmcnt(1)
    v_smfmac_f32_16x16x64_bf16 v[40:43], v[12:15], v[72:79], v7
    s_waitcnt lgkmcnt(0)
    v_smfmac_f32_16x16x64_bf16 v[40:43], v[16:19], v[64:71], v7
    v_smfmac_f32_16x16x64_bf16 v[24:27], v[12:15], v[208:215], v7
    v_smfmac_f32_16x16x64_bf16 v[24:27], v[16:19], v[240:247], v7
    v_add_f32 v40, v40, v42
    v_smfmac_f32_16x16x64_bf16 v[28:31], v[12:15], v[216:223], v7
    v_add_f32 v41, v41, v43
    v_smfmac_f32_16x16x64_bf16 v[28:31], v[16:19], v[248:255], v7
    v_cvt_pk_bf16_f32 v20, v40, v41
    v_smfmac_f32_16x16x64_bf16 v[32:35], v[12:15], v[224:231], v7
    v_bfi_b32 v20, 1, s19, v20
    v_smfmac_f32_16x16x64_bf16 v[32:35], v[16:19], v[80:87], v7
    buffer_store_dword v20, v6, s[4:7], s35 offen sc1
    v_add_f32 v24, v24, v26
    v_smfmac_f32_16x16x64_bf16 v[36:39], v[12:15], v[232:239], v7
    v_add_f32 v25, v25, v27
    v_smfmac_f32_16x16x64_bf16 v[36:39], v[16:19], v[56:63], v7
    v_add_f32 v28, v28, v30
    v_add_f32 v29, v29, v31
    v_cvt_pk_bf16_f32 v8, v24, v25
    v_add_f32 v32, v32, v34
    v_cvt_pk_bf16_f32 v9, v28, v29
    v_add_f32 v33, v33, v35
    v_bfi_b32 v8, 1, s19, v8
    v_cvt_pk_bf16_f32 v10, v32, v33
    v_pk_add_f32 v[36:37], v[36:37], v[38:39]
    v_cvt_pk_bf16_f32 v11, v36, v37
    buffer_store_dwordx4 v[8:11], v5, s[4:7], s35 offen sc1
    s_add_u32 s39, s39, 262144
    s_add_u32 s47, s47, 262144
    s_xor_b32 s35, s35, 262144
    s_add_u32 s40, s40, 131072
    s_cmp_eq_u32 s42, 0
    s_cbranch_scc1 L_recunred_118
    v_bfe_u32 v8, v0, 4, 1
    v_lshlrev_b32 v21, 4, v8
    v_mov_b32 v10, 0x3f80
    v_lshlrev_b32 v10, v21, v10
    v_bfe_u32 v11, v0, 5, 3
    v_cmp_eq_u32 s[52:53], 0, v11
    v_cmp_eq_u32 s[54:55], 1, v11
    v_cmp_eq_u32 s[56:57], 2, v11
    v_cmp_eq_u32 s[58:59], 3, v11
    v_cndmask_b32 v12, 0, v10, s[52:53]
    v_cndmask_b32 v13, 0, v10, s[54:55]
    v_cndmask_b32 v14, 0, v10, s[56:57]
    v_cndmask_b32 v15, 0, v10, s[58:59]
    v_and_b32 v11, 3, v11
    v_lshl_add_u32 v21, v11, 2, v21
    v_bfe_u32 v11, v0, 8, 1
    v_lshl_add_u32 v21, v11, 6, v21
    v_lshrrev_b32 v11, 9, v0
    v_lshl_add_u32 v21, v11, 5, v21
    v_mov_b64 v[24:25], 0
    v_mov_b64 v[26:27], 0
    v_mov_b64 v[28:29], 0
    v_mov_b64 v[30:31], 0
    v_mov_b64 v[32:33], 0
    v_mov_b64 v[34:35], 0
    v_mov_b64 v[36:37], 0
    v_mov_b64 v[38:39], 0
    v_mov_b64 v[40:41], 0
    v_mov_b64 v[42:43], 0
    v_mov_b64 v[44:45], 0
    v_mov_b64 v[46:47], 0
    s_mov_b32 s50, 3200000
    s_nop 15
    s_nop 15
    s_nop 11
    buffer_load_dwordx4 v[56:59], v0, s[4:7], s36 offen offset:0 sc1
    buffer_load_dwordx4 v[60:63], v0, s[4:7], s36 offen offset:1024 sc1
    buffer_load_dwordx4 v[64:67], v0, s[4:7], s36 offen offset:2048 sc1
    buffer_load_dwordx4 v[68:71], v0, s[4:7], s36 offen offset:3072 sc1
    s_nop 15
    s_nop 3
    buffer_load_dwordx4 v[56:59], v0, s[4:7], s36 offen offset:0 sc1
    buffer_load_dwordx4 v[60:63], v0, s[4:7], s36 offen offset:1024 sc1
    buffer_load_dwordx4 v[64:67], v0, s[4:7], s36 offen offset:2048 sc1
    buffer_load_dwordx4 v[68:71], v0, s[4:7], s36 offen offset:3072 sc1
L_recursl_121:
    s_waitcnt vmcnt(7)
    v_xor_b32 v8, s19, v56
    v_mfma_f32_16x16x32_bf16 v[16:19], v[56:59], v[12:15], 0
    buffer_load_dwordx4 v[56:59], v0, s[4:7], s36 offen offset:0 sc1
    s_waitcnt vmcnt(7)
    v_bitop3_b32 v8, v8, v60, s19 bitop3:0xf6
    v_mfma_f32_16x16x32_bf16 v[16:19], v[60:63], v[12:15], v[16:19]
    buffer_load_dwordx4 v[60:63], v0, s[4:7], s36 offen offset:1024 sc1
    s_waitcnt vmcnt(7)
    v_bitop3_b32 v8, v8, v64, s19 bitop3:0xf6
    v_mfma_f32_16x16x32_bf16 v[16:19], v[64:67], v[12:15], v[16:19]
    buffer_load_dwordx4 v[64:67], v0, s[4:7], s36 offen offset:2048 sc1
    s_waitcnt vmcnt(7)
    v_bitop3_b32 v8, v8, v68, s19 bitop3:0xf6
    v_mfma_f32_16x16x32_bf16 v[16:19], v[68:71], v[12:15], v[16:19]
    buffer_load_dwordx4 v[68:71], v0, s[4:7], s36 offen offset:3072 sc1
    v_and_b32 v8, 1, v8
    v_cmp_ne_u32 vcc, 0, v8
    s_cbranch_vccz L_recursok_120
    s_waitcnt vmcnt(7)
    v_xor_b32 v8, s19, v56
    v_mfma_f32_16x16x32_bf16 v[16:19], v[56:59], v[12:15], 0
    buffer_load_dwordx4 v[56:59], v0, s[4:7], s36 offen offset:0 sc1
    s_waitcnt vmcnt(7)
    v_bitop3_b32 v8, v8, v60, s19 bitop3:0xf6
    v_mfma_f32_16x16x32_bf16 v[16:19], v[60:63], v[12:15], v[16:19]
    buffer_load_dwordx4 v[60:63], v0, s[4:7], s36 offen offset:1024 sc1
    s_waitcnt vmcnt(7)
    v_bitop3_b32 v8, v8, v64, s19 bitop3:0xf6
    v_mfma_f32_16x16x32_bf16 v[16:19], v[64:67], v[12:15], v[16:19]
    buffer_load_dwordx4 v[64:67], v0, s[4:7], s36 offen offset:2048 sc1
    s_waitcnt vmcnt(7)
    v_bitop3_b32 v8, v8, v68, s19 bitop3:0xf6
    v_mfma_f32_16x16x32_bf16 v[16:19], v[68:71], v[12:15], v[16:19]
    buffer_load_dwordx4 v[68:71], v0, s[4:7], s36 offen offset:3072 sc1
    v_and_b32 v8, 1, v8
    v_cmp_ne_u32 vcc, 0, v8
    s_cbranch_vccz L_recursok_120
    s_sub_u32 s50, s50, 1
    s_cbranch_scc0 L_recursl_121
    s_branch L_exit_recurrent_scan__memory_aug_recurrent_mem_tr__moe_arch_mod__prompt_kernel
L_recursok_120:
    s_nop 1
    v_permlane32_swap_b32 v16, v18
    v_permlane32_swap_b32 v17, v19
    v_pk_add_f32 v[16:17], v[16:17], v[18:19]
    v_cvt_pk_bf16_f32 v16, v16, v17
    s_mov_b64 exec, s[74:75]
    buffer_store_dword v16, v21, s[4:7], s48 offen sc1
    buffer_store_dword v16, v21, s[4:7], s37 offen sc1
    s_mov_b64 exec, -1
    s_barrier
    v_mov_b64 v[8:9], -1
    v_mov_b64 v[10:11], -1
    s_mov_b64 exec, 0xff
    buffer_store_dwordx4 v[8:11], v0, s[4:7], s45 offen sc1
    s_mov_b64 exec, -1
    s_xor_b32 s36, s36, 262144
    s_mov_b32 s45, s37
    s_add_u32 s37, s37, 8192
    s_andn2_b32 s37, s37, 0x8000
    s_add_u32 s48, s48, 10240
    s_waitcnt vmcnt(3)
    s_branch L_recun2_119
L_recunred_118:
    v_mov_b64 v[24:25], 0
    v_mov_b64 v[26:27], 0
    v_mov_b64 v[28:29], 0
    v_mov_b64 v[30:31], 0
    v_mov_b64 v[32:33], 0
    v_mov_b64 v[34:35], 0
    v_mov_b64 v[36:37], 0
    v_mov_b64 v[38:39], 0
    v_mov_b64 v[40:41], 0
    v_mov_b64 v[42:43], 0
    v_mov_b64 v[44:45], 0
    v_mov_b64 v[46:47], 0
    s_barrier
    s_waitcnt vmcnt(0)
L_recun2_119:
    v_bfe_u32 v4, v0, 7, 2
    v_lshl_add_u32 v4, v4, 2, v0
    s_add_u32 s34, s34, 1
    ds_read_b128 v[56:59], v1 offset:12288
    ds_read_b128 v[60:63], v1 offset:13312
    ds_read_b128 v[64:67], v1 offset:14336
    ds_read_b128 v[68:71], v1 offset:15360
    ds_read_b128 v[72:75], v1 offset:16384
    ds_read_b128 v[76:79], v1 offset:17408
    ds_read_b128 v[80:83], v1 offset:18432
    ds_read_b128 v[84:87], v1 offset:19456
    s_add_u32 s26, s34, 1
    s_min_u32 s26, s26, 63
    s_cmp_gt_u32 s44, s26
    s_cbranch_scc1 L_recuf_122
    v_bfe_u32 v8, v0, 6, 1
    v_lshlrev_b32 v8, 13, v8
    v_bfe_u32 v9, v0, 4, 2
    v_lshl_add_u32 v8, v9, 2, v8
    v_bfe_u32 v10, v0, 7, 1
    v_lshl_add_u32 v8, v10, 7, v8
    s_mov_b32 s50, 0
L_recufs_123:
    buffer_load_dword v9, v8, s[4:7], s46 offen sc1
    s_waitcnt vmcnt(0)
    v_lshl_add_u32 v9, v9, 1, v10
    v_cmp_ge_u32 vcc, s26, v9
    s_cbranch_vccz L_recufsok_124
    s_add_u32 s50, s50, 1
    s_cmp_lt_u32 s50, 400000
    s_cbranch_scc0 L_exit_recurrent_scan__memory_aug_recurrent_mem_tr__moe_arch_mod__prompt_kernel
    s_sleep 2
    s_branch L_recufs_123
L_recufsok_124:
    v_min_u32_dpp v9, v9, v9 quad_perm:[1,0,3,2] row_mask:0xf bank_mask:0xf
    s_nop 1
    v_min_u32_dpp v9, v9, v9 quad_perm:[2,3,0,1] row_mask:0xf bank_mask:0xf
    s_nop 1
    v_min_u32_dpp v9, v9, v9 row_half_mirror row_mask:0xf bank_mask:0xf
    s_nop 1
    v_min_u32_dpp v9, v9, v9 row_mirror row_mask:0xf bank_mask:0xf
    s_nop 0
    v_readfirstlane_b32 s44, v9
L_recuf_122:
    s_mov_b32 m0, s66
    s_mov_b32 s30, s38
    s_mov_b64 s[8:9], -1
    s_add_u32 s67, s67, 262144
    s_add_u32 s38, s38, 10240
    s_waitcnt lgkmcnt(0)
    s_bfe_u32 s19, s34, 0x10001
    s_branch L_recucl_114
L_recurt_116:
    s_cmp_eq_u32 s34, 0
    s_cbranch_scc1 L_recurb_117
    s_mov_b32 s50, 0
    s_mov_b32 m0, s66
    ds_read2st64_b32 v[8:9], v4 offset0:20 offset1:24
    ds_read_b32 v10, v4 offset:7168
    s_waitcnt lgkmcnt(0)
    v_cmp_eq_u32 s[52:53], -1, v8
    v_cmp_eq_u32 s[54:55], -1, v9
    v_cmp_eq_u32 s[56:57], -1, v10
    s_or_b64 s[58:59], s[52:53], s[54:55]
    s_or_b64 s[58:59], s[58:59], s[56:57]
    s_cbranch_scc0 L_recurb_117
    s_mov_b64 exec, s[52:53]
    buffer_load_dwordx4 v0, s[4:7], s30 offen offset:0 sc1 lds
    s_mov_b64 exec, s[54:55]
    buffer_load_dwordx4 v0, s[4:7], s30 offen offset:1024 sc1 lds
    s_mov_b64 exec, s[56:57]
    buffer_load_dwordx4 v0, s[4:7], s30 offen offset:2048 sc1 lds
    s_mov_b64 exec, -1
    s_nop 15
    s_nop 15
L_recur2_126:
    s_mov_b64 exec, s[52:53]
    buffer_load_dwordx4 v0, s[4:7], s30 offen offset:0 sc1 lds
    s_mov_b64 exec, s[54:55]
    buffer_load_dwordx4 v0, s[4:7], s30 offen offset:1024 sc1 lds
    s_mov_b64 exec, s[56:57]
    buffer_load_dwordx4 v0, s[4:7], s30 offen offset:2048 sc1 lds
    s_mov_b64 exec, -1
    s_waitcnt vmcnt(3)
    ds_read2st64_b32 v[8:9], v4 offset0:20 offset1:24
    ds_read_b32 v10, v4 offset:7168
    s_waitcnt lgkmcnt(0)
    v_cmp_eq_u32 s[52:53], -1, v8
    v_cmp_eq_u32 s[54:55], -1, v9
    v_cmp_eq_u32 s[56:57], -1, v10
    s_or_b64 s[58:59], s[52:53], s[54:55]
    s_or_b64 s[58:59], s[58:59], s[56:57]
    s_cbranch_scc0 L_recurb_117
    s_add_u32 s50, s50, 1
    s_cmp_lt_u32 s50, 3200000
    s_cbranch_scc0 L_exit_recurrent_scan__memory_aug_recurrent_mem_tr__moe_arch_mod__prompt_kernel
    s_branch L_recur2_126
L_recufin_115:
    s_waitcnt lgkmcnt(0)
    s_nop 7
    s_waitcnt vmcnt(0)
    v_mov_b32 v9, 64
    buffer_store_dword v9, off, s[4:7], s41 sc1
    s_waitcnt vmcnt(0)
    s_branch L_exit_recurrent_scan__memory_aug_recurrent_mem_tr__moe_arch_mod__prompt_kernel
L_recub_107:
L_recucl_127:
    s_barrier
    ds_read_b128 v[12:15], v2 offset:0
    ds_read_b128 v[16:19], v2 offset:1024
    ds_read_b128 v[20:23], v2 offset:2048
    s_mov_b64 exec, s[8:9]
    buffer_load_dwordx4 v0, s[4:7], s30 offen offset:0 sc1 lds
    buffer_load_dwordx4 v0, s[4:7], s30 offen offset:1024 sc1 lds
    s_mov_b64 exec, -1
    s_waitcnt lgkmcnt(2)
    v_smfmac_f32_16x16x64_bf16 v[24:27], v[12:15], a[0:7], v7
    v_mov_b32 v8, s34
    v_smfmac_f32_16x16x64_bf16 v[28:31], v[12:15], v[56:63], v7
    ds_read_b128 v[56:59], v1 offset:20480
    v_smfmac_f32_16x16x64_bf16 v[32:35], v[12:15], a[8:15], v7
    ds_read_b128 v[60:63], v1 offset:21504
    v_smfmac_f32_16x16x64_bf16 v[36:39], v[12:15], v[64:71], v7
    ds_read_b128 v[64:67], v1 offset:22528
    v_smfmac_f32_16x16x64_bf16 v[40:43], v[12:15], a[16:23], v7
    ds_read_b128 v[68:71], v1 offset:23552
    v_smfmac_f32_16x16x64_bf16 v[44:47], v[12:15], a[24:31], v7
    buffer_load_dwordx4 v[48:51], v0, s[4:7], s47 offen offset:0
    ds_read_b128 v[12:15], v2 offset:3072
    s_waitcnt lgkmcnt(6)
    v_smfmac_f32_16x16x64_bf16 v[24:27], v[16:19], a[32:39], v7
    buffer_load_dwordx4 v[52:55], v0, s[4:7], s47 offen offset:1024
    v_smfmac_f32_16x16x64_bf16 v[28:31], v[16:19], v[72:79], v7
    ds_read_b128 v[72:75], v1 offset:24576
    v_smfmac_f32_16x16x64_bf16 v[32:35], v[16:19], a[40:47], v7
    ds_read_b128 v[76:79], v1 offset:25600
    buffer_store_dword v8, off, s[4:7], s41 sc1
    v_smfmac_f32_16x16x64_bf16 v[36:39], v[16:19], v[80:87], v7
    ds_read_b128 v[80:83], v1 offset:26624
    v_smfmac_f32_16x16x64_bf16 v[40:43], v[16:19], a[48:55], v7
    ds_read_b128 v[84:87], v1 offset:27648
    v_smfmac_f32_16x16x64_bf16 v[44:47], v[16:19], a[56:63], v7
    ds_read_b128 v[16:19], v2 offset:4096
    s_waitcnt lgkmcnt(10)
    v_smfmac_f32_16x16x64_bf16 v[24:27], v[20:23], a[64:71], v7
    s_waitcnt lgkmcnt(8)
    v_smfmac_f32_16x16x64_bf16 v[28:31], v[20:23], v[56:63], v7
    ds_read_b128 v[56:59], v1 offset:28672
    v_smfmac_f32_16x16x64_bf16 v[32:35], v[20:23], a[72:79], v7
    ds_read_b128 v[60:63], v1 offset:29696
    s_waitcnt lgkmcnt(8)
    v_smfmac_f32_16x16x64_bf16 v[36:39], v[20:23], v[64:71], v7
    ds_read_b128 v[64:67], v1 offset:30720
    v_smfmac_f32_16x16x64_bf16 v[40:43], v[20:23], a[80:87], v7
    ds_read_b128 v[68:71], v1 offset:31744
    v_smfmac_f32_16x16x64_bf16 v[44:47], v[20:23], a[88:95], v7
    s_waitcnt lgkmcnt(9)
    v_smfmac_f32_16x16x64_bf16 v[24:27], v[12:15], a[96:103], v7
    s_waitcnt lgkmcnt(7)
    v_smfmac_f32_16x16x64_bf16 v[28:31], v[12:15], v[72:79], v7
    ds_read_b128 v[72:75], v1 offset:0
    v_smfmac_f32_16x16x64_bf16 v[32:35], v[12:15], a[104:111], v7
    ds_read_b128 v[76:79], v1 offset:1024
    s_waitcnt lgkmcnt(7)
    v_smfmac_f32_16x16x64_bf16 v[36:39], v[12:15], v[80:87], v7
    ds_read_b128 v[80:83], v1 offset:2048
    s_waitcnt vmcnt(3)
    ds_read2st64_b32 v[8:9], v4 offset0:32 offset1:36
    s_waitcnt lgkmcnt(8)
    v_smfmac_f32_16x16x64_bf16 v[24:27], v[16:19], a[128:135], v7
    ds_read_b128 v[84:87], v1 offset:3072
    s_waitcnt lgkmcnt(7)
    v_smfmac_f32_16x16x64_bf16 v[28:31], v[16:19], v[56:63], v7
    ds_read_b128 v[56:59], v1 offset:32768
    v_smfmac_f32_16x16x64_bf16 v[32:35], v[16:19], a[136:143], v7
    ds_read_b128 v[60:63], v1 offset:33792
    s_waitcnt lgkmcnt(3)
    v_max_u32 v8, v8, v9
    v_smfmac_f32_16x16x64_bf16 v[36:39], v[16:19], v[64:71], v7
    v_cmp_eq_u32 vcc, -1, v8
    s_cbranch_vccnz L_recurt_129
L_recurb_130:
    s_barrier
    ds_read_b128 v[20:23], v2 offset:5120
    v_smfmac_f32_16x16x64_bf16 v[40:43], v[12:15], a[112:119], v7
    v_smfmac_f32_16x16x64_bf16 v[44:47], v[12:15], a[120:127], v7
    ds_read_b128 v[12:15], v2 offset:6144
    v_smfmac_f32_16x16x64_bf16 v[40:43], v[16:19], a[144:151], v7
    v_smfmac_f32_16x16x64_bf16 v[44:47], v[16:19], a[152:159], v7
    ds_read_b128 v[16:19], v2 offset:7168
    s_waitcnt lgkmcnt(2)
    v_smfmac_f32_16x16x64_bf16 v[24:27], v[20:23], a[160:167], v7
    v_smfmac_f32_16x16x64_bf16 v[28:31], v[20:23], v[72:79], v7
    v_smfmac_f32_16x16x64_bf16 v[32:35], v[20:23], a[168:175], v7
    v_smfmac_f32_16x16x64_bf16 v[36:39], v[20:23], v[80:87], v7
    ds_read_b128 v[20:23], v2 offset:8192
    s_waitcnt lgkmcnt(2)
    v_smfmac_f32_16x16x64_bf16 v[24:27], v[12:15], a[192:199], v7
    v_smfmac_f32_16x16x64_bf16 v[28:31], v[12:15], v[56:63], v7
    ds_read_b128 v[72:75], v0 offset:10240
    v_smfmac_f32_16x16x64_bf16 v[32:35], v[12:15], a[200:207], v7
    v_lshlrev_b32 v4, 3, v0
    v_smfmac_f32_16x16x64_bf16 v[36:39], v[12:15], a[208:215], v7
    buffer_load_dword v4, v4, s[4:7], s67 offen
    ds_read_b128 v[76:79], v0 offset:11264
    ds_read_b128 v[12:15], v2 offset:9216
    s_waitcnt lgkmcnt(4)
    v_smfmac_f32_16x16x64_bf16 v[24:27], v[16:19], a[232:239], v7
    v_lshrrev_b32 v71, 9, v0
    v_smfmac_f32_16x16x64_bf16 v[28:31], v[16:19], a[248:255], v7
    ds_read_b128 v[80:83], v0 offset:12288
    v_smfmac_f32_16x16x64_bf16 v[32:35], v[16:19], a[240:247], v7
    v_lshlrev_b32 v71, 3, v71
    v_smfmac_f32_16x16x64_bf16 v[36:39], v[16:19], v[88:95], v7
    ds_read_b128 v[84:87], v0 offset:13312
    s_waitcnt lgkmcnt(5)
    v_smfmac_f32_16x16x64_bf16 v[24:27], v[20:23], v[112:119], v7
    v_lshrrev_b32 v70, 1, v0
    v_smfmac_f32_16x16x64_bf16 v[28:31], v[20:23], v[128:135], v7
    v_xor_b32 v70, v71, v70
    v_smfmac_f32_16x16x64_bf16 v[32:35], v[20:23], v[120:127], v7
    v_xor_b32 v71, 16, v70
    v_smfmac_f32_16x16x64_bf16 v[36:39], v[20:23], v[136:143], v7
    s_waitcnt lgkmcnt(2)
    v_smfmac_f32_16x16x64_bf16 v[24:27], v[12:15], v[160:167], v7
    v_smfmac_f32_16x16x64_bf16 v[28:31], v[12:15], v[176:183], v7
    v_smfmac_f32_16x16x64_bf16 v[32:35], v[12:15], v[168:175], v7
    v_add_f32 v24, v24, v26
    v_smfmac_f32_16x16x64_bf16 v[36:39], v[12:15], v[184:191], v7
    v_add_f32 v25, v25, v27
    v_add_f32 v28, v28, v30
    v_cvt_pk_bf16_f32 v8, v24, v25
    v_add_f32 v29, v29, v31
    v_add_f32 v32, v32, v34
    v_cvt_pk_bf16_f32 v9, v28, v29
    v_add_f32 v33, v33, v35
    ds_write_b64 v3, v[8:9]
    v_pk_add_f32 v[36:37], v[36:37], v[38:39]
    v_cvt_pk_bf16_f32 v10, v32, v33
    v_cvt_pk_bf16_f32 v11, v36, v37
    ds_write_b64 v3, v[10:11] offset:128
    v_smfmac_f32_16x16x64_bf16 v[40:43], v[12:15], v[192:199], v7
    v_smfmac_f32_16x16x64_bf16 v[44:47], v[12:15], v[200:207], v7
    ds_read_b128 v[12:15], v2 offset:6144
    v_smfmac_f32_16x16x64_bf16 v[40:43], v[20:23], v[144:151], v7
    v_smfmac_f32_16x16x64_bf16 v[44:47], v[20:23], v[152:159], v7
    ds_read_b128 v[20:23], v2 offset:5120
    v_smfmac_f32_16x16x64_bf16 v[40:43], v[16:19], v[96:103], v7
    s_waitcnt lgkmcnt(2)
    s_barrier
    ds_read_b64_tr_b16 v[56:57], v70 offset:18432
    ds_read_b64_tr_b16 v[58:59], v71 offset:18944
    v_smfmac_f32_16x16x64_bf16 v[44:47], v[16:19], v[104:111], v7
    ds_read_b64_tr_b16 v[60:61], v70 offset:19456
    ds_read_b64_tr_b16 v[62:63], v71 offset:19968
    s_waitcnt lgkmcnt(5)
    v_smfmac_f32_16x16x64_bf16 v[40:43], v[12:15], a[216:223], v7
    ds_read_b64_tr_b16 v[64:65], v70 offset:20480
    ds_read_b64_tr_b16 v[66:67], v71 offset:20992
    v_smfmac_f32_16x16x64_bf16 v[44:47], v[12:15], a[224:231], v7
    ds_read_b64_tr_b16 v[68:69], v70 offset:21504
    ds_read_b64_tr_b16 v[70:71], v71 offset:22016
    s_waitcnt lgkmcnt(8)
    v_smfmac_f32_16x16x64_bf16 v[40:43], v[20:23], a[176:183], v7
    v_smfmac_f32_16x16x64_bf16 v[44:47], v[20:23], a[184:191], v7
    s_waitcnt lgkmcnt(6)
    v_mfma_f32_16x16x32_bf16 v[28:31], v[72:75], v[56:59], 0
    ds_read_b128 v[72:75], v0 offset:14336
    s_waitcnt lgkmcnt(5)
    v_mfma_f32_16x16x32_bf16 v[28:31], v[76:79], v[60:63], v[28:31]
    ds_read_b128 v[76:79], v0 offset:15360
    s_waitcnt lgkmcnt(4)
    v_mfma_f32_16x16x32_bf16 v[28:31], v[80:83], v[64:67], v[28:31]
    ds_read_b128 v[80:83], v0 offset:16384
    v_add_f32 v40, v40, v42
    s_waitcnt lgkmcnt(3)
    v_mfma_f32_16x16x32_bf16 v[28:31], v[84:87], v[68:71], v[28:31]
    ds_read_b128 v[84:87], v0 offset:17408
    v_add_f32 v44, v44, v46
    v_mfma_f32_16x16x32_bf16 v[24:27], v[56:59], v[56:59], 0
    v_add_f32 v41, v41, v43
    v_add_f32 v45, v45, v47
    v_mfma_f32_16x16x32_bf16 v[24:27], v[60:63], v[60:63], v[24:27]
    v_cvt_pk_bf16_f32 v46, v40, v41
    v_cvt_pk_bf16_f32 v47, v44, v45
    v_mfma_f32_16x16x32_bf16 v[24:27], v[64:67], v[64:67], v[24:27]
    s_cmp_eq_u32 s34, 63
    buffer_store_dwordx4 v[60:63], v0, s[4:7], s40 offen sc1
    s_cbranch_scc1 L_recufin_128
    v_max3_f32 v8, v28, v29, v30
    v_mfma_f32_16x16x32_bf16 v[24:27], v[68:71], v[68:71], v[24:27]
    v_mov_b64 v[12:13], s[70:71]
    v_mov_b64 v[14:15], s[70:71]
    s_waitcnt lgkmcnt(3)
    v_mfma_f32_16x16x32_bf16 v[32:35], v[72:75], v[56:59], 0
    v_add_u32 v10, s49, v0
    v_mov_b64 v[36:37], 0
    s_waitcnt lgkmcnt(2)
    v_mfma_f32_16x16x32_bf16 v[32:35], v[76:79], v[60:63], v[32:35]
    v_max3_f32 v8, v8, v31, v26
    v_mov_b64 v[38:39], 0
    s_waitcnt lgkmcnt(1)
    v_mfma_f32_16x16x32_bf16 v[32:35], v[80:83], v[64:67], v[32:35]
    v_max_f32 v8, v8, v27
    ds_read_b128 v[72:75], v1 offset:8192
    ds_read_b128 v[76:79], v1 offset:9216
    s_waitcnt lgkmcnt(2)
    v_mfma_f32_16x16x32_bf16 v[32:35], v[84:87], v[68:71], v[32:35]
    ds_read_b128 v[80:83], v1 offset:4096
    ds_read_b128 v[84:87], v1 offset:5120
    v_mov_b32 v69, 0
    v_mov_b32 v70, 0
    v_mov_b64 v[40:41], 0
    v_mov_b64 v[42:43], 0
    s_nop 1
    v_max3_f32 v8, v8, v32, v33
    v_max3_f32 v9, v8, v34, v35
    v_max3_f32 v8, v8, v34, v35
    s_nop 1
    v_permlane32_swap_b32 v9, v8
    v_max_f32 v11, v8, v9
    v_max_f32 v8, v8, v9
    s_nop 1
    v_permlane16_swap_b32 v11, v8
    v_max_f32 v8, v8, v11
    v_mul_f32 v8, 0xbe0293ee, v8
    v_pk_fma_f32 v[26:27], v[26:27], s[68:69], v[8:9] op_sel_hi:[1,1,0]
    v_pk_fma_f32 v[28:29], v[28:29], s[68:69], v[8:9] op_sel_hi:[1,1,0]
    v_exp_f32 v26, v26
    v_exp_f32 v27, v27
    v_pk_fma_f32 v[30:31], v[30:31], s[68:69], v[8:9] op_sel_hi:[1,1,0]
    v_exp_f32 v28, v28
    v_pk_fma_f32 v[32:33], v[32:33], s[68:69], v[8:9] op_sel_hi:[1,1,0]
    v_exp_f32 v29, v29
    v_cvt_pk_bf16_f32 v68, v26, v27
    v_pk_fma_f32 v[34:35], v[34:35], s[68:69], v[8:9] op_sel_hi:[1,1,0]
    v_cvt_pk_bf16_f32 v71, v26, v27
    v_exp_f32 v30, v30
    v_mfma_f32_16x16x16_bf16 v[16:19], v[12:13], v[68:69], 0
    v_exp_f32 v31, v31
    v_cvt_pk_bf16_f32 v64, v28, v29
    v_mfma_f32_16x16x16_bf16 v[56:59], v[46:47], v[68:69], 0
    v_exp_f32 v32, v32
    v_exp_f32 v33, v33
    v_mfma_f32_16x16x16_bf16 v[60:63], v[46:47], v[70:71], 0
    v_cvt_pk_bf16_f32 v65, v30, v31
    v_exp_f32 v34, v34
    v_exp_f32 v35, v35
    v_cvt_pk_bf16_f32 v66, v32, v33
    s_waitcnt vmcnt(2)
    v_cvt_pk_bf16_f32 v67, v34, v35
    v_mov_b64 v[24:25], 0
    s_nop 0
    v_mfma_f32_16x16x32_bf16 v[16:19], v[12:15], v[64:67], v[16:19]
    v_mov_b64 v[26:27], 0
    v_mov_b64 v[28:29], 0
    v_mfma_f32_16x16x32_bf16 v[56:59], v[48:51], v[64:67], v[56:59]
    v_mov_b64 v[30:31], 0
    v_mov_b64 v[32:33], 0
    v_mfma_f32_16x16x32_bf16 v[60:63], v[52:55], v[64:67], v[60:63]
    v_mov_b64 v[34:35], 0
    v_rcp_f32 v8, v16
    s_nop 1
    v_pk_mul_f32 v[56:57], v[56:57], v[8:9] op_sel_hi:[1,0]
    v_pk_mul_f32 v[58:59], v[58:59], v[8:9] op_sel_hi:[1,0]
    v_cvt_pk_bf16_f32 v20, v56, v57
    v_cvt_pk_bf16_f32 v21, v58, v59
    v_pk_mul_f32 v[60:61], v[60:61], v[8:9] op_sel_hi:[1,0]
    v_pk_mul_f32 v[62:63], v[62:63], v[8:9] op_sel_hi:[1,0]
    v_cvt_pk_bf16_f32 v22, v60, v61
    v_cvt_pk_bf16_f32 v23, v62, v63
    s_mov_b64 exec, s[64:65]
    ds_write_b128 v10, v[20:23]
    s_mov_b64 exec, -1
    ds_read_b128 v[56:59], v1 offset:6144
    ds_read_b128 v[60:63], v1 offset:7168
    ds_read_b128 v[64:67], v1 offset:10240
    ds_read_b128 v[68:71], v1 offset:11264
    s_waitcnt lgkmcnt(4)
    s_barrier
    ds_read_b128 v[12:15], v0 offset:22528
    ds_read_b128 v[16:19], v0 offset:23552
    s_mov_b32 m0, s51
    s_nop 0
    buffer_load_dwordx4 v0, s[4:7], s39 offen lds
    buffer_load_dwordx4 v0, s[4:7], s39 offen offset:1024 lds
    s_waitcnt lgkmcnt(1)
    v_smfmac_f32_16x16x64_bf16 v[40:43], v[12:15], v[72:79], v7
    s_waitcnt lgkmcnt(0)
    v_smfmac_f32_16x16x64_bf16 v[40:43], v[16:19], v[64:71], v7
    v_smfmac_f32_16x16x64_bf16 v[24:27], v[12:15], v[208:215], v7
    v_smfmac_f32_16x16x64_bf16 v[24:27], v[16:19], v[240:247], v7
    v_add_f32 v40, v40, v42
    v_smfmac_f32_16x16x64_bf16 v[28:31], v[12:15], v[216:223], v7
    v_add_f32 v41, v41, v43
    v_smfmac_f32_16x16x64_bf16 v[28:31], v[16:19], v[248:255], v7
    v_cvt_pk_bf16_f32 v20, v40, v41
    v_smfmac_f32_16x16x64_bf16 v[32:35], v[12:15], v[224:231], v7
    v_bfi_b32 v20, 1, s19, v20
    v_smfmac_f32_16x16x64_bf16 v[32:35], v[16:19], v[80:87], v7
    buffer_store_dword v20, v6, s[4:7], s35 offen sc1
    v_add_f32 v24, v24, v26
    v_smfmac_f32_16x16x64_bf16 v[36:39], v[12:15], v[232:239], v7
    v_add_f32 v25, v25, v27
    v_smfmac_f32_16x16x64_bf16 v[36:39], v[16:19], v[56:63], v7
    v_add_f32 v28, v28, v30
    v_add_f32 v29, v29, v31
    v_cvt_pk_bf16_f32 v8, v24, v25
    v_add_f32 v32, v32, v34
    v_cvt_pk_bf16_f32 v9, v28, v29
    v_add_f32 v33, v33, v35
    v_bfi_b32 v8, 1, s19, v8
    v_cvt_pk_bf16_f32 v10, v32, v33
    v_pk_add_f32 v[36:37], v[36:37], v[38:39]
    v_cvt_pk_bf16_f32 v11, v36, v37
    buffer_store_dwordx4 v[8:11], v5, s[4:7], s35 offen sc1
    s_add_u32 s39, s39, 262144
    s_add_u32 s47, s47, 262144
    s_xor_b32 s35, s35, 262144
    s_add_u32 s40, s40, 131072
    s_cmp_eq_u32 s42, 0
    s_cbranch_scc1 L_recunred_131
    v_bfe_u32 v8, v0, 4, 1
    v_lshlrev_b32 v21, 4, v8
    v_mov_b32 v10, 0x3f80
    v_lshlrev_b32 v10, v21, v10
    v_bfe_u32 v11, v0, 5, 3
    v_cmp_eq_u32 s[52:53], 0, v11
    v_cmp_eq_u32 s[54:55], 1, v11
    v_cmp_eq_u32 s[56:57], 2, v11
    v_cmp_eq_u32 s[58:59], 3, v11
    v_cndmask_b32 v12, 0, v10, s[52:53]
    v_cndmask_b32 v13, 0, v10, s[54:55]
    v_cndmask_b32 v14, 0, v10, s[56:57]
    v_cndmask_b32 v15, 0, v10, s[58:59]
    v_and_b32 v11, 3, v11
    v_lshl_add_u32 v21, v11, 2, v21
    v_bfe_u32 v11, v0, 8, 1
    v_lshl_add_u32 v21, v11, 6, v21
    v_lshrrev_b32 v11, 9, v0
    v_lshl_add_u32 v21, v11, 5, v21
    v_mov_b64 v[24:25], 0
    v_mov_b64 v[26:27], 0
    v_mov_b64 v[28:29], 0
    v_mov_b64 v[30:31], 0
    v_mov_b64 v[32:33], 0
    v_mov_b64 v[34:35], 0
    v_mov_b64 v[36:37], 0
    v_mov_b64 v[38:39], 0
    v_mov_b64 v[40:41], 0
    v_mov_b64 v[42:43], 0
    v_mov_b64 v[44:45], 0
    v_mov_b64 v[46:47], 0
    s_mov_b32 s50, 3200000
    s_nop 15
    s_nop 15
    s_nop 11
    buffer_load_dwordx4 v[56:59], v0, s[4:7], s36 offen offset:0 sc1
    buffer_load_dwordx4 v[60:63], v0, s[4:7], s36 offen offset:1024 sc1
    buffer_load_dwordx4 v[64:67], v0, s[4:7], s36 offen offset:2048 sc1
    buffer_load_dwordx4 v[68:71], v0, s[4:7], s36 offen offset:3072 sc1
    s_nop 15
    s_nop 3
    buffer_load_dwordx4 v[56:59], v0, s[4:7], s36 offen offset:0 sc1
    buffer_load_dwordx4 v[60:63], v0, s[4:7], s36 offen offset:1024 sc1
    buffer_load_dwordx4 v[64:67], v0, s[4:7], s36 offen offset:2048 sc1
    buffer_load_dwordx4 v[68:71], v0, s[4:7], s36 offen offset:3072 sc1
L_recursl_134:
    s_waitcnt vmcnt(7)
    v_xor_b32 v8, s19, v56
    v_mfma_f32_16x16x32_bf16 v[16:19], v[56:59], v[12:15], 0
    buffer_load_dwordx4 v[56:59], v0, s[4:7], s36 offen offset:0 sc1
    s_waitcnt vmcnt(7)
    v_bitop3_b32 v8, v8, v60, s19 bitop3:0xf6
    v_mfma_f32_16x16x32_bf16 v[16:19], v[60:63], v[12:15], v[16:19]
    buffer_load_dwordx4 v[60:63], v0, s[4:7], s36 offen offset:1024 sc1
    s_waitcnt vmcnt(7)
    v_bitop3_b32 v8, v8, v64, s19 bitop3:0xf6
    v_mfma_f32_16x16x32_bf16 v[16:19], v[64:67], v[12:15], v[16:19]
    buffer_load_dwordx4 v[64:67], v0, s[4:7], s36 offen offset:2048 sc1
    s_waitcnt vmcnt(7)
    v_bitop3_b32 v8, v8, v68, s19 bitop3:0xf6
    v_mfma_f32_16x16x32_bf16 v[16:19], v[68:71], v[12:15], v[16:19]
    buffer_load_dwordx4 v[68:71], v0, s[4:7], s36 offen offset:3072 sc1
    v_and_b32 v8, 1, v8
    v_cmp_ne_u32 vcc, 0, v8
    s_cbranch_vccz L_recursok_133
    s_waitcnt vmcnt(7)
    v_xor_b32 v8, s19, v56
    v_mfma_f32_16x16x32_bf16 v[16:19], v[56:59], v[12:15], 0
    buffer_load_dwordx4 v[56:59], v0, s[4:7], s36 offen offset:0 sc1
    s_waitcnt vmcnt(7)
    v_bitop3_b32 v8, v8, v60, s19 bitop3:0xf6
    v_mfma_f32_16x16x32_bf16 v[16:19], v[60:63], v[12:15], v[16:19]
    buffer_load_dwordx4 v[60:63], v0, s[4:7], s36 offen offset:1024 sc1
    s_waitcnt vmcnt(7)
    v_bitop3_b32 v8, v8, v64, s19 bitop3:0xf6
    v_mfma_f32_16x16x32_bf16 v[16:19], v[64:67], v[12:15], v[16:19]
    buffer_load_dwordx4 v[64:67], v0, s[4:7], s36 offen offset:2048 sc1
    s_waitcnt vmcnt(7)
    v_bitop3_b32 v8, v8, v68, s19 bitop3:0xf6
    v_mfma_f32_16x16x32_bf16 v[16:19], v[68:71], v[12:15], v[16:19]
    buffer_load_dwordx4 v[68:71], v0, s[4:7], s36 offen offset:3072 sc1
    v_and_b32 v8, 1, v8
    v_cmp_ne_u32 vcc, 0, v8
    s_cbranch_vccz L_recursok_133
    s_sub_u32 s50, s50, 1
    s_cbranch_scc0 L_recursl_134
    s_branch L_exit_recurrent_scan__memory_aug_recurrent_mem_tr__moe_arch_mod__prompt_kernel
L_recursok_133:
    s_nop 1
    v_permlane32_swap_b32 v16, v18
    v_permlane32_swap_b32 v17, v19
    v_pk_add_f32 v[16:17], v[16:17], v[18:19]
    v_cvt_pk_bf16_f32 v16, v16, v17
    s_mov_b64 exec, s[74:75]
    buffer_store_dword v16, v21, s[4:7], s48 offen sc1
    buffer_store_dword v16, v21, s[4:7], s37 offen sc1
    s_mov_b64 exec, -1
    s_barrier
    v_mov_b64 v[8:9], -1
    v_mov_b64 v[10:11], -1
    s_mov_b64 exec, 0xff
    buffer_store_dwordx4 v[8:11], v0, s[4:7], s45 offen sc1
    s_mov_b64 exec, -1
    s_xor_b32 s36, s36, 262144
    s_mov_b32 s45, s37
    s_add_u32 s37, s37, 8192
    s_andn2_b32 s37, s37, 0x8000
    s_add_u32 s48, s48, 10240
    s_waitcnt vmcnt(3)
    s_branch L_recun2_132
L_recunred_131:
    v_mov_b64 v[24:25], 0
    v_mov_b64 v[26:27], 0
    v_mov_b64 v[28:29], 0
    v_mov_b64 v[30:31], 0
    v_mov_b64 v[32:33], 0
    v_mov_b64 v[34:35], 0
    v_mov_b64 v[36:37], 0
    v_mov_b64 v[38:39], 0
    v_mov_b64 v[40:41], 0
    v_mov_b64 v[42:43], 0
    v_mov_b64 v[44:45], 0
    v_mov_b64 v[46:47], 0
    s_barrier
    s_waitcnt vmcnt(0)
L_recun2_132:
    v_bfe_u32 v4, v0, 7, 2
    v_lshl_add_u32 v4, v4, 2, v0
    s_add_u32 s34, s34, 1
    ds_read_b128 v[56:59], v1 offset:12288
    ds_read_b128 v[60:63], v1 offset:13312
    ds_read_b128 v[64:67], v1 offset:14336
    ds_read_b128 v[68:71], v1 offset:15360
    ds_read_b128 v[72:75], v1 offset:16384
    ds_read_b128 v[76:79], v1 offset:17408
    ds_read_b128 v[80:83], v1 offset:18432
    ds_read_b128 v[84:87], v1 offset:19456
    s_add_u32 s26, s34, 1
    s_min_u32 s26, s26, 63
    s_cmp_gt_u32 s44, s26
    s_cbranch_scc1 L_recuf_135
    v_bfe_u32 v8, v0, 6, 1
    v_lshlrev_b32 v8, 13, v8
    v_bfe_u32 v9, v0, 4, 2
    v_lshl_add_u32 v8, v9, 2, v8
    v_bfe_u32 v10, v0, 7, 1
    v_lshl_add_u32 v8, v10, 7, v8
    s_mov_b32 s50, 0
L_recufs_136:
    buffer_load_dword v9, v8, s[4:7], s46 offen sc1
    s_waitcnt vmcnt(0)
    v_lshl_add_u32 v9, v9, 1, v10
    v_cmp_ge_u32 vcc, s26, v9
    s_cbranch_vccz L_recufsok_137
    s_add_u32 s50, s50, 1
    s_cmp_lt_u32 s50, 400000
    s_cbranch_scc0 L_exit_recurrent_scan__memory_aug_recurrent_mem_tr__moe_arch_mod__prompt_kernel
    s_sleep 2
    s_branch L_recufs_136
L_recufsok_137:
    v_min_u32_dpp v9, v9, v9 quad_perm:[1,0,3,2] row_mask:0xf bank_mask:0xf
    s_nop 1
    v_min_u32_dpp v9, v9, v9 quad_perm:[2,3,0,1] row_mask:0xf bank_mask:0xf
    s_nop 1
    v_min_u32_dpp v9, v9, v9 row_half_mirror row_mask:0xf bank_mask:0xf
    s_nop 1
    v_min_u32_dpp v9, v9, v9 row_mirror row_mask:0xf bank_mask:0xf
    s_nop 0
    v_readfirstlane_b32 s44, v9
L_recuf_135:
    s_mov_b32 m0, s66
    s_mov_b32 s30, s38
    s_mov_b64 s[8:9], -1
    s_add_u32 s67, s67, 262144
    s_add_u32 s38, s38, 10240
    s_waitcnt lgkmcnt(0)
    s_bfe_u32 s19, s34, 0x10001
    s_branch L_recucl_127
L_recurt_129:
    s_cmp_eq_u32 s34, 0
    s_cbranch_scc1 L_recurb_130
    s_mov_b32 s50, 0
    s_mov_b32 m0, s66
    ds_read2st64_b32 v[8:9], v4 offset0:32 offset1:36
    s_waitcnt lgkmcnt(0)
    v_cmp_eq_u32 s[52:53], -1, v8
    v_cmp_eq_u32 s[54:55], -1, v9
    s_or_b64 s[58:59], s[52:53], s[54:55]
    s_cbranch_scc0 L_recurb_130
    s_mov_b64 exec, s[52:53]
    buffer_load_dwordx4 v0, s[4:7], s30 offen offset:0 sc1 lds
    s_mov_b64 exec, s[54:55]
    buffer_load_dwordx4 v0, s[4:7], s30 offen offset:1024 sc1 lds
    s_mov_b64 exec, -1
    s_nop 15
    s_nop 15
L_recur2_139:
    s_mov_b64 exec, s[52:53]
    buffer_load_dwordx4 v0, s[4:7], s30 offen offset:0 sc1 lds
    s_mov_b64 exec, s[54:55]
    buffer_load_dwordx4 v0, s[4:7], s30 offen offset:1024 sc1 lds
    s_mov_b64 exec, -1
    s_waitcnt vmcnt(2)
    ds_read2st64_b32 v[8:9], v4 offset0:32 offset1:36
    s_waitcnt lgkmcnt(0)
    v_cmp_eq_u32 s[52:53], -1, v8
    v_cmp_eq_u32 s[54:55], -1, v9
    s_or_b64 s[58:59], s[52:53], s[54:55]
    s_cbranch_scc0 L_recurb_130
    s_add_u32 s50, s50, 1
    s_cmp_lt_u32 s50, 3200000
    s_cbranch_scc0 L_exit_recurrent_scan__memory_aug_recurrent_mem_tr__moe_arch_mod__prompt_kernel
    s_branch L_recur2_139
L_recufin_128:
    s_waitcnt lgkmcnt(0)
    s_nop 7
    s_waitcnt vmcnt(0)
    v_mov_b32 v9, 64
    buffer_store_dword v9, off, s[4:7], s41 sc1
    s_waitcnt vmcnt(0)
    s_branch L_exit_recurrent_scan__memory_aug_recurrent_mem_tr__moe_arch_mod__prompt_kernel
L_recub_108:
L_recucl_140:
    s_barrier
    ds_read_b128 v[12:15], v2 offset:0
    ds_read_b128 v[16:19], v2 offset:1024
    ds_read_b128 v[20:23], v2 offset:2048
    s_waitcnt lgkmcnt(2)
    v_smfmac_f32_16x16x64_bf16 v[24:27], v[12:15], a[0:7], v7
    v_mov_b32 v8, s34
    v_smfmac_f32_16x16x64_bf16 v[28:31], v[12:15], v[56:63], v7
    ds_read_b128 v[56:59], v1 offset:20480
    v_smfmac_f32_16x16x64_bf16 v[32:35], v[12:15], a[8:15], v7
    ds_read_b128 v[60:63], v1 offset:21504
    v_smfmac_f32_16x16x64_bf16 v[36:39], v[12:15], v[64:71], v7
    ds_read_b128 v[64:67], v1 offset:22528
    v_smfmac_f32_16x16x64_bf16 v[40:43], v[12:15], a[16:23], v7
    ds_read_b128 v[68:71], v1 offset:23552
    v_smfmac_f32_16x16x64_bf16 v[44:47], v[12:15], a[24:31], v7
    buffer_load_dwordx4 v[48:51], v0, s[4:7], s47 offen offset:0
    ds_read_b128 v[12:15], v2 offset:3072
    s_waitcnt lgkmcnt(6)
    v_smfmac_f32_16x16x64_bf16 v[24:27], v[16:19], a[32:39], v7
    buffer_load_dwordx4 v[52:55], v0, s[4:7], s47 offen offset:1024
    v_smfmac_f32_16x16x64_bf16 v[28:31], v[16:19], v[72:79], v7
    ds_read_b128 v[72:75], v1 offset:24576
    v_smfmac_f32_16x16x64_bf16 v[32:35], v[16:19], a[40:47], v7
    ds_read_b128 v[76:79], v1 offset:25600
    buffer_store_dword v8, off, s[4:7], s41 sc1
    v_smfmac_f32_16x16x64_bf16 v[36:39], v[16:19], v[80:87], v7
    ds_read_b128 v[80:83], v1 offset:26624
    v_smfmac_f32_16x16x64_bf16 v[40:43], v[16:19], a[48:55], v7
    ds_read_b128 v[84:87], v1 offset:27648
    v_smfmac_f32_16x16x64_bf16 v[44:47], v[16:19], a[56:63], v7
    ds_read_b128 v[16:19], v2 offset:4096
    s_waitcnt lgkmcnt(10)
    v_smfmac_f32_16x16x64_bf16 v[24:27], v[20:23], a[64:71], v7
    s_waitcnt lgkmcnt(8)
    v_smfmac_f32_16x16x64_bf16 v[28:31], v[20:23], v[56:63], v7
    ds_read_b128 v[56:59], v1 offset:28672
    v_smfmac_f32_16x16x64_bf16 v[32:35], v[20:23], a[72:79], v7
    ds_read_b128 v[60:63], v1 offset:29696
    s_waitcnt lgkmcnt(8)
    v_smfmac_f32_16x16x64_bf16 v[36:39], v[20:23], v[64:71], v7
    ds_read_b128 v[64:67], v1 offset:30720
    v_smfmac_f32_16x16x64_bf16 v[40:43], v[20:23], a[80:87], v7
    ds_read_b128 v[68:71], v1 offset:31744
    v_smfmac_f32_16x16x64_bf16 v[44:47], v[20:23], a[88:95], v7
    s_waitcnt lgkmcnt(9)
    v_smfmac_f32_16x16x64_bf16 v[24:27], v[12:15], a[96:103], v7
    s_waitcnt lgkmcnt(7)
    v_smfmac_f32_16x16x64_bf16 v[28:31], v[12:15], v[72:79], v7
    ds_read_b128 v[72:75], v1 offset:0
    v_smfmac_f32_16x16x64_bf16 v[32:35], v[12:15], a[104:111], v7
    ds_read_b128 v[76:79], v1 offset:1024
    s_waitcnt lgkmcnt(7)
    v_smfmac_f32_16x16x64_bf16 v[36:39], v[12:15], v[80:87], v7
    ds_read_b128 v[80:83], v1 offset:2048
    s_waitcnt lgkmcnt(7)
    v_smfmac_f32_16x16x64_bf16 v[24:27], v[16:19], a[128:135], v7
    ds_read_b128 v[84:87], v1 offset:3072
    s_waitcnt lgkmcnt(6)
    v_smfmac_f32_16x16x64_bf16 v[28:31], v[16:19], v[56:63], v7
    ds_read_b128 v[56:59], v1 offset:32768
    v_smfmac_f32_16x16x64_bf16 v[32:35], v[16:19], a[136:143], v7
    ds_read_b128 v[60:63], v1 offset:33792
    s_waitcnt lgkmcnt(6)
    v_smfmac_f32_16x16x64_bf16 v[36:39], v[16:19], v[64:71], v7
    s_waitcnt vmcnt(3)
    s_barrier
    ds_read_b128 v[20:23], v2 offset:5120
    v_smfmac_f32_16x16x64_bf16 v[40:43], v[12:15], a[112:119], v7
    v_smfmac_f32_16x16x64_bf16 v[44:47], v[12:15], a[120:127], v7
    ds_read_b128 v[12:15], v2 offset:6144
    v_smfmac_f32_16x16x64_bf16 v[40:43], v[16:19], a[144:151], v7
    v_smfmac_f32_16x16x64_bf16 v[44:47], v[16:19], a[152:159], v7
    ds_read_b128 v[16:19], v2 offset:7168
    s_waitcnt lgkmcnt(2)
    v_smfmac_f32_16x16x64_bf16 v[24:27], v[20:23], a[160:167], v7
    v_smfmac_f32_16x16x64_bf16 v[28:31], v[20:23], v[72:79], v7
    v_smfmac_f32_16x16x64_bf16 v[32:35], v[20:23], a[168:175], v7
    v_smfmac_f32_16x16x64_bf16 v[36:39], v[20:23], v[80:87], v7
    ds_read_b128 v[20:23], v2 offset:8192
    s_waitcnt lgkmcnt(2)
    v_smfmac_f32_16x16x64_bf16 v[24:27], v[12:15], a[192:199], v7
    v_smfmac_f32_16x16x64_bf16 v[28:31], v[12:15], v[56:63], v7
    ds_read_b128 v[72:75], v0 offset:10240
    v_smfmac_f32_16x16x64_bf16 v[32:35], v[12:15], a[200:207], v7
    v_smfmac_f32_16x16x64_bf16 v[36:39], v[12:15], a[208:215], v7
    ds_read_b128 v[76:79], v0 offset:11264
    ds_read_b128 v[12:15], v2 offset:9216
    s_waitcnt lgkmcnt(4)
    v_smfmac_f32_16x16x64_bf16 v[24:27], v[16:19], a[232:239], v7
    v_lshrrev_b32 v71, 9, v0
    v_smfmac_f32_16x16x64_bf16 v[28:31], v[16:19], a[248:255], v7
    ds_read_b128 v[80:83], v0 offset:12288
    v_smfmac_f32_16x16x64_bf16 v[32:35], v[16:19], a[240:247], v7
    v_lshlrev_b32 v71, 3, v71
    v_smfmac_f32_16x16x64_bf16 v[36:39], v[16:19], v[88:95], v7
    ds_read_b128 v[84:87], v0 offset:13312
    s_waitcnt lgkmcnt(5)
    v_smfmac_f32_16x16x64_bf16 v[24:27], v[20:23], v[112:119], v7
    v_lshrrev_b32 v70, 1, v0
    v_smfmac_f32_16x16x64_bf16 v[28:31], v[20:23], v[128:135], v7
    v_xor_b32 v70, v71, v70
    v_smfmac_f32_16x16x64_bf16 v[32:35], v[20:23], v[120:127], v7
    v_xor_b32 v71, 16, v70
    v_smfmac_f32_16x16x64_bf16 v[36:39], v[20:23], v[136:143], v7
    s_waitcnt lgkmcnt(2)
    v_smfmac_f32_16x16x64_bf16 v[24:27], v[12:15], v[160:167], v7
    v_smfmac_f32_16x16x64_bf16 v[28:31], v[12:15], v[176:183], v7
    v_smfmac_f32_16x16x64_bf16 v[32:35], v[12:15], v[168:175], v7
    v_add_f32 v24, v24, v26
    v_smfmac_f32_16x16x64_bf16 v[36:39], v[12:15], v[184:191], v7
    v_add_f32 v25, v25, v27
    v_add_f32 v28, v28, v30
    v_cvt_pk_bf16_f32 v8, v24, v25
    v_add_f32 v29, v29, v31
    v_add_f32 v32, v32, v34
    v_cvt_pk_bf16_f32 v9, v28, v29
    v_add_f32 v33, v33, v35
    ds_write_b64 v3, v[8:9]
    v_pk_add_f32 v[36:37], v[36:37], v[38:39]
    v_cvt_pk_bf16_f32 v10, v32, v33
    v_cvt_pk_bf16_f32 v11, v36, v37
    ds_write_b64 v3, v[10:11] offset:128
    v_smfmac_f32_16x16x64_bf16 v[40:43], v[12:15], v[192:199], v7
    v_smfmac_f32_16x16x64_bf16 v[44:47], v[12:15], v[200:207], v7
    ds_read_b128 v[12:15], v2 offset:6144
    v_smfmac_f32_16x16x64_bf16 v[40:43], v[20:23], v[144:151], v7
    v_smfmac_f32_16x16x64_bf16 v[44:47], v[20:23], v[152:159], v7
    ds_read_b128 v[20:23], v2 offset:5120
    v_smfmac_f32_16x16x64_bf16 v[40:43], v[16:19], v[96:103], v7
    s_waitcnt lgkmcnt(2)
    s_barrier
    ds_read_b64_tr_b16 v[56:57], v70 offset:18432
    ds_read_b64_tr_b16 v[58:59], v71 offset:18944
    v_smfmac_f32_16x16x64_bf16 v[44:47], v[16:19], v[104:111], v7
    ds_read_b64_tr_b16 v[60:61], v70 offset:19456
    ds_read_b64_tr_b16 v[62:63], v71 offset:19968
    s_waitcnt lgkmcnt(5)
    v_smfmac_f32_16x16x64_bf16 v[40:43], v[12:15], a[216:223], v7
    ds_read_b64_tr_b16 v[64:65], v70 offset:20480
    ds_read_b64_tr_b16 v[66:67], v71 offset:20992
    v_smfmac_f32_16x16x64_bf16 v[44:47], v[12:15], a[224:231], v7
    ds_read_b64_tr_b16 v[68:69], v70 offset:21504
    ds_read_b64_tr_b16 v[70:71], v71 offset:22016
    s_waitcnt lgkmcnt(8)
    v_smfmac_f32_16x16x64_bf16 v[40:43], v[20:23], a[176:183], v7
    v_smfmac_f32_16x16x64_bf16 v[44:47], v[20:23], a[184:191], v7
    s_waitcnt lgkmcnt(6)
    v_mfma_f32_16x16x32_bf16 v[28:31], v[72:75], v[56:59], 0
    ds_read_b128 v[72:75], v0 offset:14336
    s_waitcnt lgkmcnt(5)
    v_mfma_f32_16x16x32_bf16 v[28:31], v[76:79], v[60:63], v[28:31]
    ds_read_b128 v[76:79], v0 offset:15360
    s_waitcnt lgkmcnt(4)
    v_mfma_f32_16x16x32_bf16 v[28:31], v[80:83], v[64:67], v[28:31]
    ds_read_b128 v[80:83], v0 offset:16384
    v_add_f32 v40, v40, v42
    s_waitcnt lgkmcnt(3)
    v_mfma_f32_16x16x32_bf16 v[28:31], v[84:87], v[68:71], v[28:31]
    ds_read_b128 v[84:87], v0 offset:17408
    v_add_f32 v44, v44, v46
    v_mfma_f32_16x16x32_bf16 v[24:27], v[56:59], v[56:59], 0
    v_add_f32 v41, v41, v43
    v_add_f32 v45, v45, v47
    v_mfma_f32_16x16x32_bf16 v[24:27], v[60:63], v[60:63], v[24:27]
    v_cvt_pk_bf16_f32 v46, v40, v41
    v_cvt_pk_bf16_f32 v47, v44, v45
    v_mfma_f32_16x16x32_bf16 v[24:27], v[64:67], v[64:67], v[24:27]
    s_cmp_eq_u32 s34, 63
    buffer_store_dwordx4 v[64:67], v0, s[4:7], s40 offen sc1
    s_cbranch_scc1 L_recufin_141
    v_max3_f32 v8, v28, v29, v30
    v_mfma_f32_16x16x32_bf16 v[24:27], v[68:71], v[68:71], v[24:27]
    v_mov_b64 v[12:13], s[70:71]
    v_mov_b64 v[14:15], s[70:71]
    s_waitcnt lgkmcnt(3)
    v_mfma_f32_16x16x32_bf16 v[32:35], v[72:75], v[56:59], 0
    v_add_u32 v10, s49, v0
    v_mov_b64 v[36:37], 0
    s_waitcnt lgkmcnt(2)
    v_mfma_f32_16x16x32_bf16 v[32:35], v[76:79], v[60:63], v[32:35]
    v_max3_f32 v8, v8, v31, v26
    v_mov_b64 v[38:39], 0
    s_waitcnt lgkmcnt(1)
    v_mfma_f32_16x16x32_bf16 v[32:35], v[80:83], v[64:67], v[32:35]
    v_max_f32 v8, v8, v27
    ds_read_b128 v[72:75], v1 offset:8192
    ds_read_b128 v[76:79], v1 offset:9216
    s_waitcnt lgkmcnt(2)
    v_mfma_f32_16x16x32_bf16 v[32:35], v[84:87], v[68:71], v[32:35]
    ds_read_b128 v[80:83], v1 offset:4096
    ds_read_b128 v[84:87], v1 offset:5120
    v_mov_b32 v69, 0
    v_mov_b32 v70, 0
    v_mov_b64 v[40:41], 0
    v_mov_b64 v[42:43], 0
    s_nop 1
    v_max3_f32 v8, v8, v32, v33
    v_max3_f32 v9, v8, v34, v35
    v_max3_f32 v8, v8, v34, v35
    s_nop 1
    v_permlane32_swap_b32 v9, v8
    v_max_f32 v11, v8, v9
    v_max_f32 v8, v8, v9
    s_nop 1
    v_permlane16_swap_b32 v11, v8
    v_max_f32 v8, v8, v11
    v_mul_f32 v8, 0xbe0293ee, v8
    v_pk_fma_f32 v[26:27], v[26:27], s[68:69], v[8:9] op_sel_hi:[1,1,0]
    v_pk_fma_f32 v[28:29], v[28:29], s[68:69], v[8:9] op_sel_hi:[1,1,0]
    v_exp_f32 v26, v26
    v_exp_f32 v27, v27
    v_pk_fma_f32 v[30:31], v[30:31], s[68:69], v[8:9] op_sel_hi:[1,1,0]
    v_exp_f32 v28, v28
    v_pk_fma_f32 v[32:33], v[32:33], s[68:69], v[8:9] op_sel_hi:[1,1,0]
    v_exp_f32 v29, v29
    v_cvt_pk_bf16_f32 v68, v26, v27
    v_pk_fma_f32 v[34:35], v[34:35], s[68:69], v[8:9] op_sel_hi:[1,1,0]
    v_cvt_pk_bf16_f32 v71, v26, v27
    v_exp_f32 v30, v30
    v_mfma_f32_16x16x16_bf16 v[16:19], v[12:13], v[68:69], 0
    v_exp_f32 v31, v31
    v_cvt_pk_bf16_f32 v64, v28, v29
    v_mfma_f32_16x16x16_bf16 v[56:59], v[46:47], v[68:69], 0
    v_exp_f32 v32, v32
    v_exp_f32 v33, v33
    v_mfma_f32_16x16x16_bf16 v[60:63], v[46:47], v[70:71], 0
    v_cvt_pk_bf16_f32 v65, v30, v31
    v_exp_f32 v34, v34
    v_exp_f32 v35, v35
    v_cvt_pk_bf16_f32 v66, v32, v33
    s_waitcnt vmcnt(1)
    v_cvt_pk_bf16_f32 v67, v34, v35
    v_mov_b64 v[24:25], 0
    s_nop 0
    v_mfma_f32_16x16x32_bf16 v[16:19], v[12:15], v[64:67], v[16:19]
    v_mov_b64 v[26:27], 0
    v_mov_b64 v[28:29], 0
    v_mfma_f32_16x16x32_bf16 v[56:59], v[48:51], v[64:67], v[56:59]
    v_mov_b64 v[30:31], 0
    v_mov_b64 v[32:33], 0
    v_mfma_f32_16x16x32_bf16 v[60:63], v[52:55], v[64:67], v[60:63]
    v_mov_b64 v[34:35], 0
    v_rcp_f32 v8, v16
    s_nop 1
    v_pk_mul_f32 v[56:57], v[56:57], v[8:9] op_sel_hi:[1,0]
    v_pk_mul_f32 v[58:59], v[58:59], v[8:9] op_sel_hi:[1,0]
    v_cvt_pk_bf16_f32 v20, v56, v57
    v_cvt_pk_bf16_f32 v21, v58, v59
    v_pk_mul_f32 v[60:61], v[60:61], v[8:9] op_sel_hi:[1,0]
    v_pk_mul_f32 v[62:63], v[62:63], v[8:9] op_sel_hi:[1,0]
    v_cvt_pk_bf16_f32 v22, v60, v61
    v_cvt_pk_bf16_f32 v23, v62, v63
    s_mov_b64 exec, s[64:65]
    ds_write_b128 v10, v[20:23]
    s_mov_b64 exec, -1
    ds_read_b128 v[56:59], v1 offset:6144
    ds_read_b128 v[60:63], v1 offset:7168
    ds_read_b128 v[64:67], v1 offset:10240
    ds_read_b128 v[68:71], v1 offset:11264
    s_waitcnt lgkmcnt(4)
    s_barrier
    ds_read_b128 v[12:15], v0 offset:22528
    ds_read_b128 v[16:19], v0 offset:23552
    s_mov_b32 m0, s51
    s_nop 0
    buffer_load_dwordx4 v0, s[4:7], s39 offen lds
    buffer_load_dwordx4 v0, s[4:7], s39 offen offset:1024 lds
    s_waitcnt lgkmcnt(1)
    v_smfmac_f32_16x16x64_bf16 v[40:43], v[12:15], v[72:79], v7
    s_waitcnt lgkmcnt(0)
    v_smfmac_f32_16x16x64_bf16 v[40:43], v[16:19], v[64:71], v7
    v_smfmac_f32_16x16x64_bf16 v[24:27], v[12:15], v[208:215], v7
    v_smfmac_f32_16x16x64_bf16 v[24:27], v[16:19], v[240:247], v7
    v_add_f32 v40, v40, v42
    v_smfmac_f32_16x16x64_bf16 v[28:31], v[12:15], v[216:223], v7
    v_add_f32 v41, v41, v43
    v_smfmac_f32_16x16x64_bf16 v[28:31], v[16:19], v[248:255], v7
    v_cvt_pk_bf16_f32 v20, v40, v41
    v_smfmac_f32_16x16x64_bf16 v[32:35], v[12:15], v[224:231], v7
    v_bfi_b32 v20, 1, s19, v20
    v_smfmac_f32_16x16x64_bf16 v[32:35], v[16:19], v[80:87], v7
    buffer_store_dword v20, v6, s[4:7], s35 offen sc1
    v_add_f32 v24, v24, v26
    v_smfmac_f32_16x16x64_bf16 v[36:39], v[12:15], v[232:239], v7
    v_add_f32 v25, v25, v27
    v_smfmac_f32_16x16x64_bf16 v[36:39], v[16:19], v[56:63], v7
    v_add_f32 v28, v28, v30
    v_add_f32 v29, v29, v31
    v_cvt_pk_bf16_f32 v8, v24, v25
    v_add_f32 v32, v32, v34
    v_cvt_pk_bf16_f32 v9, v28, v29
    v_add_f32 v33, v33, v35
    v_bfi_b32 v8, 1, s19, v8
    v_cvt_pk_bf16_f32 v10, v32, v33
    v_pk_add_f32 v[36:37], v[36:37], v[38:39]
    v_cvt_pk_bf16_f32 v11, v36, v37
    buffer_store_dwordx4 v[8:11], v5, s[4:7], s35 offen sc1
    s_add_u32 s39, s39, 262144
    s_add_u32 s47, s47, 262144
    s_xor_b32 s35, s35, 262144
    s_add_u32 s40, s40, 131072
    v_mov_b64 v[24:25], 0
    v_mov_b64 v[26:27], 0
    v_mov_b64 v[28:29], 0
    v_mov_b64 v[30:31], 0
    v_mov_b64 v[32:33], 0
    v_mov_b64 v[34:35], 0
    v_mov_b64 v[36:37], 0
    v_mov_b64 v[38:39], 0
    v_mov_b64 v[40:41], 0
    v_mov_b64 v[42:43], 0
    v_mov_b64 v[44:45], 0
    v_mov_b64 v[46:47], 0
    ds_read_b128 v[56:59], v1 offset:12288
    ds_read_b128 v[60:63], v1 offset:13312
    ds_read_b128 v[64:67], v1 offset:14336
    ds_read_b128 v[68:71], v1 offset:15360
    ds_read_b128 v[72:75], v1 offset:16384
    ds_read_b128 v[76:79], v1 offset:17408
    ds_read_b128 v[80:83], v1 offset:18432
    ds_read_b128 v[84:87], v1 offset:19456
    s_mov_b32 m0, s66
    s_add_u32 s34, s34, 1
    s_bfe_u32 s19, s34, 0x10001
    s_mov_b32 s50, 3200000
    s_mov_b32 s30, s37
    s_add_u32 s37, s37, 8192
    s_andn2_b32 s37, s37, 0x8000
    s_waitcnt lgkmcnt(0)
    s_barrier
    s_nop 15
    s_nop 15
    s_nop 15
    s_nop 15
    s_nop 15
    buffer_load_dwordx4 v0, s[4:7], s30 offen offset:0 sc1 lds
    buffer_load_dwordx4 v0, s[4:7], s30 offen offset:1024 sc1 lds
    buffer_load_dwordx4 v0, s[4:7], s30 offen offset:2048 sc1 lds
    s_nop 15
    s_nop 15
    s_nop 11
    buffer_load_dwordx4 v0, s[4:7], s30 offen offset:0 sc1 lds
    buffer_load_dwordx4 v0, s[4:7], s30 offen offset:1024 sc1 lds
    buffer_load_dwordx4 v0, s[4:7], s30 offen offset:2048 sc1 lds
L_recuagl_144:
    s_waitcnt vmcnt(3)
    ds_read2st64_b32 v[8:9], v4 offset0:0 offset1:4
    ds_read_b32 v10, v4 offset:2048
    buffer_load_dwordx4 v0, s[4:7], s30 offen offset:0 sc1 lds
    buffer_load_dwordx4 v0, s[4:7], s30 offen offset:1024 sc1 lds
    buffer_load_dwordx4 v0, s[4:7], s30 offen offset:2048 sc1 lds
    s_waitcnt lgkmcnt(0)
    v_max3_u32 v8, v8, v9, v10
    v_cmp_eq_u32 vcc, -1, v8
    s_cbranch_vccz L_recucl_140
    s_waitcnt vmcnt(3)
    ds_read2st64_b32 v[8:9], v4 offset0:0 offset1:4
    ds_read_b32 v10, v4 offset:2048
    buffer_load_dwordx4 v0, s[4:7], s30 offen offset:0 sc1 lds
    buffer_load_dwordx4 v0, s[4:7], s30 offen offset:1024 sc1 lds
    buffer_load_dwordx4 v0, s[4:7], s30 offen offset:2048 sc1 lds
    s_waitcnt lgkmcnt(0)
    v_max3_u32 v8, v8, v9, v10
    v_cmp_eq_u32 vcc, -1, v8
    s_cbranch_vccz L_recucl_140
    s_sub_u32 s50, s50, 1
    s_cbranch_scc0 L_recuagl_144
    s_branch L_exit_recurrent_scan__memory_aug_recurrent_mem_tr__moe_arch_mod__prompt_kernel
    s_branch L_recucl_140
L_recufin_141:
    s_waitcnt lgkmcnt(0)
    s_nop 7
    s_waitcnt vmcnt(0)
    v_mov_b32 v9, 64
    buffer_store_dword v9, off, s[4:7], s41 sc1
    s_waitcnt vmcnt(0)
    s_branch L_exit_recurrent_scan__memory_aug_recurrent_mem_tr__moe_arch_mod__prompt_kernel
L_recub_109:
L_recucl_145:
    s_barrier
    ds_read_b128 v[12:15], v2 offset:0
    ds_read_b128 v[16:19], v2 offset:1024
    ds_read_b128 v[20:23], v2 offset:2048
    s_waitcnt lgkmcnt(2)
    v_smfmac_f32_16x16x64_bf16 v[24:27], v[12:15], a[0:7], v7
    v_mov_b32 v8, s34
    v_smfmac_f32_16x16x64_bf16 v[28:31], v[12:15], v[56:63], v7
    ds_read_b128 v[56:59], v1 offset:20480
    v_smfmac_f32_16x16x64_bf16 v[32:35], v[12:15], a[8:15], v7
    ds_read_b128 v[60:63], v1 offset:21504
    v_smfmac_f32_16x16x64_bf16 v[36:39], v[12:15], v[64:71], v7
    ds_read_b128 v[64:67], v1 offset:22528
    v_smfmac_f32_16x16x64_bf16 v[40:43], v[12:15], a[16:23], v7
    ds_read_b128 v[68:71], v1 offset:23552
    v_smfmac_f32_16x16x64_bf16 v[44:47], v[12:15], a[24:31], v7
    buffer_load_dwordx4 v[48:51], v0, s[4:7], s47 offen offset:0
    ds_read_b128 v[12:15], v2 offset:3072
    s_waitcnt lgkmcnt(6)
    v_smfmac_f32_16x16x64_bf16 v[24:27], v[16:19], a[32:39], v7
    buffer_load_dwordx4 v[52:55], v0, s[4:7], s47 offen offset:1024
    v_smfmac_f32_16x16x64_bf16 v[28:31], v[16:19], v[72:79], v7
    ds_read_b128 v[72:75], v1 offset:24576
    v_smfmac_f32_16x16x64_bf16 v[32:35], v[16:19], a[40:47], v7
    ds_read_b128 v[76:79], v1 offset:25600
    buffer_store_dword v8, off, s[4:7], s41 sc1
    v_smfmac_f32_16x16x64_bf16 v[36:39], v[16:19], v[80:87], v7
    ds_read_b128 v[80:83], v1 offset:26624
    v_smfmac_f32_16x16x64_bf16 v[40:43], v[16:19], a[48:55], v7
    ds_read_b128 v[84:87], v1 offset:27648
    v_smfmac_f32_16x16x64_bf16 v[44:47], v[16:19], a[56:63], v7
    ds_read_b128 v[16:19], v2 offset:4096
    s_waitcnt lgkmcnt(10)
    v_smfmac_f32_16x16x64_bf16 v[24:27], v[20:23], a[64:71], v7
    s_waitcnt lgkmcnt(8)
    v_smfmac_f32_16x16x64_bf16 v[28:31], v[20:23], v[56:63], v7
    ds_read_b128 v[56:59], v1 offset:28672
    v_smfmac_f32_16x16x64_bf16 v[32:35], v[20:23], a[72:79], v7
    ds_read_b128 v[60:63], v1 offset:29696
    s_waitcnt lgkmcnt(8)
    v_smfmac_f32_16x16x64_bf16 v[36:39], v[20:23], v[64:71], v7
    ds_read_b128 v[64:67], v1 offset:30720
    v_smfmac_f32_16x16x64_bf16 v[40:43], v[20:23], a[80:87], v7
    ds_read_b128 v[68:71], v1 offset:31744
    v_smfmac_f32_16x16x64_bf16 v[44:47], v[20:23], a[88:95], v7
    s_waitcnt lgkmcnt(9)
    v_smfmac_f32_16x16x64_bf16 v[24:27], v[12:15], a[96:103], v7
    s_waitcnt lgkmcnt(7)
    v_smfmac_f32_16x16x64_bf16 v[28:31], v[12:15], v[72:79], v7
    ds_read_b128 v[72:75], v1 offset:0
    v_smfmac_f32_16x16x64_bf16 v[32:35], v[12:15], a[104:111], v7
    ds_read_b128 v[76:79], v1 offset:1024
    s_waitcnt lgkmcnt(7)
    v_smfmac_f32_16x16x64_bf16 v[36:39], v[12:15], v[80:87], v7
    ds_read_b128 v[80:83], v1 offset:2048
    s_waitcnt lgkmcnt(7)
    v_smfmac_f32_16x16x64_bf16 v[24:27], v[16:19], a[128:135], v7
    ds_read_b128 v[84:87], v1 offset:3072
    s_waitcnt lgkmcnt(6)
    v_smfmac_f32_16x16x64_bf16 v[28:31], v[16:19], v[56:63], v7
    ds_read_b128 v[56:59], v1 offset:32768
    v_smfmac_f32_16x16x64_bf16 v[32:35], v[16:19], a[136:143], v7
    ds_read_b128 v[60:63], v1 offset:33792
    s_waitcnt lgkmcnt(6)
    v_smfmac_f32_16x16x64_bf16 v[36:39], v[16:19], v[64:71], v7
    s_waitcnt vmcnt(3)
    s_barrier
    ds_read_b128 v[20:23], v2 offset:5120
    v_smfmac_f32_16x16x64_bf16 v[40:43], v[12:15], a[112:119], v7
    v_smfmac_f32_16x16x64_bf16 v[44:47], v[12:15], a[120:127], v7
    ds_read_b128 v[12:15], v2 offset:6144
    v_smfmac_f32_16x16x64_bf16 v[40:43], v[16:19], a[144:151], v7
    v_smfmac_f32_16x16x64_bf16 v[44:47], v[16:19], a[152:159], v7
    ds_read_b128 v[16:19], v2 offset:7168
    s_waitcnt lgkmcnt(2)
    v_smfmac_f32_16x16x64_bf16 v[24:27], v[20:23], a[160:167], v7
    v_smfmac_f32_16x16x64_bf16 v[28:31], v[20:23], v[72:79], v7
    v_smfmac_f32_16x16x64_bf16 v[32:35], v[20:23], a[168:175], v7
    v_smfmac_f32_16x16x64_bf16 v[36:39], v[20:23], v[80:87], v7
    ds_read_b128 v[20:23], v2 offset:8192
    s_waitcnt lgkmcnt(2)
    v_smfmac_f32_16x16x64_bf16 v[24:27], v[12:15], a[192:199], v7
    v_smfmac_f32_16x16x64_bf16 v[28:31], v[12:15], v[56:63], v7
    ds_read_b128 v[72:75], v0 offset:10240
    v_smfmac_f32_16x16x64_bf16 v[32:35], v[12:15], a[200:207], v7
    v_smfmac_f32_16x16x64_bf16 v[36:39], v[12:15], a[208:215], v7
    ds_read_b128 v[76:79], v0 offset:11264
    ds_read_b128 v[12:15], v2 offset:9216
    s_waitcnt lgkmcnt(4)
    v_smfmac_f32_16x16x64_bf16 v[24:27], v[16:19], a[232:239], v7
    v_lshrrev_b32 v71, 9, v0
    v_smfmac_f32_16x16x64_bf16 v[28:31], v[16:19], a[248:255], v7
    ds_read_b128 v[80:83], v0 offset:12288
    v_smfmac_f32_16x16x64_bf16 v[32:35], v[16:19], a[240:247], v7
    v_lshlrev_b32 v71, 3, v71
    v_smfmac_f32_16x16x64_bf16 v[36:39], v[16:19], v[88:95], v7
    ds_read_b128 v[84:87], v0 offset:13312
    s_waitcnt lgkmcnt(5)
    v_smfmac_f32_16x16x64_bf16 v[24:27], v[20:23], v[112:119], v7
    v_lshrrev_b32 v70, 1, v0
    v_smfmac_f32_16x16x64_bf16 v[28:31], v[20:23], v[128:135], v7
    v_xor_b32 v70, v71, v70
    v_smfmac_f32_16x16x64_bf16 v[32:35], v[20:23], v[120:127], v7
    v_xor_b32 v71, 16, v70
    v_smfmac_f32_16x16x64_bf16 v[36:39], v[20:23], v[136:143], v7
    s_waitcnt lgkmcnt(2)
    v_smfmac_f32_16x16x64_bf16 v[24:27], v[12:15], v[160:167], v7
    v_smfmac_f32_16x16x64_bf16 v[28:31], v[12:15], v[176:183], v7
    v_smfmac_f32_16x16x64_bf16 v[32:35], v[12:15], v[168:175], v7
    v_add_f32 v24, v24, v26
    v_smfmac_f32_16x16x64_bf16 v[36:39], v[12:15], v[184:191], v7
    v_add_f32 v25, v25, v27
    v_add_f32 v28, v28, v30
    v_cvt_pk_bf16_f32 v8, v24, v25
    v_add_f32 v29, v29, v31
    v_add_f32 v32, v32, v34
    v_cvt_pk_bf16_f32 v9, v28, v29
    v_add_f32 v33, v33, v35
    ds_write_b64 v3, v[8:9]
    v_pk_add_f32 v[36:37], v[36:37], v[38:39]
    v_cvt_pk_bf16_f32 v10, v32, v33
    v_cvt_pk_bf16_f32 v11, v36, v37
    ds_write_b64 v3, v[10:11] offset:128
    v_smfmac_f32_16x16x64_bf16 v[40:43], v[12:15], v[192:199], v7
    v_smfmac_f32_16x16x64_bf16 v[44:47], v[12:15], v[200:207], v7
    ds_read_b128 v[12:15], v2 offset:6144
    v_smfmac_f32_16x16x64_bf16 v[40:43], v[20:23], v[144:151], v7
    v_smfmac_f32_16x16x64_bf16 v[44:47], v[20:23], v[152:159], v7
    ds_read_b128 v[20:23], v2 offset:5120
    v_smfmac_f32_16x16x64_bf16 v[40:43], v[16:19], v[96:103], v7
    s_waitcnt lgkmcnt(2)
    s_barrier
    ds_read_b64_tr_b16 v[56:57], v70 offset:18432
    ds_read_b64_tr_b16 v[58:59], v71 offset:18944
    v_smfmac_f32_16x16x64_bf16 v[44:47], v[16:19], v[104:111], v7
    ds_read_b64_tr_b16 v[60:61], v70 offset:19456
    ds_read_b64_tr_b16 v[62:63], v71 offset:19968
    s_waitcnt lgkmcnt(5)
    v_smfmac_f32_16x16x64_bf16 v[40:43], v[12:15], a[216:223], v7
    ds_read_b64_tr_b16 v[64:65], v70 offset:20480
    ds_read_b64_tr_b16 v[66:67], v71 offset:20992
    v_smfmac_f32_16x16x64_bf16 v[44:47], v[12:15], a[224:231], v7
    ds_read_b64_tr_b16 v[68:69], v70 offset:21504
    ds_read_b64_tr_b16 v[70:71], v71 offset:22016
    s_waitcnt lgkmcnt(8)
    v_smfmac_f32_16x16x64_bf16 v[40:43], v[20:23], a[176:183], v7
    v_smfmac_f32_16x16x64_bf16 v[44:47], v[20:23], a[184:191], v7
    s_waitcnt lgkmcnt(6)
    v_mfma_f32_16x16x32_bf16 v[28:31], v[72:75], v[56:59], 0
    ds_read_b128 v[72:75], v0 offset:14336
    s_waitcnt lgkmcnt(5)
    v_mfma_f32_16x16x32_bf16 v[28:31], v[76:79], v[60:63], v[28:31]
    ds_read_b128 v[76:79], v0 offset:15360
    s_waitcnt lgkmcnt(4)
    v_mfma_f32_16x16x32_bf16 v[28:31], v[80:83], v[64:67], v[28:31]
    ds_read_b128 v[80:83], v0 offset:16384
    v_add_f32 v40, v40, v42
    s_waitcnt lgkmcnt(3)
    v_mfma_f32_16x16x32_bf16 v[28:31], v[84:87], v[68:71], v[28:31]
    ds_read_b128 v[84:87], v0 offset:17408
    v_add_f32 v44, v44, v46
    v_mfma_f32_16x16x32_bf16 v[24:27], v[56:59], v[56:59], 0
    v_add_f32 v41, v41, v43
    v_add_f32 v45, v45, v47
    v_mfma_f32_16x16x32_bf16 v[24:27], v[60:63], v[60:63], v[24:27]
    v_cvt_pk_bf16_f32 v46, v40, v41
    v_cvt_pk_bf16_f32 v47, v44, v45
    v_mfma_f32_16x16x32_bf16 v[24:27], v[64:67], v[64:67], v[24:27]
    s_cmp_eq_u32 s34, 63
    buffer_store_dwordx4 v[68:71], v0, s[4:7], s40 offen sc1
    s_cbranch_scc1 L_recufin_146
    v_max3_f32 v8, v28, v29, v30
    v_mfma_f32_16x16x32_bf16 v[24:27], v[68:71], v[68:71], v[24:27]
    v_mov_b64 v[12:13], s[70:71]
    v_mov_b64 v[14:15], s[70:71]
    s_waitcnt lgkmcnt(3)
    v_mfma_f32_16x16x32_bf16 v[32:35], v[72:75], v[56:59], 0
    v_add_u32 v10, s49, v0
    v_mov_b64 v[36:37], 0
    s_waitcnt lgkmcnt(2)
    v_mfma_f32_16x16x32_bf16 v[32:35], v[76:79], v[60:63], v[32:35]
    v_max3_f32 v8, v8, v31, v26
    v_mov_b64 v[38:39], 0
    s_waitcnt lgkmcnt(1)
    v_mfma_f32_16x16x32_bf16 v[32:35], v[80:83], v[64:67], v[32:35]
    v_max_f32 v8, v8, v27
    ds_read_b128 v[72:75], v1 offset:8192
    ds_read_b128 v[76:79], v1 offset:9216
    s_waitcnt lgkmcnt(2)
    v_mfma_f32_16x16x32_bf16 v[32:35], v[84:87], v[68:71], v[32:35]
    ds_read_b128 v[80:83], v1 offset:4096
    ds_read_b128 v[84:87], v1 offset:5120
    v_mov_b32 v69, 0
    v_mov_b32 v70, 0
    v_mov_b64 v[40:41], 0
    v_mov_b64 v[42:43], 0
    s_nop 1
    v_max3_f32 v8, v8, v32, v33
    v_max3_f32 v9, v8, v34, v35
    v_max3_f32 v8, v8, v34, v35
    s_nop 1
    v_permlane32_swap_b32 v9, v8
    v_max_f32 v11, v8, v9
    v_max_f32 v8, v8, v9
    s_nop 1
    v_permlane16_swap_b32 v11, v8
    v_max_f32 v8, v8, v11
    v_mul_f32 v8, 0xbe0293ee, v8
    v_pk_fma_f32 v[26:27], v[26:27], s[68:69], v[8:9] op_sel_hi:[1,1,0]
    v_pk_fma_f32 v[28:29], v[28:29], s[68:69], v[8:9] op_sel_hi:[1,1,0]
    v_exp_f32 v26, v26
    v_exp_f32 v27, v27
    v_pk_fma_f32 v[30:31], v[30:31], s[68:69], v[8:9] op_sel_hi:[1,1,0]
    v_exp_f32 v28, v28
    v_pk_fma_f32 v[32:33], v[32:33], s[68:69], v[8:9] op_sel_hi:[1,1,0]
    v_exp_f32 v29, v29
    v_cvt_pk_bf16_f32 v68, v26, v27
    v_pk_fma_f32 v[34:35], v[34:35], s[68:69], v[8:9] op_sel_hi:[1,1,0]
    v_cvt_pk_bf16_f32 v71, v26, v27
    v_exp_f32 v30, v30
    v_mfma_f32_16x16x16_bf16 v[16:19], v[12:13], v[68:69], 0
    v_exp_f32 v31, v31
    v_cvt_pk_bf16_f32 v64, v28, v29
    v_mfma_f32_16x16x16_bf16 v[56:59], v[46:47], v[68:69], 0
    v_exp_f32 v32, v32
    v_exp_f32 v33, v33
    v_mfma_f32_16x16x16_bf16 v[60:63], v[46:47], v[70:71], 0
    v_cvt_pk_bf16_f32 v65, v30, v31
    v_exp_f32 v34, v34
    v_exp_f32 v35, v35
    v_cvt_pk_bf16_f32 v66, v32, v33
    s_waitcnt vmcnt(1)
    v_cvt_pk_bf16_f32 v67, v34, v35
    v_mov_b64 v[24:25], 0
    s_nop 0
    v_mfma_f32_16x16x32_bf16 v[16:19], v[12:15], v[64:67], v[16:19]
    v_mov_b64 v[26:27], 0
    v_mov_b64 v[28:29], 0
    v_mfma_f32_16x16x32_bf16 v[56:59], v[48:51], v[64:67], v[56:59]
    v_mov_b64 v[30:31], 0
    v_mov_b64 v[32:33], 0
    v_mfma_f32_16x16x32_bf16 v[60:63], v[52:55], v[64:67], v[60:63]
    v_mov_b64 v[34:35], 0
    v_rcp_f32 v8, v16
    s_nop 1
    v_pk_mul_f32 v[56:57], v[56:57], v[8:9] op_sel_hi:[1,0]
    v_pk_mul_f32 v[58:59], v[58:59], v[8:9] op_sel_hi:[1,0]
    v_cvt_pk_bf16_f32 v20, v56, v57
    v_cvt_pk_bf16_f32 v21, v58, v59
    v_pk_mul_f32 v[60:61], v[60:61], v[8:9] op_sel_hi:[1,0]
    v_pk_mul_f32 v[62:63], v[62:63], v[8:9] op_sel_hi:[1,0]
    v_cvt_pk_bf16_f32 v22, v60, v61
    v_cvt_pk_bf16_f32 v23, v62, v63
    s_mov_b64 exec, s[64:65]
    ds_write_b128 v10, v[20:23]
    s_mov_b64 exec, -1
    ds_read_b128 v[56:59], v1 offset:6144
    ds_read_b128 v[60:63], v1 offset:7168
    ds_read_b128 v[64:67], v1 offset:10240
    ds_read_b128 v[68:71], v1 offset:11264
    s_waitcnt lgkmcnt(4)
    s_barrier
    ds_read_b128 v[12:15], v0 offset:22528
    ds_read_b128 v[16:19], v0 offset:23552
    s_mov_b32 m0, s51
    s_nop 0
    buffer_load_dwordx4 v0, s[4:7], s39 offen lds
    buffer_load_dwordx4 v0, s[4:7], s39 offen offset:1024 lds
    s_waitcnt lgkmcnt(1)
    v_smfmac_f32_16x16x64_bf16 v[40:43], v[12:15], v[72:79], v7
    s_waitcnt lgkmcnt(0)
    v_smfmac_f32_16x16x64_bf16 v[40:43], v[16:19], v[64:71], v7
    v_smfmac_f32_16x16x64_bf16 v[24:27], v[12:15], v[208:215], v7
    v_smfmac_f32_16x16x64_bf16 v[24:27], v[16:19], v[240:247], v7
    v_add_f32 v40, v40, v42
    v_smfmac_f32_16x16x64_bf16 v[28:31], v[12:15], v[216:223], v7
    v_add_f32 v41, v41, v43
    v_smfmac_f32_16x16x64_bf16 v[28:31], v[16:19], v[248:255], v7
    v_cvt_pk_bf16_f32 v20, v40, v41
    v_smfmac_f32_16x16x64_bf16 v[32:35], v[12:15], v[224:231], v7
    v_bfi_b32 v20, 1, s19, v20
    v_smfmac_f32_16x16x64_bf16 v[32:35], v[16:19], v[80:87], v7
    buffer_store_dword v20, v6, s[4:7], s35 offen sc1
    v_add_f32 v24, v24, v26
    v_smfmac_f32_16x16x64_bf16 v[36:39], v[12:15], v[232:239], v7
    v_add_f32 v25, v25, v27
    v_smfmac_f32_16x16x64_bf16 v[36:39], v[16:19], v[56:63], v7
    v_add_f32 v28, v28, v30
    v_add_f32 v29, v29, v31
    v_cvt_pk_bf16_f32 v8, v24, v25
    v_add_f32 v32, v32, v34
    v_cvt_pk_bf16_f32 v9, v28, v29
    v_add_f32 v33, v33, v35
    v_bfi_b32 v8, 1, s19, v8
    v_cvt_pk_bf16_f32 v10, v32, v33
    v_pk_add_f32 v[36:37], v[36:37], v[38:39]
    v_cvt_pk_bf16_f32 v11, v36, v37
    buffer_store_dwordx4 v[8:11], v5, s[4:7], s35 offen sc1
    s_add_u32 s39, s39, 262144
    s_add_u32 s47, s47, 262144
    s_xor_b32 s35, s35, 262144
    s_add_u32 s40, s40, 131072
    v_mov_b64 v[24:25], 0
    v_mov_b64 v[26:27], 0
    v_mov_b64 v[28:29], 0
    v_mov_b64 v[30:31], 0
    v_mov_b64 v[32:33], 0
    v_mov_b64 v[34:35], 0
    v_mov_b64 v[36:37], 0
    v_mov_b64 v[38:39], 0
    v_mov_b64 v[40:41], 0
    v_mov_b64 v[42:43], 0
    v_mov_b64 v[44:45], 0
    v_mov_b64 v[46:47], 0
    ds_read_b128 v[56:59], v1 offset:12288
    ds_read_b128 v[60:63], v1 offset:13312
    ds_read_b128 v[64:67], v1 offset:14336
    ds_read_b128 v[68:71], v1 offset:15360
    ds_read_b128 v[72:75], v1 offset:16384
    ds_read_b128 v[76:79], v1 offset:17408
    ds_read_b128 v[80:83], v1 offset:18432
    ds_read_b128 v[84:87], v1 offset:19456
    s_mov_b32 m0, s66
    s_add_u32 s34, s34, 1
    s_bfe_u32 s19, s34, 0x10001
    s_mov_b32 s50, 3200000
    s_mov_b32 s30, s37
    s_add_u32 s37, s37, 8192
    s_andn2_b32 s37, s37, 0x8000
    s_waitcnt lgkmcnt(0)
    s_barrier
    s_nop 15
    s_nop 15
    s_nop 15
    s_nop 15
    s_nop 15
    buffer_load_dwordx4 v0, s[4:7], s30 offen offset:0 sc1 lds
    buffer_load_dwordx4 v0, s[4:7], s30 offen offset:1024 sc1 lds
    s_nop 15
    s_nop 15
    s_nop 11
    buffer_load_dwordx4 v0, s[4:7], s30 offen offset:0 sc1 lds
    buffer_load_dwordx4 v0, s[4:7], s30 offen offset:1024 sc1 lds
L_recuagl_149:
    s_waitcnt vmcnt(2)
    ds_read2st64_b32 v[8:9], v4 offset0:12 offset1:16
    buffer_load_dwordx4 v0, s[4:7], s30 offen offset:0 sc1 lds
    buffer_load_dwordx4 v0, s[4:7], s30 offen offset:1024 sc1 lds
    s_waitcnt lgkmcnt(0)
    v_max_u32 v8, v8, v9
    v_cmp_eq_u32 vcc, -1, v8
    s_cbranch_vccz L_recucl_145
    s_waitcnt vmcnt(2)
    ds_read2st64_b32 v[8:9], v4 offset0:12 offset1:16
    buffer_load_dwordx4 v0, s[4:7], s30 offen offset:0 sc1 lds
    buffer_load_dwordx4 v0, s[4:7], s30 offen offset:1024 sc1 lds
    s_waitcnt lgkmcnt(0)
    v_max_u32 v8, v8, v9
    v_cmp_eq_u32 vcc, -1, v8
    s_cbranch_vccz L_recucl_145
    s_sub_u32 s50, s50, 1
    s_cbranch_scc0 L_recuagl_149
    s_branch L_exit_recurrent_scan__memory_aug_recurrent_mem_tr__moe_arch_mod__prompt_kernel
    s_branch L_recucl_145
L_recufin_146:
    s_waitcnt lgkmcnt(0)
    s_nop 7
    s_waitcnt vmcnt(0)
    v_mov_b32 v9, 64
    buffer_store_dword v9, off, s[4:7], s41 sc1
    s_waitcnt vmcnt(0)
    s_branch L_exit_recurrent_scan__memory_aug_recurrent_mem_tr__moe_arch_mod__prompt_kernel
L_recub_110:
L_recucl_150:
    s_barrier
    ds_read_b128 v[12:15], v2 offset:0
    ds_read_b128 v[16:19], v2 offset:1024
    ds_read_b128 v[20:23], v2 offset:2048
    s_mov_b64 exec, s[8:9]
    buffer_load_dwordx4 v0, s[4:7], s30 offen offset:0 sc1 lds
    buffer_load_dwordx4 v0, s[4:7], s30 offen offset:1024 sc1 lds
    buffer_load_dwordx4 v0, s[4:7], s30 offen offset:2048 sc1 lds
    s_mov_b64 exec, -1
    s_waitcnt lgkmcnt(2)
    v_smfmac_f32_16x16x64_bf16 v[24:27], v[12:15], a[0:7], v7
    v_mov_b32 v8, s34
    v_smfmac_f32_16x16x64_bf16 v[28:31], v[12:15], v[56:63], v7
    ds_read_b128 v[56:59], v1 offset:20480
    v_smfmac_f32_16x16x64_bf16 v[32:35], v[12:15], a[8:15], v7
    ds_read_b128 v[60:63], v1 offset:21504
    v_smfmac_f32_16x16x64_bf16 v[36:39], v[12:15], v[64:71], v7
    ds_read_b128 v[64:67], v1 offset:22528
    v_smfmac_f32_16x16x64_bf16 v[40:43], v[12:15], a[16:23], v7
    ds_read_b128 v[68:71], v1 offset:23552
    v_smfmac_f32_16x16x64_bf16 v[44:47], v[12:15], a[24:31], v7
    buffer_load_dwordx4 v[48:51], v0, s[4:7], s47 offen offset:0
    ds_read_b128 v[12:15], v2 offset:3072
    s_waitcnt lgkmcnt(6)
    v_smfmac_f32_16x16x64_bf16 v[24:27], v[16:19], a[32:39], v7
    buffer_load_dwordx4 v[52:55], v0, s[4:7], s47 offen offset:1024
    v_smfmac_f32_16x16x64_bf16 v[28:31], v[16:19], v[72:79], v7
    ds_read_b128 v[72:75], v1 offset:24576
    v_smfmac_f32_16x16x64_bf16 v[32:35], v[16:19], a[40:47], v7
    ds_read_b128 v[76:79], v1 offset:25600
    buffer_store_dword v8, off, s[4:7], s41 sc1
    v_smfmac_f32_16x16x64_bf16 v[36:39], v[16:19], v[80:87], v7
    ds_read_b128 v[80:83], v1 offset:26624
    v_smfmac_f32_16x16x64_bf16 v[40:43], v[16:19], a[48:55], v7
    ds_read_b128 v[84:87], v1 offset:27648
    v_smfmac_f32_16x16x64_bf16 v[44:47], v[16:19], a[56:63], v7
    ds_read_b128 v[16:19], v2 offset:4096
    s_waitcnt lgkmcnt(10)
    v_smfmac_f32_16x16x64_bf16 v[24:27], v[20:23], a[64:71], v7
    s_waitcnt lgkmcnt(8)
    v_smfmac_f32_16x16x64_bf16 v[28:31], v[20:23], v[56:63], v7
    ds_read_b128 v[56:59], v1 offset:28672
    v_smfmac_f32_16x16x64_bf16 v[32:35], v[20:23], a[72:79], v7
    ds_read_b128 v[60:63], v1 offset:29696
    s_waitcnt lgkmcnt(8)
    v_smfmac_f32_16x16x64_bf16 v[36:39], v[20:23], v[64:71], v7
    ds_read_b128 v[64:67], v1 offset:30720
    v_smfmac_f32_16x16x64_bf16 v[40:43], v[20:23], a[80:87], v7
    ds_read_b128 v[68:71], v1 offset:31744
    v_smfmac_f32_16x16x64_bf16 v[44:47], v[20:23], a[88:95], v7
    s_waitcnt lgkmcnt(9)
    v_smfmac_f32_16x16x64_bf16 v[24:27], v[12:15], a[96:103], v7
    s_waitcnt lgkmcnt(7)
    v_smfmac_f32_16x16x64_bf16 v[28:31], v[12:15], v[72:79], v7
    ds_read_b128 v[72:75], v1 offset:0
    v_smfmac_f32_16x16x64_bf16 v[32:35], v[12:15], a[104:111], v7
    ds_read_b128 v[76:79], v1 offset:1024
    s_waitcnt lgkmcnt(7)
    v_smfmac_f32_16x16x64_bf16 v[36:39], v[12:15], v[80:87], v7
    ds_read_b128 v[80:83], v1 offset:2048
    s_waitcnt vmcnt(3)
    ds_read2st64_b32 v[8:9], v4 offset0:20 offset1:24
    ds_read_b32 v10, v4 offset:7168
    s_waitcnt lgkmcnt(9)
    v_smfmac_f32_16x16x64_bf16 v[24:27], v[16:19], a[128:135], v7
    ds_read_b128 v[84:87], v1 offset:3072
    s_waitcnt lgkmcnt(8)
    v_smfmac_f32_16x16x64_bf16 v[28:31], v[16:19], v[56:63], v7
    ds_read_b128 v[56:59], v1 offset:32768
    v_smfmac_f32_16x16x64_bf16 v[32:35], v[16:19], a[136:143], v7
    ds_read_b128 v[60:63], v1 offset:33792
    s_waitcnt lgkmcnt(3)
    v_max3_u32 v8, v8, v9, v10
    v_smfmac_f32_16x16x64_bf16 v[36:39], v[16:19], v[64:71], v7
    v_cmp_eq_u32 vcc, -1, v8
    s_cbranch_vccnz L_recurt_152
L_recurb_153:
    s_barrier
    ds_read_b128 v[20:23], v2 offset:5120
    v_smfmac_f32_16x16x64_bf16 v[40:43], v[12:15], a[112:119], v7
    v_smfmac_f32_16x16x64_bf16 v[44:47], v[12:15], a[120:127], v7
    ds_read_b128 v[12:15], v2 offset:6144
    v_smfmac_f32_16x16x64_bf16 v[40:43], v[16:19], a[144:151], v7
    v_smfmac_f32_16x16x64_bf16 v[44:47], v[16:19], a[152:159], v7
    ds_read_b128 v[16:19], v2 offset:7168
    s_waitcnt lgkmcnt(2)
    v_smfmac_f32_16x16x64_bf16 v[24:27], v[20:23], a[160:167], v7
    v_smfmac_f32_16x16x64_bf16 v[28:31], v[20:23], v[72:79], v7
    v_smfmac_f32_16x16x64_bf16 v[32:35], v[20:23], a[168:175], v7
    v_smfmac_f32_16x16x64_bf16 v[36:39], v[20:23], v[80:87], v7
    ds_read_b128 v[20:23], v2 offset:8192
    s_waitcnt lgkmcnt(2)
    v_smfmac_f32_16x16x64_bf16 v[24:27], v[12:15], a[192:199], v7
    v_smfmac_f32_16x16x64_bf16 v[28:31], v[12:15], v[56:63], v7
    ds_read_b128 v[72:75], v0 offset:10240
    v_smfmac_f32_16x16x64_bf16 v[32:35], v[12:15], a[200:207], v7
    v_lshlrev_b32 v4, 3, v0
    v_smfmac_f32_16x16x64_bf16 v[36:39], v[12:15], a[208:215], v7
    buffer_load_dword v4, v4, s[4:7], s67 offen
    ds_read_b128 v[76:79], v0 offset:11264
    ds_read_b128 v[12:15], v2 offset:9216
    s_waitcnt lgkmcnt(4)
    v_smfmac_f32_16x16x64_bf16 v[24:27], v[16:19], a[232:239], v7
    v_lshrrev_b32 v71, 9, v0
    v_smfmac_f32_16x16x64_bf16 v[28:31], v[16:19], a[248:255], v7
    ds_read_b128 v[80:83], v0 offset:12288
    v_smfmac_f32_16x16x64_bf16 v[32:35], v[16:19], a[240:247], v7
    v_lshlrev_b32 v71, 3, v71
    v_smfmac_f32_16x16x64_bf16 v[36:39], v[16:19], v[88:95], v7
    ds_read_b128 v[84:87], v0 offset:13312
    s_waitcnt lgkmcnt(5)
    v_smfmac_f32_16x16x64_bf16 v[24:27], v[20:23], v[112:119], v7
    v_lshrrev_b32 v70, 1, v0
    v_smfmac_f32_16x16x64_bf16 v[28:31], v[20:23], v[128:135], v7
    v_xor_b32 v70, v71, v70
    v_smfmac_f32_16x16x64_bf16 v[32:35], v[20:23], v[120:127], v7
    v_xor_b32 v71, 16, v70
    v_smfmac_f32_16x16x64_bf16 v[36:39], v[20:23], v[136:143], v7
    s_waitcnt lgkmcnt(2)
    v_smfmac_f32_16x16x64_bf16 v[24:27], v[12:15], v[160:167], v7
    v_smfmac_f32_16x16x64_bf16 v[28:31], v[12:15], v[176:183], v7
    v_smfmac_f32_16x16x64_bf16 v[32:35], v[12:15], v[168:175], v7
    v_add_f32 v24, v24, v26
    v_smfmac_f32_16x16x64_bf16 v[36:39], v[12:15], v[184:191], v7
    v_add_f32 v25, v25, v27
    v_add_f32 v28, v28, v30
    v_cvt_pk_bf16_f32 v8, v24, v25
    v_add_f32 v29, v29, v31
    v_add_f32 v32, v32, v34
    v_cvt_pk_bf16_f32 v9, v28, v29
    v_add_f32 v33, v33, v35
    ds_write_b64 v3, v[8:9]
    v_pk_add_f32 v[36:37], v[36:37], v[38:39]
    v_cvt_pk_bf16_f32 v10, v32, v33
    v_cvt_pk_bf16_f32 v11, v36, v37
    ds_write_b64 v3, v[10:11] offset:128
    v_smfmac_f32_16x16x64_bf16 v[40:43], v[12:15], v[192:199], v7
    v_smfmac_f32_16x16x64_bf16 v[44:47], v[12:15], v[200:207], v7
    ds_read_b128 v[12:15], v2 offset:6144
    v_smfmac_f32_16x16x64_bf16 v[40:43], v[20:23], v[144:151], v7
    v_smfmac_f32_16x16x64_bf16 v[44:47], v[20:23], v[152:159], v7
    ds_read_b128 v[20:23], v2 offset:5120
    v_smfmac_f32_16x16x64_bf16 v[40:43], v[16:19], v[96:103], v7
    s_waitcnt lgkmcnt(2)
    s_barrier
    ds_read_b64_tr_b16 v[56:57], v70 offset:18432
    ds_read_b64_tr_b16 v[58:59], v71 offset:18944
    v_smfmac_f32_16x16x64_bf16 v[44:47], v[16:19], v[104:111], v7
    ds_read_b64_tr_b16 v[60:61], v70 offset:19456
    ds_read_b64_tr_b16 v[62:63], v71 offset:19968
    s_waitcnt lgkmcnt(5)
    v_smfmac_f32_16x16x64_bf16 v[40:43], v[12:15], a[216:223], v7
    ds_read_b64_tr_b16 v[64:65], v70 offset:20480
    ds_read_b64_tr_b16 v[66:67], v71 offset:20992
    v_smfmac_f32_16x16x64_bf16 v[44:47], v[12:15], a[224:231], v7
    ds_read_b64_tr_b16 v[68:69], v70 offset:21504
    ds_read_b64_tr_b16 v[70:71], v71 offset:22016
    s_waitcnt lgkmcnt(8)
    v_smfmac_f32_16x16x64_bf16 v[40:43], v[20:23], a[176:183], v7
    v_smfmac_f32_16x16x64_bf16 v[44:47], v[20:23], a[184:191], v7
    s_waitcnt lgkmcnt(6)
    v_mfma_f32_16x16x32_bf16 v[28:31], v[72:75], v[56:59], 0
    ds_read_b128 v[72:75], v0 offset:14336
    s_waitcnt lgkmcnt(5)
    v_mfma_f32_16x16x32_bf16 v[28:31], v[76:79], v[60:63], v[28:31]
    ds_read_b128 v[76:79], v0 offset:15360
    s_waitcnt lgkmcnt(4)
    v_mfma_f32_16x16x32_bf16 v[28:31], v[80:83], v[64:67], v[28:31]
    ds_read_b128 v[80:83], v0 offset:16384
    v_add_f32 v40, v40, v42
    s_waitcnt lgkmcnt(3)
    v_mfma_f32_16x16x32_bf16 v[28:31], v[84:87], v[68:71], v[28:31]
    ds_read_b128 v[84:87], v0 offset:17408
    v_add_f32 v44, v44, v46
    v_mfma_f32_16x16x32_bf16 v[24:27], v[56:59], v[56:59], 0
    v_add_f32 v41, v41, v43
    v_add_f32 v45, v45, v47
    v_mfma_f32_16x16x32_bf16 v[24:27], v[60:63], v[60:63], v[24:27]
    v_cvt_pk_bf16_f32 v46, v40, v41
    v_cvt_pk_bf16_f32 v47, v44, v45
    v_mfma_f32_16x16x32_bf16 v[24:27], v[64:67], v[64:67], v[24:27]
    v_lshrrev_b32 v11, 1, v0
    s_cmp_eq_u32 s34, 63
    buffer_store_dwordx2 v[46:47], v11, s[4:7], s40 offen sc1
    s_cbranch_scc1 L_recufin_151
    v_max3_f32 v8, v28, v29, v30
    v_mfma_f32_16x16x32_bf16 v[24:27], v[68:71], v[68:71], v[24:27]
    v_mov_b64 v[12:13], s[70:71]
    v_mov_b64 v[14:15], s[70:71]
    s_waitcnt lgkmcnt(3)
    v_mfma_f32_16x16x32_bf16 v[32:35], v[72:75], v[56:59], 0
    v_add_u32 v10, s49, v0
    v_mov_b64 v[36:37], 0
    s_waitcnt lgkmcnt(2)
    v_mfma_f32_16x16x32_bf16 v[32:35], v[76:79], v[60:63], v[32:35]
    v_max3_f32 v8, v8, v31, v26
    v_mov_b64 v[38:39], 0
    s_waitcnt lgkmcnt(1)
    v_mfma_f32_16x16x32_bf16 v[32:35], v[80:83], v[64:67], v[32:35]
    v_max_f32 v8, v8, v27
    ds_read_b128 v[72:75], v1 offset:8192
    ds_read_b128 v[76:79], v1 offset:9216
    s_waitcnt lgkmcnt(2)
    v_mfma_f32_16x16x32_bf16 v[32:35], v[84:87], v[68:71], v[32:35]
    ds_read_b128 v[80:83], v1 offset:4096
    ds_read_b128 v[84:87], v1 offset:5120
    v_mov_b32 v69, 0
    v_mov_b32 v70, 0
    v_mov_b64 v[40:41], 0
    v_mov_b64 v[42:43], 0
    s_nop 1
    v_max3_f32 v8, v8, v32, v33
    v_max3_f32 v9, v8, v34, v35
    v_max3_f32 v8, v8, v34, v35
    s_nop 1
    v_permlane32_swap_b32 v9, v8
    v_max_f32 v11, v8, v9
    v_max_f32 v8, v8, v9
    s_nop 1
    v_permlane16_swap_b32 v11, v8
    v_max_f32 v8, v8, v11
    v_mul_f32 v8, 0xbe0293ee, v8
    v_pk_fma_f32 v[26:27], v[26:27], s[68:69], v[8:9] op_sel_hi:[1,1,0]
    v_pk_fma_f32 v[28:29], v[28:29], s[68:69], v[8:9] op_sel_hi:[1,1,0]
    v_exp_f32 v26, v26
    v_exp_f32 v27, v27
    v_pk_fma_f32 v[30:31], v[30:31], s[68:69], v[8:9] op_sel_hi:[1,1,0]
    v_exp_f32 v28, v28
    v_pk_fma_f32 v[32:33], v[32:33], s[68:69], v[8:9] op_sel_hi:[1,1,0]
    v_exp_f32 v29, v29
    v_cvt_pk_bf16_f32 v68, v26, v27
    v_pk_fma_f32 v[34:35], v[34:35], s[68:69], v[8:9] op_sel_hi:[1,1,0]
    v_cvt_pk_bf16_f32 v71, v26, v27
    v_exp_f32 v30, v30
    v_mfma_f32_16x16x16_bf16 v[16:19], v[12:13], v[68:69], 0
    v_exp_f32 v31, v31
    v_cvt_pk_bf16_f32 v64, v28, v29
    v_mfma_f32_16x16x16_bf16 v[56:59], v[46:47], v[68:69], 0
    v_exp_f32 v32, v32
    v_exp_f32 v33, v33
    v_mfma_f32_16x16x16_bf16 v[60:63], v[46:47], v[70:71], 0
    v_cvt_pk_bf16_f32 v65, v30, v31
    v_exp_f32 v34, v34
    v_exp_f32 v35, v35
    v_cvt_pk_bf16_f32 v66, v32, v33
    s_waitcnt vmcnt(2)
    v_cvt_pk_bf16_f32 v67, v34, v35
    v_mov_b64 v[24:25], 0
    s_nop 0
    v_mfma_f32_16x16x32_bf16 v[16:19], v[12:15], v[64:67], v[16:19]
    v_mov_b64 v[26:27], 0
    v_mov_b64 v[28:29], 0
    v_mfma_f32_16x16x32_bf16 v[56:59], v[48:51], v[64:67], v[56:59]
    v_mov_b64 v[30:31], 0
    v_mov_b64 v[32:33], 0
    v_mfma_f32_16x16x32_bf16 v[60:63], v[52:55], v[64:67], v[60:63]
    v_mov_b64 v[34:35], 0
    v_rcp_f32 v8, v16
    s_nop 1
    v_pk_mul_f32 v[56:57], v[56:57], v[8:9] op_sel_hi:[1,0]
    v_pk_mul_f32 v[58:59], v[58:59], v[8:9] op_sel_hi:[1,0]
    v_cvt_pk_bf16_f32 v20, v56, v57
    v_cvt_pk_bf16_f32 v21, v58, v59
    v_pk_mul_f32 v[60:61], v[60:61], v[8:9] op_sel_hi:[1,0]
    v_pk_mul_f32 v[62:63], v[62:63], v[8:9] op_sel_hi:[1,0]
    v_cvt_pk_bf16_f32 v22, v60, v61
    v_cvt_pk_bf16_f32 v23, v62, v63
    s_mov_b64 exec, s[64:65]
    ds_write_b128 v10, v[20:23]
    s_mov_b64 exec, -1
    ds_read_b128 v[56:59], v1 offset:6144
    ds_read_b128 v[60:63], v1 offset:7168
    ds_read_b128 v[64:67], v1 offset:10240
    ds_read_b128 v[68:71], v1 offset:11264
    s_waitcnt lgkmcnt(4)
    s_barrier
    ds_read_b128 v[12:15], v0 offset:22528
    ds_read_b128 v[16:19], v0 offset:23552
    s_mov_b32 m0, s51
    s_nop 0
    buffer_load_dwordx4 v0, s[4:7], s39 offen lds
    buffer_load_dwordx4 v0, s[4:7], s39 offen offset:1024 lds
    s_waitcnt lgkmcnt(1)
    v_smfmac_f32_16x16x64_bf16 v[40:43], v[12:15], v[72:79], v7
    s_waitcnt lgkmcnt(0)
    v_smfmac_f32_16x16x64_bf16 v[40:43], v[16:19], v[64:71], v7
    v_smfmac_f32_16x16x64_bf16 v[24:27], v[12:15], v[208:215], v7
    v_smfmac_f32_16x16x64_bf16 v[24:27], v[16:19], v[240:247], v7
    v_add_f32 v40, v40, v42
    v_smfmac_f32_16x16x64_bf16 v[28:31], v[12:15], v[216:223], v7
    v_add_f32 v41, v41, v43
    v_smfmac_f32_16x16x64_bf16 v[28:31], v[16:19], v[248:255], v7
    v_cvt_pk_bf16_f32 v20, v40, v41
    v_smfmac_f32_16x16x64_bf16 v[32:35], v[12:15], v[224:231], v7
    v_bfi_b32 v20, 1, s19, v20
    v_smfmac_f32_16x16x64_bf16 v[32:35], v[16:19], v[80:87], v7
    buffer_store_dword v20, v6, s[4:7], s35 offen sc1
    v_add_f32 v24, v24, v26
    v_smfmac_f32_16x16x64_bf16 v[36:39], v[12:15], v[232:239], v7
    v_add_f32 v25, v25, v27
    v_smfmac_f32_16x16x64_bf16 v[36:39], v[16:19], v[56:63], v7
    v_add_f32 v28, v28, v30
    v_add_f32 v29, v29, v31
    v_cvt_pk_bf16_f32 v8, v24, v25
    v_add_f32 v32, v32, v34
    v_cvt_pk_bf16_f32 v9, v28, v29
    v_add_f32 v33, v33, v35
    v_bfi_b32 v8, 1, s19, v8
    v_cvt_pk_bf16_f32 v10, v32, v33
    v_pk_add_f32 v[36:37], v[36:37], v[38:39]
    v_cvt_pk_bf16_f32 v11, v36, v37
    buffer_store_dwordx4 v[8:11], v5, s[4:7], s35 offen sc1
    s_add_u32 s39, s39, 262144
    s_add_u32 s47, s47, 262144
    s_xor_b32 s35, s35, 262144
    s_add_u32 s40, s40, 65536
    s_cmp_eq_u32 s42, 0
    s_cbranch_scc1 L_recunred_154
    v_bfe_u32 v8, v0, 4, 1
    v_lshlrev_b32 v21, 4, v8
    v_mov_b32 v10, 0x3f80
    v_lshlrev_b32 v10, v21, v10
    v_bfe_u32 v11, v0, 5, 3
    v_cmp_eq_u32 s[52:53], 0, v11
    v_cmp_eq_u32 s[54:55], 1, v11
    v_cmp_eq_u32 s[56:57], 2, v11
    v_cmp_eq_u32 s[58:59], 3, v11
    v_cndmask_b32 v12, 0, v10, s[52:53]
    v_cndmask_b32 v13, 0, v10, s[54:55]
    v_cndmask_b32 v14, 0, v10, s[56:57]
    v_cndmask_b32 v15, 0, v10, s[58:59]
    v_and_b32 v11, 3, v11
    v_lshl_add_u32 v21, v11, 2, v21
    v_bfe_u32 v11, v0, 8, 1
    v_lshl_add_u32 v21, v11, 6, v21
    v_lshrrev_b32 v11, 9, v0
    v_lshl_add_u32 v21, v11, 5, v21
    v_mov_b64 v[24:25], 0
    v_mov_b64 v[26:27], 0
    v_mov_b64 v[28:29], 0
    v_mov_b64 v[30:31], 0
    v_mov_b64 v[32:33], 0
    v_mov_b64 v[34:35], 0
    v_mov_b64 v[36:37], 0
    v_mov_b64 v[38:39], 0
    v_mov_b64 v[40:41], 0
    v_mov_b64 v[42:43], 0
    v_mov_b64 v[44:45], 0
    v_mov_b64 v[46:47], 0
    s_mov_b32 s50, 3200000
    s_nop 15
    s_nop 15
    s_nop 11
    buffer_load_dwordx4 v[56:59], v0, s[4:7], s36 offen offset:0 sc1
    buffer_load_dwordx4 v[60:63], v0, s[4:7], s36 offen offset:1024 sc1
    buffer_load_dwordx4 v[64:67], v0, s[4:7], s36 offen offset:2048 sc1
    buffer_load_dwordx4 v[68:71], v0, s[4:7], s36 offen offset:3072 sc1
    s_nop 15
    s_nop 3
    buffer_load_dwordx4 v[56:59], v0, s[4:7], s36 offen offset:0 sc1
    buffer_load_dwordx4 v[60:63], v0, s[4:7], s36 offen offset:1024 sc1
    buffer_load_dwordx4 v[64:67], v0, s[4:7], s36 offen offset:2048 sc1
    buffer_load_dwordx4 v[68:71], v0, s[4:7], s36 offen offset:3072 sc1
L_recursl_157:
    s_waitcnt vmcnt(7)
    v_xor_b32 v8, s19, v56
    v_mfma_f32_16x16x32_bf16 v[16:19], v[56:59], v[12:15], 0
    buffer_load_dwordx4 v[56:59], v0, s[4:7], s36 offen offset:0 sc1
    s_waitcnt vmcnt(7)
    v_bitop3_b32 v8, v8, v60, s19 bitop3:0xf6
    v_mfma_f32_16x16x32_bf16 v[16:19], v[60:63], v[12:15], v[16:19]
    buffer_load_dwordx4 v[60:63], v0, s[4:7], s36 offen offset:1024 sc1
    s_waitcnt vmcnt(7)
    v_bitop3_b32 v8, v8, v64, s19 bitop3:0xf6
    v_mfma_f32_16x16x32_bf16 v[16:19], v[64:67], v[12:15], v[16:19]
    buffer_load_dwordx4 v[64:67], v0, s[4:7], s36 offen offset:2048 sc1
    s_waitcnt vmcnt(7)
    v_bitop3_b32 v8, v8, v68, s19 bitop3:0xf6
    v_mfma_f32_16x16x32_bf16 v[16:19], v[68:71], v[12:15], v[16:19]
    buffer_load_dwordx4 v[68:71], v0, s[4:7], s36 offen offset:3072 sc1
    v_and_b32 v8, 1, v8
    v_cmp_ne_u32 vcc, 0, v8
    s_cbranch_vccz L_recursok_156
    s_waitcnt vmcnt(7)
    v_xor_b32 v8, s19, v56
    v_mfma_f32_16x16x32_bf16 v[16:19], v[56:59], v[12:15], 0
    buffer_load_dwordx4 v[56:59], v0, s[4:7], s36 offen offset:0 sc1
    s_waitcnt vmcnt(7)
    v_bitop3_b32 v8, v8, v60, s19 bitop3:0xf6
    v_mfma_f32_16x16x32_bf16 v[16:19], v[60:63], v[12:15], v[16:19]
    buffer_load_dwordx4 v[60:63], v0, s[4:7], s36 offen offset:1024 sc1
    s_waitcnt vmcnt(7)
    v_bitop3_b32 v8, v8, v64, s19 bitop3:0xf6
    v_mfma_f32_16x16x32_bf16 v[16:19], v[64:67], v[12:15], v[16:19]
    buffer_load_dwordx4 v[64:67], v0, s[4:7], s36 offen offset:2048 sc1
    s_waitcnt vmcnt(7)
    v_bitop3_b32 v8, v8, v68, s19 bitop3:0xf6
    v_mfma_f32_16x16x32_bf16 v[16:19], v[68:71], v[12:15], v[16:19]
    buffer_load_dwordx4 v[68:71], v0, s[4:7], s36 offen offset:3072 sc1
    v_and_b32 v8, 1, v8
    v_cmp_ne_u32 vcc, 0, v8
    s_cbranch_vccz L_recursok_156
    s_sub_u32 s50, s50, 1
    s_cbranch_scc0 L_recursl_157
    s_branch L_exit_recurrent_scan__memory_aug_recurrent_mem_tr__moe_arch_mod__prompt_kernel
L_recursok_156:
    s_nop 1
    v_permlane32_swap_b32 v16, v18
    v_permlane32_swap_b32 v17, v19
    v_pk_add_f32 v[16:17], v[16:17], v[18:19]
    v_cvt_pk_bf16_f32 v16, v16, v17
    s_mov_b64 exec, s[74:75]
    buffer_store_dword v16, v21, s[4:7], s48 offen sc1
    buffer_store_dword v16, v21, s[4:7], s37 offen sc1
    s_mov_b64 exec, -1
    s_barrier
    v_mov_b64 v[8:9], -1
    v_mov_b64 v[10:11], -1
    s_mov_b64 exec, 0xff
    buffer_store_dwordx4 v[8:11], v0, s[4:7], s45 offen sc1
    s_mov_b64 exec, -1
    s_xor_b32 s36, s36, 262144
    s_mov_b32 s45, s37
    s_add_u32 s37, s37, 8192
    s_andn2_b32 s37, s37, 0x8000
    s_add_u32 s48, s48, 10240
    s_waitcnt vmcnt(3)
    s_branch L_recun2_155
L_recunred_154:
    v_mov_b64 v[24:25], 0
    v_mov_b64 v[26:27], 0
    v_mov_b64 v[28:29], 0
    v_mov_b64 v[30:31], 0
    v_mov_b64 v[32:33], 0
    v_mov_b64 v[34:35], 0
    v_mov_b64 v[36:37], 0
    v_mov_b64 v[38:39], 0
    v_mov_b64 v[40:41], 0
    v_mov_b64 v[42:43], 0
    v_mov_b64 v[44:45], 0
    v_mov_b64 v[46:47], 0
    s_barrier
    s_waitcnt vmcnt(0)
L_recun2_155:
    v_bfe_u32 v4, v0, 7, 2
    v_lshl_add_u32 v4, v4, 2, v0
    s_add_u32 s34, s34, 1
    ds_read_b128 v[56:59], v1 offset:12288
    ds_read_b128 v[60:63], v1 offset:13312
    ds_read_b128 v[64:67], v1 offset:14336
    ds_read_b128 v[68:71], v1 offset:15360
    ds_read_b128 v[72:75], v1 offset:16384
    ds_read_b128 v[76:79], v1 offset:17408
    ds_read_b128 v[80:83], v1 offset:18432
    ds_read_b128 v[84:87], v1 offset:19456
    s_add_u32 s26, s34, 1
    s_min_u32 s26, s26, 63
    s_cmp_gt_u32 s44, s26
    s_cbranch_scc1 L_recuf_158
    v_bfe_u32 v8, v0, 6, 1
    v_lshlrev_b32 v8, 13, v8
    v_bfe_u32 v9, v0, 4, 2
    v_lshl_add_u32 v8, v9, 2, v8
    v_bfe_u32 v10, v0, 7, 1
    v_lshl_add_u32 v8, v10, 7, v8
    s_mov_b32 s50, 0
L_recufs_159:
    buffer_load_dword v9, v8, s[4:7], s46 offen sc1
    s_waitcnt vmcnt(0)
    v_lshl_add_u32 v9, v9, 1, v10
    v_cmp_ge_u32 vcc, s26, v9
    s_cbranch_vccz L_recufsok_160
    s_add_u32 s50, s50, 1
    s_cmp_lt_u32 s50, 400000
    s_cbranch_scc0 L_exit_recurrent_scan__memory_aug_recurrent_mem_tr__moe_arch_mod__prompt_kernel
    s_sleep 2
    s_branch L_recufs_159
L_recufsok_160:
    v_min_u32_dpp v9, v9, v9 quad_perm:[1,0,3,2] row_mask:0xf bank_mask:0xf
    s_nop 1
    v_min_u32_dpp v9, v9, v9 quad_perm:[2,3,0,1] row_mask:0xf bank_mask:0xf
    s_nop 1
    v_min_u32_dpp v9, v9, v9 row_half_mirror row_mask:0xf bank_mask:0xf
    s_nop 1
    v_min_u32_dpp v9, v9, v9 row_mirror row_mask:0xf bank_mask:0xf
    s_nop 0
    v_readfirstlane_b32 s44, v9
L_recuf_158:
    s_mov_b32 m0, s66
    s_mov_b32 s30, s38
    s_mov_b64 s[8:9], -1
    s_add_u32 s67, s67, 262144
    s_add_u32 s38, s38, 10240
    s_waitcnt lgkmcnt(0)
    s_bfe_u32 s19, s34, 0x10001
    s_branch L_recucl_150
L_recurt_152:
    s_cmp_eq_u32 s34, 0
    s_cbranch_scc1 L_recurb_153
    s_mov_b32 s50, 0
    s_mov_b32 m0, s66
    ds_read2st64_b32 v[8:9], v4 offset0:20 offset1:24
    ds_read_b32 v10, v4 offset:7168
    s_waitcnt lgkmcnt(0)
    v_cmp_eq_u32 s[52:53], -1, v8
    v_cmp_eq_u32 s[54:55], -1, v9
    v_cmp_eq_u32 s[56:57], -1, v10
    s_or_b64 s[58:59], s[52:53], s[54:55]
    s_or_b64 s[58:59], s[58:59], s[56:57]
    s_cbranch_scc0 L_recurb_153
    s_mov_b64 exec, s[52:53]
    buffer_load_dwordx4 v0, s[4:7], s30 offen offset:0 sc1 lds
    s_mov_b64 exec, s[54:55]
    buffer_load_dwordx4 v0, s[4:7], s30 offen offset:1024 sc1 lds
    s_mov_b64 exec, s[56:57]
    buffer_load_dwordx4 v0, s[4:7], s30 offen offset:2048 sc1 lds
    s_mov_b64 exec, -1
    s_nop 15
    s_nop 15
L_recur2_162:
    s_mov_b64 exec, s[52:53]
    buffer_load_dwordx4 v0, s[4:7], s30 offen offset:0 sc1 lds
    s_mov_b64 exec, s[54:55]
    buffer_load_dwordx4 v0, s[4:7], s30 offen offset:1024 sc1 lds
    s_mov_b64 exec, s[56:57]
    buffer_load_dwordx4 v0, s[4:7], s30 offen offset:2048 sc1 lds
    s_mov_b64 exec, -1
    s_waitcnt vmcnt(3)
    ds_read2st64_b32 v[8:9], v4 offset0:20 offset1:24
    ds_read_b32 v10, v4 offset:7168
    s_waitcnt lgkmcnt(0)
    v_cmp_eq_u32 s[52:53], -1, v8
    v_cmp_eq_u32 s[54:55], -1, v9
    v_cmp_eq_u32 s[56:57], -1, v10
    s_or_b64 s[58:59], s[52:53], s[54:55]
    s_or_b64 s[58:59], s[58:59], s[56:57]
    s_cbranch_scc0 L_recurb_153
    s_add_u32 s50, s50, 1
    s_cmp_lt_u32 s50, 3200000
    s_cbranch_scc0 L_exit_recurrent_scan__memory_aug_recurrent_mem_tr__moe_arch_mod__prompt_kernel
    s_branch L_recur2_162
L_recufin_151:
    s_waitcnt lgkmcnt(0)
    s_nop 7
    s_waitcnt vmcnt(0)
    v_mov_b32 v9, 64
    buffer_store_dword v9, off, s[4:7], s41 sc1
    s_waitcnt vmcnt(0)
    s_branch L_exit_recurrent_scan__memory_aug_recurrent_mem_tr__moe_arch_mod__prompt_kernel
L_recub_111:
L_recucl_163:
    s_barrier
    ds_read_b128 v[12:15], v2 offset:0
    ds_read_b128 v[16:19], v2 offset:1024
    ds_read_b128 v[20:23], v2 offset:2048
    s_mov_b64 exec, s[8:9]
    buffer_load_dwordx4 v0, s[4:7], s30 offen offset:0 sc1 lds
    buffer_load_dwordx4 v0, s[4:7], s30 offen offset:1024 sc1 lds
    s_mov_b64 exec, -1
    s_waitcnt lgkmcnt(2)
    v_smfmac_f32_16x16x64_bf16 v[24:27], v[12:15], a[0:7], v7
    v_mov_b32 v8, s34
    v_smfmac_f32_16x16x64_bf16 v[28:31], v[12:15], v[56:63], v7
    ds_read_b128 v[56:59], v1 offset:20480
    v_smfmac_f32_16x16x64_bf16 v[32:35], v[12:15], a[8:15], v7
    ds_read_b128 v[60:63], v1 offset:21504
    v_smfmac_f32_16x16x64_bf16 v[36:39], v[12:15], v[64:71], v7
    ds_read_b128 v[64:67], v1 offset:22528
    v_smfmac_f32_16x16x64_bf16 v[40:43], v[12:15], a[16:23], v7
    ds_read_b128 v[68:71], v1 offset:23552
    v_smfmac_f32_16x16x64_bf16 v[44:47], v[12:15], a[24:31], v7
    buffer_load_dwordx4 v[48:51], v0, s[4:7], s47 offen offset:0
    ds_read_b128 v[12:15], v2 offset:3072
    s_waitcnt lgkmcnt(6)
    v_smfmac_f32_16x16x64_bf16 v[24:27], v[16:19], a[32:39], v7
    buffer_load_dwordx4 v[52:55], v0, s[4:7], s47 offen offset:1024
    v_smfmac_f32_16x16x64_bf16 v[28:31], v[16:19], v[72:79], v7
    ds_read_b128 v[72:75], v1 offset:24576
    v_smfmac_f32_16x16x64_bf16 v[32:35], v[16:19], a[40:47], v7
    ds_read_b128 v[76:79], v1 offset:25600
    buffer_store_dword v8, off, s[4:7], s41 sc1
    v_smfmac_f32_16x16x64_bf16 v[36:39], v[16:19], v[80:87], v7
    ds_read_b128 v[80:83], v1 offset:26624
    v_smfmac_f32_16x16x64_bf16 v[40:43], v[16:19], a[48:55], v7
    ds_read_b128 v[84:87], v1 offset:27648
    v_smfmac_f32_16x16x64_bf16 v[44:47], v[16:19], a[56:63], v7
    ds_read_b128 v[16:19], v2 offset:4096
    s_waitcnt lgkmcnt(10)
    v_smfmac_f32_16x16x64_bf16 v[24:27], v[20:23], a[64:71], v7
    s_waitcnt lgkmcnt(8)
    v_smfmac_f32_16x16x64_bf16 v[28:31], v[20:23], v[56:63], v7
    ds_read_b128 v[56:59], v1 offset:28672
    v_smfmac_f32_16x16x64_bf16 v[32:35], v[20:23], a[72:79], v7
    ds_read_b128 v[60:63], v1 offset:29696
    s_waitcnt lgkmcnt(8)
    v_smfmac_f32_16x16x64_bf16 v[36:39], v[20:23], v[64:71], v7
    ds_read_b128 v[64:67], v1 offset:30720
    v_smfmac_f32_16x16x64_bf16 v[40:43], v[20:23], a[80:87], v7
    ds_read_b128 v[68:71], v1 offset:31744
    v_smfmac_f32_16x16x64_bf16 v[44:47], v[20:23], a[88:95], v7
    s_waitcnt lgkmcnt(9)
    v_smfmac_f32_16x16x64_bf16 v[24:27], v[12:15], a[96:103], v7
    s_waitcnt lgkmcnt(7)
    v_smfmac_f32_16x16x64_bf16 v[28:31], v[12:15], v[72:79], v7
    ds_read_b128 v[72:75], v1 offset:0
    v_smfmac_f32_16x16x64_bf16 v[32:35], v[12:15], a[104:111], v7
    ds_read_b128 v[76:79], v1 offset:1024
    s_waitcnt lgkmcnt(7)
    v_smfmac_f32_16x16x64_bf16 v[36:39], v[12:15], v[80:87], v7
    ds_read_b128 v[80:83], v1 offset:2048
    s_waitcnt vmcnt(3)
    ds_read2st64_b32 v[8:9], v4 offset0:32 offset1:36
    s_waitcnt lgkmcnt(8)
    v_smfmac_f32_16x16x64_bf16 v[24:27], v[16:19], a[128:135], v7
    ds_read_b128 v[84:87], v1 offset:3072
    s_waitcnt lgkmcnt(7)
    v_smfmac_f32_16x16x64_bf16 v[28:31], v[16:19], v[56:63], v7
    ds_read_b128 v[56:59], v1 offset:32768
    v_smfmac_f32_16x16x64_bf16 v[32:35], v[16:19], a[136:143], v7
    ds_read_b128 v[60:63], v1 offset:33792
    s_waitcnt lgkmcnt(3)
    v_max_u32 v8, v8, v9
    v_smfmac_f32_16x16x64_bf16 v[36:39], v[16:19], v[64:71], v7
    v_cmp_eq_u32 vcc, -1, v8
    s_cbranch_vccnz L_recurt_165
L_recurb_166:
    s_barrier
    ds_read_b128 v[20:23], v2 offset:5120
    v_smfmac_f32_16x16x64_bf16 v[40:43], v[12:15], a[112:119], v7
    v_smfmac_f32_16x16x64_bf16 v[44:47], v[12:15], a[120:127], v7
    ds_read_b128 v[12:15], v2 offset:6144
    v_smfmac_f32_16x16x64_bf16 v[40:43], v[16:19], a[144:151], v7
    v_smfmac_f32_16x16x64_bf16 v[44:47], v[16:19], a[152:159], v7
    ds_read_b128 v[16:19], v2 offset:7168
    s_waitcnt lgkmcnt(2)
    v_smfmac_f32_16x16x64_bf16 v[24:27], v[20:23], a[160:167], v7
    v_smfmac_f32_16x16x64_bf16 v[28:31], v[20:23], v[72:79], v7
    v_smfmac_f32_16x16x64_bf16 v[32:35], v[20:23], a[168:175], v7
    v_smfmac_f32_16x16x64_bf16 v[36:39], v[20:23], v[80:87], v7
    ds_read_b128 v[20:23], v2 offset:8192
    s_waitcnt lgkmcnt(2)
    v_smfmac_f32_16x16x64_bf16 v[24:27], v[12:15], a[192:199], v7
    v_smfmac_f32_16x16x64_bf16 v[28:31], v[12:15], v[56:63], v7
    ds_read_b128 v[72:75], v0 offset:10240
    v_smfmac_f32_16x16x64_bf16 v[32:35], v[12:15], a[200:207], v7
    v_lshlrev_b32 v4, 3, v0
    v_smfmac_f32_16x16x64_bf16 v[36:39], v[12:15], a[208:215], v7
    buffer_load_dword v4, v4, s[4:7], s67 offen
    ds_read_b128 v[76:79], v0 offset:11264
    ds_read_b128 v[12:15], v2 offset:9216
    s_waitcnt lgkmcnt(4)
    v_smfmac_f32_16x16x64_bf16 v[24:27], v[16:19], a[232:239], v7
    v_lshrrev_b32 v71, 9, v0
    v_smfmac_f32_16x16x64_bf16 v[28:31], v[16:19], a[248:255], v7
    ds_read_b128 v[80:83], v0 offset:12288
    v_smfmac_f32_16x16x64_bf16 v[32:35], v[16:19], a[240:247], v7
    v_lshlrev_b32 v71, 3, v71
    v_smfmac_f32_16x16x64_bf16 v[36:39], v[16:19], v[88:95], v7
    ds_read_b128 v[84:87], v0 offset:13312
    s_waitcnt lgkmcnt(5)
    v_smfmac_f32_16x16x64_bf16 v[24:27], v[20:23], v[112:119], v7
    v_lshrrev_b32 v70, 1, v0
    v_smfmac_f32_16x16x64_bf16 v[28:31], v[20:23], v[128:135], v7
    v_xor_b32 v70, v71, v70
    v_smfmac_f32_16x16x64_bf16 v[32:35], v[20:23], v[120:127], v7
    v_xor_b32 v71, 16, v70
    v_smfmac_f32_16x16x64_bf16 v[36:39], v[20:23], v[136:143], v7
    s_waitcnt lgkmcnt(2)
    v_smfmac_f32_16x16x64_bf16 v[24:27], v[12:15], v[160:167], v7
    v_smfmac_f32_16x16x64_bf16 v[28:31], v[12:15], v[176:183], v7
    v_smfmac_f32_16x16x64_bf16 v[32:35], v[12:15], v[168:175], v7
    v_add_f32 v24, v24, v26
    v_smfmac_f32_16x16x64_bf16 v[36:39], v[12:15], v[184:191], v7
    v_add_f32 v25, v25, v27
    v_add_f32 v28, v28, v30
    v_cvt_pk_bf16_f32 v8, v24, v25
    v_add_f32 v29, v29, v31
    v_add_f32 v32, v32, v34
    v_cvt_pk_bf16_f32 v9, v28, v29
    v_add_f32 v33, v33, v35
    ds_write_b64 v3, v[8:9]
    v_pk_add_f32 v[36:37], v[36:37], v[38:39]
    v_cvt_pk_bf16_f32 v10, v32, v33
    v_cvt_pk_bf16_f32 v11, v36, v37
    ds_write_b64 v3, v[10:11] offset:128
    v_smfmac_f32_16x16x64_bf16 v[40:43], v[12:15], v[192:199], v7
    v_smfmac_f32_16x16x64_bf16 v[44:47], v[12:15], v[200:207], v7
    ds_read_b128 v[12:15], v2 offset:6144
    v_smfmac_f32_16x16x64_bf16 v[40:43], v[20:23], v[144:151], v7
    v_smfmac_f32_16x16x64_bf16 v[44:47], v[20:23], v[152:159], v7
    ds_read_b128 v[20:23], v2 offset:5120
    v_smfmac_f32_16x16x64_bf16 v[40:43], v[16:19], v[96:103], v7
    s_waitcnt lgkmcnt(2)
    s_barrier
    ds_read_b64_tr_b16 v[56:57], v70 offset:18432
    ds_read_b64_tr_b16 v[58:59], v71 offset:18944
    v_smfmac_f32_16x16x64_bf16 v[44:47], v[16:19], v[104:111], v7
    ds_read_b64_tr_b16 v[60:61], v70 offset:19456
    ds_read_b64_tr_b16 v[62:63], v71 offset:19968
    s_waitcnt lgkmcnt(5)
    v_smfmac_f32_16x16x64_bf16 v[40:43], v[12:15], a[216:223], v7
    ds_read_b64_tr_b16 v[64:65], v70 offset:20480
    ds_read_b64_tr_b16 v[66:67], v71 offset:20992
    v_smfmac_f32_16x16x64_bf16 v[44:47], v[12:15], a[224:231], v7
    ds_read_b64_tr_b16 v[68:69], v70 offset:21504
    ds_read_b64_tr_b16 v[70:71], v71 offset:22016
    s_waitcnt lgkmcnt(8)
    v_smfmac_f32_16x16x64_bf16 v[40:43], v[20:23], a[176:183], v7
    v_smfmac_f32_16x16x64_bf16 v[44:47], v[20:23], a[184:191], v7
    s_waitcnt lgkmcnt(6)
    v_mfma_f32_16x16x32_bf16 v[28:31], v[72:75], v[56:59], 0
    ds_read_b128 v[72:75], v0 offset:14336
    s_waitcnt lgkmcnt(5)
    v_mfma_f32_16x16x32_bf16 v[28:31], v[76:79], v[60:63], v[28:31]
    ds_read_b128 v[76:79], v0 offset:15360
    s_waitcnt lgkmcnt(4)
    v_mfma_f32_16x16x32_bf16 v[28:31], v[80:83], v[64:67], v[28:31]
    ds_read_b128 v[80:83], v0 offset:16384
    v_add_f32 v40, v40, v42
    s_waitcnt lgkmcnt(3)
    v_mfma_f32_16x16x32_bf16 v[28:31], v[84:87], v[68:71], v[28:31]
    ds_read_b128 v[84:87], v0 offset:17408
    v_add_f32 v44, v44, v46
    v_mfma_f32_16x16x32_bf16 v[24:27], v[56:59], v[56:59], 0
    v_add_f32 v41, v41, v43
    v_add_f32 v45, v45, v47
    v_mfma_f32_16x16x32_bf16 v[24:27], v[60:63], v[60:63], v[24:27]
    v_cvt_pk_bf16_f32 v46, v40, v41
    v_cvt_pk_bf16_f32 v47, v44, v45
    v_mfma_f32_16x16x32_bf16 v[24:27], v[64:67], v[64:67], v[24:27]
    v_lshrrev_b32 v11, 1, v0
    s_cmp_eq_u32 s34, 63
    buffer_store_dwordx2 v[46:47], v11, s[4:7], s40 offen sc1
    s_cbranch_scc1 L_recufin_164
    v_max3_f32 v8, v28, v29, v30
    v_mfma_f32_16x16x32_bf16 v[24:27], v[68:71], v[68:71], v[24:27]
    v_mov_b64 v[12:13], s[70:71]
    v_mov_b64 v[14:15], s[70:71]
    s_waitcnt lgkmcnt(3)
    v_mfma_f32_16x16x32_bf16 v[32:35], v[72:75], v[56:59], 0
    v_add_u32 v10, s49, v0
    v_mov_b64 v[36:37], 0
    s_waitcnt lgkmcnt(2)
    v_mfma_f32_16x16x32_bf16 v[32:35], v[76:79], v[60:63], v[32:35]
    v_max3_f32 v8, v8, v31, v26
    v_mov_b64 v[38:39], 0
    s_waitcnt lgkmcnt(1)
    v_mfma_f32_16x16x32_bf16 v[32:35], v[80:83], v[64:67], v[32:35]
    v_max_f32 v8, v8, v27
    ds_read_b128 v[72:75], v1 offset:8192
    ds_read_b128 v[76:79], v1 offset:9216
    s_waitcnt lgkmcnt(2)
    v_mfma_f32_16x16x32_bf16 v[32:35], v[84:87], v[68:71], v[32:35]
    ds_read_b128 v[80:83], v1 offset:4096
    ds_read_b128 v[84:87], v1 offset:5120
    v_mov_b32 v69, 0
    v_mov_b32 v70, 0
    v_mov_b64 v[40:41], 0
    v_mov_b64 v[42:43], 0
    s_nop 1
    v_max3_f32 v8, v8, v32, v33
    v_max3_f32 v9, v8, v34, v35
    v_max3_f32 v8, v8, v34, v35
    s_nop 1
    v_permlane32_swap_b32 v9, v8
    v_max_f32 v11, v8, v9
    v_max_f32 v8, v8, v9
    s_nop 1
    v_permlane16_swap_b32 v11, v8
    v_max_f32 v8, v8, v11
    v_mul_f32 v8, 0xbe0293ee, v8
    v_pk_fma_f32 v[26:27], v[26:27], s[68:69], v[8:9] op_sel_hi:[1,1,0]
    v_pk_fma_f32 v[28:29], v[28:29], s[68:69], v[8:9] op_sel_hi:[1,1,0]
    v_exp_f32 v26, v26
    v_exp_f32 v27, v27
    v_pk_fma_f32 v[30:31], v[30:31], s[68:69], v[8:9] op_sel_hi:[1,1,0]
    v_exp_f32 v28, v28
    v_pk_fma_f32 v[32:33], v[32:33], s[68:69], v[8:9] op_sel_hi:[1,1,0]
    v_exp_f32 v29, v29
    v_cvt_pk_bf16_f32 v68, v26, v27
    v_pk_fma_f32 v[34:35], v[34:35], s[68:69], v[8:9] op_sel_hi:[1,1,0]
    v_cvt_pk_bf16_f32 v71, v26, v27
    v_exp_f32 v30, v30
    v_mfma_f32_16x16x16_bf16 v[16:19], v[12:13], v[68:69], 0
    v_exp_f32 v31, v31
    v_cvt_pk_bf16_f32 v64, v28, v29
    v_mfma_f32_16x16x16_bf16 v[56:59], v[46:47], v[68:69], 0
    v_exp_f32 v32, v32
    v_exp_f32 v33, v33
    v_mfma_f32_16x16x16_bf16 v[60:63], v[46:47], v[70:71], 0
    v_cvt_pk_bf16_f32 v65, v30, v31
    v_exp_f32 v34, v34
    v_exp_f32 v35, v35
    v_cvt_pk_bf16_f32 v66, v32, v33
    s_waitcnt vmcnt(2)
    v_cvt_pk_bf16_f32 v67, v34, v35
    v_mov_b64 v[24:25], 0
    s_nop 0
    v_mfma_f32_16x16x32_bf16 v[16:19], v[12:15], v[64:67], v[16:19]
    v_mov_b64 v[26:27], 0
    v_mov_b64 v[28:29], 0
    v_mfma_f32_16x16x32_bf16 v[56:59], v[48:51], v[64:67], v[56:59]
    v_mov_b64 v[30:31], 0
    v_mov_b64 v[32:33], 0
    v_mfma_f32_16x16x32_bf16 v[60:63], v[52:55], v[64:67], v[60:63]
    v_mov_b64 v[34:35], 0
    v_rcp_f32 v8, v16
    s_nop 1
    v_pk_mul_f32 v[56:57], v[56:57], v[8:9] op_sel_hi:[1,0]
    v_pk_mul_f32 v[58:59], v[58:59], v[8:9] op_sel_hi:[1,0]
    v_cvt_pk_bf16_f32 v20, v56, v57
    v_cvt_pk_bf16_f32 v21, v58, v59
    v_pk_mul_f32 v[60:61], v[60:61], v[8:9] op_sel_hi:[1,0]
    v_pk_mul_f32 v[62:63], v[62:63], v[8:9] op_sel_hi:[1,0]
    v_cvt_pk_bf16_f32 v22, v60, v61
    v_cvt_pk_bf16_f32 v23, v62, v63
    s_mov_b64 exec, s[64:65]
    ds_write_b128 v10, v[20:23]
    s_mov_b64 exec, -1
    ds_read_b128 v[56:59], v1 offset:6144
    ds_read_b128 v[60:63], v1 offset:7168
    ds_read_b128 v[64:67], v1 offset:10240
    ds_read_b128 v[68:71], v1 offset:11264
    s_waitcnt lgkmcnt(4)
    s_barrier
    ds_read_b128 v[12:15], v0 offset:22528
    ds_read_b128 v[16:19], v0 offset:23552
    s_mov_b32 m0, s51
    s_nop 0
    buffer_load_dwordx4 v0, s[4:7], s39 offen lds
    buffer_load_dwordx4 v0, s[4:7], s39 offen offset:1024 lds
    s_waitcnt lgkmcnt(1)
    v_smfmac_f32_16x16x64_bf16 v[40:43], v[12:15], v[72:79], v7
    s_waitcnt lgkmcnt(0)
    v_smfmac_f32_16x16x64_bf16 v[40:43], v[16:19], v[64:71], v7
    v_smfmac_f32_16x16x64_bf16 v[24:27], v[12:15], v[208:215], v7
    v_smfmac_f32_16x16x64_bf16 v[24:27], v[16:19], v[240:247], v7
    v_add_f32 v40, v40, v42
    v_smfmac_f32_16x16x64_bf16 v[28:31], v[12:15], v[216:223], v7
    v_add_f32 v41, v41, v43
    v_smfmac_f32_16x16x64_bf16 v[28:31], v[16:19], v[248:255], v7
    v_cvt_pk_bf16_f32 v20, v40, v41
    v_smfmac_f32_16x16x64_bf16 v[32:35], v[12:15], v[224:231], v7
    v_bfi_b32 v20, 1, s19, v20
    v_smfmac_f32_16x16x64_bf16 v[32:35], v[16:19], v[80:87], v7
    buffer_store_dword v20, v6, s[4:7], s35 offen sc1
    v_add_f32 v24, v24, v26
    v_smfmac_f32_16x16x64_bf16 v[36:39], v[12:15], v[232:239], v7
    v_add_f32 v25, v25, v27
    v_smfmac_f32_16x16x64_bf16 v[36:39], v[16:19], v[56:63], v7
    v_add_f32 v28, v28, v30
    v_add_f32 v29, v29, v31
    v_cvt_pk_bf16_f32 v8, v24, v25
    v_add_f32 v32, v32, v34
    v_cvt_pk_bf16_f32 v9, v28, v29
    v_add_f32 v33, v33, v35
    v_bfi_b32 v8, 1, s19, v8
    v_cvt_pk_bf16_f32 v10, v32, v33
    v_pk_add_f32 v[36:37], v[36:37], v[38:39]
    v_cvt_pk_bf16_f32 v11, v36, v37
    buffer_store_dwordx4 v[8:11], v5, s[4:7], s35 offen sc1
    s_add_u32 s39, s39, 262144
    s_add_u32 s47, s47, 262144
    s_xor_b32 s35, s35, 262144
    s_add_u32 s40, s40, 65536
    s_cmp_eq_u32 s42, 0
    s_cbranch_scc1 L_recunred_167
    v_bfe_u32 v8, v0, 4, 1
    v_lshlrev_b32 v21, 4, v8
    v_mov_b32 v10, 0x3f80
    v_lshlrev_b32 v10, v21, v10
    v_bfe_u32 v11, v0, 5, 3
    v_cmp_eq_u32 s[52:53], 0, v11
    v_cmp_eq_u32 s[54:55], 1, v11
    v_cmp_eq_u32 s[56:57], 2, v11
    v_cmp_eq_u32 s[58:59], 3, v11
    v_cndmask_b32 v12, 0, v10, s[52:53]
    v_cndmask_b32 v13, 0, v10, s[54:55]
    v_cndmask_b32 v14, 0, v10, s[56:57]
    v_cndmask_b32 v15, 0, v10, s[58:59]
    v_and_b32 v11, 3, v11
    v_lshl_add_u32 v21, v11, 2, v21
    v_bfe_u32 v11, v0, 8, 1
    v_lshl_add_u32 v21, v11, 6, v21
    v_lshrrev_b32 v11, 9, v0
    v_lshl_add_u32 v21, v11, 5, v21
    v_mov_b64 v[24:25], 0
    v_mov_b64 v[26:27], 0
    v_mov_b64 v[28:29], 0
    v_mov_b64 v[30:31], 0
    v_mov_b64 v[32:33], 0
    v_mov_b64 v[34:35], 0
    v_mov_b64 v[36:37], 0
    v_mov_b64 v[38:39], 0
    v_mov_b64 v[40:41], 0
    v_mov_b64 v[42:43], 0
    v_mov_b64 v[44:45], 0
    v_mov_b64 v[46:47], 0
    s_mov_b32 s50, 3200000
    s_nop 15
    s_nop 15
    s_nop 11
    buffer_load_dwordx4 v[56:59], v0, s[4:7], s36 offen offset:0 sc1
    buffer_load_dwordx4 v[60:63], v0, s[4:7], s36 offen offset:1024 sc1
    buffer_load_dwordx4 v[64:67], v0, s[4:7], s36 offen offset:2048 sc1
    buffer_load_dwordx4 v[68:71], v0, s[4:7], s36 offen offset:3072 sc1
    s_nop 15
    s_nop 3
    buffer_load_dwordx4 v[56:59], v0, s[4:7], s36 offen offset:0 sc1
    buffer_load_dwordx4 v[60:63], v0, s[4:7], s36 offen offset:1024 sc1
    buffer_load_dwordx4 v[64:67], v0, s[4:7], s36 offen offset:2048 sc1
    buffer_load_dwordx4 v[68:71], v0, s[4:7], s36 offen offset:3072 sc1
L_recursl_170:
    s_waitcnt vmcnt(7)
    v_xor_b32 v8, s19, v56
    v_mfma_f32_16x16x32_bf16 v[16:19], v[56:59], v[12:15], 0
    buffer_load_dwordx4 v[56:59], v0, s[4:7], s36 offen offset:0 sc1
    s_waitcnt vmcnt(7)
    v_bitop3_b32 v8, v8, v60, s19 bitop3:0xf6
    v_mfma_f32_16x16x32_bf16 v[16:19], v[60:63], v[12:15], v[16:19]
    buffer_load_dwordx4 v[60:63], v0, s[4:7], s36 offen offset:1024 sc1
    s_waitcnt vmcnt(7)
    v_bitop3_b32 v8, v8, v64, s19 bitop3:0xf6
    v_mfma_f32_16x16x32_bf16 v[16:19], v[64:67], v[12:15], v[16:19]
    buffer_load_dwordx4 v[64:67], v0, s[4:7], s36 offen offset:2048 sc1
    s_waitcnt vmcnt(7)
    v_bitop3_b32 v8, v8, v68, s19 bitop3:0xf6
    v_mfma_f32_16x16x32_bf16 v[16:19], v[68:71], v[12:15], v[16:19]
    buffer_load_dwordx4 v[68:71], v0, s[4:7], s36 offen offset:3072 sc1
    v_and_b32 v8, 1, v8
    v_cmp_ne_u32 vcc, 0, v8
    s_cbranch_vccz L_recursok_169
    s_waitcnt vmcnt(7)
    v_xor_b32 v8, s19, v56
    v_mfma_f32_16x16x32_bf16 v[16:19], v[56:59], v[12:15], 0
    buffer_load_dwordx4 v[56:59], v0, s[4:7], s36 offen offset:0 sc1
    s_waitcnt vmcnt(7)
    v_bitop3_b32 v8, v8, v60, s19 bitop3:0xf6
    v_mfma_f32_16x16x32_bf16 v[16:19], v[60:63], v[12:15], v[16:19]
    buffer_load_dwordx4 v[60:63], v0, s[4:7], s36 offen offset:1024 sc1
    s_waitcnt vmcnt(7)
    v_bitop3_b32 v8, v8, v64, s19 bitop3:0xf6
    v_mfma_f32_16x16x32_bf16 v[16:19], v[64:67], v[12:15], v[16:19]
    buffer_load_dwordx4 v[64:67], v0, s[4:7], s36 offen offset:2048 sc1
    s_waitcnt vmcnt(7)
    v_bitop3_b32 v8, v8, v68, s19 bitop3:0xf6
    v_mfma_f32_16x16x32_bf16 v[16:19], v[68:71], v[12:15], v[16:19]
    buffer_load_dwordx4 v[68:71], v0, s[4:7], s36 offen offset:3072 sc1
    v_and_b32 v8, 1, v8
    v_cmp_ne_u32 vcc, 0, v8
    s_cbranch_vccz L_recursok_169
    s_sub_u32 s50, s50, 1
    s_cbranch_scc0 L_recursl_170
    s_branch L_exit_recurrent_scan__memory_aug_recurrent_mem_tr__moe_arch_mod__prompt_kernel
L_recursok_169:
    s_nop 1
    v_permlane32_swap_b32 v16, v18
    v_permlane32_swap_b32 v17, v19
    v_pk_add_f32 v[16:17], v[16:17], v[18:19]
    v_cvt_pk_bf16_f32 v16, v16, v17
    s_mov_b64 exec, s[74:75]
    buffer_store_dword v16, v21, s[4:7], s48 offen sc1
    buffer_store_dword v16, v21, s[4:7], s37 offen sc1
    s_mov_b64 exec, -1
    s_barrier
    v_mov_b64 v[8:9], -1
    v_mov_b64 v[10:11], -1
    s_mov_b64 exec, 0xff
    buffer_store_dwordx4 v[8:11], v0, s[4:7], s45 offen sc1
    s_mov_b64 exec, -1
    s_xor_b32 s36, s36, 262144
    s_mov_b32 s45, s37
    s_add_u32 s37, s37, 8192
    s_andn2_b32 s37, s37, 0x8000
    s_add_u32 s48, s48, 10240
    s_waitcnt vmcnt(3)
    s_branch L_recun2_168
L_recunred_167:
    v_mov_b64 v[24:25], 0
    v_mov_b64 v[26:27], 0
    v_mov_b64 v[28:29], 0
    v_mov_b64 v[30:31], 0
    v_mov_b64 v[32:33], 0
    v_mov_b64 v[34:35], 0
    v_mov_b64 v[36:37], 0
    v_mov_b64 v[38:39], 0
    v_mov_b64 v[40:41], 0
    v_mov_b64 v[42:43], 0
    v_mov_b64 v[44:45], 0
    v_mov_b64 v[46:47], 0
    s_barrier
    s_waitcnt vmcnt(0)
L_recun2_168:
    v_bfe_u32 v4, v0, 7, 2
    v_lshl_add_u32 v4, v4, 2, v0
    s_add_u32 s34, s34, 1
    ds_read_b128 v[56:59], v1 offset:12288
    ds_read_b128 v[60:63], v1 offset:13312
    ds_read_b128 v[64:67], v1 offset:14336
    ds_read_b128 v[68:71], v1 offset:15360
    ds_read_b128 v[72:75], v1 offset:16384
    ds_read_b128 v[76:79], v1 offset:17408
    ds_read_b128 v[80:83], v1 offset:18432
    ds_read_b128 v[84:87], v1 offset:19456
    s_add_u32 s26, s34, 1
    s_min_u32 s26, s26, 63
    s_cmp_gt_u32 s44, s26
    s_cbranch_scc1 L_recuf_171
    v_bfe_u32 v8, v0, 6, 1
    v_lshlrev_b32 v8, 13, v8
    v_bfe_u32 v9, v0, 4, 2
    v_lshl_add_u32 v8, v9, 2, v8
    v_bfe_u32 v10, v0, 7, 1
    v_lshl_add_u32 v8, v10, 7, v8
    s_mov_b32 s50, 0
L_recufs_172:
    buffer_load_dword v9, v8, s[4:7], s46 offen sc1
    s_waitcnt vmcnt(0)
    v_lshl_add_u32 v9, v9, 1, v10
    v_cmp_ge_u32 vcc, s26, v9
    s_cbranch_vccz L_recufsok_173
    s_add_u32 s50, s50, 1
    s_cmp_lt_u32 s50, 400000
    s_cbranch_scc0 L_exit_recurrent_scan__memory_aug_recurrent_mem_tr__moe_arch_mod__prompt_kernel
    s_sleep 2
    s_branch L_recufs_172
L_recufsok_173:
    v_min_u32_dpp v9, v9, v9 quad_perm:[1,0,3,2] row_mask:0xf bank_mask:0xf
    s_nop 1
    v_min_u32_dpp v9, v9, v9 quad_perm:[2,3,0,1] row_mask:0xf bank_mask:0xf
    s_nop 1
    v_min_u32_dpp v9, v9, v9 row_half_mirror row_mask:0xf bank_mask:0xf
    s_nop 1
    v_min_u32_dpp v9, v9, v9 row_mirror row_mask:0xf bank_mask:0xf
    s_nop 0
    v_readfirstlane_b32 s44, v9
L_recuf_171:
    s_mov_b32 m0, s66
    s_mov_b32 s30, s38
    s_mov_b64 s[8:9], -1
    s_add_u32 s67, s67, 262144
    s_add_u32 s38, s38, 10240
    s_waitcnt lgkmcnt(0)
    s_bfe_u32 s19, s34, 0x10001
    s_branch L_recucl_163
L_recurt_165:
    s_cmp_eq_u32 s34, 0
    s_cbranch_scc1 L_recurb_166
    s_mov_b32 s50, 0
    s_mov_b32 m0, s66
    ds_read2st64_b32 v[8:9], v4 offset0:32 offset1:36
    s_waitcnt lgkmcnt(0)
    v_cmp_eq_u32 s[52:53], -1, v8
    v_cmp_eq_u32 s[54:55], -1, v9
    s_or_b64 s[58:59], s[52:53], s[54:55]
    s_cbranch_scc0 L_recurb_166
    s_mov_b64 exec, s[52:53]
    buffer_load_dwordx4 v0, s[4:7], s30 offen offset:0 sc1 lds
    s_mov_b64 exec, s[54:55]
    buffer_load_dwordx4 v0, s[4:7], s30 offen offset:1024 sc1 lds
    s_mov_b64 exec, -1
    s_nop 15
    s_nop 15
L_recur2_175:
    s_mov_b64 exec, s[52:53]
    buffer_load_dwordx4 v0, s[4:7], s30 offen offset:0 sc1 lds
    s_mov_b64 exec, s[54:55]
    buffer_load_dwordx4 v0, s[4:7], s30 offen offset:1024 sc1 lds
    s_mov_b64 exec, -1
    s_waitcnt vmcnt(2)
    ds_read2st64_b32 v[8:9], v4 offset0:32 offset1:36
    s_waitcnt lgkmcnt(0)
    v_cmp_eq_u32 s[52:53], -1, v8
    v_cmp_eq_u32 s[54:55], -1, v9
    s_or_b64 s[58:59], s[52:53], s[54:55]
    s_cbranch_scc0 L_recurb_166
    s_add_u32 s50, s50, 1
    s_cmp_lt_u32 s50, 3200000
    s_cbranch_scc0 L_exit_recurrent_scan__memory_aug_recurrent_mem_tr__moe_arch_mod__prompt_kernel
    s_branch L_recur2_175
L_recufin_164:
    s_waitcnt lgkmcnt(0)
    s_nop 7
    s_waitcnt vmcnt(0)
    v_mov_b32 v9, 64
    buffer_store_dword v9, off, s[4:7], s41 sc1
    s_waitcnt vmcnt(0)
    s_branch L_exit_recurrent_scan__memory_aug_recurrent_mem_tr__moe_arch_mod__prompt_kernel
L_recub_112:
L_recucl_176:
    s_barrier
    ds_read_b128 v[12:15], v2 offset:0
    ds_read_b128 v[16:19], v2 offset:1024
    ds_read_b128 v[20:23], v2 offset:2048
    s_waitcnt lgkmcnt(2)
    v_smfmac_f32_16x16x64_bf16 v[24:27], v[12:15], a[0:7], v7
    v_mov_b32 v8, s34
    v_smfmac_f32_16x16x64_bf16 v[28:31], v[12:15], v[56:63], v7
    ds_read_b128 v[56:59], v1 offset:20480
    v_smfmac_f32_16x16x64_bf16 v[32:35], v[12:15], a[8:15], v7
    ds_read_b128 v[60:63], v1 offset:21504
    v_smfmac_f32_16x16x64_bf16 v[36:39], v[12:15], v[64:71], v7
    ds_read_b128 v[64:67], v1 offset:22528
    v_smfmac_f32_16x16x64_bf16 v[40:43], v[12:15], a[16:23], v7
    ds_read_b128 v[68:71], v1 offset:23552
    v_smfmac_f32_16x16x64_bf16 v[44:47], v[12:15], a[24:31], v7
    buffer_load_dwordx4 v[48:51], v0, s[4:7], s47 offen offset:0
    ds_read_b128 v[12:15], v2 offset:3072
    s_waitcnt lgkmcnt(6)
    v_smfmac_f32_16x16x64_bf16 v[24:27], v[16:19], a[32:39], v7
    buffer_load_dwordx4 v[52:55], v0, s[4:7], s47 offen offset:1024
    v_smfmac_f32_16x16x64_bf16 v[28:31], v[16:19], v[72:79], v7
    ds_read_b128 v[72:75], v1 offset:24576
    v_smfmac_f32_16x16x64_bf16 v[32:35], v[16:19], a[40:47], v7
    ds_read_b128 v[76:79], v1 offset:25600
    buffer_store_dword v8, off, s[4:7], s41 sc1
    v_smfmac_f32_16x16x64_bf16 v[36:39], v[16:19], v[80:87], v7
    ds_read_b128 v[80:83], v1 offset:26624
    v_smfmac_f32_16x16x64_bf16 v[40:43], v[16:19], a[48:55], v7
    ds_read_b128 v[84:87], v1 offset:27648
    v_smfmac_f32_16x16x64_bf16 v[44:47], v[16:19], a[56:63], v7
    ds_read_b128 v[16:19], v2 offset:4096
    s_waitcnt lgkmcnt(10)
    v_smfmac_f32_16x16x64_bf16 v[24:27], v[20:23], a[64:71], v7
    s_waitcnt lgkmcnt(8)
    v_smfmac_f32_16x16x64_bf16 v[28:31], v[20:23], v[56:63], v7
    ds_read_b128 v[56:59], v1 offset:28672
    v_smfmac_f32_16x16x64_bf16 v[32:35], v[20:23], a[72:79], v7
    ds_read_b128 v[60:63], v1 offset:29696
    s_waitcnt lgkmcnt(8)
    v_smfmac_f32_16x16x64_bf16 v[36:39], v[20:23], v[64:71], v7
    ds_read_b128 v[64:67], v1 offset:30720
    v_smfmac_f32_16x16x64_bf16 v[40:43], v[20:23], a[80:87], v7
    ds_read_b128 v[68:71], v1 offset:31744
    v_smfmac_f32_16x16x64_bf16 v[44:47], v[20:23], a[88:95], v7
    s_waitcnt lgkmcnt(9)
    v_smfmac_f32_16x16x64_bf16 v[24:27], v[12:15], a[96:103], v7
    s_waitcnt lgkmcnt(7)
    v_smfmac_f32_16x16x64_bf16 v[28:31], v[12:15], v[72:79], v7
    ds_read_b128 v[72:75], v1 offset:0
    v_smfmac_f32_16x16x64_bf16 v[32:35], v[12:15], a[104:111], v7
    ds_read_b128 v[76:79], v1 offset:1024
    s_waitcnt lgkmcnt(7)
    v_smfmac_f32_16x16x64_bf16 v[36:39], v[12:15], v[80:87], v7
    ds_read_b128 v[80:83], v1 offset:2048
    s_waitcnt lgkmcnt(7)
    v_smfmac_f32_16x16x64_bf16 v[24:27], v[16:19], a[128:135], v7
    ds_read_b128 v[84:87], v1 offset:3072
    s_waitcnt lgkmcnt(6)
    v_smfmac_f32_16x16x64_bf16 v[28:31], v[16:19], v[56:63], v7
    ds_read_b128 v[56:59], v1 offset:32768
    v_smfmac_f32_16x16x64_bf16 v[32:35], v[16:19], a[136:143], v7
    ds_read_b128 v[60:63], v1 offset:33792
    s_waitcnt lgkmcnt(6)
    v_smfmac_f32_16x16x64_bf16 v[36:39], v[16:19], v[64:71], v7
    s_waitcnt vmcnt(3)
    s_barrier
    ds_read_b128 v[20:23], v2 offset:5120
    v_smfmac_f32_16x16x64_bf16 v[40:43], v[12:15], a[112:119], v7
    v_smfmac_f32_16x16x64_bf16 v[44:47], v[12:15], a[120:127], v7
    ds_read_b128 v[12:15], v2 offset:6144
    v_smfmac_f32_16x16x64_bf16 v[40:43], v[16:19], a[144:151], v7
    v_smfmac_f32_16x16x64_bf16 v[44:47], v[16:19], a[152:159], v7
    ds_read_b128 v[16:19], v2 offset:7168
    s_waitcnt lgkmcnt(2)
    v_smfmac_f32_16x16x64_bf16 v[24:27], v[20:23], a[160:167], v7
    v_smfmac_f32_16x16x64_bf16 v[28:31], v[20:23], v[72:79], v7
    v_smfmac_f32_16x16x64_bf16 v[32:35], v[20:23], a[168:175], v7
    v_smfmac_f32_16x16x64_bf16 v[36:39], v[20:23], v[80:87], v7
    ds_read_b128 v[20:23], v2 offset:8192
    s_waitcnt lgkmcnt(2)
    v_smfmac_f32_16x16x64_bf16 v[24:27], v[12:15], a[192:199], v7
    v_smfmac_f32_16x16x64_bf16 v[28:31], v[12:15], v[56:63], v7
    ds_read_b128 v[72:75], v0 offset:10240
    v_smfmac_f32_16x16x64_bf16 v[32:35], v[12:15], a[200:207], v7
    v_smfmac_f32_16x16x64_bf16 v[36:39], v[12:15], a[208:215], v7
    ds_read_b128 v[76:79], v0 offset:11264
    ds_read_b128 v[12:15], v2 offset:9216
    s_waitcnt lgkmcnt(4)
    v_smfmac_f32_16x16x64_bf16 v[24:27], v[16:19], a[232:239], v7
    v_lshrrev_b32 v71, 9, v0
    v_smfmac_f32_16x16x64_bf16 v[28:31], v[16:19], a[248:255], v7
    ds_read_b128 v[80:83], v0 offset:12288
    v_smfmac_f32_16x16x64_bf16 v[32:35], v[16:19], a[240:247], v7
    v_lshlrev_b32 v71, 3, v71
    v_smfmac_f32_16x16x64_bf16 v[36:39], v[16:19], v[88:95], v7
    ds_read_b128 v[84:87], v0 offset:13312
    s_waitcnt lgkmcnt(5)
    v_smfmac_f32_16x16x64_bf16 v[24:27], v[20:23], v[112:119], v7
    v_lshrrev_b32 v70, 1, v0
    v_smfmac_f32_16x16x64_bf16 v[28:31], v[20:23], v[128:135], v7
    v_xor_b32 v70, v71, v70
    v_smfmac_f32_16x16x64_bf16 v[32:35], v[20:23], v[120:127], v7
    v_xor_b32 v71, 16, v70
    v_smfmac_f32_16x16x64_bf16 v[36:39], v[20:23], v[136:143], v7
    s_waitcnt lgkmcnt(2)
    v_smfmac_f32_16x16x64_bf16 v[24:27], v[12:15], v[160:167], v7
    v_smfmac_f32_16x16x64_bf16 v[28:31], v[12:15], v[176:183], v7
    v_smfmac_f32_16x16x64_bf16 v[32:35], v[12:15], v[168:175], v7
    v_add_f32 v24, v24, v26
    v_smfmac_f32_16x16x64_bf16 v[36:39], v[12:15], v[184:191], v7
    v_add_f32 v25, v25, v27
    v_add_f32 v28, v28, v30
    v_cvt_pk_bf16_f32 v8, v24, v25
    v_add_f32 v29, v29, v31
    v_add_f32 v32, v32, v34
    v_cvt_pk_bf16_f32 v9, v28, v29
    v_add_f32 v33, v33, v35
    ds_write_b64 v3, v[8:9]
    v_pk_add_f32 v[36:37], v[36:37], v[38:39]
    v_cvt_pk_bf16_f32 v10, v32, v33
    v_cvt_pk_bf16_f32 v11, v36, v37
    ds_write_b64 v3, v[10:11] offset:128
    v_smfmac_f32_16x16x64_bf16 v[40:43], v[12:15], v[192:199], v7
    v_smfmac_f32_16x16x64_bf16 v[44:47], v[12:15], v[200:207], v7
    ds_read_b128 v[12:15], v2 offset:6144
    v_smfmac_f32_16x16x64_bf16 v[40:43], v[20:23], v[144:151], v7
    v_smfmac_f32_16x16x64_bf16 v[44:47], v[20:23], v[152:159], v7
    ds_read_b128 v[20:23], v2 offset:5120
    v_smfmac_f32_16x16x64_bf16 v[40:43], v[16:19], v[96:103], v7
    s_waitcnt lgkmcnt(2)
    s_barrier
    ds_read_b64_tr_b16 v[56:57], v70 offset:18432
    ds_read_b64_tr_b16 v[58:59], v71 offset:18944
    v_smfmac_f32_16x16x64_bf16 v[44:47], v[16:19], v[104:111], v7
    ds_read_b64_tr_b16 v[60:61], v70 offset:19456
    ds_read_b64_tr_b16 v[62:63], v71 offset:19968
    s_waitcnt lgkmcnt(5)
    v_smfmac_f32_16x16x64_bf16 v[40:43], v[12:15], a[216:223], v7
    ds_read_b64_tr_b16 v[64:65], v70 offset:20480
    ds_read_b64_tr_b16 v[66:67], v71 offset:20992
    v_smfmac_f32_16x16x64_bf16 v[44:47], v[12:15], a[224:231], v7
    ds_read_b64_tr_b16 v[68:69], v70 offset:21504
    ds_read_b64_tr_b16 v[70:71], v71 offset:22016
    s_waitcnt lgkmcnt(8)
    v_smfmac_f32_16x16x64_bf16 v[40:43], v[20:23], a[176:183], v7
    v_smfmac_f32_16x16x64_bf16 v[44:47], v[20:23], a[184:191], v7
    s_waitcnt lgkmcnt(6)
    v_mfma_f32_16x16x32_bf16 v[28:31], v[72:75], v[56:59], 0
    ds_read_b128 v[72:75], v0 offset:14336
    s_waitcnt lgkmcnt(5)
    v_mfma_f32_16x16x32_bf16 v[28:31], v[76:79], v[60:63], v[28:31]
    ds_read_b128 v[76:79], v0 offset:15360
    s_waitcnt lgkmcnt(4)
    v_mfma_f32_16x16x32_bf16 v[28:31], v[80:83], v[64:67], v[28:31]
    ds_read_b128 v[80:83], v0 offset:16384
    v_add_f32 v40, v40, v42
    s_waitcnt lgkmcnt(3)
    v_mfma_f32_16x16x32_bf16 v[28:31], v[84:87], v[68:71], v[28:31]
    ds_read_b128 v[84:87], v0 offset:17408
    v_add_f32 v44, v44, v46
    v_mfma_f32_16x16x32_bf16 v[24:27], v[56:59], v[56:59], 0
    v_add_f32 v41, v41, v43
    v_add_f32 v45, v45, v47
    v_mfma_f32_16x16x32_bf16 v[24:27], v[60:63], v[60:63], v[24:27]
    v_cvt_pk_bf16_f32 v46, v40, v41
    v_cvt_pk_bf16_f32 v47, v44, v45
    v_mfma_f32_16x16x32_bf16 v[24:27], v[64:67], v[64:67], v[24:27]
    v_lshrrev_b32 v11, 1, v0
    s_cmp_eq_u32 s34, 63
    buffer_store_dwordx2 v[46:47], v11, s[4:7], s40 offen sc1
    s_cbranch_scc1 L_recufin_177
    v_max3_f32 v8, v28, v29, v30
    v_mfma_f32_16x16x32_bf16 v[24:27], v[68:71], v[68:71], v[24:27]
    v_mov_b64 v[12:13], s[70:71]
    v_mov_b64 v[14:15], s[70:71]
    s_waitcnt lgkmcnt(3)
    v_mfma_f32_16x16x32_bf16 v[32:35], v[72:75], v[56:59], 0
    v_add_u32 v10, s49, v0
    v_mov_b64 v[36:37], 0
    s_waitcnt lgkmcnt(2)
    v_mfma_f32_16x16x32_bf16 v[32:35], v[76:79], v[60:63], v[32:35]
    v_max3_f32 v8, v8, v31, v26
    v_mov_b64 v[38:39], 0
    s_waitcnt lgkmcnt(1)
    v_mfma_f32_16x16x32_bf16 v[32:35], v[80:83], v[64:67], v[32:35]
    v_max_f32 v8, v8, v27
    ds_read_b128 v[72:75], v1 offset:8192
    ds_read_b128 v[76:79], v1 offset:9216
    s_waitcnt lgkmcnt(2)
    v_mfma_f32_16x16x32_bf16 v[32:35], v[84:87], v[68:71], v[32:35]
    ds_read_b128 v[80:83], v1 offset:4096
    ds_read_b128 v[84:87], v1 offset:5120
    v_mov_b32 v69, 0
    v_mov_b32 v70, 0
    v_mov_b64 v[40:41], 0
    v_mov_b64 v[42:43], 0
    s_nop 1
    v_max3_f32 v8, v8, v32, v33
    v_max3_f32 v9, v8, v34, v35
    v_max3_f32 v8, v8, v34, v35
    s_nop 1
    v_permlane32_swap_b32 v9, v8
    v_max_f32 v11, v8, v9
    v_max_f32 v8, v8, v9
    s_nop 1
    v_permlane16_swap_b32 v11, v8
    v_max_f32 v8, v8, v11
    v_mul_f32 v8, 0xbe0293ee, v8
    v_pk_fma_f32 v[26:27], v[26:27], s[68:69], v[8:9] op_sel_hi:[1,1,0]
    v_pk_fma_f32 v[28:29], v[28:29], s[68:69], v[8:9] op_sel_hi:[1,1,0]
    v_exp_f32 v26, v26
    v_exp_f32 v27, v27
    v_pk_fma_f32 v[30:31], v[30:31], s[68:69], v[8:9] op_sel_hi:[1,1,0]
    v_exp_f32 v28, v28
    v_pk_fma_f32 v[32:33], v[32:33], s[68:69], v[8:9] op_sel_hi:[1,1,0]
    v_exp_f32 v29, v29
    v_cvt_pk_bf16_f32 v68, v26, v27
    v_pk_fma_f32 v[34:35], v[34:35], s[68:69], v[8:9] op_sel_hi:[1,1,0]
    v_cvt_pk_bf16_f32 v71, v26, v27
    v_exp_f32 v30, v30
    v_mfma_f32_16x16x16_bf16 v[16:19], v[12:13], v[68:69], 0
    v_exp_f32 v31, v31
    v_cvt_pk_bf16_f32 v64, v28, v29
    v_mfma_f32_16x16x16_bf16 v[56:59], v[46:47], v[68:69], 0
    v_exp_f32 v32, v32
    v_exp_f32 v33, v33
    v_mfma_f32_16x16x16_bf16 v[60:63], v[46:47], v[70:71], 0
    v_cvt_pk_bf16_f32 v65, v30, v31
    v_exp_f32 v34, v34
    v_exp_f32 v35, v35
    v_cvt_pk_bf16_f32 v66, v32, v33
    s_waitcnt vmcnt(1)
    v_cvt_pk_bf16_f32 v67, v34, v35
    v_mov_b64 v[24:25], 0
    s_nop 0
    v_mfma_f32_16x16x32_bf16 v[16:19], v[12:15], v[64:67], v[16:19]
    v_mov_b64 v[26:27], 0
    v_mov_b64 v[28:29], 0
    v_mfma_f32_16x16x32_bf16 v[56:59], v[48:51], v[64:67], v[56:59]
    v_mov_b64 v[30:31], 0
    v_mov_b64 v[32:33], 0
    v_mfma_f32_16x16x32_bf16 v[60:63], v[52:55], v[64:67], v[60:63]
    v_mov_b64 v[34:35], 0
    v_rcp_f32 v8, v16
    s_nop 1
    v_pk_mul_f32 v[56:57], v[56:57], v[8:9] op_sel_hi:[1,0]
    v_pk_mul_f32 v[58:59], v[58:59], v[8:9] op_sel_hi:[1,0]
    v_cvt_pk_bf16_f32 v20, v56, v57
    v_cvt_pk_bf16_f32 v21, v58, v59
    v_pk_mul_f32 v[60:61], v[60:61], v[8:9] op_sel_hi:[1,0]
    v_pk_mul_f32 v[62:63], v[62:63], v[8:9] op_sel_hi:[1,0]
    v_cvt_pk_bf16_f32 v22, v60, v61
    v_cvt_pk_bf16_f32 v23, v62, v63
    s_mov_b64 exec, s[64:65]
    ds_write_b128 v10, v[20:23]
    s_mov_b64 exec, -1
    ds_read_b128 v[56:59], v1 offset:6144
    ds_read_b128 v[60:63], v1 offset:7168
    ds_read_b128 v[64:67], v1 offset:10240
    ds_read_b128 v[68:71], v1 offset:11264
    s_waitcnt lgkmcnt(4)
    s_barrier
    ds_read_b128 v[12:15], v0 offset:22528
    ds_read_b128 v[16:19], v0 offset:23552
    s_mov_b32 m0, s51
    s_nop 0
    buffer_load_dwordx4 v0, s[4:7], s39 offen lds
    buffer_load_dwordx4 v0, s[4:7], s39 offen offset:1024 lds
    s_waitcnt lgkmcnt(1)
    v_smfmac_f32_16x16x64_bf16 v[40:43], v[12:15], v[72:79], v7
    s_waitcnt lgkmcnt(0)
    v_smfmac_f32_16x16x64_bf16 v[40:43], v[16:19], v[64:71], v7
    v_smfmac_f32_16x16x64_bf16 v[24:27], v[12:15], v[208:215], v7
    v_smfmac_f32_16x16x64_bf16 v[24:27], v[16:19], v[240:247], v7
    v_add_f32 v40, v40, v42
    v_smfmac_f32_16x16x64_bf16 v[28:31], v[12:15], v[216:223], v7
    v_add_f32 v41, v41, v43
    v_smfmac_f32_16x16x64_bf16 v[28:31], v[16:19], v[248:255], v7
    v_cvt_pk_bf16_f32 v20, v40, v41
    v_smfmac_f32_16x16x64_bf16 v[32:35], v[12:15], v[224:231], v7
    v_bfi_b32 v20, 1, s19, v20
    v_smfmac_f32_16x16x64_bf16 v[32:35], v[16:19], v[80:87], v7
    buffer_store_dword v20, v6, s[4:7], s35 offen sc1
    v_add_f32 v24, v24, v26
    v_smfmac_f32_16x16x64_bf16 v[36:39], v[12:15], v[232:239], v7
    v_add_f32 v25, v25, v27
    v_smfmac_f32_16x16x64_bf16 v[36:39], v[16:19], v[56:63], v7
    v_add_f32 v28, v28, v30
    v_add_f32 v29, v29, v31
    v_cvt_pk_bf16_f32 v8, v24, v25
    v_add_f32 v32, v32, v34
    v_cvt_pk_bf16_f32 v9, v28, v29
    v_add_f32 v33, v33, v35
    v_bfi_b32 v8, 1, s19, v8
    v_cvt_pk_bf16_f32 v10, v32, v33
    v_pk_add_f32 v[36:37], v[36:37], v[38:39]
    v_cvt_pk_bf16_f32 v11, v36, v37
    buffer_store_dwordx4 v[8:11], v5, s[4:7], s35 offen sc1
    s_add_u32 s39, s39, 262144
    s_add_u32 s47, s47, 262144
    s_xor_b32 s35, s35, 262144
    s_add_u32 s40, s40, 65536
    v_mov_b64 v[24:25], 0
    v_mov_b64 v[26:27], 0
    v_mov_b64 v[28:29], 0
    v_mov_b64 v[30:31], 0
    v_mov_b64 v[32:33], 0
    v_mov_b64 v[34:35], 0
    v_mov_b64 v[36:37], 0
    v_mov_b64 v[38:39], 0
    v_mov_b64 v[40:41], 0
    v_mov_b64 v[42:43], 0
    v_mov_b64 v[44:45], 0
    v_mov_b64 v[46:47], 0
    ds_read_b128 v[56:59], v1 offset:12288
    ds_read_b128 v[60:63], v1 offset:13312
    ds_read_b128 v[64:67], v1 offset:14336
    ds_read_b128 v[68:71], v1 offset:15360
    ds_read_b128 v[72:75], v1 offset:16384
    ds_read_b128 v[76:79], v1 offset:17408
    ds_read_b128 v[80:83], v1 offset:18432
    ds_read_b128 v[84:87], v1 offset:19456
    s_mov_b32 m0, s66
    s_add_u32 s34, s34, 1
    s_bfe_u32 s19, s34, 0x10001
    s_mov_b32 s50, 3200000
    s_mov_b32 s30, s37
    s_add_u32 s37, s37, 8192
    s_andn2_b32 s37, s37, 0x8000
    s_waitcnt lgkmcnt(0)
    s_barrier
    s_nop 15
    s_nop 15
    s_nop 15
    s_nop 15
    s_nop 15
    buffer_load_dwordx4 v0, s[4:7], s30 offen offset:0 sc1 lds
    buffer_load_dwordx4 v0, s[4:7], s30 offen offset:1024 sc1 lds
    buffer_load_dwordx4 v0, s[4:7], s30 offen offset:2048 sc1 lds
    s_nop 15
    s_nop 15
    s_nop 11
    buffer_load_dwordx4 v0, s[4:7], s30 offen offset:0 sc1 lds
    buffer_load_dwordx4 v0, s[4:7], s30 offen offset:1024 sc1 lds
    buffer_load_dwordx4 v0, s[4:7], s30 offen offset:2048 sc1 lds
L_recuagl_180:
    s_waitcnt vmcnt(3)
    ds_read2st64_b32 v[8:9], v4 offset0:0 offset1:4
    ds_read_b32 v10, v4 offset:2048
    buffer_load_dwordx4 v0, s[4:7], s30 offen offset:0 sc1 lds
    buffer_load_dwordx4 v0, s[4:7], s30 offen offset:1024 sc1 lds
    buffer_load_dwordx4 v0, s[4:7], s30 offen offset:2048 sc1 lds
    s_waitcnt lgkmcnt(0)
    v_max3_u32 v8, v8, v9, v10
    v_cmp_eq_u32 vcc, -1, v8
    s_cbranch_vccz L_recucl_176
    s_waitcnt vmcnt(3)
    ds_read2st64_b32 v[8:9], v4 offset0:0 offset1:4
    ds_read_b32 v10, v4 offset:2048
    buffer_load_dwordx4 v0, s[4:7], s30 offen offset:0 sc1 lds
    buffer_load_dwordx4 v0, s[4:7], s30 offen offset:1024 sc1 lds
    buffer_load_dwordx4 v0, s[4:7], s30 offen offset:2048 sc1 lds
    s_waitcnt lgkmcnt(0)
    v_max3_u32 v8, v8, v9, v10
    v_cmp_eq_u32 vcc, -1, v8
    s_cbranch_vccz L_recucl_176
    s_sub_u32 s50, s50, 1
    s_cbranch_scc0 L_recuagl_180
    s_branch L_exit_recurrent_scan__memory_aug_recurrent_mem_tr__moe_arch_mod__prompt_kernel
    s_branch L_recucl_176
L_recufin_177:
    s_waitcnt lgkmcnt(0)
    s_nop 7
    s_waitcnt vmcnt(0)
    v_mov_b32 v9, 64
    buffer_store_dword v9, off, s[4:7], s41 sc1
    s_waitcnt vmcnt(0)
    s_branch L_exit_recurrent_scan__memory_aug_recurrent_mem_tr__moe_arch_mod__prompt_kernel
L_recub_113:
L_recucl_181:
    s_barrier
    ds_read_b128 v[12:15], v2 offset:0
    ds_read_b128 v[16:19], v2 offset:1024
    ds_read_b128 v[20:23], v2 offset:2048
    s_waitcnt lgkmcnt(2)
    v_smfmac_f32_16x16x64_bf16 v[24:27], v[12:15], a[0:7], v7
    v_mov_b32 v8, s34
    v_smfmac_f32_16x16x64_bf16 v[28:31], v[12:15], v[56:63], v7
    ds_read_b128 v[56:59], v1 offset:20480
    v_smfmac_f32_16x16x64_bf16 v[32:35], v[12:15], a[8:15], v7
    ds_read_b128 v[60:63], v1 offset:21504
    v_smfmac_f32_16x16x64_bf16 v[36:39], v[12:15], v[64:71], v7
    ds_read_b128 v[64:67], v1 offset:22528
    v_smfmac_f32_16x16x64_bf16 v[40:43], v[12:15], a[16:23], v7
    ds_read_b128 v[68:71], v1 offset:23552
    v_smfmac_f32_16x16x64_bf16 v[44:47], v[12:15], a[24:31], v7
    buffer_load_dwordx4 v[48:51], v0, s[4:7], s47 offen offset:0
    ds_read_b128 v[12:15], v2 offset:3072
    s_waitcnt lgkmcnt(6)
    v_smfmac_f32_16x16x64_bf16 v[24:27], v[16:19], a[32:39], v7
    buffer_load_dwordx4 v[52:55], v0, s[4:7], s47 offen offset:1024
    v_smfmac_f32_16x16x64_bf16 v[28:31], v[16:19], v[72:79], v7
    ds_read_b128 v[72:75], v1 offset:24576
    v_smfmac_f32_16x16x64_bf16 v[32:35], v[16:19], a[40:47], v7
    ds_read_b128 v[76:79], v1 offset:25600
    buffer_store_dword v8, off, s[4:7], s41 sc1
    v_smfmac_f32_16x16x64_bf16 v[36:39], v[16:19], v[80:87], v7
    ds_read_b128 v[80:83], v1 offset:26624
    v_smfmac_f32_16x16x64_bf16 v[40:43], v[16:19], a[48:55], v7
    ds_read_b128 v[84:87], v1 offset:27648
    v_smfmac_f32_16x16x64_bf16 v[44:47], v[16:19], a[56:63], v7
    ds_read_b128 v[16:19], v2 offset:4096
    s_waitcnt lgkmcnt(10)
    v_smfmac_f32_16x16x64_bf16 v[24:27], v[20:23], a[64:71], v7
    s_waitcnt lgkmcnt(8)
    v_smfmac_f32_16x16x64_bf16 v[28:31], v[20:23], v[56:63], v7
    ds_read_b128 v[56:59], v1 offset:28672
    v_smfmac_f32_16x16x64_bf16 v[32:35], v[20:23], a[72:79], v7
    ds_read_b128 v[60:63], v1 offset:29696
    s_waitcnt lgkmcnt(8)
    v_smfmac_f32_16x16x64_bf16 v[36:39], v[20:23], v[64:71], v7
    ds_read_b128 v[64:67], v1 offset:30720
    v_smfmac_f32_16x16x64_bf16 v[40:43], v[20:23], a[80:87], v7
    ds_read_b128 v[68:71], v1 offset:31744
    v_smfmac_f32_16x16x64_bf16 v[44:47], v[20:23], a[88:95], v7
    s_waitcnt lgkmcnt(9)
    v_smfmac_f32_16x16x64_bf16 v[24:27], v[12:15], a[96:103], v7
    s_waitcnt lgkmcnt(7)
    v_smfmac_f32_16x16x64_bf16 v[28:31], v[12:15], v[72:79], v7
    ds_read_b128 v[72:75], v1 offset:0
    v_smfmac_f32_16x16x64_bf16 v[32:35], v[12:15], a[104:111], v7
    ds_read_b128 v[76:79], v1 offset:1024
    s_waitcnt lgkmcnt(7)
    v_smfmac_f32_16x16x64_bf16 v[36:39], v[12:15], v[80:87], v7
    ds_read_b128 v[80:83], v1 offset:2048
    s_waitcnt lgkmcnt(7)
    v_smfmac_f32_16x16x64_bf16 v[24:27], v[16:19], a[128:135], v7
    ds_read_b128 v[84:87], v1 offset:3072
    s_waitcnt lgkmcnt(6)
    v_smfmac_f32_16x16x64_bf16 v[28:31], v[16:19], v[56:63], v7
    ds_read_b128 v[56:59], v1 offset:32768
    v_smfmac_f32_16x16x64_bf16 v[32:35], v[16:19], a[136:143], v7
    ds_read_b128 v[60:63], v1 offset:33792
    s_waitcnt lgkmcnt(6)
    v_smfmac_f32_16x16x64_bf16 v[36:39], v[16:19], v[64:71], v7
    s_waitcnt vmcnt(3)
    s_barrier
    ds_read_b128 v[20:23], v2 offset:5120
    v_smfmac_f32_16x16x64_bf16 v[40:43], v[12:15], a[112:119], v7
    v_smfmac_f32_16x16x64_bf16 v[44:47], v[12:15], a[120:127], v7
    ds_read_b128 v[12:15], v2 offset:6144
    v_smfmac_f32_16x16x64_bf16 v[40:43], v[16:19], a[144:151], v7
    v_smfmac_f32_16x16x64_bf16 v[44:47], v[16:19], a[152:159], v7
    ds_read_b128 v[16:19], v2 offset:7168
    s_waitcnt lgkmcnt(2)
    v_smfmac_f32_16x16x64_bf16 v[24:27], v[20:23], a[160:167], v7
    v_smfmac_f32_16x16x64_bf16 v[28:31], v[20:23], v[72:79], v7
    v_smfmac_f32_16x16x64_bf16 v[32:35], v[20:23], a[168:175], v7
    v_smfmac_f32_16x16x64_bf16 v[36:39], v[20:23], v[80:87], v7
    ds_read_b128 v[20:23], v2 offset:8192
    s_waitcnt lgkmcnt(2)
    v_smfmac_f32_16x16x64_bf16 v[24:27], v[12:15], a[192:199], v7
    v_smfmac_f32_16x16x64_bf16 v[28:31], v[12:15], v[56:63], v7
    ds_read_b128 v[72:75], v0 offset:10240
    v_smfmac_f32_16x16x64_bf16 v[32:35], v[12:15], a[200:207], v7
    v_smfmac_f32_16x16x64_bf16 v[36:39], v[12:15], a[208:215], v7
    ds_read_b128 v[76:79], v0 offset:11264
    ds_read_b128 v[12:15], v2 offset:9216
    s_waitcnt lgkmcnt(4)
    v_smfmac_f32_16x16x64_bf16 v[24:27], v[16:19], a[232:239], v7
    v_lshrrev_b32 v71, 9, v0
    v_smfmac_f32_16x16x64_bf16 v[28:31], v[16:19], a[248:255], v7
    ds_read_b128 v[80:83], v0 offset:12288
    v_smfmac_f32_16x16x64_bf16 v[32:35], v[16:19], a[240:247], v7
    v_lshlrev_b32 v71, 3, v71
    v_smfmac_f32_16x16x64_bf16 v[36:39], v[16:19], v[88:95], v7
    ds_read_b128 v[84:87], v0 offset:13312
    s_waitcnt lgkmcnt(5)
    v_smfmac_f32_16x16x64_bf16 v[24:27], v[20:23], v[112:119], v7
    v_lshrrev_b32 v70, 1, v0
    v_smfmac_f32_16x16x64_bf16 v[28:31], v[20:23], v[128:135], v7
    v_xor_b32 v70, v71, v70
    v_smfmac_f32_16x16x64_bf16 v[32:35], v[20:23], v[120:127], v7
    v_xor_b32 v71, 16, v70
    v_smfmac_f32_16x16x64_bf16 v[36:39], v[20:23], v[136:143], v7
    s_waitcnt lgkmcnt(2)
    v_smfmac_f32_16x16x64_bf16 v[24:27], v[12:15], v[160:167], v7
    v_smfmac_f32_16x16x64_bf16 v[28:31], v[12:15], v[176:183], v7
    v_smfmac_f32_16x16x64_bf16 v[32:35], v[12:15], v[168:175], v7
    v_add_f32 v24, v24, v26
    v_smfmac_f32_16x16x64_bf16 v[36:39], v[12:15], v[184:191], v7
    v_add_f32 v25, v25, v27
    v_add_f32 v28, v28, v30
    v_cvt_pk_bf16_f32 v8, v24, v25
    v_add_f32 v29, v29, v31
    v_add_f32 v32, v32, v34
    v_cvt_pk_bf16_f32 v9, v28, v29
    v_add_f32 v33, v33, v35
    ds_write_b64 v3, v[8:9]
    v_pk_add_f32 v[36:37], v[36:37], v[38:39]
    v_cvt_pk_bf16_f32 v10, v32, v33
    v_cvt_pk_bf16_f32 v11, v36, v37
    ds_write_b64 v3, v[10:11] offset:128
    v_smfmac_f32_16x16x64_bf16 v[40:43], v[12:15], v[192:199], v7
    v_smfmac_f32_16x16x64_bf16 v[44:47], v[12:15], v[200:207], v7
    ds_read_b128 v[12:15], v2 offset:6144
    v_smfmac_f32_16x16x64_bf16 v[40:43], v[20:23], v[144:151], v7
    v_smfmac_f32_16x16x64_bf16 v[44:47], v[20:23], v[152:159], v7
    ds_read_b128 v[20:23], v2 offset:5120
    v_smfmac_f32_16x16x64_bf16 v[40:43], v[16:19], v[96:103], v7
    s_waitcnt lgkmcnt(2)
    s_barrier
    ds_read_b64_tr_b16 v[56:57], v70 offset:18432
    ds_read_b64_tr_b16 v[58:59], v71 offset:18944
    v_smfmac_f32_16x16x64_bf16 v[44:47], v[16:19], v[104:111], v7
    ds_read_b64_tr_b16 v[60:61], v70 offset:19456
    ds_read_b64_tr_b16 v[62:63], v71 offset:19968
    s_waitcnt lgkmcnt(5)
    v_smfmac_f32_16x16x64_bf16 v[40:43], v[12:15], a[216:223], v7
    ds_read_b64_tr_b16 v[64:65], v70 offset:20480
    ds_read_b64_tr_b16 v[66:67], v71 offset:20992
    v_smfmac_f32_16x16x64_bf16 v[44:47], v[12:15], a[224:231], v7
    ds_read_b64_tr_b16 v[68:69], v70 offset:21504
    ds_read_b64_tr_b16 v[70:71], v71 offset:22016
    s_waitcnt lgkmcnt(8)
    v_smfmac_f32_16x16x64_bf16 v[40:43], v[20:23], a[176:183], v7
    v_smfmac_f32_16x16x64_bf16 v[44:47], v[20:23], a[184:191], v7
    s_waitcnt lgkmcnt(6)
    v_mfma_f32_16x16x32_bf16 v[28:31], v[72:75], v[56:59], 0
    ds_read_b128 v[72:75], v0 offset:14336
    s_waitcnt lgkmcnt(5)
    v_mfma_f32_16x16x32_bf16 v[28:31], v[76:79], v[60:63], v[28:31]
    ds_read_b128 v[76:79], v0 offset:15360
    s_waitcnt lgkmcnt(4)
    v_mfma_f32_16x16x32_bf16 v[28:31], v[80:83], v[64:67], v[28:31]
    ds_read_b128 v[80:83], v0 offset:16384
    v_add_f32 v40, v40, v42
    s_waitcnt lgkmcnt(3)
    v_mfma_f32_16x16x32_bf16 v[28:31], v[84:87], v[68:71], v[28:31]
    ds_read_b128 v[84:87], v0 offset:17408
    v_add_f32 v44, v44, v46
    v_mfma_f32_16x16x32_bf16 v[24:27], v[56:59], v[56:59], 0
    v_add_f32 v41, v41, v43
    v_add_f32 v45, v45, v47
    v_mfma_f32_16x16x32_bf16 v[24:27], v[60:63], v[60:63], v[24:27]
    v_cvt_pk_bf16_f32 v46, v40, v41
    v_cvt_pk_bf16_f32 v47, v44, v45
    v_mfma_f32_16x16x32_bf16 v[24:27], v[64:67], v[64:67], v[24:27]
    v_lshrrev_b32 v11, 1, v0
    s_cmp_eq_u32 s34, 63
    buffer_store_dwordx2 v[46:47], v11, s[4:7], s40 offen sc1
    s_cbranch_scc1 L_recufin_182
    v_max3_f32 v8, v28, v29, v30
    v_mfma_f32_16x16x32_bf16 v[24:27], v[68:71], v[68:71], v[24:27]
    v_mov_b64 v[12:13], s[70:71]
    v_mov_b64 v[14:15], s[70:71]
    s_waitcnt lgkmcnt(3)
    v_mfma_f32_16x16x32_bf16 v[32:35], v[72:75], v[56:59], 0
    v_add_u32 v10, s49, v0
    v_mov_b64 v[36:37], 0
    s_waitcnt lgkmcnt(2)
    v_mfma_f32_16x16x32_bf16 v[32:35], v[76:79], v[60:63], v[32:35]
    v_max3_f32 v8, v8, v31, v26
    v_mov_b64 v[38:39], 0
    s_waitcnt lgkmcnt(1)
    v_mfma_f32_16x16x32_bf16 v[32:35], v[80:83], v[64:67], v[32:35]
    v_max_f32 v8, v8, v27
    ds_read_b128 v[72:75], v1 offset:8192
    ds_read_b128 v[76:79], v1 offset:9216
    s_waitcnt lgkmcnt(2)
    v_mfma_f32_16x16x32_bf16 v[32:35], v[84:87], v[68:71], v[32:35]
    ds_read_b128 v[80:83], v1 offset:4096
    ds_read_b128 v[84:87], v1 offset:5120
    v_mov_b32 v69, 0
    v_mov_b32 v70, 0
    v_mov_b64 v[40:41], 0
    v_mov_b64 v[42:43], 0
    s_nop 1
    v_max3_f32 v8, v8, v32, v33
    v_max3_f32 v9, v8, v34, v35
    v_max3_f32 v8, v8, v34, v35
    s_nop 1
    v_permlane32_swap_b32 v9, v8
    v_max_f32 v11, v8, v9
    v_max_f32 v8, v8, v9
    s_nop 1
    v_permlane16_swap_b32 v11, v8
    v_max_f32 v8, v8, v11
    v_mul_f32 v8, 0xbe0293ee, v8
    v_pk_fma_f32 v[26:27], v[26:27], s[68:69], v[8:9] op_sel_hi:[1,1,0]
    v_pk_fma_f32 v[28:29], v[28:29], s[68:69], v[8:9] op_sel_hi:[1,1,0]
    v_exp_f32 v26, v26
    v_exp_f32 v27, v27
    v_pk_fma_f32 v[30:31], v[30:31], s[68:69], v[8:9] op_sel_hi:[1,1,0]
    v_exp_f32 v28, v28
    v_pk_fma_f32 v[32:33], v[32:33], s[68:69], v[8:9] op_sel_hi:[1,1,0]
    v_exp_f32 v29, v29
    v_cvt_pk_bf16_f32 v68, v26, v27
    v_pk_fma_f32 v[34:35], v[34:35], s[68:69], v[8:9] op_sel_hi:[1,1,0]
    v_cvt_pk_bf16_f32 v71, v26, v27
    v_exp_f32 v30, v30
    v_mfma_f32_16x16x16_bf16 v[16:19], v[12:13], v[68:69], 0
    v_exp_f32 v31, v31
    v_cvt_pk_bf16_f32 v64, v28, v29
    v_mfma_f32_16x16x16_bf16 v[56:59], v[46:47], v[68:69], 0
    v_exp_f32 v32, v32
    v_exp_f32 v33, v33
    v_mfma_f32_16x16x16_bf16 v[60:63], v[46:47], v[70:71], 0
    v_cvt_pk_bf16_f32 v65, v30, v31
    v_exp_f32 v34, v34
    v_exp_f32 v35, v35
    v_cvt_pk_bf16_f32 v66, v32, v33
    s_waitcnt vmcnt(1)
    v_cvt_pk_bf16_f32 v67, v34, v35
    v_mov_b64 v[24:25], 0
    s_nop 0
    v_mfma_f32_16x16x32_bf16 v[16:19], v[12:15], v[64:67], v[16:19]
    v_mov_b64 v[26:27], 0
    v_mov_b64 v[28:29], 0
    v_mfma_f32_16x16x32_bf16 v[56:59], v[48:51], v[64:67], v[56:59]
    v_mov_b64 v[30:31], 0
    v_mov_b64 v[32:33], 0
    v_mfma_f32_16x16x32_bf16 v[60:63], v[52:55], v[64:67], v[60:63]
    v_mov_b64 v[34:35], 0
    v_rcp_f32 v8, v16
    s_nop 1
    v_pk_mul_f32 v[56:57], v[56:57], v[8:9] op_sel_hi:[1,0]
    v_pk_mul_f32 v[58:59], v[58:59], v[8:9] op_sel_hi:[1,0]
    v_cvt_pk_bf16_f32 v20, v56, v57
    v_cvt_pk_bf16_f32 v21, v58, v59
    v_pk_mul_f32 v[60:61], v[60:61], v[8:9] op_sel_hi:[1,0]
    v_pk_mul_f32 v[62:63], v[62:63], v[8:9] op_sel_hi:[1,0]
    v_cvt_pk_bf16_f32 v22, v60, v61
    v_cvt_pk_bf16_f32 v23, v62, v63
    s_mov_b64 exec, s[64:65]
    ds_write_b128 v10, v[20:23]
    s_mov_b64 exec, -1
    ds_read_b128 v[56:59], v1 offset:6144
    ds_read_b128 v[60:63], v1 offset:7168
    ds_read_b128 v[64:67], v1 offset:10240
    ds_read_b128 v[68:71], v1 offset:11264
    s_waitcnt lgkmcnt(4)
    s_barrier
    ds_read_b128 v[12:15], v0 offset:22528
    ds_read_b128 v[16:19], v0 offset:23552
    s_mov_b32 m0, s51
    s_nop 0
    buffer_load_dwordx4 v0, s[4:7], s39 offen lds
    buffer_load_dwordx4 v0, s[4:7], s39 offen offset:1024 lds
    s_waitcnt lgkmcnt(1)
    v_smfmac_f32_16x16x64_bf16 v[40:43], v[12:15], v[72:79], v7
    s_waitcnt lgkmcnt(0)
    v_smfmac_f32_16x16x64_bf16 v[40:43], v[16:19], v[64:71], v7
    v_smfmac_f32_16x16x64_bf16 v[24:27], v[12:15], v[208:215], v7
    v_smfmac_f32_16x16x64_bf16 v[24:27], v[16:19], v[240:247], v7
    v_add_f32 v40, v40, v42
    v_smfmac_f32_16x16x64_bf16 v[28:31], v[12:15], v[216:223], v7
    v_add_f32 v41, v41, v43
    v_smfmac_f32_16x16x64_bf16 v[28:31], v[16:19], v[248:255], v7
    v_cvt_pk_bf16_f32 v20, v40, v41
    v_smfmac_f32_16x16x64_bf16 v[32:35], v[12:15], v[224:231], v7
    v_bfi_b32 v20, 1, s19, v20
    v_smfmac_f32_16x16x64_bf16 v[32:35], v[16:19], v[80:87], v7
    buffer_store_dword v20, v6, s[4:7], s35 offen sc1
    v_add_f32 v24, v24, v26
    v_smfmac_f32_16x16x64_bf16 v[36:39], v[12:15], v[232:239], v7
    v_add_f32 v25, v25, v27
    v_smfmac_f32_16x16x64_bf16 v[36:39], v[16:19], v[56:63], v7
    v_add_f32 v28, v28, v30
    v_add_f32 v29, v29, v31
    v_cvt_pk_bf16_f32 v8, v24, v25
    v_add_f32 v32, v32, v34
    v_cvt_pk_bf16_f32 v9, v28, v29
    v_add_f32 v33, v33, v35
    v_bfi_b32 v8, 1, s19, v8
    v_cvt_pk_bf16_f32 v10, v32, v33
    v_pk_add_f32 v[36:37], v[36:37], v[38:39]
    v_cvt_pk_bf16_f32 v11, v36, v37
    buffer_store_dwordx4 v[8:11], v5, s[4:7], s35 offen sc1
    s_add_u32 s39, s39, 262144
    s_add_u32 s47, s47, 262144
    s_xor_b32 s35, s35, 262144
    s_add_u32 s40, s40, 65536
    v_mov_b64 v[24:25], 0
    v_mov_b64 v[26:27], 0
    v_mov_b64 v[28:29], 0
    v_mov_b64 v[30:31], 0
    v_mov_b64 v[32:33], 0
    v_mov_b64 v[34:35], 0
    v_mov_b64 v[36:37], 0
    v_mov_b64 v[38:39], 0
    v_mov_b64 v[40:41], 0
    v_mov_b64 v[42:43], 0
    v_mov_b64 v[44:45], 0
    v_mov_b64 v[46:47], 0
    ds_read_b128 v[56:59], v1 offset:12288
    ds_read_b128 v[60:63], v1 offset:13312
    ds_read_b128 v[64:67], v1 offset:14336
    ds_read_b128 v[68:71], v1 offset:15360
    ds_read_b128 v[72:75], v1 offset:16384
    ds_read_b128 v[76:79], v1 offset:17408
    ds_read_b128 v[80:83], v1 offset:18432
    ds_read_b128 v[84:87], v1 offset:19456
    s_mov_b32 m0, s66
    s_add_u32 s34, s34, 1
    s_bfe_u32 s19, s34, 0x10001
    s_mov_b32 s50, 3200000
    s_mov_b32 s30, s37
    s_add_u32 s37, s37, 8192
    s_andn2_b32 s37, s37, 0x8000
    s_waitcnt lgkmcnt(0)
    s_barrier
    s_nop 15
    s_nop 15
    s_nop 15
    s_nop 15
    s_nop 15
    buffer_load_dwordx4 v0, s[4:7], s30 offen offset:0 sc1 lds
    buffer_load_dwordx4 v0, s[4:7], s30 offen offset:1024 sc1 lds
    s_nop 15
    s_nop 15
    s_nop 11
    buffer_load_dwordx4 v0, s[4:7], s30 offen offset:0 sc1 lds
    buffer_load_dwordx4 v0, s[4:7], s30 offen offset:1024 sc1 lds
L_recuagl_185:
    s_waitcnt vmcnt(2)
    ds_read2st64_b32 v[8:9], v4 offset0:12 offset1:16
    buffer_load_dwordx4 v0, s[4:7], s30 offen offset:0 sc1 lds
    buffer_load_dwordx4 v0, s[4:7], s30 offen offset:1024 sc1 lds
    s_waitcnt lgkmcnt(0)
    v_max_u32 v8, v8, v9
    v_cmp_eq_u32 vcc, -1, v8
    s_cbranch_vccz L_recucl_181
    s_waitcnt vmcnt(2)
    ds_read2st64_b32 v[8:9], v4 offset0:12 offset1:16
    buffer_load_dwordx4 v0, s[4:7], s30 offen offset:0 sc1 lds
    buffer_load_dwordx4 v0, s[4:7], s30 offen offset:1024 sc1 lds
    s_waitcnt lgkmcnt(0)
    v_max_u32 v8, v8, v9
    v_cmp_eq_u32 vcc, -1, v8
    s_cbranch_vccz L_recucl_181
    s_sub_u32 s50, s50, 1
    s_cbranch_scc0 L_recuagl_185
    s_branch L_exit_recurrent_scan__memory_aug_recurrent_mem_tr__moe_arch_mod__prompt_kernel
    s_branch L_recucl_181
L_recufin_182:
    s_waitcnt lgkmcnt(0)
    s_nop 7
    s_waitcnt vmcnt(0)
    v_mov_b32 v9, 64
    buffer_store_dword v9, off, s[4:7], s41 sc1
    s_waitcnt vmcnt(0)
    s_branch L_exit_recurrent_scan__memory_aug_recurrent_mem_tr__moe_arch_mod__prompt_kernel
    s_branch L_exit_recurrent_scan__memory_aug_recurrent_mem_tr__moe_arch_mod__prompt_kernel
L_recuwk_2:
    s_sub_u32 s25, s25, 64
    s_waitcnt vmcnt(0)
    s_bitcmp1_b32 s77, 0
    s_cbranch_scc1 L_recuna_186
    s_or_b32 s77, s77, 1
    s_cmp_lg_u32 s24, 0
    s_cbranch_scc1 L_recuna_186
    s_lshr_b32 s26, s2, 3
    s_lshl_b32 s26, 1, s26
    s_lshl_b32 s27, s73, 3
    v_mov_b32 v4, s26
    v_mov_b32 v5, 0x100
    v_mov_b32 v6, 0
    s_mov_b64 exec, 1
    buffer_atomic_add_x2 v[4:5], v6, s[20:23], s27 offen offset:0 sc1
    s_mov_b64 exec, -1
L_recuna_186:
    s_cmp_ge_u32 s25, 96
    s_cselect_b32 s34, 1, 0
    s_mul_i32 s26, s34, 96
    s_sub_u32 s26, s25, s26
    s_lshr_b32 s32, s26, 5
    s_and_b32 s33, s26, 31
    s_cmp_lg_u32 s32, 2
    s_cbranch_scc1 L_recunl_187
    s_lshl_b32 s35, s34, 5
    s_add_u32 s35, s35, s33
    s_load_dwordx2 s[8:9], s[0:1], 0
    s_mov_b32 s10, 0x280000
    s_mov_b32 s11, 0x00020000
    s_load_dwordx2 s[12:13], s[0:1], 64
    s_mov_b32 s14, 0x500
    s_mov_b32 s15, 0x00020000
    v_lshrrev_b32 v4, 3, v0
    v_and_b32 v5, 7, v0
    v_lshlrev_b32 v3, 4, v5
    v_mul_u32_u24 v1, 1280, v4
    v_add_u32 v1, v1, v3
    s_lshl_b32 s26, s35, 2
    s_add_u32 s26, s26, s24
    s_mul_i32 s27, s26, 10240
    v_lshrrev_b32 v6, 1, v5
    v_lshlrev_b32 v6, 10, v6
    v_and_b32 v7, 1, v5
    v_lshlrev_b32 v7, 9, v7
    v_lshlrev_b32 v2, 4, v4
    v_add3_u32 v2, v2, v6, v7
    s_mul_i32 s28, s35, 40960
    s_lshl_b32 s29, s24, 7
    s_add_u32 s28, s28, s29
    s_add_u32 s28, s28, 0
    s_waitcnt lgkmcnt(0)
    buffer_load_dwordx4 v[8:11], v1, s[8:11], s27 offen offset:0
    buffer_load_dwordx4 v[12:15], v1, s[8:11], s27 offen offset:128
    buffer_load_dwordx4 v[16:19], v1, s[8:11], s27 offen offset:256
    buffer_load_dwordx4 v[20:23], v1, s[8:11], s27 offen offset:384
    buffer_load_dwordx4 v[24:27], v1, s[8:11], s27 offen offset:512
    buffer_load_dwordx4 v[28:31], v1, s[8:11], s27 offen offset:640
    buffer_load_dwordx4 v[32:35], v1, s[8:11], s27 offen offset:768
    buffer_load_dwordx4 v[36:39], v1, s[8:11], s27 offen offset:896
    buffer_load_dwordx4 v[40:43], v1, s[8:11], s27 offen offset:1024
    buffer_load_dwordx4 v[44:47], v1, s[8:11], s27 offen offset:1152
    buffer_load_dwordx4 v[140:143], v3, s[12:15], 0 offen offset:0
    buffer_load_dwordx4 v[144:147], v3, s[12:15], 0 offen offset:128
    buffer_load_dwordx4 v[148:151], v3, s[12:15], 0 offen offset:256
    buffer_load_dwordx4 v[152:155], v3, s[12:15], 0 offen offset:384
    buffer_load_dwordx4 v[156:159], v3, s[12:15], 0 offen offset:512
    buffer_load_dwordx4 v[160:163], v3, s[12:15], 0 offen offset:640
    buffer_load_dwordx4 v[164:167], v3, s[12:15], 0 offen offset:768
    buffer_load_dwordx4 v[168:171], v3, s[12:15], 0 offen offset:896
    buffer_load_dwordx4 v[172:175], v3, s[12:15], 0 offen offset:1024
    buffer_load_dwordx4 v[176:179], v3, s[12:15], 0 offen offset:1152
    s_waitcnt vmcnt(19)
    v_lshlrev_b32 v48, 16, v8
    v_and_b32 v49, 0xffff0000, v8
    v_lshlrev_b32 v50, 16, v9
    v_and_b32 v51, 0xffff0000, v9
    v_lshlrev_b32 v52, 16, v10
    v_and_b32 v53, 0xffff0000, v10
    v_lshlrev_b32 v54, 16, v11
    v_and_b32 v55, 0xffff0000, v11
    s_waitcnt vmcnt(18)
    v_lshlrev_b32 v56, 16, v12
    v_and_b32 v57, 0xffff0000, v12
    v_lshlrev_b32 v58, 16, v13
    v_and_b32 v59, 0xffff0000, v13
    v_lshlrev_b32 v60, 16, v14
    v_and_b32 v61, 0xffff0000, v14
    v_lshlrev_b32 v62, 16, v15
    v_and_b32 v63, 0xffff0000, v15
    s_waitcnt vmcnt(17)
    v_lshlrev_b32 v64, 16, v16
    v_and_b32 v65, 0xffff0000, v16
    v_lshlrev_b32 v66, 16, v17
    v_and_b32 v67, 0xffff0000, v17
    v_lshlrev_b32 v68, 16, v18
    v_and_b32 v69, 0xffff0000, v18
    v_lshlrev_b32 v70, 16, v19
    v_and_b32 v71, 0xffff0000, v19
    s_waitcnt vmcnt(16)
    v_lshlrev_b32 v72, 16, v20
    v_and_b32 v73, 0xffff0000, v20
    v_lshlrev_b32 v74, 16, v21
    v_and_b32 v75, 0xffff0000, v21
    v_lshlrev_b32 v76, 16, v22
    v_and_b32 v77, 0xffff0000, v22
    v_lshlrev_b32 v78, 16, v23
    v_and_b32 v79, 0xffff0000, v23
    s_waitcnt vmcnt(15)
    v_lshlrev_b32 v80, 16, v24
    v_and_b32 v81, 0xffff0000, v24
    v_lshlrev_b32 v82, 16, v25
    v_and_b32 v83, 0xffff0000, v25
    v_lshlrev_b32 v84, 16, v26
    v_and_b32 v85, 0xffff0000, v26
    v_lshlrev_b32 v86, 16, v27
    v_and_b32 v87, 0xffff0000, v27
    s_waitcnt vmcnt(14)
    v_lshlrev_b32 v88, 16, v28
    v_and_b32 v89, 0xffff0000, v28
    v_lshlrev_b32 v90, 16, v29
    v_and_b32 v91, 0xffff0000, v29
    v_lshlrev_b32 v92, 16, v30
    v_and_b32 v93, 0xffff0000, v30
    v_lshlrev_b32 v94, 16, v31
    v_and_b32 v95, 0xffff0000, v31
    s_waitcnt vmcnt(13)
    v_lshlrev_b32 v96, 16, v32
    v_and_b32 v97, 0xffff0000, v32
    v_lshlrev_b32 v98, 16, v33
    v_and_b32 v99, 0xffff0000, v33
    v_lshlrev_b32 v100, 16, v34
    v_and_b32 v101, 0xffff0000, v34
    v_lshlrev_b32 v102, 16, v35
    v_and_b32 v103, 0xffff0000, v35
    s_waitcnt vmcnt(12)
    v_lshlrev_b32 v104, 16, v36
    v_and_b32 v105, 0xffff0000, v36
    v_lshlrev_b32 v106, 16, v37
    v_and_b32 v107, 0xffff0000, v37
    v_lshlrev_b32 v108, 16, v38
    v_and_b32 v109, 0xffff0000, v38
    v_lshlrev_b32 v110, 16, v39
    v_and_b32 v111, 0xffff0000, v39
    s_waitcnt vmcnt(11)
    v_lshlrev_b32 v112, 16, v40
    v_and_b32 v113, 0xffff0000, v40
    v_lshlrev_b32 v114, 16, v41
    v_and_b32 v115, 0xffff0000, v41
    v_lshlrev_b32 v116, 16, v42
    v_and_b32 v117, 0xffff0000, v42
    v_lshlrev_b32 v118, 16, v43
    v_and_b32 v119, 0xffff0000, v43
    s_waitcnt vmcnt(10)
    v_lshlrev_b32 v120, 16, v44
    v_and_b32 v121, 0xffff0000, v44
    v_lshlrev_b32 v122, 16, v45
    v_and_b32 v123, 0xffff0000, v45
    v_lshlrev_b32 v124, 16, v46
    v_and_b32 v125, 0xffff0000, v46
    v_lshlrev_b32 v126, 16, v47
    v_and_b32 v127, 0xffff0000, v47
    v_pk_add_f32 v[4:5], v[48:49], v[50:51]
    v_pk_add_f32 v[6:7], v[52:53], v[54:55]
    v_pk_add_f32 v[4:5], v[4:5], v[56:57]
    v_pk_add_f32 v[6:7], v[6:7], v[58:59]
    v_pk_add_f32 v[4:5], v[4:5], v[60:61]
    v_pk_add_f32 v[6:7], v[6:7], v[62:63]
    v_pk_add_f32 v[4:5], v[4:5], v[64:65]
    v_pk_add_f32 v[6:7], v[6:7], v[66:67]
    v_pk_add_f32 v[4:5], v[4:5], v[68:69]
    v_pk_add_f32 v[6:7], v[6:7], v[70:71]
    v_pk_add_f32 v[4:5], v[4:5], v[72:73]
    v_pk_add_f32 v[6:7], v[6:7], v[74:75]
    v_pk_add_f32 v[4:5], v[4:5], v[76:77]
    v_pk_add_f32 v[6:7], v[6:7], v[78:79]
    v_pk_add_f32 v[4:5], v[4:5], v[80:81]
    v_pk_add_f32 v[6:7], v[6:7], v[82:83]
    v_pk_add_f32 v[4:5], v[4:5], v[84:85]
    v_pk_add_f32 v[6:7], v[6:7], v[86:87]
    v_pk_add_f32 v[4:5], v[4:5], v[88:89]
    v_pk_add_f32 v[6:7], v[6:7], v[90:91]
    v_pk_add_f32 v[4:5], v[4:5], v[92:93]
    v_pk_add_f32 v[6:7], v[6:7], v[94:95]
    v_pk_add_f32 v[4:5], v[4:5], v[96:97]
    v_pk_add_f32 v[6:7], v[6:7], v[98:99]
    v_pk_add_f32 v[4:5], v[4:5], v[100:101]
    v_pk_add_f32 v[6:7], v[6:7], v[102:103]
    v_pk_add_f32 v[4:5], v[4:5], v[104:105]
    v_pk_add_f32 v[6:7], v[6:7], v[106:107]
    v_pk_add_f32 v[4:5], v[4:5], v[108:109]
    v_pk_add_f32 v[6:7], v[6:7], v[110:111]
    v_pk_add_f32 v[4:5], v[4:5], v[112:113]
    v_pk_add_f32 v[6:7], v[6:7], v[114:115]
    v_pk_add_f32 v[4:5], v[4:5], v[116:117]
    v_pk_add_f32 v[6:7], v[6:7], v[118:119]
    v_pk_add_f32 v[4:5], v[4:5], v[120:121]
    v_pk_add_f32 v[6:7], v[6:7], v[122:123]
    v_pk_add_f32 v[4:5], v[4:5], v[124:125]
    v_pk_add_f32 v[6:7], v[6:7], v[126:127]
    v_pk_add_f32 v[4:5], v[4:5], v[6:7]
    v_add_f32 v4, v4, v5
    s_nop 1
    v_add_f32_dpp v4, v4, v4 quad_perm:[1,0,3,2] row_mask:0xf bank_mask:0xf
    s_nop 1
    v_add_f32_dpp v4, v4, v4 quad_perm:[2,3,0,1] row_mask:0xf bank_mask:0xf
    s_nop 1
    v_add_f32_dpp v4, v4, v4 row_half_mirror row_mask:0xf bank_mask:0xf
    v_mul_f32 v4, 0x3acccccd, v4
    v_mov_b32 v5, v4
    v_mov_b32 v6, 0
    v_mov_b32 v7, 0
    v_mov_b32 v130, 0
    v_mov_b32 v131, 0
    v_pk_add_f32 v[132:133], v[48:49], v[4:5] neg_lo:[0,1] neg_hi:[0,1]
    v_pk_add_f32 v[134:135], v[50:51], v[4:5] neg_lo:[0,1] neg_hi:[0,1]
    v_pk_fma_f32 v[6:7], v[132:133], v[132:133], v[6:7]
    v_pk_fma_f32 v[130:131], v[134:135], v[134:135], v[130:131]
    v_pk_add_f32 v[132:133], v[52:53], v[4:5] neg_lo:[0,1] neg_hi:[0,1]
    v_pk_add_f32 v[134:135], v[54:55], v[4:5] neg_lo:[0,1] neg_hi:[0,1]
    v_pk_fma_f32 v[6:7], v[132:133], v[132:133], v[6:7]
    v_pk_fma_f32 v[130:131], v[134:135], v[134:135], v[130:131]
    v_pk_add_f32 v[132:133], v[56:57], v[4:5] neg_lo:[0,1] neg_hi:[0,1]
    v_pk_add_f32 v[134:135], v[58:59], v[4:5] neg_lo:[0,1] neg_hi:[0,1]
    v_pk_fma_f32 v[6:7], v[132:133], v[132:133], v[6:7]
    v_pk_fma_f32 v[130:131], v[134:135], v[134:135], v[130:131]
    v_pk_add_f32 v[132:133], v[60:61], v[4:5] neg_lo:[0,1] neg_hi:[0,1]
    v_pk_add_f32 v[134:135], v[62:63], v[4:5] neg_lo:[0,1] neg_hi:[0,1]
    v_pk_fma_f32 v[6:7], v[132:133], v[132:133], v[6:7]
    v_pk_fma_f32 v[130:131], v[134:135], v[134:135], v[130:131]
    v_pk_add_f32 v[132:133], v[64:65], v[4:5] neg_lo:[0,1] neg_hi:[0,1]
    v_pk_add_f32 v[134:135], v[66:67], v[4:5] neg_lo:[0,1] neg_hi:[0,1]
    v_pk_fma_f32 v[6:7], v[132:133], v[132:133], v[6:7]
    v_pk_fma_f32 v[130:131], v[134:135], v[134:135], v[130:131]
    v_pk_add_f32 v[132:133], v[68:69], v[4:5] neg_lo:[0,1] neg_hi:[0,1]
    v_pk_add_f32 v[134:135], v[70:71], v[4:5] neg_lo:[0,1] neg_hi:[0,1]
    v_pk_fma_f32 v[6:7], v[132:133], v[132:133], v[6:7]
    v_pk_fma_f32 v[130:131], v[134:135], v[134:135], v[130:131]
    v_pk_add_f32 v[132:133], v[72:73], v[4:5] neg_lo:[0,1] neg_hi:[0,1]
    v_pk_add_f32 v[134:135], v[74:75], v[4:5] neg_lo:[0,1] neg_hi:[0,1]
    v_pk_fma_f32 v[6:7], v[132:133], v[132:133], v[6:7]
    v_pk_fma_f32 v[130:131], v[134:135], v[134:135], v[130:131]
    v_pk_add_f32 v[132:133], v[76:77], v[4:5] neg_lo:[0,1] neg_hi:[0,1]
    v_pk_add_f32 v[134:135], v[78:79], v[4:5] neg_lo:[0,1] neg_hi:[0,1]
    v_pk_fma_f32 v[6:7], v[132:133], v[132:133], v[6:7]
    v_pk_fma_f32 v[130:131], v[134:135], v[134:135], v[130:131]
    v_pk_add_f32 v[132:133], v[80:81], v[4:5] neg_lo:[0,1] neg_hi:[0,1]
    v_pk_add_f32 v[134:135], v[82:83], v[4:5] neg_lo:[0,1] neg_hi:[0,1]
    v_pk_fma_f32 v[6:7], v[132:133], v[132:133], v[6:7]
    v_pk_fma_f32 v[130:131], v[134:135], v[134:135], v[130:131]
    v_pk_add_f32 v[132:133], v[84:85], v[4:5] neg_lo:[0,1] neg_hi:[0,1]
    v_pk_add_f32 v[134:135], v[86:87], v[4:5] neg_lo:[0,1] neg_hi:[0,1]
    v_pk_fma_f32 v[6:7], v[132:133], v[132:133], v[6:7]
    v_pk_fma_f32 v[130:131], v[134:135], v[134:135], v[130:131]
    v_pk_add_f32 v[132:133], v[88:89], v[4:5] neg_lo:[0,1] neg_hi:[0,1]
    v_pk_add_f32 v[134:135], v[90:91], v[4:5] neg_lo:[0,1] neg_hi:[0,1]
    v_pk_fma_f32 v[6:7], v[132:133], v[132:133], v[6:7]
    v_pk_fma_f32 v[130:131], v[134:135], v[134:135], v[130:131]
    v_pk_add_f32 v[132:133], v[92:93], v[4:5] neg_lo:[0,1] neg_hi:[0,1]
    v_pk_add_f32 v[134:135], v[94:95], v[4:5] neg_lo:[0,1] neg_hi:[0,1]
    v_pk_fma_f32 v[6:7], v[132:133], v[132:133], v[6:7]
    v_pk_fma_f32 v[130:131], v[134:135], v[134:135], v[130:131]
    v_pk_add_f32 v[132:133], v[96:97], v[4:5] neg_lo:[0,1] neg_hi:[0,1]
    v_pk_add_f32 v[134:135], v[98:99], v[4:5] neg_lo:[0,1] neg_hi:[0,1]
    v_pk_fma_f32 v[6:7], v[132:133], v[132:133], v[6:7]
    v_pk_fma_f32 v[130:131], v[134:135], v[134:135], v[130:131]
    v_pk_add_f32 v[132:133], v[100:101], v[4:5] neg_lo:[0,1] neg_hi:[0,1]
    v_pk_add_f32 v[134:135], v[102:103], v[4:5] neg_lo:[0,1] neg_hi:[0,1]
    v_pk_fma_f32 v[6:7], v[132:133], v[132:133], v[6:7]
    v_pk_fma_f32 v[130:131], v[134:135], v[134:135], v[130:131]
    v_pk_add_f32 v[132:133], v[104:105], v[4:5] neg_lo:[0,1] neg_hi:[0,1]
    v_pk_add_f32 v[134:135], v[106:107], v[4:5] neg_lo:[0,1] neg_hi:[0,1]
    v_pk_fma_f32 v[6:7], v[132:133], v[132:133], v[6:7]
    v_pk_fma_f32 v[130:131], v[134:135], v[134:135], v[130:131]
    v_pk_add_f32 v[132:133], v[108:109], v[4:5] neg_lo:[0,1] neg_hi:[0,1]
    v_pk_add_f32 v[134:135], v[110:111], v[4:5] neg_lo:[0,1] neg_hi:[0,1]
    v_pk_fma_f32 v[6:7], v[132:133], v[132:133], v[6:7]
    v_pk_fma_f32 v[130:131], v[134:135], v[134:135], v[130:131]
    v_pk_add_f32 v[132:133], v[112:113], v[4:5] neg_lo:[0,1] neg_hi:[0,1]
    v_pk_add_f32 v[134:135], v[114:115], v[4:5] neg_lo:[0,1] neg_hi:[0,1]
    v_pk_fma_f32 v[6:7], v[132:133], v[132:133], v[6:7]
    v_pk_fma_f32 v[130:131], v[134:135], v[134:135], v[130:131]
    v_pk_add_f32 v[132:133], v[116:117], v[4:5] neg_lo:[0,1] neg_hi:[0,1]
    v_pk_add_f32 v[134:135], v[118:119], v[4:5] neg_lo:[0,1] neg_hi:[0,1]
    v_pk_fma_f32 v[6:7], v[132:133], v[132:133], v[6:7]
    v_pk_fma_f32 v[130:131], v[134:135], v[134:135], v[130:131]
    v_pk_add_f32 v[132:133], v[120:121], v[4:5] neg_lo:[0,1] neg_hi:[0,1]
    v_pk_add_f32 v[134:135], v[122:123], v[4:5] neg_lo:[0,1] neg_hi:[0,1]
    v_pk_fma_f32 v[6:7], v[132:133], v[132:133], v[6:7]
    v_pk_fma_f32 v[130:131], v[134:135], v[134:135], v[130:131]
    v_pk_add_f32 v[132:133], v[124:125], v[4:5] neg_lo:[0,1] neg_hi:[0,1]
    v_pk_add_f32 v[134:135], v[126:127], v[4:5] neg_lo:[0,1] neg_hi:[0,1]
    v_pk_fma_f32 v[6:7], v[132:133], v[132:133], v[6:7]
    v_pk_fma_f32 v[130:131], v[134:135], v[134:135], v[130:131]
    v_pk_add_f32 v[6:7], v[6:7], v[130:131]
    v_add_f32 v6, v6, v7
    s_nop 1
    v_add_f32_dpp v6, v6, v6 quad_perm:[1,0,3,2] row_mask:0xf bank_mask:0xf
    s_nop 1
    v_add_f32_dpp v6, v6, v6 quad_perm:[2,3,0,1] row_mask:0xf bank_mask:0xf
    s_nop 1
    v_add_f32_dpp v6, v6, v6 row_half_mirror row_mask:0xf bank_mask:0xf
    v_mul_f32 v6, 0x3acccccd, v6
    v_cvt_pk_bf16_f32 v4, v4, v6
    v_and_b32 v6, 0xffff0000, v4
    v_lshlrev_b32 v4, 16, v4
    v_add_f32 v6, 0x3727c5ac, v6
    v_cvt_pk_bf16_f32 v6, v6, v6
    v_and_b32 v6, 0xffff0000, v6
    v_sqrt_f32 v6, v6
    v_mov_b32 v5, v4
    v_cvt_pk_bf16_f32 v6, v6, v6
    v_and_b32 v6, 0xffff0000, v6
    v_rcp_f32 v6, v6
    s_nop 0
    v_mov_b32 v7, v6
    v_pk_add_f32 v[48:49], v[48:49], v[4:5] neg_lo:[0,1] neg_hi:[0,1]
    v_cvt_pk_bf16_f32 v8, v48, v49
    v_lshlrev_b32 v48, 16, v8
    v_and_b32 v49, 0xffff0000, v8
    v_pk_mul_f32 v[48:49], v[48:49], v[6:7]
    v_cvt_pk_bf16_f32 v8, v48, v49
    v_pk_add_f32 v[50:51], v[50:51], v[4:5] neg_lo:[0,1] neg_hi:[0,1]
    v_cvt_pk_bf16_f32 v9, v50, v51
    v_lshlrev_b32 v50, 16, v9
    v_and_b32 v51, 0xffff0000, v9
    v_pk_mul_f32 v[50:51], v[50:51], v[6:7]
    v_cvt_pk_bf16_f32 v9, v50, v51
    v_pk_add_f32 v[52:53], v[52:53], v[4:5] neg_lo:[0,1] neg_hi:[0,1]
    v_cvt_pk_bf16_f32 v10, v52, v53
    v_lshlrev_b32 v52, 16, v10
    v_and_b32 v53, 0xffff0000, v10
    v_pk_mul_f32 v[52:53], v[52:53], v[6:7]
    v_cvt_pk_bf16_f32 v10, v52, v53
    v_pk_add_f32 v[54:55], v[54:55], v[4:5] neg_lo:[0,1] neg_hi:[0,1]
    v_cvt_pk_bf16_f32 v11, v54, v55
    v_lshlrev_b32 v54, 16, v11
    v_and_b32 v55, 0xffff0000, v11
    v_pk_mul_f32 v[54:55], v[54:55], v[6:7]
    v_cvt_pk_bf16_f32 v11, v54, v55
    buffer_store_dwordx4 v[8:11], v2, s[4:7], s28 offen sc1
    s_add_u32 s28, s28, 4096
    v_pk_add_f32 v[56:57], v[56:57], v[4:5] neg_lo:[0,1] neg_hi:[0,1]
    v_cvt_pk_bf16_f32 v12, v56, v57
    v_lshlrev_b32 v56, 16, v12
    v_and_b32 v57, 0xffff0000, v12
    v_pk_mul_f32 v[56:57], v[56:57], v[6:7]
    v_cvt_pk_bf16_f32 v12, v56, v57
    v_pk_add_f32 v[58:59], v[58:59], v[4:5] neg_lo:[0,1] neg_hi:[0,1]
    v_cvt_pk_bf16_f32 v13, v58, v59
    v_lshlrev_b32 v58, 16, v13
    v_and_b32 v59, 0xffff0000, v13
    v_pk_mul_f32 v[58:59], v[58:59], v[6:7]
    v_cvt_pk_bf16_f32 v13, v58, v59
    v_pk_add_f32 v[60:61], v[60:61], v[4:5] neg_lo:[0,1] neg_hi:[0,1]
    v_cvt_pk_bf16_f32 v14, v60, v61
    v_lshlrev_b32 v60, 16, v14
    v_and_b32 v61, 0xffff0000, v14
    v_pk_mul_f32 v[60:61], v[60:61], v[6:7]
    v_cvt_pk_bf16_f32 v14, v60, v61
    v_pk_add_f32 v[62:63], v[62:63], v[4:5] neg_lo:[0,1] neg_hi:[0,1]
    v_cvt_pk_bf16_f32 v15, v62, v63
    v_lshlrev_b32 v62, 16, v15
    v_and_b32 v63, 0xffff0000, v15
    v_pk_mul_f32 v[62:63], v[62:63], v[6:7]
    v_cvt_pk_bf16_f32 v15, v62, v63
    buffer_store_dwordx4 v[12:15], v2, s[4:7], s28 offen sc1
    s_add_u32 s28, s28, 4096
    v_pk_add_f32 v[64:65], v[64:65], v[4:5] neg_lo:[0,1] neg_hi:[0,1]
    v_cvt_pk_bf16_f32 v16, v64, v65
    v_lshlrev_b32 v64, 16, v16
    v_and_b32 v65, 0xffff0000, v16
    v_pk_mul_f32 v[64:65], v[64:65], v[6:7]
    v_cvt_pk_bf16_f32 v16, v64, v65
    v_pk_add_f32 v[66:67], v[66:67], v[4:5] neg_lo:[0,1] neg_hi:[0,1]
    v_cvt_pk_bf16_f32 v17, v66, v67
    v_lshlrev_b32 v66, 16, v17
    v_and_b32 v67, 0xffff0000, v17
    v_pk_mul_f32 v[66:67], v[66:67], v[6:7]
    v_cvt_pk_bf16_f32 v17, v66, v67
    v_pk_add_f32 v[68:69], v[68:69], v[4:5] neg_lo:[0,1] neg_hi:[0,1]
    v_cvt_pk_bf16_f32 v18, v68, v69
    v_lshlrev_b32 v68, 16, v18
    v_and_b32 v69, 0xffff0000, v18
    v_pk_mul_f32 v[68:69], v[68:69], v[6:7]
    v_cvt_pk_bf16_f32 v18, v68, v69
    v_pk_add_f32 v[70:71], v[70:71], v[4:5] neg_lo:[0,1] neg_hi:[0,1]
    v_cvt_pk_bf16_f32 v19, v70, v71
    v_lshlrev_b32 v70, 16, v19
    v_and_b32 v71, 0xffff0000, v19
    v_pk_mul_f32 v[70:71], v[70:71], v[6:7]
    v_cvt_pk_bf16_f32 v19, v70, v71
    buffer_store_dwordx4 v[16:19], v2, s[4:7], s28 offen sc1
    s_add_u32 s28, s28, 4096
    v_pk_add_f32 v[72:73], v[72:73], v[4:5] neg_lo:[0,1] neg_hi:[0,1]
    v_cvt_pk_bf16_f32 v20, v72, v73
    v_lshlrev_b32 v72, 16, v20
    v_and_b32 v73, 0xffff0000, v20
    v_pk_mul_f32 v[72:73], v[72:73], v[6:7]
    v_cvt_pk_bf16_f32 v20, v72, v73
    v_pk_add_f32 v[74:75], v[74:75], v[4:5] neg_lo:[0,1] neg_hi:[0,1]
    v_cvt_pk_bf16_f32 v21, v74, v75
    v_lshlrev_b32 v74, 16, v21
    v_and_b32 v75, 0xffff0000, v21
    v_pk_mul_f32 v[74:75], v[74:75], v[6:7]
    v_cvt_pk_bf16_f32 v21, v74, v75
    v_pk_add_f32 v[76:77], v[76:77], v[4:5] neg_lo:[0,1] neg_hi:[0,1]
    v_cvt_pk_bf16_f32 v22, v76, v77
    v_lshlrev_b32 v76, 16, v22
    v_and_b32 v77, 0xffff0000, v22
    v_pk_mul_f32 v[76:77], v[76:77], v[6:7]
    v_cvt_pk_bf16_f32 v22, v76, v77
    v_pk_add_f32 v[78:79], v[78:79], v[4:5] neg_lo:[0,1] neg_hi:[0,1]
    v_cvt_pk_bf16_f32 v23, v78, v79
    v_lshlrev_b32 v78, 16, v23
    v_and_b32 v79, 0xffff0000, v23
    v_pk_mul_f32 v[78:79], v[78:79], v[6:7]
    v_cvt_pk_bf16_f32 v23, v78, v79
    buffer_store_dwordx4 v[20:23], v2, s[4:7], s28 offen sc1
    s_add_u32 s28, s28, 4096
    v_pk_add_f32 v[80:81], v[80:81], v[4:5] neg_lo:[0,1] neg_hi:[0,1]
    v_cvt_pk_bf16_f32 v24, v80, v81
    v_lshlrev_b32 v80, 16, v24
    v_and_b32 v81, 0xffff0000, v24
    v_pk_mul_f32 v[80:81], v[80:81], v[6:7]
    v_cvt_pk_bf16_f32 v24, v80, v81
    v_pk_add_f32 v[82:83], v[82:83], v[4:5] neg_lo:[0,1] neg_hi:[0,1]
    v_cvt_pk_bf16_f32 v25, v82, v83
    v_lshlrev_b32 v82, 16, v25
    v_and_b32 v83, 0xffff0000, v25
    v_pk_mul_f32 v[82:83], v[82:83], v[6:7]
    v_cvt_pk_bf16_f32 v25, v82, v83
    v_pk_add_f32 v[84:85], v[84:85], v[4:5] neg_lo:[0,1] neg_hi:[0,1]
    v_cvt_pk_bf16_f32 v26, v84, v85
    v_lshlrev_b32 v84, 16, v26
    v_and_b32 v85, 0xffff0000, v26
    v_pk_mul_f32 v[84:85], v[84:85], v[6:7]
    v_cvt_pk_bf16_f32 v26, v84, v85
    v_pk_add_f32 v[86:87], v[86:87], v[4:5] neg_lo:[0,1] neg_hi:[0,1]
    v_cvt_pk_bf16_f32 v27, v86, v87
    v_lshlrev_b32 v86, 16, v27
    v_and_b32 v87, 0xffff0000, v27
    v_pk_mul_f32 v[86:87], v[86:87], v[6:7]
    v_cvt_pk_bf16_f32 v27, v86, v87
    buffer_store_dwordx4 v[24:27], v2, s[4:7], s28 offen sc1
    s_add_u32 s28, s28, 4096
    v_pk_add_f32 v[88:89], v[88:89], v[4:5] neg_lo:[0,1] neg_hi:[0,1]
    v_cvt_pk_bf16_f32 v28, v88, v89
    v_lshlrev_b32 v88, 16, v28
    v_and_b32 v89, 0xffff0000, v28
    v_pk_mul_f32 v[88:89], v[88:89], v[6:7]
    v_cvt_pk_bf16_f32 v28, v88, v89
    v_pk_add_f32 v[90:91], v[90:91], v[4:5] neg_lo:[0,1] neg_hi:[0,1]
    v_cvt_pk_bf16_f32 v29, v90, v91
    v_lshlrev_b32 v90, 16, v29
    v_and_b32 v91, 0xffff0000, v29
    v_pk_mul_f32 v[90:91], v[90:91], v[6:7]
    v_cvt_pk_bf16_f32 v29, v90, v91
    v_pk_add_f32 v[92:93], v[92:93], v[4:5] neg_lo:[0,1] neg_hi:[0,1]
    v_cvt_pk_bf16_f32 v30, v92, v93
    v_lshlrev_b32 v92, 16, v30
    v_and_b32 v93, 0xffff0000, v30
    v_pk_mul_f32 v[92:93], v[92:93], v[6:7]
    v_cvt_pk_bf16_f32 v30, v92, v93
    v_pk_add_f32 v[94:95], v[94:95], v[4:5] neg_lo:[0,1] neg_hi:[0,1]
    v_cvt_pk_bf16_f32 v31, v94, v95
    v_lshlrev_b32 v94, 16, v31
    v_and_b32 v95, 0xffff0000, v31
    v_pk_mul_f32 v[94:95], v[94:95], v[6:7]
    v_cvt_pk_bf16_f32 v31, v94, v95
    buffer_store_dwordx4 v[28:31], v2, s[4:7], s28 offen sc1
    s_add_u32 s28, s28, 4096
    v_pk_add_f32 v[96:97], v[96:97], v[4:5] neg_lo:[0,1] neg_hi:[0,1]
    v_cvt_pk_bf16_f32 v32, v96, v97
    v_lshlrev_b32 v96, 16, v32
    v_and_b32 v97, 0xffff0000, v32
    v_pk_mul_f32 v[96:97], v[96:97], v[6:7]
    v_cvt_pk_bf16_f32 v32, v96, v97
    v_pk_add_f32 v[98:99], v[98:99], v[4:5] neg_lo:[0,1] neg_hi:[0,1]
    v_cvt_pk_bf16_f32 v33, v98, v99
    v_lshlrev_b32 v98, 16, v33
    v_and_b32 v99, 0xffff0000, v33
    v_pk_mul_f32 v[98:99], v[98:99], v[6:7]
    v_cvt_pk_bf16_f32 v33, v98, v99
    v_pk_add_f32 v[100:101], v[100:101], v[4:5] neg_lo:[0,1] neg_hi:[0,1]
    v_cvt_pk_bf16_f32 v34, v100, v101
    v_lshlrev_b32 v100, 16, v34
    v_and_b32 v101, 0xffff0000, v34
    v_pk_mul_f32 v[100:101], v[100:101], v[6:7]
    v_cvt_pk_bf16_f32 v34, v100, v101
    v_pk_add_f32 v[102:103], v[102:103], v[4:5] neg_lo:[0,1] neg_hi:[0,1]
    v_cvt_pk_bf16_f32 v35, v102, v103
    v_lshlrev_b32 v102, 16, v35
    v_and_b32 v103, 0xffff0000, v35
    v_pk_mul_f32 v[102:103], v[102:103], v[6:7]
    v_cvt_pk_bf16_f32 v35, v102, v103
    buffer_store_dwordx4 v[32:35], v2, s[4:7], s28 offen sc1
    s_add_u32 s28, s28, 4096
    v_pk_add_f32 v[104:105], v[104:105], v[4:5] neg_lo:[0,1] neg_hi:[0,1]
    v_cvt_pk_bf16_f32 v36, v104, v105
    v_lshlrev_b32 v104, 16, v36
    v_and_b32 v105, 0xffff0000, v36
    v_pk_mul_f32 v[104:105], v[104:105], v[6:7]
    v_cvt_pk_bf16_f32 v36, v104, v105
    v_pk_add_f32 v[106:107], v[106:107], v[4:5] neg_lo:[0,1] neg_hi:[0,1]
    v_cvt_pk_bf16_f32 v37, v106, v107
    v_lshlrev_b32 v106, 16, v37
    v_and_b32 v107, 0xffff0000, v37
    v_pk_mul_f32 v[106:107], v[106:107], v[6:7]
    v_cvt_pk_bf16_f32 v37, v106, v107
    v_pk_add_f32 v[108:109], v[108:109], v[4:5] neg_lo:[0,1] neg_hi:[0,1]
    v_cvt_pk_bf16_f32 v38, v108, v109
    v_lshlrev_b32 v108, 16, v38
    v_and_b32 v109, 0xffff0000, v38
    v_pk_mul_f32 v[108:109], v[108:109], v[6:7]
    v_cvt_pk_bf16_f32 v38, v108, v109
    v_pk_add_f32 v[110:111], v[110:111], v[4:5] neg_lo:[0,1] neg_hi:[0,1]
    v_cvt_pk_bf16_f32 v39, v110, v111
    v_lshlrev_b32 v110, 16, v39
    v_and_b32 v111, 0xffff0000, v39
    v_pk_mul_f32 v[110:111], v[110:111], v[6:7]
    v_cvt_pk_bf16_f32 v39, v110, v111
    buffer_store_dwordx4 v[36:39], v2, s[4:7], s28 offen sc1
    s_add_u32 s28, s28, 4096
    v_pk_add_f32 v[112:113], v[112:113], v[4:5] neg_lo:[0,1] neg_hi:[0,1]
    v_cvt_pk_bf16_f32 v40, v112, v113
    v_lshlrev_b32 v112, 16, v40
    v_and_b32 v113, 0xffff0000, v40
    v_pk_mul_f32 v[112:113], v[112:113], v[6:7]
    v_cvt_pk_bf16_f32 v40, v112, v113
    v_pk_add_f32 v[114:115], v[114:115], v[4:5] neg_lo:[0,1] neg_hi:[0,1]
    v_cvt_pk_bf16_f32 v41, v114, v115
    v_lshlrev_b32 v114, 16, v41
    v_and_b32 v115, 0xffff0000, v41
    v_pk_mul_f32 v[114:115], v[114:115], v[6:7]
    v_cvt_pk_bf16_f32 v41, v114, v115
    v_pk_add_f32 v[116:117], v[116:117], v[4:5] neg_lo:[0,1] neg_hi:[0,1]
    v_cvt_pk_bf16_f32 v42, v116, v117
    v_lshlrev_b32 v116, 16, v42
    v_and_b32 v117, 0xffff0000, v42
    v_pk_mul_f32 v[116:117], v[116:117], v[6:7]
    v_cvt_pk_bf16_f32 v42, v116, v117
    v_pk_add_f32 v[118:119], v[118:119], v[4:5] neg_lo:[0,1] neg_hi:[0,1]
    v_cvt_pk_bf16_f32 v43, v118, v119
    v_lshlrev_b32 v118, 16, v43
    v_and_b32 v119, 0xffff0000, v43
    v_pk_mul_f32 v[118:119], v[118:119], v[6:7]
    v_cvt_pk_bf16_f32 v43, v118, v119
    buffer_store_dwordx4 v[40:43], v2, s[4:7], s28 offen sc1
    s_add_u32 s28, s28, 4096
    v_pk_add_f32 v[120:121], v[120:121], v[4:5] neg_lo:[0,1] neg_hi:[0,1]
    v_cvt_pk_bf16_f32 v44, v120, v121
    v_lshlrev_b32 v120, 16, v44
    v_and_b32 v121, 0xffff0000, v44
    v_pk_mul_f32 v[120:121], v[120:121], v[6:7]
    v_cvt_pk_bf16_f32 v44, v120, v121
    v_pk_add_f32 v[122:123], v[122:123], v[4:5] neg_lo:[0,1] neg_hi:[0,1]
    v_cvt_pk_bf16_f32 v45, v122, v123
    v_lshlrev_b32 v122, 16, v45
    v_and_b32 v123, 0xffff0000, v45
    v_pk_mul_f32 v[122:123], v[122:123], v[6:7]
    v_cvt_pk_bf16_f32 v45, v122, v123
    v_pk_add_f32 v[124:125], v[124:125], v[4:5] neg_lo:[0,1] neg_hi:[0,1]
    v_cvt_pk_bf16_f32 v46, v124, v125
    v_lshlrev_b32 v124, 16, v46
    v_and_b32 v125, 0xffff0000, v46
    v_pk_mul_f32 v[124:125], v[124:125], v[6:7]
    v_cvt_pk_bf16_f32 v46, v124, v125
    v_pk_add_f32 v[126:127], v[126:127], v[4:5] neg_lo:[0,1] neg_hi:[0,1]
    v_cvt_pk_bf16_f32 v47, v126, v127
    v_lshlrev_b32 v126, 16, v47
    v_and_b32 v127, 0xffff0000, v47
    v_pk_mul_f32 v[126:127], v[126:127], v[6:7]
    v_cvt_pk_bf16_f32 v47, v126, v127
    buffer_store_dwordx4 v[44:47], v2, s[4:7], s28 offen sc1
    s_lshl_b32 s29, s35, 7
    s_lshl_b32 s30, s24, 2
    s_add_u32 s29, s29, s30
    s_add_u32 s29, s29, 5373952
    s_bitcmp1_b32 s77, 1
    s_cbranch_scc1 L_recuvtr_191
    v_lshlrev_b32 v4, 2, v0
    v_and_b32 v4, 60, v4
    s_mov_b32 s72, 0
L_recuvf_188:
    buffer_load_dword v5, v4, s[20:23], 0 offen offset:0 sc1
L_recuvok_189:
    s_waitcnt vmcnt(0)
    v_lshrrev_b32 v6, 8, v5
    s_nop 1
    v_add_u32_dpp v6, v6, v6 quad_perm:[2,3,0,1] row_mask:0xf bank_mask:0xf
    s_nop 1
    v_add_u32_dpp v6, v6, v6 row_ror:4 row_mask:0xf bank_mask:0xf
    s_nop 1
    v_add_u32_dpp v6, v6, v6 row_ror:8 row_mask:0xf bank_mask:0xf
    s_nop 0
    v_readlane_b32 s70, v6, 1
    s_cmp_ge_u32 s70, 0x100
    s_cbranch_scc1 L_recuvfu_190
    s_add_u32 s72, s72, 1
    s_cmp_lt_u32 s72, 400000
    s_cbranch_scc1 L_recuvf_188
    s_branch L_exit_recurrent_scan__memory_aug_recurrent_mem_tr__moe_arch_mod__prompt_kernel
L_recuvfu_190:
    s_cmp_gt_u32 s70, 0x100
    s_cbranch_scc1 L_exit_recurrent_scan__memory_aug_recurrent_mem_tr__moe_arch_mod__prompt_kernel
    v_mov_b32 v6, 0x2000
    v_bfe_u32 v4, v4, 2, 1
    v_cmp_eq_u32 vcc, 1, v4
    s_nop 1
    v_cndmask_b32 v6, -1, v6, vcc
    v_cmp_ne_u32 vcc, v5, v6
    s_cbranch_vccnz L_gen_recurrent_scan__memory_aug_recurrent_mem_tr__moe_arch_mod__prompt_kernel
    s_or_b32 s77, s77, 2
L_recuvtr_191:
    s_waitcnt vmcnt(0)
    v_mov_b32 v4, 1
    v_mov_b32 v5, 0
    buffer_store_dword v4, v5, s[4:7], s29 offen sc1
    v_mov_b32 v4, 0
    v_mov_b32 v5, 0
    s_add_u32 s31, s27, 2621440
    v_lshlrev_b32 v48, 16, v8
    v_and_b32 v49, 0xffff0000, v8
    v_lshlrev_b32 v50, 16, v9
    v_and_b32 v51, 0xffff0000, v9
    v_lshlrev_b32 v52, 16, v10
    v_and_b32 v53, 0xffff0000, v10
    v_lshlrev_b32 v54, 16, v11
    v_and_b32 v55, 0xffff0000, v11
    v_lshlrev_b32 v136, 16, v140
    v_and_b32 v137, 0xffff0000, v140
    v_pk_fma_f32 v[4:5], v[48:49], v[136:137], v[4:5]
    v_lshlrev_b32 v136, 16, v141
    v_and_b32 v137, 0xffff0000, v141
    v_pk_fma_f32 v[4:5], v[50:51], v[136:137], v[4:5]
    v_lshlrev_b32 v136, 16, v142
    v_and_b32 v137, 0xffff0000, v142
    v_pk_fma_f32 v[4:5], v[52:53], v[136:137], v[4:5]
    v_lshlrev_b32 v136, 16, v143
    v_and_b32 v137, 0xffff0000, v143
    v_pk_fma_f32 v[4:5], v[54:55], v[136:137], v[4:5]
    v_mul_f32 v56, 0xbfb8aa3b, v48
    v_exp_f32 v56, v56
    s_nop 0
    v_add_f32 v56, 1.0, v56
    v_rcp_f32 v56, v56
    s_nop 0
    v_mul_f32 v48, v48, v56
    v_mul_f32 v57, 0xbfb8aa3b, v49
    v_exp_f32 v57, v57
    s_nop 0
    v_add_f32 v57, 1.0, v57
    v_rcp_f32 v57, v57
    s_nop 0
    v_mul_f32 v49, v49, v57
    v_mul_f32 v58, 0xbfb8aa3b, v50
    v_exp_f32 v58, v58
    s_nop 0
    v_add_f32 v58, 1.0, v58
    v_rcp_f32 v58, v58
    s_nop 0
    v_mul_f32 v50, v50, v58
    v_mul_f32 v59, 0xbfb8aa3b, v51
    v_exp_f32 v59, v59
    s_nop 0
    v_add_f32 v59, 1.0, v59
    v_rcp_f32 v59, v59
    s_nop 0
    v_mul_f32 v51, v51, v59
    v_mul_f32 v60, 0xbfb8aa3b, v52
    v_exp_f32 v60, v60
    s_nop 0
    v_add_f32 v60, 1.0, v60
    v_rcp_f32 v60, v60
    s_nop 0
    v_mul_f32 v52, v52, v60
    v_mul_f32 v61, 0xbfb8aa3b, v53
    v_exp_f32 v61, v61
    s_nop 0
    v_add_f32 v61, 1.0, v61
    v_rcp_f32 v61, v61
    s_nop 0
    v_mul_f32 v53, v53, v61
    v_mul_f32 v62, 0xbfb8aa3b, v54
    v_exp_f32 v62, v62
    s_nop 0
    v_add_f32 v62, 1.0, v62
    v_rcp_f32 v62, v62
    s_nop 0
    v_mul_f32 v54, v54, v62
    v_mul_f32 v63, 0xbfb8aa3b, v55
    v_exp_f32 v63, v63
    s_nop 0
    v_add_f32 v63, 1.0, v63
    v_rcp_f32 v63, v63
    s_nop 0
    v_mul_f32 v55, v55, v63
    v_cvt_pk_bf16_f32 v64, v48, v49
    v_cvt_pk_bf16_f32 v65, v50, v51
    v_cvt_pk_bf16_f32 v66, v52, v53
    v_cvt_pk_bf16_f32 v67, v54, v55
    buffer_store_dwordx4 v[64:67], v1, s[4:7], s31 offen offset:0 sc1
    v_lshlrev_b32 v48, 16, v12
    v_and_b32 v49, 0xffff0000, v12
    v_lshlrev_b32 v50, 16, v13
    v_and_b32 v51, 0xffff0000, v13
    v_lshlrev_b32 v52, 16, v14
    v_and_b32 v53, 0xffff0000, v14
    v_lshlrev_b32 v54, 16, v15
    v_and_b32 v55, 0xffff0000, v15
    v_lshlrev_b32 v136, 16, v144
    v_and_b32 v137, 0xffff0000, v144
    v_pk_fma_f32 v[4:5], v[48:49], v[136:137], v[4:5]
    v_lshlrev_b32 v136, 16, v145
    v_and_b32 v137, 0xffff0000, v145
    v_pk_fma_f32 v[4:5], v[50:51], v[136:137], v[4:5]
    v_lshlrev_b32 v136, 16, v146
    v_and_b32 v137, 0xffff0000, v146
    v_pk_fma_f32 v[4:5], v[52:53], v[136:137], v[4:5]
    v_lshlrev_b32 v136, 16, v147
    v_and_b32 v137, 0xffff0000, v147
    v_pk_fma_f32 v[4:5], v[54:55], v[136:137], v[4:5]
    v_mul_f32 v56, 0xbfb8aa3b, v48
    v_exp_f32 v56, v56
    s_nop 0
    v_add_f32 v56, 1.0, v56
    v_rcp_f32 v56, v56
    s_nop 0
    v_mul_f32 v48, v48, v56
    v_mul_f32 v57, 0xbfb8aa3b, v49
    v_exp_f32 v57, v57
    s_nop 0
    v_add_f32 v57, 1.0, v57
    v_rcp_f32 v57, v57
    s_nop 0
    v_mul_f32 v49, v49, v57
    v_mul_f32 v58, 0xbfb8aa3b, v50
    v_exp_f32 v58, v58
    s_nop 0
    v_add_f32 v58, 1.0, v58
    v_rcp_f32 v58, v58
    s_nop 0
    v_mul_f32 v50, v50, v58
    v_mul_f32 v59, 0xbfb8aa3b, v51
    v_exp_f32 v59, v59
    s_nop 0
    v_add_f32 v59, 1.0, v59
    v_rcp_f32 v59, v59
    s_nop 0
    v_mul_f32 v51, v51, v59
    v_mul_f32 v60, 0xbfb8aa3b, v52
    v_exp_f32 v60, v60
    s_nop 0
    v_add_f32 v60, 1.0, v60
    v_rcp_f32 v60, v60
    s_nop 0
    v_mul_f32 v52, v52, v60
    v_mul_f32 v61, 0xbfb8aa3b, v53
    v_exp_f32 v61, v61
    s_nop 0
    v_add_f32 v61, 1.0, v61
    v_rcp_f32 v61, v61
    s_nop 0
    v_mul_f32 v53, v53, v61
    v_mul_f32 v62, 0xbfb8aa3b, v54
    v_exp_f32 v62, v62
    s_nop 0
    v_add_f32 v62, 1.0, v62
    v_rcp_f32 v62, v62
    s_nop 0
    v_mul_f32 v54, v54, v62
    v_mul_f32 v63, 0xbfb8aa3b, v55
    v_exp_f32 v63, v63
    s_nop 0
    v_add_f32 v63, 1.0, v63
    v_rcp_f32 v63, v63
    s_nop 0
    v_mul_f32 v55, v55, v63
    v_cvt_pk_bf16_f32 v64, v48, v49
    v_cvt_pk_bf16_f32 v65, v50, v51
    v_cvt_pk_bf16_f32 v66, v52, v53
    v_cvt_pk_bf16_f32 v67, v54, v55
    buffer_store_dwordx4 v[64:67], v1, s[4:7], s31 offen offset:128 sc1
    v_lshlrev_b32 v48, 16, v16
    v_and_b32 v49, 0xffff0000, v16
    v_lshlrev_b32 v50, 16, v17
    v_and_b32 v51, 0xffff0000, v17
    v_lshlrev_b32 v52, 16, v18
    v_and_b32 v53, 0xffff0000, v18
    v_lshlrev_b32 v54, 16, v19
    v_and_b32 v55, 0xffff0000, v19
    v_lshlrev_b32 v136, 16, v148
    v_and_b32 v137, 0xffff0000, v148
    v_pk_fma_f32 v[4:5], v[48:49], v[136:137], v[4:5]
    v_lshlrev_b32 v136, 16, v149
    v_and_b32 v137, 0xffff0000, v149
    v_pk_fma_f32 v[4:5], v[50:51], v[136:137], v[4:5]
    v_lshlrev_b32 v136, 16, v150
    v_and_b32 v137, 0xffff0000, v150
    v_pk_fma_f32 v[4:5], v[52:53], v[136:137], v[4:5]
    v_lshlrev_b32 v136, 16, v151
    v_and_b32 v137, 0xffff0000, v151
    v_pk_fma_f32 v[4:5], v[54:55], v[136:137], v[4:5]
    v_mul_f32 v56, 0xbfb8aa3b, v48
    v_exp_f32 v56, v56
    s_nop 0
    v_add_f32 v56, 1.0, v56
    v_rcp_f32 v56, v56
    s_nop 0
    v_mul_f32 v48, v48, v56
    v_mul_f32 v57, 0xbfb8aa3b, v49
    v_exp_f32 v57, v57
    s_nop 0
    v_add_f32 v57, 1.0, v57
    v_rcp_f32 v57, v57
    s_nop 0
    v_mul_f32 v49, v49, v57
    v_mul_f32 v58, 0xbfb8aa3b, v50
    v_exp_f32 v58, v58
    s_nop 0
    v_add_f32 v58, 1.0, v58
    v_rcp_f32 v58, v58
    s_nop 0
    v_mul_f32 v50, v50, v58
    v_mul_f32 v59, 0xbfb8aa3b, v51
    v_exp_f32 v59, v59
    s_nop 0
    v_add_f32 v59, 1.0, v59
    v_rcp_f32 v59, v59
    s_nop 0
    v_mul_f32 v51, v51, v59
    v_mul_f32 v60, 0xbfb8aa3b, v52
    v_exp_f32 v60, v60
    s_nop 0
    v_add_f32 v60, 1.0, v60
    v_rcp_f32 v60, v60
    s_nop 0
    v_mul_f32 v52, v52, v60
    v_mul_f32 v61, 0xbfb8aa3b, v53
    v_exp_f32 v61, v61
    s_nop 0
    v_add_f32 v61, 1.0, v61
    v_rcp_f32 v61, v61
    s_nop 0
    v_mul_f32 v53, v53, v61
    v_mul_f32 v62, 0xbfb8aa3b, v54
    v_exp_f32 v62, v62
    s_nop 0
    v_add_f32 v62, 1.0, v62
    v_rcp_f32 v62, v62
    s_nop 0
    v_mul_f32 v54, v54, v62
    v_mul_f32 v63, 0xbfb8aa3b, v55
    v_exp_f32 v63, v63
    s_nop 0
    v_add_f32 v63, 1.0, v63
    v_rcp_f32 v63, v63
    s_nop 0
    v_mul_f32 v55, v55, v63
    v_cvt_pk_bf16_f32 v64, v48, v49
    v_cvt_pk_bf16_f32 v65, v50, v51
    v_cvt_pk_bf16_f32 v66, v52, v53
    v_cvt_pk_bf16_f32 v67, v54, v55
    buffer_store_dwordx4 v[64:67], v1, s[4:7], s31 offen offset:256 sc1
    v_lshlrev_b32 v48, 16, v20
    v_and_b32 v49, 0xffff0000, v20
    v_lshlrev_b32 v50, 16, v21
    v_and_b32 v51, 0xffff0000, v21
    v_lshlrev_b32 v52, 16, v22
    v_and_b32 v53, 0xffff0000, v22
    v_lshlrev_b32 v54, 16, v23
    v_and_b32 v55, 0xffff0000, v23
    v_lshlrev_b32 v136, 16, v152
    v_and_b32 v137, 0xffff0000, v152
    v_pk_fma_f32 v[4:5], v[48:49], v[136:137], v[4:5]
    v_lshlrev_b32 v136, 16, v153
    v_and_b32 v137, 0xffff0000, v153
    v_pk_fma_f32 v[4:5], v[50:51], v[136:137], v[4:5]
    v_lshlrev_b32 v136, 16, v154
    v_and_b32 v137, 0xffff0000, v154
    v_pk_fma_f32 v[4:5], v[52:53], v[136:137], v[4:5]
    v_lshlrev_b32 v136, 16, v155
    v_and_b32 v137, 0xffff0000, v155
    v_pk_fma_f32 v[4:5], v[54:55], v[136:137], v[4:5]
    v_mul_f32 v56, 0xbfb8aa3b, v48
    v_exp_f32 v56, v56
    s_nop 0
    v_add_f32 v56, 1.0, v56
    v_rcp_f32 v56, v56
    s_nop 0
    v_mul_f32 v48, v48, v56
    v_mul_f32 v57, 0xbfb8aa3b, v49
    v_exp_f32 v57, v57
    s_nop 0
    v_add_f32 v57, 1.0, v57
    v_rcp_f32 v57, v57
    s_nop 0
    v_mul_f32 v49, v49, v57
    v_mul_f32 v58, 0xbfb8aa3b, v50
    v_exp_f32 v58, v58
    s_nop 0
    v_add_f32 v58, 1.0, v58
    v_rcp_f32 v58, v58
    s_nop 0
    v_mul_f32 v50, v50, v58
    v_mul_f32 v59, 0xbfb8aa3b, v51
    v_exp_f32 v59, v59
    s_nop 0
    v_add_f32 v59, 1.0, v59
    v_rcp_f32 v59, v59
    s_nop 0
    v_mul_f32 v51, v51, v59
    v_mul_f32 v60, 0xbfb8aa3b, v52
    v_exp_f32 v60, v60
    s_nop 0
    v_add_f32 v60, 1.0, v60
    v_rcp_f32 v60, v60
    s_nop 0
    v_mul_f32 v52, v52, v60
    v_mul_f32 v61, 0xbfb8aa3b, v53
    v_exp_f32 v61, v61
    s_nop 0
    v_add_f32 v61, 1.0, v61
    v_rcp_f32 v61, v61
    s_nop 0
    v_mul_f32 v53, v53, v61
    v_mul_f32 v62, 0xbfb8aa3b, v54
    v_exp_f32 v62, v62
    s_nop 0
    v_add_f32 v62, 1.0, v62
    v_rcp_f32 v62, v62
    s_nop 0
    v_mul_f32 v54, v54, v62
    v_mul_f32 v63, 0xbfb8aa3b, v55
    v_exp_f32 v63, v63
    s_nop 0
    v_add_f32 v63, 1.0, v63
    v_rcp_f32 v63, v63
    s_nop 0
    v_mul_f32 v55, v55, v63
    v_cvt_pk_bf16_f32 v64, v48, v49
    v_cvt_pk_bf16_f32 v65, v50, v51
    v_cvt_pk_bf16_f32 v66, v52, v53
    v_cvt_pk_bf16_f32 v67, v54, v55
    buffer_store_dwordx4 v[64:67], v1, s[4:7], s31 offen offset:384 sc1
    v_lshlrev_b32 v48, 16, v24
    v_and_b32 v49, 0xffff0000, v24
    v_lshlrev_b32 v50, 16, v25
    v_and_b32 v51, 0xffff0000, v25
    v_lshlrev_b32 v52, 16, v26
    v_and_b32 v53, 0xffff0000, v26
    v_lshlrev_b32 v54, 16, v27
    v_and_b32 v55, 0xffff0000, v27
    v_lshlrev_b32 v136, 16, v156
    v_and_b32 v137, 0xffff0000, v156
    v_pk_fma_f32 v[4:5], v[48:49], v[136:137], v[4:5]
    v_lshlrev_b32 v136, 16, v157
    v_and_b32 v137, 0xffff0000, v157
    v_pk_fma_f32 v[4:5], v[50:51], v[136:137], v[4:5]
    v_lshlrev_b32 v136, 16, v158
    v_and_b32 v137, 0xffff0000, v158
    v_pk_fma_f32 v[4:5], v[52:53], v[136:137], v[4:5]
    v_lshlrev_b32 v136, 16, v159
    v_and_b32 v137, 0xffff0000, v159
    v_pk_fma_f32 v[4:5], v[54:55], v[136:137], v[4:5]
    v_mul_f32 v56, 0xbfb8aa3b, v48
    v_exp_f32 v56, v56
    s_nop 0
    v_add_f32 v56, 1.0, v56
    v_rcp_f32 v56, v56
    s_nop 0
    v_mul_f32 v48, v48, v56
    v_mul_f32 v57, 0xbfb8aa3b, v49
    v_exp_f32 v57, v57
    s_nop 0
    v_add_f32 v57, 1.0, v57
    v_rcp_f32 v57, v57
    s_nop 0
    v_mul_f32 v49, v49, v57
    v_mul_f32 v58, 0xbfb8aa3b, v50
    v_exp_f32 v58, v58
    s_nop 0
    v_add_f32 v58, 1.0, v58
    v_rcp_f32 v58, v58
    s_nop 0
    v_mul_f32 v50, v50, v58
    v_mul_f32 v59, 0xbfb8aa3b, v51
    v_exp_f32 v59, v59
    s_nop 0
    v_add_f32 v59, 1.0, v59
    v_rcp_f32 v59, v59
    s_nop 0
    v_mul_f32 v51, v51, v59
    v_mul_f32 v60, 0xbfb8aa3b, v52
    v_exp_f32 v60, v60
    s_nop 0
    v_add_f32 v60, 1.0, v60
    v_rcp_f32 v60, v60
    s_nop 0
    v_mul_f32 v52, v52, v60
    v_mul_f32 v61, 0xbfb8aa3b, v53
    v_exp_f32 v61, v61
    s_nop 0
    v_add_f32 v61, 1.0, v61
    v_rcp_f32 v61, v61
    s_nop 0
    v_mul_f32 v53, v53, v61
    v_mul_f32 v62, 0xbfb8aa3b, v54
    v_exp_f32 v62, v62
    s_nop 0
    v_add_f32 v62, 1.0, v62
    v_rcp_f32 v62, v62
    s_nop 0
    v_mul_f32 v54, v54, v62
    v_mul_f32 v63, 0xbfb8aa3b, v55
    v_exp_f32 v63, v63
    s_nop 0
    v_add_f32 v63, 1.0, v63
    v_rcp_f32 v63, v63
    s_nop 0
    v_mul_f32 v55, v55, v63
    v_cvt_pk_bf16_f32 v64, v48, v49
    v_cvt_pk_bf16_f32 v65, v50, v51
    v_cvt_pk_bf16_f32 v66, v52, v53
    v_cvt_pk_bf16_f32 v67, v54, v55
    buffer_store_dwordx4 v[64:67], v1, s[4:7], s31 offen offset:512 sc1
    v_lshlrev_b32 v48, 16, v28
    v_and_b32 v49, 0xffff0000, v28
    v_lshlrev_b32 v50, 16, v29
    v_and_b32 v51, 0xffff0000, v29
    v_lshlrev_b32 v52, 16, v30
    v_and_b32 v53, 0xffff0000, v30
    v_lshlrev_b32 v54, 16, v31
    v_and_b32 v55, 0xffff0000, v31
    v_lshlrev_b32 v136, 16, v160
    v_and_b32 v137, 0xffff0000, v160
    v_pk_fma_f32 v[4:5], v[48:49], v[136:137], v[4:5]
    v_lshlrev_b32 v136, 16, v161
    v_and_b32 v137, 0xffff0000, v161
    v_pk_fma_f32 v[4:5], v[50:51], v[136:137], v[4:5]
    v_lshlrev_b32 v136, 16, v162
    v_and_b32 v137, 0xffff0000, v162
    v_pk_fma_f32 v[4:5], v[52:53], v[136:137], v[4:5]
    v_lshlrev_b32 v136, 16, v163
    v_and_b32 v137, 0xffff0000, v163
    v_pk_fma_f32 v[4:5], v[54:55], v[136:137], v[4:5]
    v_mul_f32 v56, 0xbfb8aa3b, v48
    v_exp_f32 v56, v56
    s_nop 0
    v_add_f32 v56, 1.0, v56
    v_rcp_f32 v56, v56
    s_nop 0
    v_mul_f32 v48, v48, v56
    v_mul_f32 v57, 0xbfb8aa3b, v49
    v_exp_f32 v57, v57
    s_nop 0
    v_add_f32 v57, 1.0, v57
    v_rcp_f32 v57, v57
    s_nop 0
    v_mul_f32 v49, v49, v57
    v_mul_f32 v58, 0xbfb8aa3b, v50
    v_exp_f32 v58, v58
    s_nop 0
    v_add_f32 v58, 1.0, v58
    v_rcp_f32 v58, v58
    s_nop 0
    v_mul_f32 v50, v50, v58
    v_mul_f32 v59, 0xbfb8aa3b, v51
    v_exp_f32 v59, v59
    s_nop 0
    v_add_f32 v59, 1.0, v59
    v_rcp_f32 v59, v59
    s_nop 0
    v_mul_f32 v51, v51, v59
    v_mul_f32 v60, 0xbfb8aa3b, v52
    v_exp_f32 v60, v60
    s_nop 0
    v_add_f32 v60, 1.0, v60
    v_rcp_f32 v60, v60
    s_nop 0
    v_mul_f32 v52, v52, v60
    v_mul_f32 v61, 0xbfb8aa3b, v53
    v_exp_f32 v61, v61
    s_nop 0
    v_add_f32 v61, 1.0, v61
    v_rcp_f32 v61, v61
    s_nop 0
    v_mul_f32 v53, v53, v61
    v_mul_f32 v62, 0xbfb8aa3b, v54
    v_exp_f32 v62, v62
    s_nop 0
    v_add_f32 v62, 1.0, v62
    v_rcp_f32 v62, v62
    s_nop 0
    v_mul_f32 v54, v54, v62
    v_mul_f32 v63, 0xbfb8aa3b, v55
    v_exp_f32 v63, v63
    s_nop 0
    v_add_f32 v63, 1.0, v63
    v_rcp_f32 v63, v63
    s_nop 0
    v_mul_f32 v55, v55, v63
    v_cvt_pk_bf16_f32 v64, v48, v49
    v_cvt_pk_bf16_f32 v65, v50, v51
    v_cvt_pk_bf16_f32 v66, v52, v53
    v_cvt_pk_bf16_f32 v67, v54, v55
    buffer_store_dwordx4 v[64:67], v1, s[4:7], s31 offen offset:640 sc1
    v_lshlrev_b32 v48, 16, v32
    v_and_b32 v49, 0xffff0000, v32
    v_lshlrev_b32 v50, 16, v33
    v_and_b32 v51, 0xffff0000, v33
    v_lshlrev_b32 v52, 16, v34
    v_and_b32 v53, 0xffff0000, v34
    v_lshlrev_b32 v54, 16, v35
    v_and_b32 v55, 0xffff0000, v35
    v_lshlrev_b32 v136, 16, v164
    v_and_b32 v137, 0xffff0000, v164
    v_pk_fma_f32 v[4:5], v[48:49], v[136:137], v[4:5]
    v_lshlrev_b32 v136, 16, v165
    v_and_b32 v137, 0xffff0000, v165
    v_pk_fma_f32 v[4:5], v[50:51], v[136:137], v[4:5]
    v_lshlrev_b32 v136, 16, v166
    v_and_b32 v137, 0xffff0000, v166
    v_pk_fma_f32 v[4:5], v[52:53], v[136:137], v[4:5]
    v_lshlrev_b32 v136, 16, v167
    v_and_b32 v137, 0xffff0000, v167
    v_pk_fma_f32 v[4:5], v[54:55], v[136:137], v[4:5]
    v_mul_f32 v56, 0xbfb8aa3b, v48
    v_exp_f32 v56, v56
    s_nop 0
    v_add_f32 v56, 1.0, v56
    v_rcp_f32 v56, v56
    s_nop 0
    v_mul_f32 v48, v48, v56
    v_mul_f32 v57, 0xbfb8aa3b, v49
    v_exp_f32 v57, v57
    s_nop 0
    v_add_f32 v57, 1.0, v57
    v_rcp_f32 v57, v57
    s_nop 0
    v_mul_f32 v49, v49, v57
    v_mul_f32 v58, 0xbfb8aa3b, v50
    v_exp_f32 v58, v58
    s_nop 0
    v_add_f32 v58, 1.0, v58
    v_rcp_f32 v58, v58
    s_nop 0
    v_mul_f32 v50, v50, v58
    v_mul_f32 v59, 0xbfb8aa3b, v51
    v_exp_f32 v59, v59
    s_nop 0
    v_add_f32 v59, 1.0, v59
    v_rcp_f32 v59, v59
    s_nop 0
    v_mul_f32 v51, v51, v59
    v_mul_f32 v60, 0xbfb8aa3b, v52
    v_exp_f32 v60, v60
    s_nop 0
    v_add_f32 v60, 1.0, v60
    v_rcp_f32 v60, v60
    s_nop 0
    v_mul_f32 v52, v52, v60
    v_mul_f32 v61, 0xbfb8aa3b, v53
    v_exp_f32 v61, v61
    s_nop 0
    v_add_f32 v61, 1.0, v61
    v_rcp_f32 v61, v61
    s_nop 0
    v_mul_f32 v53, v53, v61
    v_mul_f32 v62, 0xbfb8aa3b, v54
    v_exp_f32 v62, v62
    s_nop 0
    v_add_f32 v62, 1.0, v62
    v_rcp_f32 v62, v62
    s_nop 0
    v_mul_f32 v54, v54, v62
    v_mul_f32 v63, 0xbfb8aa3b, v55
    v_exp_f32 v63, v63
    s_nop 0
    v_add_f32 v63, 1.0, v63
    v_rcp_f32 v63, v63
    s_nop 0
    v_mul_f32 v55, v55, v63
    v_cvt_pk_bf16_f32 v64, v48, v49
    v_cvt_pk_bf16_f32 v65, v50, v51
    v_cvt_pk_bf16_f32 v66, v52, v53
    v_cvt_pk_bf16_f32 v67, v54, v55
    buffer_store_dwordx4 v[64:67], v1, s[4:7], s31 offen offset:768 sc1
    v_lshlrev_b32 v48, 16, v36
    v_and_b32 v49, 0xffff0000, v36
    v_lshlrev_b32 v50, 16, v37
    v_and_b32 v51, 0xffff0000, v37
    v_lshlrev_b32 v52, 16, v38
    v_and_b32 v53, 0xffff0000, v38
    v_lshlrev_b32 v54, 16, v39
    v_and_b32 v55, 0xffff0000, v39
    v_lshlrev_b32 v136, 16, v168
    v_and_b32 v137, 0xffff0000, v168
    v_pk_fma_f32 v[4:5], v[48:49], v[136:137], v[4:5]
    v_lshlrev_b32 v136, 16, v169
    v_and_b32 v137, 0xffff0000, v169
    v_pk_fma_f32 v[4:5], v[50:51], v[136:137], v[4:5]
    v_lshlrev_b32 v136, 16, v170
    v_and_b32 v137, 0xffff0000, v170
    v_pk_fma_f32 v[4:5], v[52:53], v[136:137], v[4:5]
    v_lshlrev_b32 v136, 16, v171
    v_and_b32 v137, 0xffff0000, v171
    v_pk_fma_f32 v[4:5], v[54:55], v[136:137], v[4:5]
    v_mul_f32 v56, 0xbfb8aa3b, v48
    v_exp_f32 v56, v56
    s_nop 0
    v_add_f32 v56, 1.0, v56
    v_rcp_f32 v56, v56
    s_nop 0
    v_mul_f32 v48, v48, v56
    v_mul_f32 v57, 0xbfb8aa3b, v49
    v_exp_f32 v57, v57
    s_nop 0
    v_add_f32 v57, 1.0, v57
    v_rcp_f32 v57, v57
    s_nop 0
    v_mul_f32 v49, v49, v57
    v_mul_f32 v58, 0xbfb8aa3b, v50
    v_exp_f32 v58, v58
    s_nop 0
    v_add_f32 v58, 1.0, v58
    v_rcp_f32 v58, v58
    s_nop 0
    v_mul_f32 v50, v50, v58
    v_mul_f32 v59, 0xbfb8aa3b, v51
    v_exp_f32 v59, v59
    s_nop 0
    v_add_f32 v59, 1.0, v59
    v_rcp_f32 v59, v59
    s_nop 0
    v_mul_f32 v51, v51, v59
    v_mul_f32 v60, 0xbfb8aa3b, v52
    v_exp_f32 v60, v60
    s_nop 0
    v_add_f32 v60, 1.0, v60
    v_rcp_f32 v60, v60
    s_nop 0
    v_mul_f32 v52, v52, v60
    v_mul_f32 v61, 0xbfb8aa3b, v53
    v_exp_f32 v61, v61
    s_nop 0
    v_add_f32 v61, 1.0, v61
    v_rcp_f32 v61, v61
    s_nop 0
    v_mul_f32 v53, v53, v61
    v_mul_f32 v62, 0xbfb8aa3b, v54
    v_exp_f32 v62, v62
    s_nop 0
    v_add_f32 v62, 1.0, v62
    v_rcp_f32 v62, v62
    s_nop 0
    v_mul_f32 v54, v54, v62
    v_mul_f32 v63, 0xbfb8aa3b, v55
    v_exp_f32 v63, v63
    s_nop 0
    v_add_f32 v63, 1.0, v63
    v_rcp_f32 v63, v63
    s_nop 0
    v_mul_f32 v55, v55, v63
    v_cvt_pk_bf16_f32 v64, v48, v49
    v_cvt_pk_bf16_f32 v65, v50, v51
    v_cvt_pk_bf16_f32 v66, v52, v53
    v_cvt_pk_bf16_f32 v67, v54, v55
    buffer_store_dwordx4 v[64:67], v1, s[4:7], s31 offen offset:896 sc1
    v_lshlrev_b32 v48, 16, v40
    v_and_b32 v49, 0xffff0000, v40
    v_lshlrev_b32 v50, 16, v41
    v_and_b32 v51, 0xffff0000, v41
    v_lshlrev_b32 v52, 16, v42
    v_and_b32 v53, 0xffff0000, v42
    v_lshlrev_b32 v54, 16, v43
    v_and_b32 v55, 0xffff0000, v43
    v_lshlrev_b32 v136, 16, v172
    v_and_b32 v137, 0xffff0000, v172
    v_pk_fma_f32 v[4:5], v[48:49], v[136:137], v[4:5]
    v_lshlrev_b32 v136, 16, v173
    v_and_b32 v137, 0xffff0000, v173
    v_pk_fma_f32 v[4:5], v[50:51], v[136:137], v[4:5]
    v_lshlrev_b32 v136, 16, v174
    v_and_b32 v137, 0xffff0000, v174
    v_pk_fma_f32 v[4:5], v[52:53], v[136:137], v[4:5]
    v_lshlrev_b32 v136, 16, v175
    v_and_b32 v137, 0xffff0000, v175
    v_pk_fma_f32 v[4:5], v[54:55], v[136:137], v[4:5]
    v_mul_f32 v56, 0xbfb8aa3b, v48
    v_exp_f32 v56, v56
    s_nop 0
    v_add_f32 v56, 1.0, v56
    v_rcp_f32 v56, v56
    s_nop 0
    v_mul_f32 v48, v48, v56
    v_mul_f32 v57, 0xbfb8aa3b, v49
    v_exp_f32 v57, v57
    s_nop 0
    v_add_f32 v57, 1.0, v57
    v_rcp_f32 v57, v57
    s_nop 0
    v_mul_f32 v49, v49, v57
    v_mul_f32 v58, 0xbfb8aa3b, v50
    v_exp_f32 v58, v58
    s_nop 0
    v_add_f32 v58, 1.0, v58
    v_rcp_f32 v58, v58
    s_nop 0
    v_mul_f32 v50, v50, v58
    v_mul_f32 v59, 0xbfb8aa3b, v51
    v_exp_f32 v59, v59
    s_nop 0
    v_add_f32 v59, 1.0, v59
    v_rcp_f32 v59, v59
    s_nop 0
    v_mul_f32 v51, v51, v59
    v_mul_f32 v60, 0xbfb8aa3b, v52
    v_exp_f32 v60, v60
    s_nop 0
    v_add_f32 v60, 1.0, v60
    v_rcp_f32 v60, v60
    s_nop 0
    v_mul_f32 v52, v52, v60
    v_mul_f32 v61, 0xbfb8aa3b, v53
    v_exp_f32 v61, v61
    s_nop 0
    v_add_f32 v61, 1.0, v61
    v_rcp_f32 v61, v61
    s_nop 0
    v_mul_f32 v53, v53, v61
    v_mul_f32 v62, 0xbfb8aa3b, v54
    v_exp_f32 v62, v62
    s_nop 0
    v_add_f32 v62, 1.0, v62
    v_rcp_f32 v62, v62
    s_nop 0
    v_mul_f32 v54, v54, v62
    v_mul_f32 v63, 0xbfb8aa3b, v55
    v_exp_f32 v63, v63
    s_nop 0
    v_add_f32 v63, 1.0, v63
    v_rcp_f32 v63, v63
    s_nop 0
    v_mul_f32 v55, v55, v63
    v_cvt_pk_bf16_f32 v64, v48, v49
    v_cvt_pk_bf16_f32 v65, v50, v51
    v_cvt_pk_bf16_f32 v66, v52, v53
    v_cvt_pk_bf16_f32 v67, v54, v55
    buffer_store_dwordx4 v[64:67], v1, s[4:7], s31 offen offset:1024 sc1
    v_lshlrev_b32 v48, 16, v44
    v_and_b32 v49, 0xffff0000, v44
    v_lshlrev_b32 v50, 16, v45
    v_and_b32 v51, 0xffff0000, v45
    v_lshlrev_b32 v52, 16, v46
    v_and_b32 v53, 0xffff0000, v46
    v_lshlrev_b32 v54, 16, v47
    v_and_b32 v55, 0xffff0000, v47
    v_lshlrev_b32 v136, 16, v176
    v_and_b32 v137, 0xffff0000, v176
    v_pk_fma_f32 v[4:5], v[48:49], v[136:137], v[4:5]
    v_lshlrev_b32 v136, 16, v177
    v_and_b32 v137, 0xffff0000, v177
    v_pk_fma_f32 v[4:5], v[50:51], v[136:137], v[4:5]
    v_lshlrev_b32 v136, 16, v178
    v_and_b32 v137, 0xffff0000, v178
    v_pk_fma_f32 v[4:5], v[52:53], v[136:137], v[4:5]
    v_lshlrev_b32 v136, 16, v179
    v_and_b32 v137, 0xffff0000, v179
    v_pk_fma_f32 v[4:5], v[54:55], v[136:137], v[4:5]
    v_mul_f32 v56, 0xbfb8aa3b, v48
    v_exp_f32 v56, v56
    s_nop 0
    v_add_f32 v56, 1.0, v56
    v_rcp_f32 v56, v56
    s_nop 0
    v_mul_f32 v48, v48, v56
    v_mul_f32 v57, 0xbfb8aa3b, v49
    v_exp_f32 v57, v57
    s_nop 0
    v_add_f32 v57, 1.0, v57
    v_rcp_f32 v57, v57
    s_nop 0
    v_mul_f32 v49, v49, v57
    v_mul_f32 v58, 0xbfb8aa3b, v50
    v_exp_f32 v58, v58
    s_nop 0
    v_add_f32 v58, 1.0, v58
    v_rcp_f32 v58, v58
    s_nop 0
    v_mul_f32 v50, v50, v58
    v_mul_f32 v59, 0xbfb8aa3b, v51
    v_exp_f32 v59, v59
    s_nop 0
    v_add_f32 v59, 1.0, v59
    v_rcp_f32 v59, v59
    s_nop 0
    v_mul_f32 v51, v51, v59
    v_mul_f32 v60, 0xbfb8aa3b, v52
    v_exp_f32 v60, v60
    s_nop 0
    v_add_f32 v60, 1.0, v60
    v_rcp_f32 v60, v60
    s_nop 0
    v_mul_f32 v52, v52, v60
    v_mul_f32 v61, 0xbfb8aa3b, v53
    v_exp_f32 v61, v61
    s_nop 0
    v_add_f32 v61, 1.0, v61
    v_rcp_f32 v61, v61
    s_nop 0
    v_mul_f32 v53, v53, v61
    v_mul_f32 v62, 0xbfb8aa3b, v54
    v_exp_f32 v62, v62
    s_nop 0
    v_add_f32 v62, 1.0, v62
    v_rcp_f32 v62, v62
    s_nop 0
    v_mul_f32 v54, v54, v62
    v_mul_f32 v63, 0xbfb8aa3b, v55
    v_exp_f32 v63, v63
    s_nop 0
    v_add_f32 v63, 1.0, v63
    v_rcp_f32 v63, v63
    s_nop 0
    v_mul_f32 v55, v55, v63
    v_cvt_pk_bf16_f32 v64, v48, v49
    v_cvt_pk_bf16_f32 v65, v50, v51
    v_cvt_pk_bf16_f32 v66, v52, v53
    v_cvt_pk_bf16_f32 v67, v54, v55
    buffer_store_dwordx4 v[64:67], v1, s[4:7], s31 offen offset:1152 sc1
    v_add_f32 v4, v4, v5
    s_nop 1
    v_add_f32_dpp v4, v4, v4 quad_perm:[1,0,3,2] row_mask:0xf bank_mask:0xf
    s_nop 1
    v_add_f32_dpp v4, v4, v4 quad_perm:[2,3,0,1] row_mask:0xf bank_mask:0xf
    s_nop 1
    v_add_f32_dpp v4, v4, v4 row_half_mirror row_mask:0xf bank_mask:0xf
    v_cvt_pk_bf16_f32 v4, v4, v4
    v_and_b32 v4, 0xffff0000, v4
    v_lshrrev_b32 v5, 3, v0
    v_lshlrev_b32 v5, 2, v5
    s_lshl_b32 s30, s26, 5
    s_add_u32 s30, s30, 5242880
    buffer_store_dword v4, v5, s[4:7], s30 offen sc1
    s_waitcnt vmcnt(0)
    v_mov_b32 v4, 2
    v_mov_b32 v5, 0
    buffer_store_dword v4, v5, s[4:7], s29 offen sc1
    s_branch L_recun2_192
L_recunl_187:
L_recun2_192:
    s_load_dwordx2 s[26:27], s[0:1], 24
    s_load_dwordx2 s[28:29], s[0:1], 32
    s_load_dwordx2 s[16:17], s[0:1], 16
    s_mov_b32 s18, 5242880
    s_mov_b32 s19, 0x00020000
    s_waitcnt lgkmcnt(0)
    s_cmp_eq_u32 s32, 0
    s_cselect_b32 s16, s26, s16
    s_cselect_b32 s17, s27, s17
    s_cmp_eq_u32 s32, 1
    s_cselect_b32 s16, s28, s16
    s_cselect_b32 s17, s29, s17
    s_and_b32 s27, s24, 1
    v_lshrrev_b32 v1, 3, v0
    v_lshl_add_u32 v1, s27, 3, v1
    v_lshlrev_b32 v1, 13, v1
    v_and_b32 v2, 3, v0
    v_lshl_add_u32 v1, v2, 4, v1
    v_bfe_u32 v2, v0, 2, 1
    v_bfe_u32 v3, v0, 4, 1
    v_xor_b32 v2, v2, v3
    v_lshl_add_u32 v1, v2, 6, v1
    s_lshl_b32 s26, s33, 8
    s_and_b32 s27, s24, 2
    s_lshl_b32 s27, s27, 6
    s_add_u32 s26, s26, s27
    s_mul_i32 s27, s24, 40960
    s_mov_b32 m0, s27
    s_nop 0
    buffer_load_dwordx4 v1, s[16:19], s26 offen lds
    s_add_u32 s26, s26, 131072
    s_add_u32 m0, m0, 1024
    s_nop 0
    buffer_load_dwordx4 v1, s[16:19], s26 offen lds
    s_add_u32 s26, s26, 131072
    s_add_u32 m0, m0, 1024
    s_nop 0
    buffer_load_dwordx4 v1, s[16:19], s26 offen lds
    s_add_u32 s26, s26, 131072
    s_add_u32 m0, m0, 1024
    s_nop 0
    buffer_load_dwordx4 v1, s[16:19], s26 offen lds
    s_add_u32 s26, s26, 131072
    s_add_u32 m0, m0, 1024
    s_nop 0
    buffer_load_dwordx4 v1, s[16:19], s26 offen lds
    s_add_u32 s26, s26, 131072
    s_add_u32 m0, m0, 1024
    s_nop 0
    buffer_load_dwordx4 v1, s[16:19], s26 offen lds
    s_add_u32 s26, s26, 131072
    s_add_u32 m0, m0, 1024
    s_nop 0
    buffer_load_dwordx4 v1, s[16:19], s26 offen lds
    s_add_u32 s26, s26, 131072
    s_add_u32 m0, m0, 1024
    s_nop 0
    buffer_load_dwordx4 v1, s[16:19], s26 offen lds
    s_add_u32 s26, s26, 131072
    s_add_u32 m0, m0, 1024
    s_nop 0
    buffer_load_dwordx4 v1, s[16:19], s26 offen lds
    s_add_u32 s26, s26, 131072
    s_add_u32 m0, m0, 1024
    s_nop 0
    buffer_load_dwordx4 v1, s[16:19], s26 offen lds
    s_add_u32 s26, s26, 131072
    s_add_u32 m0, m0, 1024
    s_nop 0
    buffer_load_dwordx4 v1, s[16:19], s26 offen lds
    s_add_u32 s26, s26, 131072
    s_add_u32 m0, m0, 1024
    s_nop 0
    buffer_load_dwordx4 v1, s[16:19], s26 offen lds
    s_add_u32 s26, s26, 131072
    s_add_u32 m0, m0, 1024
    s_nop 0
    buffer_load_dwordx4 v1, s[16:19], s26 offen lds
    s_add_u32 s26, s26, 131072
    s_add_u32 m0, m0, 1024
    s_nop 0
    buffer_load_dwordx4 v1, s[16:19], s26 offen lds
    s_add_u32 s26, s26, 131072
    s_add_u32 m0, m0, 1024
    s_nop 0
    buffer_load_dwordx4 v1, s[16:19], s26 offen lds
    s_add_u32 s26, s26, 131072
    s_add_u32 m0, m0, 1024
    s_nop 0
    buffer_load_dwordx4 v1, s[16:19], s26 offen lds
    s_add_u32 s26, s26, 131072
    s_add_u32 m0, m0, 1024
    s_nop 0
    buffer_load_dwordx4 v1, s[16:19], s26 offen lds
    s_add_u32 s26, s26, 131072
    s_add_u32 m0, m0, 1024
    s_nop 0
    buffer_load_dwordx4 v1, s[16:19], s26 offen lds
    s_add_u32 s26, s26, 131072
    s_add_u32 m0, m0, 1024
    s_nop 0
    buffer_load_dwordx4 v1, s[16:19], s26 offen lds
    s_add_u32 s26, s26, 131072
    s_add_u32 m0, m0, 1024
    s_nop 0
    buffer_load_dwordx4 v1, s[16:19], s26 offen lds
    s_add_u32 s26, s26, 131072
    s_add_u32 m0, m0, 1024
    s_nop 0
    buffer_load_dwordx4 v1, s[16:19], s26 offen lds
    s_add_u32 s26, s26, 131072
    s_add_u32 m0, m0, 1024
    s_nop 0
    buffer_load_dwordx4 v1, s[16:19], s26 offen lds
    s_add_u32 s26, s26, 131072
    s_add_u32 m0, m0, 1024
    s_nop 0
    buffer_load_dwordx4 v1, s[16:19], s26 offen lds
    s_add_u32 s26, s26, 131072
    s_add_u32 m0, m0, 1024
    s_nop 0
    buffer_load_dwordx4 v1, s[16:19], s26 offen lds
    s_add_u32 s26, s26, 131072
    s_add_u32 m0, m0, 1024
    s_nop 0
    buffer_load_dwordx4 v1, s[16:19], s26 offen lds
    s_add_u32 s26, s26, 131072
    s_add_u32 m0, m0, 1024
    s_nop 0
    buffer_load_dwordx4 v1, s[16:19], s26 offen lds
    s_add_u32 s26, s26, 131072
    s_add_u32 m0, m0, 1024
    s_nop 0
    buffer_load_dwordx4 v1, s[16:19], s26 offen lds
    s_add_u32 s26, s26, 131072
    s_add_u32 m0, m0, 1024
    s_nop 0
    buffer_load_dwordx4 v1, s[16:19], s26 offen lds
    s_add_u32 s26, s26, 131072
    s_add_u32 m0, m0, 1024
    s_nop 0
    buffer_load_dwordx4 v1, s[16:19], s26 offen lds
    s_add_u32 s26, s26, 131072
    s_add_u32 m0, m0, 1024
    s_nop 0
    buffer_load_dwordx4 v1, s[16:19], s26 offen lds
    s_add_u32 s26, s26, 131072
    s_add_u32 m0, m0, 1024
    s_nop 0
    buffer_load_dwordx4 v1, s[16:19], s26 offen lds
    s_add_u32 s26, s26, 131072
    s_add_u32 m0, m0, 1024
    s_nop 0
    buffer_load_dwordx4 v1, s[16:19], s26 offen lds
    s_add_u32 s26, s26, 131072
    s_add_u32 m0, m0, 1024
    s_nop 0
    buffer_load_dwordx4 v1, s[16:19], s26 offen lds
    s_add_u32 s26, s26, 131072
    s_add_u32 m0, m0, 1024
    s_nop 0
    buffer_load_dwordx4 v1, s[16:19], s26 offen lds
    s_add_u32 s26, s26, 131072
    s_add_u32 m0, m0, 1024
    s_nop 0
    buffer_load_dwordx4 v1, s[16:19], s26 offen lds
    s_add_u32 s26, s26, 131072
    s_add_u32 m0, m0, 1024
    s_nop 0
    buffer_load_dwordx4 v1, s[16:19], s26 offen lds
    s_add_u32 s26, s26, 131072
    s_add_u32 m0, m0, 1024
    s_nop 0
    buffer_load_dwordx4 v1, s[16:19], s26 offen lds
    s_add_u32 s26, s26, 131072
    s_add_u32 m0, m0, 1024
    s_nop 0
    buffer_load_dwordx4 v1, s[16:19], s26 offen lds
    s_add_u32 s26, s26, 131072
    s_add_u32 m0, m0, 1024
    s_nop 0
    buffer_load_dwordx4 v1, s[16:19], s26 offen lds
    s_add_u32 s26, s26, 131072
    s_add_u32 m0, m0, 1024
    s_nop 0
    buffer_load_dwordx4 v1, s[16:19], s26 offen lds
    v_lshrrev_b32 v1, 5, v0
    v_mul_u32_u24 v1, 40960, v1
    v_bfe_u32 v2, v0, 2, 2
    v_lshl_add_u32 v1, v2, 7, v1
    v_bfe_u32 v2, v0, 3, 1
    s_and_b32 s27, s24, 1
    v_xor_b32 v2, s27, v2
    v_lshl_add_u32 v1, v2, 6, v1
    v_bfe_u32 v2, v0, 4, 1
    v_lshl_add_u32 v1, v2, 5, v1
    v_and_b32 v2, 3, v0
    v_lshl_add_u32 v1, v2, 3, v1
    s_and_b32 s27, s24, 2
    s_mul_i32 s27, s27, 40960
    v_add_u32 v1, s27, v1
    s_waitcnt vmcnt(32)
    s_barrier
    ds_read_b64_tr_b16 v[96:97], v1 offset:0
    ds_read_b64_tr_b16 v[98:99], v1 offset:512
    ds_read_b64_tr_b16 v[100:101], v1 offset:1024
    ds_read_b64_tr_b16 v[102:103], v1 offset:1536
    ds_read_b64_tr_b16 v[104:105], v1 offset:2048
    ds_read_b64_tr_b16 v[106:107], v1 offset:2560
    ds_read_b64_tr_b16 v[108:109], v1 offset:3072
    ds_read_b64_tr_b16 v[110:111], v1 offset:3584
    ds_read_b64_tr_b16 v[112:113], v1 offset:4096
    ds_read_b64_tr_b16 v[114:115], v1 offset:4608
    ds_read_b64_tr_b16 v[116:117], v1 offset:5120
    ds_read_b64_tr_b16 v[118:119], v1 offset:5632
    ds_read_b64_tr_b16 v[120:121], v1 offset:6144
    ds_read_b64_tr_b16 v[122:123], v1 offset:6656
    ds_read_b64_tr_b16 v[124:125], v1 offset:7168
    ds_read_b64_tr_b16 v[126:127], v1 offset:7680
    s_waitcnt vmcnt(24)
    s_barrier
    ds_read_b64_tr_b16 v[128:129], v1 offset:8192
    ds_read_b64_tr_b16 v[130:131], v1 offset:8704
    ds_read_b64_tr_b16 v[132:133], v1 offset:9216
    ds_read_b64_tr_b16 v[134:135], v1 offset:9728
    ds_read_b64_tr_b16 v[136:137], v1 offset:10240
    ds_read_b64_tr_b16 v[138:139], v1 offset:10752
    ds_read_b64_tr_b16 v[140:141], v1 offset:11264
    ds_read_b64_tr_b16 v[142:143], v1 offset:11776
    ds_read_b64_tr_b16 v[144:145], v1 offset:12288
    ds_read_b64_tr_b16 v[146:147], v1 offset:12800
    ds_read_b64_tr_b16 v[148:149], v1 offset:13312
    ds_read_b64_tr_b16 v[150:151], v1 offset:13824
    ds_read_b64_tr_b16 v[152:153], v1 offset:14336
    ds_read_b64_tr_b16 v[154:155], v1 offset:14848
    ds_read_b64_tr_b16 v[156:157], v1 offset:15360
    ds_read_b64_tr_b16 v[158:159], v1 offset:15872
    s_waitcnt vmcnt(16)
    s_barrier
    ds_read_b64_tr_b16 v[160:161], v1 offset:16384
    ds_read_b64_tr_b16 v[162:163], v1 offset:16896
    ds_read_b64_tr_b16 v[164:165], v1 offset:17408
    ds_read_b64_tr_b16 v[166:167], v1 offset:17920
    ds_read_b64_tr_b16 v[168:169], v1 offset:18432
    ds_read_b64_tr_b16 v[170:171], v1 offset:18944
    ds_read_b64_tr_b16 v[172:173], v1 offset:19456
    ds_read_b64_tr_b16 v[174:175], v1 offset:19968
    ds_read_b64_tr_b16 v[176:177], v1 offset:20480
    ds_read_b64_tr_b16 v[178:179], v1 offset:20992
    ds_read_b64_tr_b16 v[180:181], v1 offset:21504
    ds_read_b64_tr_b16 v[182:183], v1 offset:22016
    ds_read_b64_tr_b16 v[184:185], v1 offset:22528
    ds_read_b64_tr_b16 v[186:187], v1 offset:23040
    ds_read_b64_tr_b16 v[188:189], v1 offset:23552
    ds_read_b64_tr_b16 v[190:191], v1 offset:24064
    s_waitcnt vmcnt(8)
    s_barrier
    ds_read_b64_tr_b16 v[192:193], v1 offset:24576
    ds_read_b64_tr_b16 v[194:195], v1 offset:25088
    ds_read_b64_tr_b16 v[196:197], v1 offset:25600
    ds_read_b64_tr_b16 v[198:199], v1 offset:26112
    ds_read_b64_tr_b16 v[200:201], v1 offset:26624
    ds_read_b64_tr_b16 v[202:203], v1 offset:27136
    ds_read_b64_tr_b16 v[204:205], v1 offset:27648
    ds_read_b64_tr_b16 v[206:207], v1 offset:28160
    ds_read_b64_tr_b16 v[208:209], v1 offset:28672
    ds_read_b64_tr_b16 v[210:211], v1 offset:29184
    ds_read_b64_tr_b16 v[212:213], v1 offset:29696
    ds_read_b64_tr_b16 v[214:215], v1 offset:30208
    ds_read_b64_tr_b16 v[216:217], v1 offset:30720
    ds_read_b64_tr_b16 v[218:219], v1 offset:31232
    ds_read_b64_tr_b16 v[220:221], v1 offset:31744
    ds_read_b64_tr_b16 v[222:223], v1 offset:32256
    s_waitcnt vmcnt(0)
    s_barrier
    ds_read_b64_tr_b16 v[224:225], v1 offset:32768
    ds_read_b64_tr_b16 v[226:227], v1 offset:33280
    ds_read_b64_tr_b16 v[228:229], v1 offset:33792
    ds_read_b64_tr_b16 v[230:231], v1 offset:34304
    ds_read_b64_tr_b16 v[232:233], v1 offset:34816
    ds_read_b64_tr_b16 v[234:235], v1 offset:35328
    ds_read_b64_tr_b16 v[236:237], v1 offset:35840
    ds_read_b64_tr_b16 v[238:239], v1 offset:36352
    ds_read_b64_tr_b16 v[240:241], v1 offset:36864
    ds_read_b64_tr_b16 v[242:243], v1 offset:37376
    ds_read_b64_tr_b16 v[244:245], v1 offset:37888
    ds_read_b64_tr_b16 v[246:247], v1 offset:38400
    ds_read_b64_tr_b16 v[248:249], v1 offset:38912
    ds_read_b64_tr_b16 v[250:251], v1 offset:39424
    ds_read_b64_tr_b16 v[252:253], v1 offset:39936
    ds_read_b64_tr_b16 v[254:255], v1 offset:40448
    s_waitcnt lgkmcnt(0)
    s_barrier
    s_bitcmp1_b32 s77, 1
    s_cbranch_scc1 L_recuvtr_196
    v_lshlrev_b32 v4, 2, v0
    v_and_b32 v4, 60, v4
    s_mov_b32 s72, 0
L_recuvf_193:
    buffer_load_dword v5, v4, s[20:23], 0 offen offset:0 sc1
L_recuvok_194:
    s_waitcnt vmcnt(0)
    v_lshrrev_b32 v6, 8, v5
    s_nop 1
    v_add_u32_dpp v6, v6, v6 quad_perm:[2,3,0,1] row_mask:0xf bank_mask:0xf
    s_nop 1
    v_add_u32_dpp v6, v6, v6 row_ror:4 row_mask:0xf bank_mask:0xf
    s_nop 1
    v_add_u32_dpp v6, v6, v6 row_ror:8 row_mask:0xf bank_mask:0xf
    s_nop 0
    v_readlane_b32 s70, v6, 1
    s_cmp_ge_u32 s70, 0x100
    s_cbranch_scc1 L_recuvfu_195
    s_add_u32 s72, s72, 1
    s_cmp_lt_u32 s72, 400000
    s_cbranch_scc1 L_recuvf_193
    s_branch L_exit_recurrent_scan__memory_aug_recurrent_mem_tr__moe_arch_mod__prompt_kernel
L_recuvfu_195:
    s_cmp_gt_u32 s70, 0x100
    s_cbranch_scc1 L_exit_recurrent_scan__memory_aug_recurrent_mem_tr__moe_arch_mod__prompt_kernel
    v_mov_b32 v6, 0x2000
    v_bfe_u32 v4, v4, 2, 1
    v_cmp_eq_u32 vcc, 1, v4
    s_nop 1
    v_cndmask_b32 v6, -1, v6, vcc
    v_cmp_ne_u32 vcc, v5, v6
    s_cbranch_vccnz L_gen_recurrent_scan__memory_aug_recurrent_mem_tr__moe_arch_mod__prompt_kernel
    s_or_b32 s77, s77, 2
L_recuvtr_196:
    s_waitcnt vmcnt(0)
    v_lshlrev_b32 v1, 7, v0
    s_mov_b32 s26, 5373952
    s_mov_b32 s27, 0
L_recuwln_197:
    buffer_load_dwordx4 v[4:7], v1, s[4:7], s26 offen sc1
    s_waitcnt vmcnt(0)
    v_min_u32 v4, v4, v5
    v_min3_u32 v4, v4, v6, v7
    v_cmp_gt_u32 vcc, 1, v4
    s_cbranch_vccz L_recuwlnok_198
    s_add_u32 s27, s27, 1
    s_cmp_lt_u32 s27, 400000
    s_cbranch_scc0 L_exit_recurrent_scan__memory_aug_recurrent_mem_tr__moe_arch_mod__prompt_kernel
    s_sleep 2
    s_branch L_recuwln_197
L_recuwlnok_198:
    v_lshlrev_b32 v1, 4, v0
    s_mul_i32 s35, s34, 40960
    s_mul_i32 s26, s24, 10240
    s_add_u32 s35, s35, s26
    s_add_u32 s35, s35, 0
    s_mov_b32 s40, s26
    s_lshl_b32 s38, s34, 5
    s_add_u32 s38, s38, s33
    s_lshl_b32 s38, s38, 13
    s_add_u32 s27, s32, 2
    s_cmp_eq_u32 s32, 2
    s_cselect_b32 s27, 1, s27
    s_lshl_b32 s27, s27, 24
    s_add_u32 s38, s38, s27
    s_lshl_b32 s39, s32, 5
    s_add_u32 s39, s39, s33
    s_lshl_b32 s39, s39, 1
    s_add_u32 s39, s39, s34
    s_lshl_b32 s39, s39, 7
    s_lshl_b32 s27, s24, 2
    s_add_u32 s39, s39, s27
    s_add_u32 s39, s39, 5382144
    v_and_b32 v2, 15, v0
    v_lshlrev_b32 v2, 4, v2
    v_bfe_u32 v3, v0, 4, 1
    v_lshrrev_b32 v4, 5, v0
    s_cmp_eq_u32 s32, 1
    s_cbranch_scc1 L_gv_recurrent_scan__memory_aug_recurrent_mem_tr__moe_arch_mod__prompt_kernel
    v_lshl_add_u32 v2, v3, 12, v2
    v_lshl_add_u32 v2, v4, 9, v2
    s_lshl_b32 s27, s24, 10
    s_add_u32 s38, s38, s27
    s_mov_b32 m0, s40
    s_mov_b32 s26, s35
    buffer_load_dwordx4 v1, s[4:7], s26 offen offset:0 lds
    buffer_load_dwordx4 v1, s[4:7], s26 offen offset:1024 lds
    buffer_load_dwordx4 v1, s[4:7], s26 offen offset:2048 lds
    buffer_load_dwordx4 v1, s[4:7], s26 offen offset:3072 lds
    s_add_u32 m0, m0, 4096
    s_add_u32 s26, s26, 4096
    buffer_load_dwordx4 v1, s[4:7], s26 offen offset:0 lds
    buffer_load_dwordx4 v1, s[4:7], s26 offen offset:1024 lds
    buffer_load_dwordx4 v1, s[4:7], s26 offen offset:2048 lds
    buffer_load_dwordx4 v1, s[4:7], s26 offen offset:3072 lds
    s_add_u32 m0, m0, 4096
    s_add_u32 s26, s26, 4096
    buffer_load_dwordx4 v1, s[4:7], s26 offen offset:0 lds
    buffer_load_dwordx4 v1, s[4:7], s26 offen offset:1024 lds
    s_add_u32 s35, s35, 81920
    s_add_u32 s41, s40, 40960
    s_mov_b32 m0, s41
    s_mov_b32 s26, s35
    buffer_load_dwordx4 v1, s[4:7], s26 offen offset:0 lds
    buffer_load_dwordx4 v1, s[4:7], s26 offen offset:1024 lds
    buffer_load_dwordx4 v1, s[4:7], s26 offen offset:2048 lds
    buffer_load_dwordx4 v1, s[4:7], s26 offen offset:3072 lds
    s_add_u32 m0, m0, 4096
    s_add_u32 s26, s26, 4096
    buffer_load_dwordx4 v1, s[4:7], s26 offen offset:0 lds
    buffer_load_dwordx4 v1, s[4:7], s26 offen offset:1024 lds
    buffer_load_dwordx4 v1, s[4:7], s26 offen offset:2048 lds
    buffer_load_dwordx4 v1, s[4:7], s26 offen offset:3072 lds
    s_add_u32 m0, m0, 4096
    s_add_u32 s26, s26, 4096
    buffer_load_dwordx4 v1, s[4:7], s26 offen offset:0 lds
    buffer_load_dwordx4 v1, s[4:7], s26 offen offset:1024 lds
    s_add_u32 s35, s35, 81920
    s_mov_b32 s36, 0
    s_mov_b32 s43, 0
    s_mov_b32 s37, 0
    s_mov_b32 s42, 81920
    s_waitcnt vmcnt(10)
L_recugl_200:
    s_barrier
    s_sub_u32 s26, s37, 1
    s_max_i32 s26, s26, s43
    v_mov_b32 v4, s26
    v_mov_b32 v5, 0
    buffer_store_dword v4, v5, s[4:7], s39 offen sc1
    s_cmp_ge_u32 s37, 30
    s_cbranch_scc1 L_recund_202
    s_add_u32 s41, s42, s40
    s_mov_b32 m0, s41
    s_mov_b32 s26, s35
    buffer_load_dwordx4 v1, s[4:7], s26 offen offset:0 lds
    buffer_load_dwordx4 v1, s[4:7], s26 offen offset:1024 lds
    buffer_load_dwordx4 v1, s[4:7], s26 offen offset:2048 lds
    buffer_load_dwordx4 v1, s[4:7], s26 offen offset:3072 lds
    s_add_u32 m0, m0, 4096
    s_add_u32 s26, s26, 4096
    buffer_load_dwordx4 v1, s[4:7], s26 offen offset:0 lds
    buffer_load_dwordx4 v1, s[4:7], s26 offen offset:1024 lds
    buffer_load_dwordx4 v1, s[4:7], s26 offen offset:2048 lds
    buffer_load_dwordx4 v1, s[4:7], s26 offen offset:3072 lds
    s_add_u32 m0, m0, 4096
    s_add_u32 s26, s26, 4096
    buffer_load_dwordx4 v1, s[4:7], s26 offen offset:0 lds
    buffer_load_dwordx4 v1, s[4:7], s26 offen offset:1024 lds
    s_add_u32 s35, s35, 81920
L_recund_202:
    v_add_u32 v3, s36, v1
    ds_read_b128 v[32:35], v3 offset:0
    ds_read_b128 v[36:39], v3 offset:1024
    ds_read_b128 v[40:43], v3 offset:2048
    ds_read_b128 v[44:47], v3 offset:3072
    ds_read_b128 v[48:51], v3 offset:4096
    s_waitcnt lgkmcnt(4)
    v_mfma_f32_32x32x16_bf16 v[16:31], v[96:99], v[32:35], 0
    ds_read_b128 v[32:35], v3 offset:5120
    s_waitcnt lgkmcnt(4)
    v_mfma_f32_32x32x16_bf16 v[16:31], v[100:103], v[36:39], v[16:31]
    ds_read_b128 v[36:39], v3 offset:6144
    s_waitcnt lgkmcnt(4)
    v_mfma_f32_32x32x16_bf16 v[16:31], v[104:107], v[40:43], v[16:31]
    ds_read_b128 v[40:43], v3 offset:7168
    s_waitcnt lgkmcnt(4)
    v_mfma_f32_32x32x16_bf16 v[16:31], v[108:111], v[44:47], v[16:31]
    ds_read_b128 v[44:47], v3 offset:8192
    s_waitcnt lgkmcnt(4)
    v_mfma_f32_32x32x16_bf16 v[16:31], v[112:115], v[48:51], v[16:31]
    ds_read_b128 v[48:51], v3 offset:9216
    s_waitcnt lgkmcnt(4)
    v_mfma_f32_32x32x16_bf16 v[16:31], v[116:119], v[32:35], v[16:31]
    ds_read_b128 v[32:35], v3 offset:10240
    s_waitcnt lgkmcnt(4)
    v_mfma_f32_32x32x16_bf16 v[16:31], v[120:123], v[36:39], v[16:31]
    ds_read_b128 v[36:39], v3 offset:11264
    s_waitcnt lgkmcnt(4)
    v_mfma_f32_32x32x16_bf16 v[16:31], v[124:127], v[40:43], v[16:31]
    ds_read_b128 v[40:43], v3 offset:12288
    s_waitcnt lgkmcnt(4)
    v_mfma_f32_32x32x16_bf16 v[16:31], v[128:131], v[44:47], v[16:31]
    ds_read_b128 v[44:47], v3 offset:13312
    s_waitcnt lgkmcnt(4)
    v_mfma_f32_32x32x16_bf16 v[16:31], v[132:135], v[48:51], v[16:31]
    ds_read_b128 v[48:51], v3 offset:14336
    s_waitcnt lgkmcnt(4)
    v_mfma_f32_32x32x16_bf16 v[16:31], v[136:139], v[32:35], v[16:31]
    ds_read_b128 v[32:35], v3 offset:15360
    s_waitcnt lgkmcnt(4)
    v_mfma_f32_32x32x16_bf16 v[16:31], v[140:143], v[36:39], v[16:31]
    ds_read_b128 v[36:39], v3 offset:16384
    s_waitcnt lgkmcnt(4)
    v_mfma_f32_32x32x16_bf16 v[16:31], v[144:147], v[40:43], v[16:31]
    ds_read_b128 v[40:43], v3 offset:17408
    s_waitcnt lgkmcnt(4)
    v_mfma_f32_32x32x16_bf16 v[16:31], v[148:151], v[44:47], v[16:31]
    ds_read_b128 v[44:47], v3 offset:18432
    s_waitcnt lgkmcnt(4)
    v_mfma_f32_32x32x16_bf16 v[16:31], v[152:155], v[48:51], v[16:31]
    ds_read_b128 v[48:51], v3 offset:19456
    s_waitcnt lgkmcnt(4)
    v_mfma_f32_32x32x16_bf16 v[16:31], v[156:159], v[32:35], v[16:31]
    ds_read_b128 v[32:35], v3 offset:20480
    s_waitcnt lgkmcnt(4)
    v_mfma_f32_32x32x16_bf16 v[16:31], v[160:163], v[36:39], v[16:31]
    ds_read_b128 v[36:39], v3 offset:21504
    s_waitcnt lgkmcnt(4)
    v_mfma_f32_32x32x16_bf16 v[16:31], v[164:167], v[40:43], v[16:31]
    ds_read_b128 v[40:43], v3 offset:22528
    s_waitcnt lgkmcnt(4)
    v_mfma_f32_32x32x16_bf16 v[16:31], v[168:171], v[44:47], v[16:31]
    ds_read_b128 v[44:47], v3 offset:23552
    s_waitcnt lgkmcnt(4)
    v_mfma_f32_32x32x16_bf16 v[16:31], v[172:175], v[48:51], v[16:31]
    ds_read_b128 v[48:51], v3 offset:24576
    s_waitcnt lgkmcnt(4)
    v_mfma_f32_32x32x16_bf16 v[16:31], v[176:179], v[32:35], v[16:31]
    ds_read_b128 v[32:35], v3 offset:25600
    s_waitcnt lgkmcnt(4)
    v_mfma_f32_32x32x16_bf16 v[16:31], v[180:183], v[36:39], v[16:31]
    ds_read_b128 v[36:39], v3 offset:26624
    s_waitcnt lgkmcnt(4)
    v_mfma_f32_32x32x16_bf16 v[16:31], v[184:187], v[40:43], v[16:31]
    ds_read_b128 v[40:43], v3 offset:27648
    s_waitcnt lgkmcnt(4)
    v_mfma_f32_32x32x16_bf16 v[16:31], v[188:191], v[44:47], v[16:31]
    ds_read_b128 v[44:47], v3 offset:28672
    s_waitcnt lgkmcnt(4)
    v_mfma_f32_32x32x16_bf16 v[16:31], v[192:195], v[48:51], v[16:31]
    ds_read_b128 v[48:51], v3 offset:29696
    s_waitcnt lgkmcnt(4)
    v_mfma_f32_32x32x16_bf16 v[16:31], v[196:199], v[32:35], v[16:31]
    ds_read_b128 v[32:35], v3 offset:30720
    s_waitcnt lgkmcnt(4)
    v_mfma_f32_32x32x16_bf16 v[16:31], v[200:203], v[36:39], v[16:31]
    ds_read_b128 v[36:39], v3 offset:31744
    s_waitcnt lgkmcnt(4)
    v_mfma_f32_32x32x16_bf16 v[16:31], v[204:207], v[40:43], v[16:31]
    ds_read_b128 v[40:43], v3 offset:32768
    s_waitcnt lgkmcnt(4)
    v_mfma_f32_32x32x16_bf16 v[16:31], v[208:211], v[44:47], v[16:31]
    ds_read_b128 v[44:47], v3 offset:33792
    s_waitcnt lgkmcnt(4)
    v_mfma_f32_32x32x16_bf16 v[16:31], v[212:215], v[48:51], v[16:31]
    ds_read_b128 v[48:51], v3 offset:34816
    s_waitcnt lgkmcnt(4)
    v_mfma_f32_32x32x16_bf16 v[16:31], v[216:219], v[32:35], v[16:31]
    ds_read_b128 v[32:35], v3 offset:35840
    s_waitcnt lgkmcnt(4)
    v_mfma_f32_32x32x16_bf16 v[16:31], v[220:223], v[36:39], v[16:31]
    ds_read_b128 v[36:39], v3 offset:36864
    s_waitcnt lgkmcnt(4)
    v_mfma_f32_32x32x16_bf16 v[16:31], v[224:227], v[40:43], v[16:31]
    ds_read_b128 v[40:43], v3 offset:37888
    s_waitcnt lgkmcnt(4)
    v_mfma_f32_32x32x16_bf16 v[16:31], v[228:231], v[44:47], v[16:31]
    ds_read_b128 v[44:47], v3 offset:38912
    s_waitcnt lgkmcnt(4)
    v_mfma_f32_32x32x16_bf16 v[16:31], v[232:235], v[48:51], v[16:31]
    ds_read_b128 v[48:51], v3 offset:39936
    s_waitcnt lgkmcnt(4)
    v_mfma_f32_32x32x16_bf16 v[16:31], v[236:239], v[32:35], v[16:31]
    s_waitcnt lgkmcnt(3)
    v_mfma_f32_32x32x16_bf16 v[16:31], v[240:243], v[36:39], v[16:31]
    s_waitcnt lgkmcnt(2)
    v_mfma_f32_32x32x16_bf16 v[16:31], v[244:247], v[40:43], v[16:31]
    s_waitcnt lgkmcnt(1)
    v_mfma_f32_32x32x16_bf16 v[16:31], v[248:251], v[44:47], v[16:31]
    s_waitcnt lgkmcnt(0)
    v_mfma_f32_32x32x16_bf16 v[16:31], v[252:255], v[48:51], v[16:31]
    s_add_u32 s36, s36, 40960
    s_cmp_eq_u32 s36, 122880
    s_cselect_b32 s36, 0, s36
    s_add_u32 s42, s42, 40960
    s_cmp_eq_u32 s42, 122880
    s_cselect_b32 s42, 0, s42
    s_nop 5
    v_cvt_pk_bf16_f32 v8, v16, v17
    v_cvt_pk_bf16_f32 v9, v18, v19
    v_cvt_pk_bf16_f32 v10, v20, v21
    v_cvt_pk_bf16_f32 v11, v22, v23
    v_cvt_pk_bf16_f32 v12, v24, v25
    v_cvt_pk_bf16_f32 v13, v26, v27
    v_cvt_pk_bf16_f32 v14, v28, v29
    v_cvt_pk_bf16_f32 v15, v30, v31
    buffer_store_dwordx4 v[8:11], v2, s[4:7], s38 offen sc1
    buffer_store_dwordx4 v[12:15], v2, s[4:7], s38 offen offset:256 sc1
    s_add_u32 s38, s38, 524288
    s_add_u32 s37, s37, 1
    s_cmp_le_u32 s37, 2
    s_cbranch_scc0 L_recun0_204
    s_waitcnt vmcnt(0)
    s_mov_b32 s43, s37
L_recun0_204:
    s_cmp_ge_u32 s37, 31
    s_cbranch_scc0 L_recun1_205
    s_waitcnt vmcnt(2)
L_recun1_205:
    s_waitcnt vmcnt(13)
    s_cmp_lt_u32 s37, 32
    s_cbranch_scc1 L_recugl_200
    s_waitcnt vmcnt(0)
    v_mov_b32 v4, 32
    v_mov_b32 v5, 0
    buffer_store_dword v4, v5, s[4:7], s39 offen sc1
    s_branch L_gend_recurrent_scan__memory_aug_recurrent_mem_tr__moe_arch_mod__prompt_kernel
L_gv_recurrent_scan__memory_aug_recurrent_mem_tr__moe_arch_mod__prompt_kernel:
    v_lshl_add_u32 v2, v3, 10, v2
    v_lshl_add_u32 v2, v4, 8, v2
    s_lshl_b32 s27, s24, 11
    s_add_u32 s38, s38, s27
    s_mov_b32 m0, s40
    s_mov_b32 s26, s35
    buffer_load_dwordx4 v1, s[4:7], s26 offen offset:0 lds
    buffer_load_dwordx4 v1, s[4:7], s26 offen offset:1024 lds
    buffer_load_dwordx4 v1, s[4:7], s26 offen offset:2048 lds
    buffer_load_dwordx4 v1, s[4:7], s26 offen offset:3072 lds
    s_add_u32 m0, m0, 4096
    s_add_u32 s26, s26, 4096
    buffer_load_dwordx4 v1, s[4:7], s26 offen offset:0 lds
    buffer_load_dwordx4 v1, s[4:7], s26 offen offset:1024 lds
    buffer_load_dwordx4 v1, s[4:7], s26 offen offset:2048 lds
    buffer_load_dwordx4 v1, s[4:7], s26 offen offset:3072 lds
    s_add_u32 m0, m0, 4096
    s_add_u32 s26, s26, 4096
    buffer_load_dwordx4 v1, s[4:7], s26 offen offset:0 lds
    buffer_load_dwordx4 v1, s[4:7], s26 offen offset:1024 lds
    s_add_u32 s35, s35, 81920
    s_add_u32 s41, s40, 40960
    s_mov_b32 m0, s41
    s_mov_b32 s26, s35
    buffer_load_dwordx4 v1, s[4:7], s26 offen offset:0 lds
    buffer_load_dwordx4 v1, s[4:7], s26 offen offset:1024 lds
    buffer_load_dwordx4 v1, s[4:7], s26 offen offset:2048 lds
    buffer_load_dwordx4 v1, s[4:7], s26 offen offset:3072 lds
    s_add_u32 m0, m0, 4096
    s_add_u32 s26, s26, 4096
    buffer_load_dwordx4 v1, s[4:7], s26 offen offset:0 lds
    buffer_load_dwordx4 v1, s[4:7], s26 offen offset:1024 lds
    buffer_load_dwordx4 v1, s[4:7], s26 offen offset:2048 lds
    buffer_load_dwordx4 v1, s[4:7], s26 offen offset:3072 lds
    s_add_u32 m0, m0, 4096
    s_add_u32 s26, s26, 4096
    buffer_load_dwordx4 v1, s[4:7], s26 offen offset:0 lds
    buffer_load_dwordx4 v1, s[4:7], s26 offen offset:1024 lds
    s_add_u32 s35, s35, 81920
    s_mov_b32 s36, 0
    s_mov_b32 s43, 0
    s_mov_b32 s37, 0
    s_mov_b32 s42, 81920
    s_waitcnt vmcnt(10)
L_recugl_206:
    s_barrier
    s_sub_u32 s26, s37, 1
    s_max_i32 s26, s26, s43
    v_mov_b32 v4, s26
    v_mov_b32 v5, 0
    buffer_store_dword v4, v5, s[4:7], s39 offen sc1
    s_cmp_ge_u32 s37, 30
    s_cbranch_scc1 L_recund_208
    s_add_u32 s41, s42, s40
    s_mov_b32 m0, s41
    s_mov_b32 s26, s35
    buffer_load_dwordx4 v1, s[4:7], s26 offen offset:0 lds
    buffer_load_dwordx4 v1, s[4:7], s26 offen offset:1024 lds
    buffer_load_dwordx4 v1, s[4:7], s26 offen offset:2048 lds
    buffer_load_dwordx4 v1, s[4:7], s26 offen offset:3072 lds
    s_add_u32 m0, m0, 4096
    s_add_u32 s26, s26, 4096
    buffer_load_dwordx4 v1, s[4:7], s26 offen offset:0 lds
    buffer_load_dwordx4 v1, s[4:7], s26 offen offset:1024 lds
    buffer_load_dwordx4 v1, s[4:7], s26 offen offset:2048 lds
    buffer_load_dwordx4 v1, s[4:7], s26 offen offset:3072 lds
    s_add_u32 m0, m0, 4096
    s_add_u32 s26, s26, 4096
    buffer_load_dwordx4 v1, s[4:7], s26 offen offset:0 lds
    buffer_load_dwordx4 v1, s[4:7], s26 offen offset:1024 lds
    s_add_u32 s35, s35, 81920
L_recund_208:
    v_add_u32 v3, s36, v1
    ds_read_b128 v[32:35], v3 offset:0
    ds_read_b128 v[36:39], v3 offset:1024
    ds_read_b128 v[40:43], v3 offset:2048
    ds_read_b128 v[44:47], v3 offset:3072
    ds_read_b128 v[48:51], v3 offset:4096
    s_waitcnt lgkmcnt(4)
    v_mfma_f32_32x32x16_bf16 v[16:31], v[32:35], v[96:99], 0
    ds_read_b128 v[32:35], v3 offset:5120
    s_waitcnt lgkmcnt(4)
    v_mfma_f32_32x32x16_bf16 v[16:31], v[36:39], v[100:103], v[16:31]
    ds_read_b128 v[36:39], v3 offset:6144
    s_waitcnt lgkmcnt(4)
    v_mfma_f32_32x32x16_bf16 v[16:31], v[40:43], v[104:107], v[16:31]
    ds_read_b128 v[40:43], v3 offset:7168
    s_waitcnt lgkmcnt(4)
    v_mfma_f32_32x32x16_bf16 v[16:31], v[44:47], v[108:111], v[16:31]
    ds_read_b128 v[44:47], v3 offset:8192
    s_waitcnt lgkmcnt(4)
    v_mfma_f32_32x32x16_bf16 v[16:31], v[48:51], v[112:115], v[16:31]
    ds_read_b128 v[48:51], v3 offset:9216
    s_waitcnt lgkmcnt(4)
    v_mfma_f32_32x32x16_bf16 v[16:31], v[32:35], v[116:119], v[16:31]
    ds_read_b128 v[32:35], v3 offset:10240
    s_waitcnt lgkmcnt(4)
    v_mfma_f32_32x32x16_bf16 v[16:31], v[36:39], v[120:123], v[16:31]
    ds_read_b128 v[36:39], v3 offset:11264
    s_waitcnt lgkmcnt(4)
    v_mfma_f32_32x32x16_bf16 v[16:31], v[40:43], v[124:127], v[16:31]
    ds_read_b128 v[40:43], v3 offset:12288
    s_waitcnt lgkmcnt(4)
    v_mfma_f32_32x32x16_bf16 v[16:31], v[44:47], v[128:131], v[16:31]
    ds_read_b128 v[44:47], v3 offset:13312
    s_waitcnt lgkmcnt(4)
    v_mfma_f32_32x32x16_bf16 v[16:31], v[48:51], v[132:135], v[16:31]
    ds_read_b128 v[48:51], v3 offset:14336
    s_waitcnt lgkmcnt(4)
    v_mfma_f32_32x32x16_bf16 v[16:31], v[32:35], v[136:139], v[16:31]
    ds_read_b128 v[32:35], v3 offset:15360
    s_waitcnt lgkmcnt(4)
    v_mfma_f32_32x32x16_bf16 v[16:31], v[36:39], v[140:143], v[16:31]
    ds_read_b128 v[36:39], v3 offset:16384
    s_waitcnt lgkmcnt(4)
    v_mfma_f32_32x32x16_bf16 v[16:31], v[40:43], v[144:147], v[16:31]
    ds_read_b128 v[40:43], v3 offset:17408
    s_waitcnt lgkmcnt(4)
    v_mfma_f32_32x32x16_bf16 v[16:31], v[44:47], v[148:151], v[16:31]
    ds_read_b128 v[44:47], v3 offset:18432
    s_waitcnt lgkmcnt(4)
    v_mfma_f32_32x32x16_bf16 v[16:31], v[48:51], v[152:155], v[16:31]
    ds_read_b128 v[48:51], v3 offset:19456
    s_waitcnt lgkmcnt(4)
    v_mfma_f32_32x32x16_bf16 v[16:31], v[32:35], v[156:159], v[16:31]
    ds_read_b128 v[32:35], v3 offset:20480
    s_waitcnt lgkmcnt(4)
    v_mfma_f32_32x32x16_bf16 v[16:31], v[36:39], v[160:163], v[16:31]
    ds_read_b128 v[36:39], v3 offset:21504
    s_waitcnt lgkmcnt(4)
    v_mfma_f32_32x32x16_bf16 v[16:31], v[40:43], v[164:167], v[16:31]
    ds_read_b128 v[40:43], v3 offset:22528
    s_waitcnt lgkmcnt(4)
    v_mfma_f32_32x32x16_bf16 v[16:31], v[44:47], v[168:171], v[16:31]
    ds_read_b128 v[44:47], v3 offset:23552
    s_waitcnt lgkmcnt(4)
    v_mfma_f32_32x32x16_bf16 v[16:31], v[48:51], v[172:175], v[16:31]
    ds_read_b128 v[48:51], v3 offset:24576
    s_waitcnt lgkmcnt(4)
    v_mfma_f32_32x32x16_bf16 v[16:31], v[32:35], v[176:179], v[16:31]
    ds_read_b128 v[32:35], v3 offset:25600
    s_waitcnt lgkmcnt(4)
    v_mfma_f32_32x32x16_bf16 v[16:31], v[36:39], v[180:183], v[16:31]
    ds_read_b128 v[36:39], v3 offset:26624
    s_waitcnt lgkmcnt(4)
    v_mfma_f32_32x32x16_bf16 v[16:31], v[40:43], v[184:187], v[16:31]
    ds_read_b128 v[40:43], v3 offset:27648
    s_waitcnt lgkmcnt(4)
    v_mfma_f32_32x32x16_bf16 v[16:31], v[44:47], v[188:191], v[16:31]
    ds_read_b128 v[44:47], v3 offset:28672
    s_waitcnt lgkmcnt(4)
    v_mfma_f32_32x32x16_bf16 v[16:31], v[48:51], v[192:195], v[16:31]
    ds_read_b128 v[48:51], v3 offset:29696
    s_waitcnt lgkmcnt(4)
    v_mfma_f32_32x32x16_bf16 v[16:31], v[32:35], v[196:199], v[16:31]
    ds_read_b128 v[32:35], v3 offset:30720
    s_waitcnt lgkmcnt(4)
    v_mfma_f32_32x32x16_bf16 v[16:31], v[36:39], v[200:203], v[16:31]
    ds_read_b128 v[36:39], v3 offset:31744
    s_waitcnt lgkmcnt(4)
    v_mfma_f32_32x32x16_bf16 v[16:31], v[40:43], v[204:207], v[16:31]
    ds_read_b128 v[40:43], v3 offset:32768
    s_waitcnt lgkmcnt(4)
    v_mfma_f32_32x32x16_bf16 v[16:31], v[44:47], v[208:211], v[16:31]
    ds_read_b128 v[44:47], v3 offset:33792
    s_waitcnt lgkmcnt(4)
    v_mfma_f32_32x32x16_bf16 v[16:31], v[48:51], v[212:215], v[16:31]
    ds_read_b128 v[48:51], v3 offset:34816
    s_waitcnt lgkmcnt(4)
    v_mfma_f32_32x32x16_bf16 v[16:31], v[32:35], v[216:219], v[16:31]
    ds_read_b128 v[32:35], v3 offset:35840
    s_waitcnt lgkmcnt(4)
    v_mfma_f32_32x32x16_bf16 v[16:31], v[36:39], v[220:223], v[16:31]
    ds_read_b128 v[36:39], v3 offset:36864
    s_waitcnt lgkmcnt(4)
    v_mfma_f32_32x32x16_bf16 v[16:31], v[40:43], v[224:227], v[16:31]
    ds_read_b128 v[40:43], v3 offset:37888
    s_waitcnt lgkmcnt(4)
    v_mfma_f32_32x32x16_bf16 v[16:31], v[44:47], v[228:231], v[16:31]
    ds_read_b128 v[44:47], v3 offset:38912
    s_waitcnt lgkmcnt(4)
    v_mfma_f32_32x32x16_bf16 v[16:31], v[48:51], v[232:235], v[16:31]
    ds_read_b128 v[48:51], v3 offset:39936
    s_waitcnt lgkmcnt(4)
    v_mfma_f32_32x32x16_bf16 v[16:31], v[32:35], v[236:239], v[16:31]
    s_waitcnt lgkmcnt(3)
    v_mfma_f32_32x32x16_bf16 v[16:31], v[36:39], v[240:243], v[16:31]
    s_waitcnt lgkmcnt(2)
    v_mfma_f32_32x32x16_bf16 v[16:31], v[40:43], v[244:247], v[16:31]
    s_waitcnt lgkmcnt(1)
    v_mfma_f32_32x32x16_bf16 v[16:31], v[44:47], v[248:251], v[16:31]
    s_waitcnt lgkmcnt(0)
    v_mfma_f32_32x32x16_bf16 v[16:31], v[48:51], v[252:255], v[16:31]
    s_add_u32 s36, s36, 40960
    s_cmp_eq_u32 s36, 122880
    s_cselect_b32 s36, 0, s36
    s_add_u32 s42, s42, 40960
    s_cmp_eq_u32 s42, 122880
    s_cselect_b32 s42, 0, s42
    s_nop 5
    v_cvt_pk_bf16_f32 v8, v16, v17
    v_cvt_pk_bf16_f32 v9, v18, v19
    v_cvt_pk_bf16_f32 v10, v24, v25
    v_cvt_pk_bf16_f32 v11, v26, v27
    v_cvt_pk_bf16_f32 v12, v20, v21
    v_cvt_pk_bf16_f32 v13, v22, v23
    v_cvt_pk_bf16_f32 v14, v28, v29
    v_cvt_pk_bf16_f32 v15, v30, v31
    buffer_store_dwordx4 v[8:11], v2, s[4:7], s38 offen sc1
    buffer_store_dwordx4 v[12:15], v2, s[4:7], s38 offen offset:512 sc1
    s_add_u32 s38, s38, 524288
    s_add_u32 s37, s37, 1
    s_cmp_le_u32 s37, 2
    s_cbranch_scc0 L_recun0_210
    s_waitcnt vmcnt(0)
    s_mov_b32 s43, s37
L_recun0_210:
    s_cmp_ge_u32 s37, 31
    s_cbranch_scc0 L_recun1_211
    s_waitcnt vmcnt(2)
L_recun1_211:
    s_waitcnt vmcnt(13)
    s_cmp_lt_u32 s37, 32
    s_cbranch_scc1 L_recugl_206
    s_waitcnt vmcnt(0)
    v_mov_b32 v4, 32
    v_mov_b32 v5, 0
    buffer_store_dword v4, v5, s[4:7], s39 offen sc1
L_gend_recurrent_scan__memory_aug_recurrent_mem_tr__moe_arch_mod__prompt_kernel:
    s_waitcnt vmcnt(0)
    s_barrier
    s_cmp_ge_u32 s25, 160
    s_cbranch_scc1 L_recuat_212
    s_cmp_ge_u32 s25, 148
    s_cbranch_scc1 L_recuwo_213
    v_lshlrev_b32 v1, 7, v0
    s_mov_b32 s26, 5373952
    s_mov_b32 s27, 0
L_recuwln_215:
    buffer_load_dwordx4 v[4:7], v1, s[4:7], s26 offen sc1
    s_waitcnt vmcnt(0)
    v_min_u32 v4, v4, v5
    v_min3_u32 v4, v4, v6, v7
    v_cmp_gt_u32 vcc, 2, v4
    s_cbranch_vccz L_recuwlnok_216
    s_add_u32 s27, s27, 1
    s_cmp_lt_u32 s27, 400000
    s_cbranch_scc0 L_exit_recurrent_scan__memory_aug_recurrent_mem_tr__moe_arch_mod__prompt_kernel
    s_sleep 2
    s_branch L_recuwln_215
L_recuwlnok_216:
    v_lshlrev_b32 v1, 4, v0
    s_mov_b32 s26, 5242880
    s_add_u32 s27, s26, 4096
    buffer_load_dwordx4 v[8:11], v1, s[4:7], s26 offen offset:0 sc1
    buffer_load_dwordx4 v[12:15], v1, s[4:7], s26 offen offset:1024 sc1
    buffer_load_dwordx4 v[16:19], v1, s[4:7], s26 offen offset:2048 sc1
    buffer_load_dwordx4 v[20:23], v1, s[4:7], s26 offen offset:3072 sc1
    buffer_load_dwordx4 v[24:27], v1, s[4:7], s27 offen offset:0 sc1
    buffer_load_dwordx4 v[28:31], v1, s[4:7], s27 offen offset:1024 sc1
    buffer_load_dwordx4 v[32:35], v1, s[4:7], s27 offen offset:2048 sc1
    buffer_load_dwordx4 v[36:39], v1, s[4:7], s27 offen offset:3072 sc1
    v_lshlrev_b32 v2, 2, v0
    v_sub_u32 v2, 2047, v2
    s_waitcnt vmcnt(0)
    v_ashrrev_i32 v3, 31, v8
    v_or_b32 v3, 0x80000000, v3
    v_xor_b32 v8, v3, v8
    v_and_b32 v8, 0xffff0000, v8
    v_subrev_u32 v3, 0, v2
    v_or_b32 v8, v3, v8
    v_ashrrev_i32 v3, 31, v9
    v_or_b32 v3, 0x80000000, v3
    v_xor_b32 v9, v3, v9
    v_and_b32 v9, 0xffff0000, v9
    v_subrev_u32 v3, 1, v2
    v_or_b32 v9, v3, v9
    v_ashrrev_i32 v3, 31, v10
    v_or_b32 v3, 0x80000000, v3
    v_xor_b32 v10, v3, v10
    v_and_b32 v10, 0xffff0000, v10
    v_subrev_u32 v3, 2, v2
    v_or_b32 v10, v3, v10
    v_ashrrev_i32 v3, 31, v11
    v_or_b32 v3, 0x80000000, v3
    v_xor_b32 v11, v3, v11
    v_and_b32 v11, 0xffff0000, v11
    v_subrev_u32 v3, 3, v2
    v_or_b32 v11, v3, v11
    v_ashrrev_i32 v3, 31, v12
    v_or_b32 v3, 0x80000000, v3
    v_xor_b32 v12, v3, v12
    v_and_b32 v12, 0xffff0000, v12
    v_subrev_u32 v3, 256, v2
    v_or_b32 v12, v3, v12
    v_ashrrev_i32 v3, 31, v13
    v_or_b32 v3, 0x80000000, v3
    v_xor_b32 v13, v3, v13
    v_and_b32 v13, 0xffff0000, v13
    v_subrev_u32 v3, 257, v2
    v_or_b32 v13, v3, v13
    v_ashrrev_i32 v3, 31, v14
    v_or_b32 v3, 0x80000000, v3
    v_xor_b32 v14, v3, v14
    v_and_b32 v14, 0xffff0000, v14
    v_subrev_u32 v3, 258, v2
    v_or_b32 v14, v3, v14
    v_ashrrev_i32 v3, 31, v15
    v_or_b32 v3, 0x80000000, v3
    v_xor_b32 v15, v3, v15
    v_and_b32 v15, 0xffff0000, v15
    v_subrev_u32 v3, 259, v2
    v_or_b32 v15, v3, v15
    v_ashrrev_i32 v3, 31, v16
    v_or_b32 v3, 0x80000000, v3
    v_xor_b32 v16, v3, v16
    v_and_b32 v16, 0xffff0000, v16
    v_subrev_u32 v3, 512, v2
    v_or_b32 v16, v3, v16
    v_ashrrev_i32 v3, 31, v17
    v_or_b32 v3, 0x80000000, v3
    v_xor_b32 v17, v3, v17
    v_and_b32 v17, 0xffff0000, v17
    v_subrev_u32 v3, 513, v2
    v_or_b32 v17, v3, v17
    v_ashrrev_i32 v3, 31, v18
    v_or_b32 v3, 0x80000000, v3
    v_xor_b32 v18, v3, v18
    v_and_b32 v18, 0xffff0000, v18
    v_subrev_u32 v3, 514, v2
    v_or_b32 v18, v3, v18
    v_ashrrev_i32 v3, 31, v19
    v_or_b32 v3, 0x80000000, v3
    v_xor_b32 v19, v3, v19
    v_and_b32 v19, 0xffff0000, v19
    v_subrev_u32 v3, 515, v2
    v_or_b32 v19, v3, v19
    v_ashrrev_i32 v3, 31, v20
    v_or_b32 v3, 0x80000000, v3
    v_xor_b32 v20, v3, v20
    v_and_b32 v20, 0xffff0000, v20
    v_subrev_u32 v3, 768, v2
    v_or_b32 v20, v3, v20
    v_ashrrev_i32 v3, 31, v21
    v_or_b32 v3, 0x80000000, v3
    v_xor_b32 v21, v3, v21
    v_and_b32 v21, 0xffff0000, v21
    v_subrev_u32 v3, 769, v2
    v_or_b32 v21, v3, v21
    v_ashrrev_i32 v3, 31, v22
    v_or_b32 v3, 0x80000000, v3
    v_xor_b32 v22, v3, v22
    v_and_b32 v22, 0xffff0000, v22
    v_subrev_u32 v3, 770, v2
    v_or_b32 v22, v3, v22
    v_ashrrev_i32 v3, 31, v23
    v_or_b32 v3, 0x80000000, v3
    v_xor_b32 v23, v3, v23
    v_and_b32 v23, 0xffff0000, v23
    v_subrev_u32 v3, 771, v2
    v_or_b32 v23, v3, v23
    v_ashrrev_i32 v3, 31, v24
    v_or_b32 v3, 0x80000000, v3
    v_xor_b32 v24, v3, v24
    v_and_b32 v24, 0xffff0000, v24
    v_subrev_u32 v3, 1024, v2
    v_or_b32 v24, v3, v24
    v_ashrrev_i32 v3, 31, v25
    v_or_b32 v3, 0x80000000, v3
    v_xor_b32 v25, v3, v25
    v_and_b32 v25, 0xffff0000, v25
    v_subrev_u32 v3, 1025, v2
    v_or_b32 v25, v3, v25
    v_ashrrev_i32 v3, 31, v26
    v_or_b32 v3, 0x80000000, v3
    v_xor_b32 v26, v3, v26
    v_and_b32 v26, 0xffff0000, v26
    v_subrev_u32 v3, 1026, v2
    v_or_b32 v26, v3, v26
    v_ashrrev_i32 v3, 31, v27
    v_or_b32 v3, 0x80000000, v3
    v_xor_b32 v27, v3, v27
    v_and_b32 v27, 0xffff0000, v27
    v_subrev_u32 v3, 1027, v2
    v_or_b32 v27, v3, v27
    v_ashrrev_i32 v3, 31, v28
    v_or_b32 v3, 0x80000000, v3
    v_xor_b32 v28, v3, v28
    v_and_b32 v28, 0xffff0000, v28
    v_subrev_u32 v3, 1280, v2
    v_or_b32 v28, v3, v28
    v_ashrrev_i32 v3, 31, v29
    v_or_b32 v3, 0x80000000, v3
    v_xor_b32 v29, v3, v29
    v_and_b32 v29, 0xffff0000, v29
    v_subrev_u32 v3, 1281, v2
    v_or_b32 v29, v3, v29
    v_ashrrev_i32 v3, 31, v30
    v_or_b32 v3, 0x80000000, v3
    v_xor_b32 v30, v3, v30
    v_and_b32 v30, 0xffff0000, v30
    v_subrev_u32 v3, 1282, v2
    v_or_b32 v30, v3, v30
    v_ashrrev_i32 v3, 31, v31
    v_or_b32 v3, 0x80000000, v3
    v_xor_b32 v31, v3, v31
    v_and_b32 v31, 0xffff0000, v31
    v_subrev_u32 v3, 1283, v2
    v_or_b32 v31, v3, v31
    v_ashrrev_i32 v3, 31, v32
    v_or_b32 v3, 0x80000000, v3
    v_xor_b32 v32, v3, v32
    v_and_b32 v32, 0xffff0000, v32
    v_subrev_u32 v3, 1536, v2
    v_or_b32 v32, v3, v32
    v_ashrrev_i32 v3, 31, v33
    v_or_b32 v3, 0x80000000, v3
    v_xor_b32 v33, v3, v33
    v_and_b32 v33, 0xffff0000, v33
    v_subrev_u32 v3, 1537, v2
    v_or_b32 v33, v3, v33
    v_ashrrev_i32 v3, 31, v34
    v_or_b32 v3, 0x80000000, v3
    v_xor_b32 v34, v3, v34
    v_and_b32 v34, 0xffff0000, v34
    v_subrev_u32 v3, 1538, v2
    v_or_b32 v34, v3, v34
    v_ashrrev_i32 v3, 31, v35
    v_or_b32 v3, 0x80000000, v3
    v_xor_b32 v35, v3, v35
    v_and_b32 v35, 0xffff0000, v35
    v_subrev_u32 v3, 1539, v2
    v_or_b32 v35, v3, v35
    v_ashrrev_i32 v3, 31, v36
    v_or_b32 v3, 0x80000000, v3
    v_xor_b32 v36, v3, v36
    v_and_b32 v36, 0xffff0000, v36
    v_subrev_u32 v3, 1792, v2
    v_or_b32 v36, v3, v36
    v_ashrrev_i32 v3, 31, v37
    v_or_b32 v3, 0x80000000, v3
    v_xor_b32 v37, v3, v37
    v_and_b32 v37, 0xffff0000, v37
    v_subrev_u32 v3, 1793, v2
    v_or_b32 v37, v3, v37
    v_ashrrev_i32 v3, 31, v38
    v_or_b32 v3, 0x80000000, v3
    v_xor_b32 v38, v3, v38
    v_and_b32 v38, 0xffff0000, v38
    v_subrev_u32 v3, 1794, v2
    v_or_b32 v38, v3, v38
    v_ashrrev_i32 v3, 31, v39
    v_or_b32 v3, 0x80000000, v3
    v_xor_b32 v39, v3, v39
    v_and_b32 v39, 0xffff0000, v39
    v_subrev_u32 v3, 1795, v2
    v_or_b32 v39, v3, v39
    v_max3_u32 v3, v8, v9, v10
    v_max3_u32 v3, v3, v11, v12
    v_max3_u32 v3, v3, v13, v14
    v_max3_u32 v3, v3, v15, v16
    v_max3_u32 v3, v3, v17, v18
    v_max3_u32 v3, v3, v19, v20
    v_max3_u32 v3, v3, v21, v22
    v_max3_u32 v3, v3, v23, v24
    v_max3_u32 v3, v3, v25, v26
    v_max3_u32 v3, v3, v27, v28
    v_max3_u32 v3, v3, v29, v30
    v_max3_u32 v3, v3, v31, v32
    v_max3_u32 v3, v3, v33, v34
    v_max3_u32 v3, v3, v35, v36
    v_max3_u32 v3, v3, v37, v38
    v_max_u32 v3, v3, v39
    s_nop 1
    v_max_u32_dpp v3, v3, v3 quad_perm:[1,0,3,2] row_mask:0xf bank_mask:0xf
    s_nop 1
    v_max_u32_dpp v3, v3, v3 quad_perm:[2,3,0,1] row_mask:0xf bank_mask:0xf
    s_nop 1
    v_max_u32_dpp v3, v3, v3 row_half_mirror row_mask:0xf bank_mask:0xf
    s_nop 1
    v_max_u32_dpp v3, v3, v3 row_mirror row_mask:0xf bank_mask:0xf
    s_nop 0
    v_readlane_b32 s26, v3, 0
    v_readlane_b32 s27, v3, 16
    v_readlane_b32 s28, v3, 32
    v_readlane_b32 s29, v3, 48
    s_max_u32 s26, s26, s27
    s_max_u32 s28, s28, s29
    s_max_u32 s26, s26, s28
    s_and_b32 s27, s26, 0x7ff
    s_sub_u32 s44, 2047, s27
    s_not_b32 s27, s26
    s_xor_b32 s28, s26, 0x80000000
    s_bitcmp1_b32 s26, 31
    s_cselect_b32 s27, s28, s27
    s_and_b32 s52, s27, 0xffff0000
    v_cmp_ne_u32 s[60:61], s26, v8
    v_cmp_ne_u32 s[62:63], s26, v9
    v_cmp_ne_u32 s[64:65], s26, v10
    v_cmp_ne_u32 s[66:67], s26, v11
    v_cndmask_b32 v8, 0, v8, s[60:61]
    v_cndmask_b32 v9, 0, v9, s[62:63]
    v_cndmask_b32 v10, 0, v10, s[64:65]
    v_cndmask_b32 v11, 0, v11, s[66:67]
    v_cmp_ne_u32 s[60:61], s26, v12
    v_cmp_ne_u32 s[62:63], s26, v13
    v_cmp_ne_u32 s[64:65], s26, v14
    v_cmp_ne_u32 s[66:67], s26, v15
    v_cndmask_b32 v12, 0, v12, s[60:61]
    v_cndmask_b32 v13, 0, v13, s[62:63]
    v_cndmask_b32 v14, 0, v14, s[64:65]
    v_cndmask_b32 v15, 0, v15, s[66:67]
    v_cmp_ne_u32 s[60:61], s26, v16
    v_cmp_ne_u32 s[62:63], s26, v17
    v_cmp_ne_u32 s[64:65], s26, v18
    v_cmp_ne_u32 s[66:67], s26, v19
    v_cndmask_b32 v16, 0, v16, s[60:61]
    v_cndmask_b32 v17, 0, v17, s[62:63]
    v_cndmask_b32 v18, 0, v18, s[64:65]
    v_cndmask_b32 v19, 0, v19, s[66:67]
    v_cmp_ne_u32 s[60:61], s26, v20
    v_cmp_ne_u32 s[62:63], s26, v21
    v_cmp_ne_u32 s[64:65], s26, v22
    v_cmp_ne_u32 s[66:67], s26, v23
    v_cndmask_b32 v20, 0, v20, s[60:61]
    v_cndmask_b32 v21, 0, v21, s[62:63]
    v_cndmask_b32 v22, 0, v22, s[64:65]
    v_cndmask_b32 v23, 0, v23, s[66:67]
    v_cmp_ne_u32 s[60:61], s26, v24
    v_cmp_ne_u32 s[62:63], s26, v25
    v_cmp_ne_u32 s[64:65], s26, v26
    v_cmp_ne_u32 s[66:67], s26, v27
    v_cndmask_b32 v24, 0, v24, s[60:61]
    v_cndmask_b32 v25, 0, v25, s[62:63]
    v_cndmask_b32 v26, 0, v26, s[64:65]
    v_cndmask_b32 v27, 0, v27, s[66:67]
    v_cmp_ne_u32 s[60:61], s26, v28
    v_cmp_ne_u32 s[62:63], s26, v29
    v_cmp_ne_u32 s[64:65], s26, v30
    v_cmp_ne_u32 s[66:67], s26, v31
    v_cndmask_b32 v28, 0, v28, s[60:61]
    v_cndmask_b32 v29, 0, v29, s[62:63]
    v_cndmask_b32 v30, 0, v30, s[64:65]
    v_cndmask_b32 v31, 0, v31, s[66:67]
    v_cmp_ne_u32 s[60:61], s26, v32
    v_cmp_ne_u32 s[62:63], s26, v33
    v_cmp_ne_u32 s[64:65], s26, v34
    v_cmp_ne_u32 s[66:67], s26, v35
    v_cndmask_b32 v32, 0, v32, s[60:61]
    v_cndmask_b32 v33, 0, v33, s[62:63]
    v_cndmask_b32 v34, 0, v34, s[64:65]
    v_cndmask_b32 v35, 0, v35, s[66:67]
    v_cmp_ne_u32 s[60:61], s26, v36
    v_cmp_ne_u32 s[62:63], s26, v37
    v_cmp_ne_u32 s[64:65], s26, v38
    v_cmp_ne_u32 s[66:67], s26, v39
    v_cndmask_b32 v36, 0, v36, s[60:61]
    v_cndmask_b32 v37, 0, v37, s[62:63]
    v_cndmask_b32 v38, 0, v38, s[64:65]
    v_cndmask_b32 v39, 0, v39, s[66:67]
    v_max3_u32 v3, v8, v9, v10
    v_max3_u32 v3, v3, v11, v12
    v_max3_u32 v3, v3, v13, v14
    v_max3_u32 v3, v3, v15, v16
    v_max3_u32 v3, v3, v17, v18
    v_max3_u32 v3, v3, v19, v20
    v_max3_u32 v3, v3, v21, v22
    v_max3_u32 v3, v3, v23, v24
    v_max3_u32 v3, v3, v25, v26
    v_max3_u32 v3, v3, v27, v28
    v_max3_u32 v3, v3, v29, v30
    v_max3_u32 v3, v3, v31, v32
    v_max3_u32 v3, v3, v33, v34
    v_max3_u32 v3, v3, v35, v36
    v_max3_u32 v3, v3, v37, v38
    v_max_u32 v3, v3, v39
    s_nop 1
    v_max_u32_dpp v3, v3, v3 quad_perm:[1,0,3,2] row_mask:0xf bank_mask:0xf
    s_nop 1
    v_max_u32_dpp v3, v3, v3 quad_perm:[2,3,0,1] row_mask:0xf bank_mask:0xf
    s_nop 1
    v_max_u32_dpp v3, v3, v3 row_half_mirror row_mask:0xf bank_mask:0xf
    s_nop 1
    v_max_u32_dpp v3, v3, v3 row_mirror row_mask:0xf bank_mask:0xf
    s_nop 0
    v_readlane_b32 s26, v3, 0
    v_readlane_b32 s27, v3, 16
    v_readlane_b32 s28, v3, 32
    v_readlane_b32 s29, v3, 48
    s_max_u32 s26, s26, s27
    s_max_u32 s28, s28, s29
    s_max_u32 s26, s26, s28
    s_and_b32 s27, s26, 0x7ff
    s_sub_u32 s45, 2047, s27
    s_not_b32 s27, s26
    s_xor_b32 s28, s26, 0x80000000
    s_bitcmp1_b32 s26, 31
    s_cselect_b32 s27, s28, s27
    s_and_b32 s53, s27, 0xffff0000
    v_cmp_ne_u32 s[60:61], s26, v8
    v_cmp_ne_u32 s[62:63], s26, v9
    v_cmp_ne_u32 s[64:65], s26, v10
    v_cmp_ne_u32 s[66:67], s26, v11
    v_cndmask_b32 v8, 0, v8, s[60:61]
    v_cndmask_b32 v9, 0, v9, s[62:63]
    v_cndmask_b32 v10, 0, v10, s[64:65]
    v_cndmask_b32 v11, 0, v11, s[66:67]
    v_cmp_ne_u32 s[60:61], s26, v12
    v_cmp_ne_u32 s[62:63], s26, v13
    v_cmp_ne_u32 s[64:65], s26, v14
    v_cmp_ne_u32 s[66:67], s26, v15
    v_cndmask_b32 v12, 0, v12, s[60:61]
    v_cndmask_b32 v13, 0, v13, s[62:63]
    v_cndmask_b32 v14, 0, v14, s[64:65]
    v_cndmask_b32 v15, 0, v15, s[66:67]
    v_cmp_ne_u32 s[60:61], s26, v16
    v_cmp_ne_u32 s[62:63], s26, v17
    v_cmp_ne_u32 s[64:65], s26, v18
    v_cmp_ne_u32 s[66:67], s26, v19
    v_cndmask_b32 v16, 0, v16, s[60:61]
    v_cndmask_b32 v17, 0, v17, s[62:63]
    v_cndmask_b32 v18, 0, v18, s[64:65]
    v_cndmask_b32 v19, 0, v19, s[66:67]
    v_cmp_ne_u32 s[60:61], s26, v20
    v_cmp_ne_u32 s[62:63], s26, v21
    v_cmp_ne_u32 s[64:65], s26, v22
    v_cmp_ne_u32 s[66:67], s26, v23
    v_cndmask_b32 v20, 0, v20, s[60:61]
    v_cndmask_b32 v21, 0, v21, s[62:63]
    v_cndmask_b32 v22, 0, v22, s[64:65]
    v_cndmask_b32 v23, 0, v23, s[66:67]
    v_cmp_ne_u32 s[60:61], s26, v24
    v_cmp_ne_u32 s[62:63], s26, v25
    v_cmp_ne_u32 s[64:65], s26, v26
    v_cmp_ne_u32 s[66:67], s26, v27
    v_cndmask_b32 v24, 0, v24, s[60:61]
    v_cndmask_b32 v25, 0, v25, s[62:63]
    v_cndmask_b32 v26, 0, v26, s[64:65]
    v_cndmask_b32 v27, 0, v27, s[66:67]
    v_cmp_ne_u32 s[60:61], s26, v28
    v_cmp_ne_u32 s[62:63], s26, v29
    v_cmp_ne_u32 s[64:65], s26, v30
    v_cmp_ne_u32 s[66:67], s26, v31
    v_cndmask_b32 v28, 0, v28, s[60:61]
    v_cndmask_b32 v29, 0, v29, s[62:63]
    v_cndmask_b32 v30, 0, v30, s[64:65]
    v_cndmask_b32 v31, 0, v31, s[66:67]
    v_cmp_ne_u32 s[60:61], s26, v32
    v_cmp_ne_u32 s[62:63], s26, v33
    v_cmp_ne_u32 s[64:65], s26, v34
    v_cmp_ne_u32 s[66:67], s26, v35
    v_cndmask_b32 v32, 0, v32, s[60:61]
    v_cndmask_b32 v33, 0, v33, s[62:63]
    v_cndmask_b32 v34, 0, v34, s[64:65]
    v_cndmask_b32 v35, 0, v35, s[66:67]
    v_cmp_ne_u32 s[60:61], s26, v36
    v_cmp_ne_u32 s[62:63], s26, v37
    v_cmp_ne_u32 s[64:65], s26, v38
    v_cmp_ne_u32 s[66:67], s26, v39
    v_cndmask_b32 v36, 0, v36, s[60:61]
    v_cndmask_b32 v37, 0, v37, s[62:63]
    v_cndmask_b32 v38, 0, v38, s[64:65]
    v_cndmask_b32 v39, 0, v39, s[66:67]
    v_max3_u32 v3, v8, v9, v10
    v_max3_u32 v3, v3, v11, v12
    v_max3_u32 v3, v3, v13, v14
    v_max3_u32 v3, v3, v15, v16
    v_max3_u32 v3, v3, v17, v18
    v_max3_u32 v3, v3, v19, v20
    v_max3_u32 v3, v3, v21, v22
    v_max3_u32 v3, v3, v23, v24
    v_max3_u32 v3, v3, v25, v26
    v_max3_u32 v3, v3, v27, v28
    v_max3_u32 v3, v3, v29, v30
    v_max3_u32 v3, v3, v31, v32
    v_max3_u32 v3, v3, v33, v34
    v_max3_u32 v3, v3, v35, v36
    v_max3_u32 v3, v3, v37, v38
    v_max_u32 v3, v3, v39
    s_nop 1
    v_max_u32_dpp v3, v3, v3 quad_perm:[1,0,3,2] row_mask:0xf bank_mask:0xf
    s_nop 1
    v_max_u32_dpp v3, v3, v3 quad_perm:[2,3,0,1] row_mask:0xf bank_mask:0xf
    s_nop 1
    v_max_u32_dpp v3, v3, v3 row_half_mirror row_mask:0xf bank_mask:0xf
    s_nop 1
    v_max_u32_dpp v3, v3, v3 row_mirror row_mask:0xf bank_mask:0xf
    s_nop 0
    v_readlane_b32 s26, v3, 0
    v_readlane_b32 s27, v3, 16
    v_readlane_b32 s28, v3, 32
    v_readlane_b32 s29, v3, 48
    s_max_u32 s26, s26, s27
    s_max_u32 s28, s28, s29
    s_max_u32 s26, s26, s28
    s_and_b32 s27, s26, 0x7ff
    s_sub_u32 s46, 2047, s27
    s_not_b32 s27, s26
    s_xor_b32 s28, s26, 0x80000000
    s_bitcmp1_b32 s26, 31
    s_cselect_b32 s27, s28, s27
    s_and_b32 s54, s27, 0xffff0000
    v_cmp_ne_u32 s[60:61], s26, v8
    v_cmp_ne_u32 s[62:63], s26, v9
    v_cmp_ne_u32 s[64:65], s26, v10
    v_cmp_ne_u32 s[66:67], s26, v11
    v_cndmask_b32 v8, 0, v8, s[60:61]
    v_cndmask_b32 v9, 0, v9, s[62:63]
    v_cndmask_b32 v10, 0, v10, s[64:65]
    v_cndmask_b32 v11, 0, v11, s[66:67]
    v_cmp_ne_u32 s[60:61], s26, v12
    v_cmp_ne_u32 s[62:63], s26, v13
    v_cmp_ne_u32 s[64:65], s26, v14
    v_cmp_ne_u32 s[66:67], s26, v15
    v_cndmask_b32 v12, 0, v12, s[60:61]
    v_cndmask_b32 v13, 0, v13, s[62:63]
    v_cndmask_b32 v14, 0, v14, s[64:65]
    v_cndmask_b32 v15, 0, v15, s[66:67]
    v_cmp_ne_u32 s[60:61], s26, v16
    v_cmp_ne_u32 s[62:63], s26, v17
    v_cmp_ne_u32 s[64:65], s26, v18
    v_cmp_ne_u32 s[66:67], s26, v19
    v_cndmask_b32 v16, 0, v16, s[60:61]
    v_cndmask_b32 v17, 0, v17, s[62:63]
    v_cndmask_b32 v18, 0, v18, s[64:65]
    v_cndmask_b32 v19, 0, v19, s[66:67]
    v_cmp_ne_u32 s[60:61], s26, v20
    v_cmp_ne_u32 s[62:63], s26, v21
    v_cmp_ne_u32 s[64:65], s26, v22
    v_cmp_ne_u32 s[66:67], s26, v23
    v_cndmask_b32 v20, 0, v20, s[60:61]
    v_cndmask_b32 v21, 0, v21, s[62:63]
    v_cndmask_b32 v22, 0, v22, s[64:65]
    v_cndmask_b32 v23, 0, v23, s[66:67]
    v_cmp_ne_u32 s[60:61], s26, v24
    v_cmp_ne_u32 s[62:63], s26, v25
    v_cmp_ne_u32 s[64:65], s26, v26
    v_cmp_ne_u32 s[66:67], s26, v27
    v_cndmask_b32 v24, 0, v24, s[60:61]
    v_cndmask_b32 v25, 0, v25, s[62:63]
    v_cndmask_b32 v26, 0, v26, s[64:65]
    v_cndmask_b32 v27, 0, v27, s[66:67]
    v_cmp_ne_u32 s[60:61], s26, v28
    v_cmp_ne_u32 s[62:63], s26, v29
    v_cmp_ne_u32 s[64:65], s26, v30
    v_cmp_ne_u32 s[66:67], s26, v31
    v_cndmask_b32 v28, 0, v28, s[60:61]
    v_cndmask_b32 v29, 0, v29, s[62:63]
    v_cndmask_b32 v30, 0, v30, s[64:65]
    v_cndmask_b32 v31, 0, v31, s[66:67]
    v_cmp_ne_u32 s[60:61], s26, v32
    v_cmp_ne_u32 s[62:63], s26, v33
    v_cmp_ne_u32 s[64:65], s26, v34
    v_cmp_ne_u32 s[66:67], s26, v35
    v_cndmask_b32 v32, 0, v32, s[60:61]
    v_cndmask_b32 v33, 0, v33, s[62:63]
    v_cndmask_b32 v34, 0, v34, s[64:65]
    v_cndmask_b32 v35, 0, v35, s[66:67]
    v_cmp_ne_u32 s[60:61], s26, v36
    v_cmp_ne_u32 s[62:63], s26, v37
    v_cmp_ne_u32 s[64:65], s26, v38
    v_cmp_ne_u32 s[66:67], s26, v39
    v_cndmask_b32 v36, 0, v36, s[60:61]
    v_cndmask_b32 v37, 0, v37, s[62:63]
    v_cndmask_b32 v38, 0, v38, s[64:65]
    v_cndmask_b32 v39, 0, v39, s[66:67]
    v_max3_u32 v3, v8, v9, v10
    v_max3_u32 v3, v3, v11, v12
    v_max3_u32 v3, v3, v13, v14
    v_max3_u32 v3, v3, v15, v16
    v_max3_u32 v3, v3, v17, v18
    v_max3_u32 v3, v3, v19, v20
    v_max3_u32 v3, v3, v21, v22
    v_max3_u32 v3, v3, v23, v24
    v_max3_u32 v3, v3, v25, v26
    v_max3_u32 v3, v3, v27, v28
    v_max3_u32 v3, v3, v29, v30
    v_max3_u32 v3, v3, v31, v32
    v_max3_u32 v3, v3, v33, v34
    v_max3_u32 v3, v3, v35, v36
    v_max3_u32 v3, v3, v37, v38
    v_max_u32 v3, v3, v39
    s_nop 1
    v_max_u32_dpp v3, v3, v3 quad_perm:[1,0,3,2] row_mask:0xf bank_mask:0xf
    s_nop 1
    v_max_u32_dpp v3, v3, v3 quad_perm:[2,3,0,1] row_mask:0xf bank_mask:0xf
    s_nop 1
    v_max_u32_dpp v3, v3, v3 row_half_mirror row_mask:0xf bank_mask:0xf
    s_nop 1
    v_max_u32_dpp v3, v3, v3 row_mirror row_mask:0xf bank_mask:0xf
    s_nop 0
    v_readlane_b32 s26, v3, 0
    v_readlane_b32 s27, v3, 16
    v_readlane_b32 s28, v3, 32
    v_readlane_b32 s29, v3, 48
    s_max_u32 s26, s26, s27
    s_max_u32 s28, s28, s29
    s_max_u32 s26, s26, s28
    s_and_b32 s27, s26, 0x7ff
    s_sub_u32 s47, 2047, s27
    s_not_b32 s27, s26
    s_xor_b32 s28, s26, 0x80000000
    s_bitcmp1_b32 s26, 31
    s_cselect_b32 s27, s28, s27
    s_and_b32 s55, s27, 0xffff0000
    v_cmp_ne_u32 s[60:61], s26, v8
    v_cmp_ne_u32 s[62:63], s26, v9
    v_cmp_ne_u32 s[64:65], s26, v10
    v_cmp_ne_u32 s[66:67], s26, v11
    v_cndmask_b32 v8, 0, v8, s[60:61]
    v_cndmask_b32 v9, 0, v9, s[62:63]
    v_cndmask_b32 v10, 0, v10, s[64:65]
    v_cndmask_b32 v11, 0, v11, s[66:67]
    v_cmp_ne_u32 s[60:61], s26, v12
    v_cmp_ne_u32 s[62:63], s26, v13
    v_cmp_ne_u32 s[64:65], s26, v14
    v_cmp_ne_u32 s[66:67], s26, v15
    v_cndmask_b32 v12, 0, v12, s[60:61]
    v_cndmask_b32 v13, 0, v13, s[62:63]
    v_cndmask_b32 v14, 0, v14, s[64:65]
    v_cndmask_b32 v15, 0, v15, s[66:67]
    v_cmp_ne_u32 s[60:61], s26, v16
    v_cmp_ne_u32 s[62:63], s26, v17
    v_cmp_ne_u32 s[64:65], s26, v18
    v_cmp_ne_u32 s[66:67], s26, v19
    v_cndmask_b32 v16, 0, v16, s[60:61]
    v_cndmask_b32 v17, 0, v17, s[62:63]
    v_cndmask_b32 v18, 0, v18, s[64:65]
    v_cndmask_b32 v19, 0, v19, s[66:67]
    v_cmp_ne_u32 s[60:61], s26, v20
    v_cmp_ne_u32 s[62:63], s26, v21
    v_cmp_ne_u32 s[64:65], s26, v22
    v_cmp_ne_u32 s[66:67], s26, v23
    v_cndmask_b32 v20, 0, v20, s[60:61]
    v_cndmask_b32 v21, 0, v21, s[62:63]
    v_cndmask_b32 v22, 0, v22, s[64:65]
    v_cndmask_b32 v23, 0, v23, s[66:67]
    v_cmp_ne_u32 s[60:61], s26, v24
    v_cmp_ne_u32 s[62:63], s26, v25
    v_cmp_ne_u32 s[64:65], s26, v26
    v_cmp_ne_u32 s[66:67], s26, v27
    v_cndmask_b32 v24, 0, v24, s[60:61]
    v_cndmask_b32 v25, 0, v25, s[62:63]
    v_cndmask_b32 v26, 0, v26, s[64:65]
    v_cndmask_b32 v27, 0, v27, s[66:67]
    v_cmp_ne_u32 s[60:61], s26, v28
    v_cmp_ne_u32 s[62:63], s26, v29
    v_cmp_ne_u32 s[64:65], s26, v30
    v_cmp_ne_u32 s[66:67], s26, v31
    v_cndmask_b32 v28, 0, v28, s[60:61]
    v_cndmask_b32 v29, 0, v29, s[62:63]
    v_cndmask_b32 v30, 0, v30, s[64:65]
    v_cndmask_b32 v31, 0, v31, s[66:67]
    v_cmp_ne_u32 s[60:61], s26, v32
    v_cmp_ne_u32 s[62:63], s26, v33
    v_cmp_ne_u32 s[64:65], s26, v34
    v_cmp_ne_u32 s[66:67], s26, v35
    v_cndmask_b32 v32, 0, v32, s[60:61]
    v_cndmask_b32 v33, 0, v33, s[62:63]
    v_cndmask_b32 v34, 0, v34, s[64:65]
    v_cndmask_b32 v35, 0, v35, s[66:67]
    v_cmp_ne_u32 s[60:61], s26, v36
    v_cmp_ne_u32 s[62:63], s26, v37
    v_cmp_ne_u32 s[64:65], s26, v38
    v_cmp_ne_u32 s[66:67], s26, v39
    v_cndmask_b32 v36, 0, v36, s[60:61]
    v_cndmask_b32 v37, 0, v37, s[62:63]
    v_cndmask_b32 v38, 0, v38, s[64:65]
    v_cndmask_b32 v39, 0, v39, s[66:67]
    v_max3_u32 v3, v8, v9, v10
    v_max3_u32 v3, v3, v11, v12
    v_max3_u32 v3, v3, v13, v14
    v_max3_u32 v3, v3, v15, v16
    v_max3_u32 v3, v3, v17, v18
    v_max3_u32 v3, v3, v19, v20
    v_max3_u32 v3, v3, v21, v22
    v_max3_u32 v3, v3, v23, v24
    v_max3_u32 v3, v3, v25, v26
    v_max3_u32 v3, v3, v27, v28
    v_max3_u32 v3, v3, v29, v30
    v_max3_u32 v3, v3, v31, v32
    v_max3_u32 v3, v3, v33, v34
    v_max3_u32 v3, v3, v35, v36
    v_max3_u32 v3, v3, v37, v38
    v_max_u32 v3, v3, v39
    s_nop 1
    v_max_u32_dpp v3, v3, v3 quad_perm:[1,0,3,2] row_mask:0xf bank_mask:0xf
    s_nop 1
    v_max_u32_dpp v3, v3, v3 quad_perm:[2,3,0,1] row_mask:0xf bank_mask:0xf
    s_nop 1
    v_max_u32_dpp v3, v3, v3 row_half_mirror row_mask:0xf bank_mask:0xf
    s_nop 1
    v_max_u32_dpp v3, v3, v3 row_mirror row_mask:0xf bank_mask:0xf
    s_nop 0
    v_readlane_b32 s26, v3, 0
    v_readlane_b32 s27, v3, 16
    v_readlane_b32 s28, v3, 32
    v_readlane_b32 s29, v3, 48
    s_max_u32 s26, s26, s27
    s_max_u32 s28, s28, s29
    s_max_u32 s26, s26, s28
    s_and_b32 s27, s26, 0x7ff
    s_sub_u32 s48, 2047, s27
    s_not_b32 s27, s26
    s_xor_b32 s28, s26, 0x80000000
    s_bitcmp1_b32 s26, 31
    s_cselect_b32 s27, s28, s27
    s_and_b32 s56, s27, 0xffff0000
    v_cmp_ne_u32 s[60:61], s26, v8
    v_cmp_ne_u32 s[62:63], s26, v9
    v_cmp_ne_u32 s[64:65], s26, v10
    v_cmp_ne_u32 s[66:67], s26, v11
    v_cndmask_b32 v8, 0, v8, s[60:61]
    v_cndmask_b32 v9, 0, v9, s[62:63]
    v_cndmask_b32 v10, 0, v10, s[64:65]
    v_cndmask_b32 v11, 0, v11, s[66:67]
    v_cmp_ne_u32 s[60:61], s26, v12
    v_cmp_ne_u32 s[62:63], s26, v13
    v_cmp_ne_u32 s[64:65], s26, v14
    v_cmp_ne_u32 s[66:67], s26, v15
    v_cndmask_b32 v12, 0, v12, s[60:61]
    v_cndmask_b32 v13, 0, v13, s[62:63]
    v_cndmask_b32 v14, 0, v14, s[64:65]
    v_cndmask_b32 v15, 0, v15, s[66:67]
    v_cmp_ne_u32 s[60:61], s26, v16
    v_cmp_ne_u32 s[62:63], s26, v17
    v_cmp_ne_u32 s[64:65], s26, v18
    v_cmp_ne_u32 s[66:67], s26, v19
    v_cndmask_b32 v16, 0, v16, s[60:61]
    v_cndmask_b32 v17, 0, v17, s[62:63]
    v_cndmask_b32 v18, 0, v18, s[64:65]
    v_cndmask_b32 v19, 0, v19, s[66:67]
    v_cmp_ne_u32 s[60:61], s26, v20
    v_cmp_ne_u32 s[62:63], s26, v21
    v_cmp_ne_u32 s[64:65], s26, v22
    v_cmp_ne_u32 s[66:67], s26, v23
    v_cndmask_b32 v20, 0, v20, s[60:61]
    v_cndmask_b32 v21, 0, v21, s[62:63]
    v_cndmask_b32 v22, 0, v22, s[64:65]
    v_cndmask_b32 v23, 0, v23, s[66:67]
    v_cmp_ne_u32 s[60:61], s26, v24
    v_cmp_ne_u32 s[62:63], s26, v25
    v_cmp_ne_u32 s[64:65], s26, v26
    v_cmp_ne_u32 s[66:67], s26, v27
    v_cndmask_b32 v24, 0, v24, s[60:61]
    v_cndmask_b32 v25, 0, v25, s[62:63]
    v_cndmask_b32 v26, 0, v26, s[64:65]
    v_cndmask_b32 v27, 0, v27, s[66:67]
    v_cmp_ne_u32 s[60:61], s26, v28
    v_cmp_ne_u32 s[62:63], s26, v29
    v_cmp_ne_u32 s[64:65], s26, v30
    v_cmp_ne_u32 s[66:67], s26, v31
    v_cndmask_b32 v28, 0, v28, s[60:61]
    v_cndmask_b32 v29, 0, v29, s[62:63]
    v_cndmask_b32 v30, 0, v30, s[64:65]
    v_cndmask_b32 v31, 0, v31, s[66:67]
    v_cmp_ne_u32 s[60:61], s26, v32
    v_cmp_ne_u32 s[62:63], s26, v33
    v_cmp_ne_u32 s[64:65], s26, v34
    v_cmp_ne_u32 s[66:67], s26, v35
    v_cndmask_b32 v32, 0, v32, s[60:61]
    v_cndmask_b32 v33, 0, v33, s[62:63]
    v_cndmask_b32 v34, 0, v34, s[64:65]
    v_cndmask_b32 v35, 0, v35, s[66:67]
    v_cmp_ne_u32 s[60:61], s26, v36
    v_cmp_ne_u32 s[62:63], s26, v37
    v_cmp_ne_u32 s[64:65], s26, v38
    v_cmp_ne_u32 s[66:67], s26, v39
    v_cndmask_b32 v36, 0, v36, s[60:61]
    v_cndmask_b32 v37, 0, v37, s[62:63]
    v_cndmask_b32 v38, 0, v38, s[64:65]
    v_cndmask_b32 v39, 0, v39, s[66:67]
    v_max3_u32 v3, v8, v9, v10
    v_max3_u32 v3, v3, v11, v12
    v_max3_u32 v3, v3, v13, v14
    v_max3_u32 v3, v3, v15, v16
    v_max3_u32 v3, v3, v17, v18
    v_max3_u32 v3, v3, v19, v20
    v_max3_u32 v3, v3, v21, v22
    v_max3_u32 v3, v3, v23, v24
    v_max3_u32 v3, v3, v25, v26
    v_max3_u32 v3, v3, v27, v28
    v_max3_u32 v3, v3, v29, v30
    v_max3_u32 v3, v3, v31, v32
    v_max3_u32 v3, v3, v33, v34
    v_max3_u32 v3, v3, v35, v36
    v_max3_u32 v3, v3, v37, v38
    v_max_u32 v3, v3, v39
    s_nop 1
    v_max_u32_dpp v3, v3, v3 quad_perm:[1,0,3,2] row_mask:0xf bank_mask:0xf
    s_nop 1
    v_max_u32_dpp v3, v3, v3 quad_perm:[2,3,0,1] row_mask:0xf bank_mask:0xf
    s_nop 1
    v_max_u32_dpp v3, v3, v3 row_half_mirror row_mask:0xf bank_mask:0xf
    s_nop 1
    v_max_u32_dpp v3, v3, v3 row_mirror row_mask:0xf bank_mask:0xf
    s_nop 0
    v_readlane_b32 s26, v3, 0
    v_readlane_b32 s27, v3, 16
    v_readlane_b32 s28, v3, 32
    v_readlane_b32 s29, v3, 48
    s_max_u32 s26, s26, s27
    s_max_u32 s28, s28, s29
    s_max_u32 s26, s26, s28
    s_and_b32 s27, s26, 0x7ff
    s_sub_u32 s49, 2047, s27
    s_not_b32 s27, s26
    s_xor_b32 s28, s26, 0x80000000
    s_bitcmp1_b32 s26, 31
    s_cselect_b32 s27, s28, s27
    s_and_b32 s57, s27, 0xffff0000
    v_cmp_ne_u32 s[60:61], s26, v8
    v_cmp_ne_u32 s[62:63], s26, v9
    v_cmp_ne_u32 s[64:65], s26, v10
    v_cmp_ne_u32 s[66:67], s26, v11
    v_cndmask_b32 v8, 0, v8, s[60:61]
    v_cndmask_b32 v9, 0, v9, s[62:63]
    v_cndmask_b32 v10, 0, v10, s[64:65]
    v_cndmask_b32 v11, 0, v11, s[66:67]
    v_cmp_ne_u32 s[60:61], s26, v12
    v_cmp_ne_u32 s[62:63], s26, v13
    v_cmp_ne_u32 s[64:65], s26, v14
    v_cmp_ne_u32 s[66:67], s26, v15
    v_cndmask_b32 v12, 0, v12, s[60:61]
    v_cndmask_b32 v13, 0, v13, s[62:63]
    v_cndmask_b32 v14, 0, v14, s[64:65]
    v_cndmask_b32 v15, 0, v15, s[66:67]
    v_cmp_ne_u32 s[60:61], s26, v16
    v_cmp_ne_u32 s[62:63], s26, v17
    v_cmp_ne_u32 s[64:65], s26, v18
    v_cmp_ne_u32 s[66:67], s26, v19
    v_cndmask_b32 v16, 0, v16, s[60:61]
    v_cndmask_b32 v17, 0, v17, s[62:63]
    v_cndmask_b32 v18, 0, v18, s[64:65]
    v_cndmask_b32 v19, 0, v19, s[66:67]
    v_cmp_ne_u32 s[60:61], s26, v20
    v_cmp_ne_u32 s[62:63], s26, v21
    v_cmp_ne_u32 s[64:65], s26, v22
    v_cmp_ne_u32 s[66:67], s26, v23
    v_cndmask_b32 v20, 0, v20, s[60:61]
    v_cndmask_b32 v21, 0, v21, s[62:63]
    v_cndmask_b32 v22, 0, v22, s[64:65]
    v_cndmask_b32 v23, 0, v23, s[66:67]
    v_cmp_ne_u32 s[60:61], s26, v24
    v_cmp_ne_u32 s[62:63], s26, v25
    v_cmp_ne_u32 s[64:65], s26, v26
    v_cmp_ne_u32 s[66:67], s26, v27
    v_cndmask_b32 v24, 0, v24, s[60:61]
    v_cndmask_b32 v25, 0, v25, s[62:63]
    v_cndmask_b32 v26, 0, v26, s[64:65]
    v_cndmask_b32 v27, 0, v27, s[66:67]
    v_cmp_ne_u32 s[60:61], s26, v28
    v_cmp_ne_u32 s[62:63], s26, v29
    v_cmp_ne_u32 s[64:65], s26, v30
    v_cmp_ne_u32 s[66:67], s26, v31
    v_cndmask_b32 v28, 0, v28, s[60:61]
    v_cndmask_b32 v29, 0, v29, s[62:63]
    v_cndmask_b32 v30, 0, v30, s[64:65]
    v_cndmask_b32 v31, 0, v31, s[66:67]
    v_cmp_ne_u32 s[60:61], s26, v32
    v_cmp_ne_u32 s[62:63], s26, v33
    v_cmp_ne_u32 s[64:65], s26, v34
    v_cmp_ne_u32 s[66:67], s26, v35
    v_cndmask_b32 v32, 0, v32, s[60:61]
    v_cndmask_b32 v33, 0, v33, s[62:63]
    v_cndmask_b32 v34, 0, v34, s[64:65]
    v_cndmask_b32 v35, 0, v35, s[66:67]
    v_cmp_ne_u32 s[60:61], s26, v36
    v_cmp_ne_u32 s[62:63], s26, v37
    v_cmp_ne_u32 s[64:65], s26, v38
    v_cmp_ne_u32 s[66:67], s26, v39
    v_cndmask_b32 v36, 0, v36, s[60:61]
    v_cndmask_b32 v37, 0, v37, s[62:63]
    v_cndmask_b32 v38, 0, v38, s[64:65]
    v_cndmask_b32 v39, 0, v39, s[66:67]
    v_max3_u32 v3, v8, v9, v10
    v_max3_u32 v3, v3, v11, v12
    v_max3_u32 v3, v3, v13, v14
    v_max3_u32 v3, v3, v15, v16
    v_max3_u32 v3, v3, v17, v18
    v_max3_u32 v3, v3, v19, v20
    v_max3_u32 v3, v3, v21, v22
    v_max3_u32 v3, v3, v23, v24
    v_max3_u32 v3, v3, v25, v26
    v_max3_u32 v3, v3, v27, v28
    v_max3_u32 v3, v3, v29, v30
    v_max3_u32 v3, v3, v31, v32
    v_max3_u32 v3, v3, v33, v34
    v_max3_u32 v3, v3, v35, v36
    v_max3_u32 v3, v3, v37, v38
    v_max_u32 v3, v3, v39
    s_nop 1
    v_max_u32_dpp v3, v3, v3 quad_perm:[1,0,3,2] row_mask:0xf bank_mask:0xf
    s_nop 1
    v_max_u32_dpp v3, v3, v3 quad_perm:[2,3,0,1] row_mask:0xf bank_mask:0xf
    s_nop 1
    v_max_u32_dpp v3, v3, v3 row_half_mirror row_mask:0xf bank_mask:0xf
    s_nop 1
    v_max_u32_dpp v3, v3, v3 row_mirror row_mask:0xf bank_mask:0xf
    s_nop 0
    v_readlane_b32 s26, v3, 0
    v_readlane_b32 s27, v3, 16
    v_readlane_b32 s28, v3, 32
    v_readlane_b32 s29, v3, 48
    s_max_u32 s26, s26, s27
    s_max_u32 s28, s28, s29
    s_max_u32 s26, s26, s28
    s_and_b32 s27, s26, 0x7ff
    s_sub_u32 s50, 2047, s27
    s_not_b32 s27, s26
    s_xor_b32 s28, s26, 0x80000000
    s_bitcmp1_b32 s26, 31
    s_cselect_b32 s27, s28, s27
    s_and_b32 s58, s27, 0xffff0000
    v_cmp_ne_u32 s[60:61], s26, v8
    v_cmp_ne_u32 s[62:63], s26, v9
    v_cmp_ne_u32 s[64:65], s26, v10
    v_cmp_ne_u32 s[66:67], s26, v11
    v_cndmask_b32 v8, 0, v8, s[60:61]
    v_cndmask_b32 v9, 0, v9, s[62:63]
    v_cndmask_b32 v10, 0, v10, s[64:65]
    v_cndmask_b32 v11, 0, v11, s[66:67]
    v_cmp_ne_u32 s[60:61], s26, v12
    v_cmp_ne_u32 s[62:63], s26, v13
    v_cmp_ne_u32 s[64:65], s26, v14
    v_cmp_ne_u32 s[66:67], s26, v15
    v_cndmask_b32 v12, 0, v12, s[60:61]
    v_cndmask_b32 v13, 0, v13, s[62:63]
    v_cndmask_b32 v14, 0, v14, s[64:65]
    v_cndmask_b32 v15, 0, v15, s[66:67]
    v_cmp_ne_u32 s[60:61], s26, v16
    v_cmp_ne_u32 s[62:63], s26, v17
    v_cmp_ne_u32 s[64:65], s26, v18
    v_cmp_ne_u32 s[66:67], s26, v19
    v_cndmask_b32 v16, 0, v16, s[60:61]
    v_cndmask_b32 v17, 0, v17, s[62:63]
    v_cndmask_b32 v18, 0, v18, s[64:65]
    v_cndmask_b32 v19, 0, v19, s[66:67]
    v_cmp_ne_u32 s[60:61], s26, v20
    v_cmp_ne_u32 s[62:63], s26, v21
    v_cmp_ne_u32 s[64:65], s26, v22
    v_cmp_ne_u32 s[66:67], s26, v23
    v_cndmask_b32 v20, 0, v20, s[60:61]
    v_cndmask_b32 v21, 0, v21, s[62:63]
    v_cndmask_b32 v22, 0, v22, s[64:65]
    v_cndmask_b32 v23, 0, v23, s[66:67]
    v_cmp_ne_u32 s[60:61], s26, v24
    v_cmp_ne_u32 s[62:63], s26, v25
    v_cmp_ne_u32 s[64:65], s26, v26
    v_cmp_ne_u32 s[66:67], s26, v27
    v_cndmask_b32 v24, 0, v24, s[60:61]
    v_cndmask_b32 v25, 0, v25, s[62:63]
    v_cndmask_b32 v26, 0, v26, s[64:65]
    v_cndmask_b32 v27, 0, v27, s[66:67]
    v_cmp_ne_u32 s[60:61], s26, v28
    v_cmp_ne_u32 s[62:63], s26, v29
    v_cmp_ne_u32 s[64:65], s26, v30
    v_cmp_ne_u32 s[66:67], s26, v31
    v_cndmask_b32 v28, 0, v28, s[60:61]
    v_cndmask_b32 v29, 0, v29, s[62:63]
    v_cndmask_b32 v30, 0, v30, s[64:65]
    v_cndmask_b32 v31, 0, v31, s[66:67]
    v_cmp_ne_u32 s[60:61], s26, v32
    v_cmp_ne_u32 s[62:63], s26, v33
    v_cmp_ne_u32 s[64:65], s26, v34
    v_cmp_ne_u32 s[66:67], s26, v35
    v_cndmask_b32 v32, 0, v32, s[60:61]
    v_cndmask_b32 v33, 0, v33, s[62:63]
    v_cndmask_b32 v34, 0, v34, s[64:65]
    v_cndmask_b32 v35, 0, v35, s[66:67]
    v_cmp_ne_u32 s[60:61], s26, v36
    v_cmp_ne_u32 s[62:63], s26, v37
    v_cmp_ne_u32 s[64:65], s26, v38
    v_cmp_ne_u32 s[66:67], s26, v39
    v_cndmask_b32 v36, 0, v36, s[60:61]
    v_cndmask_b32 v37, 0, v37, s[62:63]
    v_cndmask_b32 v38, 0, v38, s[64:65]
    v_cndmask_b32 v39, 0, v39, s[66:67]
    v_max3_u32 v3, v8, v9, v10
    v_max3_u32 v3, v3, v11, v12
    v_max3_u32 v3, v3, v13, v14
    v_max3_u32 v3, v3, v15, v16
    v_max3_u32 v3, v3, v17, v18
    v_max3_u32 v3, v3, v19, v20
    v_max3_u32 v3, v3, v21, v22
    v_max3_u32 v3, v3, v23, v24
    v_max3_u32 v3, v3, v25, v26
    v_max3_u32 v3, v3, v27, v28
    v_max3_u32 v3, v3, v29, v30
    v_max3_u32 v3, v3, v31, v32
    v_max3_u32 v3, v3, v33, v34
    v_max3_u32 v3, v3, v35, v36
    v_max3_u32 v3, v3, v37, v38
    v_max_u32 v3, v3, v39
    s_nop 1
    v_max_u32_dpp v3, v3, v3 quad_perm:[1,0,3,2] row_mask:0xf bank_mask:0xf
    s_nop 1
    v_max_u32_dpp v3, v3, v3 quad_perm:[2,3,0,1] row_mask:0xf bank_mask:0xf
    s_nop 1
    v_max_u32_dpp v3, v3, v3 row_half_mirror row_mask:0xf bank_mask:0xf
    s_nop 1
    v_max_u32_dpp v3, v3, v3 row_mirror row_mask:0xf bank_mask:0xf
    s_nop 0
    v_readlane_b32 s26, v3, 0
    v_readlane_b32 s27, v3, 16
    v_readlane_b32 s28, v3, 32
    v_readlane_b32 s29, v3, 48
    s_max_u32 s26, s26, s27
    s_max_u32 s28, s28, s29
    s_max_u32 s26, s26, s28
    s_and_b32 s27, s26, 0x7ff
    s_sub_u32 s51, 2047, s27
    s_not_b32 s27, s26
    s_xor_b32 s28, s26, 0x80000000
    s_bitcmp1_b32 s26, 31
    s_cselect_b32 s27, s28, s27
    s_and_b32 s59, s27, 0xffff0000
    s_cmp_ge_u32 s25, 108
    s_cbranch_scc1 L_recum2_214
    s_load_dwordx2 s[8:9], s[0:1], 72
    s_mov_b32 s10, 0x21c000
    s_mov_b32 s11, 0x00020000
    s_load_dwordx2 s[12:13], s[0:1], 80
    s_mov_b32 s14, 0x21c000
    s_mov_b32 s15, 0x00020000
    v_and_b32 v3, 7, v0
    v_mov_b32 v4, s44
    v_mov_b32 v5, s45
    v_cmp_eq_u32 vcc, 1, v3
    s_nop 1
    v_cndmask_b32 v4, v4, v5, vcc
    v_mov_b32 v5, s46
    v_cmp_eq_u32 vcc, 2, v3
    s_nop 1
    v_cndmask_b32 v4, v4, v5, vcc
    v_mov_b32 v5, s47
    v_cmp_eq_u32 vcc, 3, v3
    s_nop 1
    v_cndmask_b32 v4, v4, v5, vcc
    v_mov_b32 v5, s48
    v_cmp_eq_u32 vcc, 4, v3
    s_nop 1
    v_cndmask_b32 v4, v4, v5, vcc
    v_mov_b32 v5, s49
    v_cmp_eq_u32 vcc, 5, v3
    s_nop 1
    v_cndmask_b32 v4, v4, v5, vcc
    v_mov_b32 v5, s50
    v_cmp_eq_u32 vcc, 6, v3
    s_nop 1
    v_cndmask_b32 v4, v4, v5, vcc
    v_mov_b32 v5, s51
    v_cmp_eq_u32 vcc, 7, v3
    s_nop 1
    v_cndmask_b32 v4, v4, v5, vcc
    v_lshrrev_b32 v5, 5, v4
    v_mul_u32_u24 v5, 40960, v5
    v_and_b32 v4, 31, v4
    v_lshl_add_u32 v5, v4, 4, v5
    v_bfe_u32 v4, v0, 4, 1
    v_lshl_add_u32 v5, v4, 9, v5
    v_lshrrev_b32 v4, 5, v0
    v_lshl_add_u32 v5, v4, 10, v5
    s_mul_i32 s26, s24, 10240
    s_add_u32 s26, s26, 0
    v_lshrrev_b32 v4, 4, v0
    v_mul_u32_u24 v4, 27648, v4
    v_and_b32 v6, 15, v0
    v_lshl_add_u32 v4, v6, 1, v4
    s_mul_i32 s27, s24, 552960
    s_lshl_b32 s28, s25, 5
    s_add_u32 s27, s27, s28
    s_waitcnt lgkmcnt(0)
    buffer_load_dwordx4 v[16:19], v5, s[4:7], s26 offen sc1
    s_add_u32 s26, s26, 2048
    buffer_load_dwordx4 v[20:23], v5, s[4:7], s26 offen sc1
    s_add_u32 s26, s26, 2048
    buffer_load_dwordx4 v[24:27], v5, s[4:7], s26 offen sc1
    s_add_u32 s26, s26, 2048
    buffer_load_dwordx4 v[28:31], v5, s[4:7], s26 offen sc1
    s_add_u32 s26, s26, 2048
    buffer_load_dwordx4 v[32:35], v5, s[4:7], s26 offen sc1
    s_add_u32 s26, s26, 2048
    buffer_load_ushort v40, v4, s[8:11], s27 offen
    buffer_load_ushort v80, v4, s[12:15], s27 offen
    s_add_u32 s27, s27, 3456
    buffer_load_ushort v41, v4, s[8:11], s27 offen
    buffer_load_ushort v81, v4, s[12:15], s27 offen
    s_add_u32 s27, s27, 3456
    buffer_load_ushort v42, v4, s[8:11], s27 offen
    buffer_load_ushort v82, v4, s[12:15], s27 offen
    s_add_u32 s27, s27, 3456
    buffer_load_ushort v43, v4, s[8:11], s27 offen
    buffer_load_ushort v83, v4, s[12:15], s27 offen
    s_add_u32 s27, s27, 3456
    buffer_load_ushort v44, v4, s[8:11], s27 offen
    buffer_load_ushort v84, v4, s[12:15], s27 offen
    s_add_u32 s27, s27, 3456
    buffer_load_ushort v45, v4, s[8:11], s27 offen
    buffer_load_ushort v85, v4, s[12:15], s27 offen
    s_add_u32 s27, s27, 3456
    buffer_load_ushort v46, v4, s[8:11], s27 offen
    buffer_load_ushort v86, v4, s[12:15], s27 offen
    s_add_u32 s27, s27, 3456
    buffer_load_ushort v47, v4, s[8:11], s27 offen
    buffer_load_ushort v87, v4, s[12:15], s27 offen
    s_add_u32 s27, s27, 86400
    buffer_load_ushort v48, v4, s[8:11], s27 offen
    buffer_load_ushort v88, v4, s[12:15], s27 offen
    s_add_u32 s27, s27, 3456
    buffer_load_ushort v49, v4, s[8:11], s27 offen
    buffer_load_ushort v89, v4, s[12:15], s27 offen
    s_add_u32 s27, s27, 3456
    buffer_load_ushort v50, v4, s[8:11], s27 offen
    buffer_load_ushort v90, v4, s[12:15], s27 offen
    s_add_u32 s27, s27, 3456
    buffer_load_ushort v51, v4, s[8:11], s27 offen
    buffer_load_ushort v91, v4, s[12:15], s27 offen
    s_add_u32 s27, s27, 3456
    buffer_load_ushort v52, v4, s[8:11], s27 offen
    buffer_load_ushort v92, v4, s[12:15], s27 offen
    s_add_u32 s27, s27, 3456
    buffer_load_ushort v53, v4, s[8:11], s27 offen
    buffer_load_ushort v93, v4, s[12:15], s27 offen
    s_add_u32 s27, s27, 3456
    buffer_load_ushort v54, v4, s[8:11], s27 offen
    buffer_load_ushort v94, v4, s[12:15], s27 offen
    s_add_u32 s27, s27, 3456
    buffer_load_ushort v55, v4, s[8:11], s27 offen
    buffer_load_ushort v95, v4, s[12:15], s27 offen
    s_add_u32 s27, s27, 86400
    buffer_load_ushort v56, v4, s[8:11], s27 offen
    buffer_load_ushort v96, v4, s[12:15], s27 offen
    s_add_u32 s27, s27, 3456
    buffer_load_ushort v57, v4, s[8:11], s27 offen
    buffer_load_ushort v97, v4, s[12:15], s27 offen
    s_add_u32 s27, s27, 3456
    buffer_load_ushort v58, v4, s[8:11], s27 offen
    buffer_load_ushort v98, v4, s[12:15], s27 offen
    s_add_u32 s27, s27, 3456
    buffer_load_ushort v59, v4, s[8:11], s27 offen
    buffer_load_ushort v99, v4, s[12:15], s27 offen
    s_add_u32 s27, s27, 3456
    buffer_load_ushort v60, v4, s[8:11], s27 offen
    buffer_load_ushort v100, v4, s[12:15], s27 offen
    s_add_u32 s27, s27, 3456
    buffer_load_ushort v61, v4, s[8:11], s27 offen
    buffer_load_ushort v101, v4, s[12:15], s27 offen
    s_add_u32 s27, s27, 3456
    buffer_load_ushort v62, v4, s[8:11], s27 offen
    buffer_load_ushort v102, v4, s[12:15], s27 offen
    s_add_u32 s27, s27, 3456
    buffer_load_ushort v63, v4, s[8:11], s27 offen
    buffer_load_ushort v103, v4, s[12:15], s27 offen
    s_add_u32 s27, s27, 86400
    buffer_load_ushort v64, v4, s[8:11], s27 offen
    buffer_load_ushort v104, v4, s[12:15], s27 offen
    s_add_u32 s27, s27, 3456
    buffer_load_ushort v65, v4, s[8:11], s27 offen
    buffer_load_ushort v105, v4, s[12:15], s27 offen
    s_add_u32 s27, s27, 3456
    buffer_load_ushort v66, v4, s[8:11], s27 offen
    buffer_load_ushort v106, v4, s[12:15], s27 offen
    s_add_u32 s27, s27, 3456
    buffer_load_ushort v67, v4, s[8:11], s27 offen
    buffer_load_ushort v107, v4, s[12:15], s27 offen
    s_add_u32 s27, s27, 3456
    buffer_load_ushort v68, v4, s[8:11], s27 offen
    buffer_load_ushort v108, v4, s[12:15], s27 offen
    s_add_u32 s27, s27, 3456
    buffer_load_ushort v69, v4, s[8:11], s27 offen
    buffer_load_ushort v109, v4, s[12:15], s27 offen
    s_add_u32 s27, s27, 3456
    buffer_load_ushort v70, v4, s[8:11], s27 offen
    buffer_load_ushort v110, v4, s[12:15], s27 offen
    s_add_u32 s27, s27, 3456
    buffer_load_ushort v71, v4, s[8:11], s27 offen
    buffer_load_ushort v111, v4, s[12:15], s27 offen
    s_add_u32 s27, s27, 86400
    buffer_load_ushort v72, v4, s[8:11], s27 offen
    buffer_load_ushort v112, v4, s[12:15], s27 offen
    s_add_u32 s27, s27, 3456
    buffer_load_ushort v73, v4, s[8:11], s27 offen
    buffer_load_ushort v113, v4, s[12:15], s27 offen
    s_add_u32 s27, s27, 3456
    buffer_load_ushort v74, v4, s[8:11], s27 offen
    buffer_load_ushort v114, v4, s[12:15], s27 offen
    s_add_u32 s27, s27, 3456
    buffer_load_ushort v75, v4, s[8:11], s27 offen
    buffer_load_ushort v115, v4, s[12:15], s27 offen
    s_add_u32 s27, s27, 3456
    buffer_load_ushort v76, v4, s[8:11], s27 offen
    buffer_load_ushort v116, v4, s[12:15], s27 offen
    s_add_u32 s27, s27, 3456
    buffer_load_ushort v77, v4, s[8:11], s27 offen
    buffer_load_ushort v117, v4, s[12:15], s27 offen
    s_add_u32 s27, s27, 3456
    buffer_load_ushort v78, v4, s[8:11], s27 offen
    buffer_load_ushort v118, v4, s[12:15], s27 offen
    s_add_u32 s27, s27, 3456
    buffer_load_ushort v79, v4, s[8:11], s27 offen
    buffer_load_ushort v119, v4, s[12:15], s27 offen
    s_add_u32 s27, s27, 86400
    s_waitcnt vmcnt(0)
    v_lshl_or_b32 v40, v41, 16, v40
    v_lshl_or_b32 v41, v43, 16, v42
    v_lshl_or_b32 v42, v45, 16, v44
    v_lshl_or_b32 v43, v47, 16, v46
    s_nop 1
    v_mfma_f32_16x16x32_bf16 v[8:11], v[16:19], v[40:43], 0
    v_lshl_or_b32 v48, v49, 16, v48
    v_lshl_or_b32 v49, v51, 16, v50
    v_lshl_or_b32 v50, v53, 16, v52
    v_lshl_or_b32 v51, v55, 16, v54
    s_nop 1
    v_mfma_f32_16x16x32_bf16 v[8:11], v[20:23], v[48:51], v[8:11]
    v_lshl_or_b32 v56, v57, 16, v56
    v_lshl_or_b32 v57, v59, 16, v58
    v_lshl_or_b32 v58, v61, 16, v60
    v_lshl_or_b32 v59, v63, 16, v62
    s_nop 1
    v_mfma_f32_16x16x32_bf16 v[8:11], v[24:27], v[56:59], v[8:11]
    v_lshl_or_b32 v64, v65, 16, v64
    v_lshl_or_b32 v65, v67, 16, v66
    v_lshl_or_b32 v66, v69, 16, v68
    v_lshl_or_b32 v67, v71, 16, v70
    s_nop 1
    v_mfma_f32_16x16x32_bf16 v[8:11], v[28:31], v[64:67], v[8:11]
    v_lshl_or_b32 v72, v73, 16, v72
    v_lshl_or_b32 v73, v75, 16, v74
    v_lshl_or_b32 v74, v77, 16, v76
    v_lshl_or_b32 v75, v79, 16, v78
    s_nop 1
    v_mfma_f32_16x16x32_bf16 v[8:11], v[32:35], v[72:75], v[8:11]
    v_lshl_or_b32 v80, v81, 16, v80
    v_lshl_or_b32 v81, v83, 16, v82
    v_lshl_or_b32 v82, v85, 16, v84
    v_lshl_or_b32 v83, v87, 16, v86
    s_nop 1
    v_mfma_f32_16x16x32_bf16 v[12:15], v[16:19], v[80:83], 0
    v_lshl_or_b32 v88, v89, 16, v88
    v_lshl_or_b32 v89, v91, 16, v90
    v_lshl_or_b32 v90, v93, 16, v92
    v_lshl_or_b32 v91, v95, 16, v94
    s_nop 1
    v_mfma_f32_16x16x32_bf16 v[12:15], v[20:23], v[88:91], v[12:15]
    v_lshl_or_b32 v96, v97, 16, v96
    v_lshl_or_b32 v97, v99, 16, v98
    v_lshl_or_b32 v98, v101, 16, v100
    v_lshl_or_b32 v99, v103, 16, v102
    s_nop 1
    v_mfma_f32_16x16x32_bf16 v[12:15], v[24:27], v[96:99], v[12:15]
    v_lshl_or_b32 v104, v105, 16, v104
    v_lshl_or_b32 v105, v107, 16, v106
    v_lshl_or_b32 v106, v109, 16, v108
    v_lshl_or_b32 v107, v111, 16, v110
    s_nop 1
    v_mfma_f32_16x16x32_bf16 v[12:15], v[28:31], v[104:107], v[12:15]
    v_lshl_or_b32 v112, v113, 16, v112
    v_lshl_or_b32 v113, v115, 16, v114
    v_lshl_or_b32 v114, v117, 16, v116
    v_lshl_or_b32 v115, v119, 16, v118
    s_nop 1
    v_mfma_f32_16x16x32_bf16 v[12:15], v[32:35], v[112:115], v[12:15]
    v_lshlrev_b32 v1, 4, v0
    s_lshl_b32 s26, s24, 11
    v_add_u32 v2, s26, v1
    ds_write_b128 v2, v[8:11] offset:0
    s_nop 3
    ds_write_b128 v2, v[12:15] offset:1024
    s_waitcnt lgkmcnt(0)
    s_barrier
    s_cmp_lg_u32 s24, 0
    s_cbranch_scc1 L_recuxd_218
    ds_read_b128 v[100:103], v1 offset:2048
    ds_read_b128 v[104:107], v1 offset:3072
    ds_read_b128 v[108:111], v1 offset:4096
    ds_read_b128 v[112:115], v1 offset:5120
    ds_read_b128 v[116:119], v1 offset:6144
    ds_read_b128 v[120:123], v1 offset:7168
    s_waitcnt lgkmcnt(0)
    v_add_f32 v8, v8, v100
    v_add_f32 v9, v9, v101
    v_add_f32 v10, v10, v102
    v_add_f32 v11, v11, v103
    v_add_f32 v12, v12, v104
    v_add_f32 v13, v13, v105
    v_add_f32 v14, v14, v106
    v_add_f32 v15, v15, v107
    v_add_f32 v8, v8, v108
    v_add_f32 v9, v9, v109
    v_add_f32 v10, v10, v110
    v_add_f32 v11, v11, v111
    v_add_f32 v12, v12, v112
    v_add_f32 v13, v13, v113
    v_add_f32 v14, v14, v114
    v_add_f32 v15, v15, v115
    v_add_f32 v8, v8, v116
    v_add_f32 v9, v9, v117
    v_add_f32 v10, v10, v118
    v_add_f32 v11, v11, v119
    v_add_f32 v12, v12, v120
    v_add_f32 v13, v13, v121
    v_add_f32 v14, v14, v122
    v_add_f32 v15, v15, v123
    v_lshrrev_b32 v4, 4, v0
    v_lshlrev_b32 v4, 7, v4
    v_lshl_add_u32 v4, v6, 1, v4
    s_lshl_b32 s26, s25, 8
    s_add_u32 s26, s26, 5308416
    s_mov_b32 exec_hi, 0
    v_cvt_pk_bf16_f32 v8, v8, v8
    v_and_b32 v8, 0xffff0000, v8
    v_mul_f32 v20, 0xbfb8aa3b, v8
    v_exp_f32 v20, v20
    s_nop 0
    v_add_f32 v20, 1.0, v20
    v_rcp_f32 v20, v20
    s_nop 0
    v_mul_f32 v8, v8, v20
    v_cvt_pk_bf16_f32 v8, v8, v8
    v_and_b32 v8, 0xffff0000, v8
    v_cvt_pk_bf16_f32 v12, v12, v12
    v_and_b32 v12, 0xffff0000, v12
    v_mul_f32 v8, v8, v12
    v_cvt_pk_bf16_f32 v8, v8, v8
    buffer_store_short v8, v4, s[4:7], s26 offen offset:0 sc1
    v_cvt_pk_bf16_f32 v9, v9, v9
    v_and_b32 v9, 0xffff0000, v9
    v_mul_f32 v20, 0xbfb8aa3b, v9
    v_exp_f32 v20, v20
    s_nop 0
    v_add_f32 v20, 1.0, v20
    v_rcp_f32 v20, v20
    s_nop 0
    v_mul_f32 v9, v9, v20
    v_cvt_pk_bf16_f32 v9, v9, v9
    v_and_b32 v9, 0xffff0000, v9
    v_cvt_pk_bf16_f32 v13, v13, v13
    v_and_b32 v13, 0xffff0000, v13
    v_mul_f32 v9, v9, v13
    v_cvt_pk_bf16_f32 v9, v9, v9
    buffer_store_short v9, v4, s[4:7], s26 offen offset:32 sc1
    v_cvt_pk_bf16_f32 v10, v10, v10
    v_and_b32 v10, 0xffff0000, v10
    v_mul_f32 v20, 0xbfb8aa3b, v10
    v_exp_f32 v20, v20
    s_nop 0
    v_add_f32 v20, 1.0, v20
    v_rcp_f32 v20, v20
    s_nop 0
    v_mul_f32 v10, v10, v20
    v_cvt_pk_bf16_f32 v10, v10, v10
    v_and_b32 v10, 0xffff0000, v10
    v_cvt_pk_bf16_f32 v14, v14, v14
    v_and_b32 v14, 0xffff0000, v14
    v_mul_f32 v10, v10, v14
    v_cvt_pk_bf16_f32 v10, v10, v10
    buffer_store_short v10, v4, s[4:7], s26 offen offset:64 sc1
    v_cvt_pk_bf16_f32 v11, v11, v11
    v_and_b32 v11, 0xffff0000, v11
    v_mul_f32 v20, 0xbfb8aa3b, v11
    v_exp_f32 v20, v20
    s_nop 0
    v_add_f32 v20, 1.0, v20
    v_rcp_f32 v20, v20
    s_nop 0
    v_mul_f32 v11, v11, v20
    v_cvt_pk_bf16_f32 v11, v11, v11
    v_and_b32 v11, 0xffff0000, v11
    v_cvt_pk_bf16_f32 v15, v15, v15
    v_and_b32 v15, 0xffff0000, v15
    v_mul_f32 v11, v11, v15
    v_cvt_pk_bf16_f32 v11, v11, v11
    buffer_store_short v11, v4, s[4:7], s26 offen offset:96 sc1
    s_mov_b32 exec_hi, -1
    s_waitcnt vmcnt(0)
    v_mov_b32 v4, 0
    v_mov_b32 v5, 1
    s_mov_b64 exec, 1
    buffer_atomic_add v5, v4, s[20:23], 0 offen offset:132 sc1
    s_mov_b64 exec, -1
L_recuxd_218:
    s_branch L_recuwo_213
L_recum2_214:
    s_sub_u32 s35, s25, 108
    v_mov_b32 v5, 0
    s_mov_b32 s27, 0
L_recuwm1_219:
    buffer_load_dword v6, v5, s[20:23], 0 offen offset:132 sc1
    s_waitcnt vmcnt(0)
    v_cmp_gt_u32 vcc, 0x6c, v6
    s_cbranch_vccz L_recuwm1ok_220
    s_add_u32 s27, s27, 1
    s_cmp_lt_u32 s27, 400000
    s_cbranch_scc0 L_exit_recurrent_scan__memory_aug_recurrent_mem_tr__moe_arch_mod__prompt_kernel
    s_sleep 2
    s_branch L_recuwm1_219
L_recuwm1ok_220:
    s_load_dwordx2 s[8:9], s[0:1], 88
    s_mov_b32 s10, 0x21c000
    s_mov_b32 s11, 0x00020000
    s_add_u32 s12, s4, 5308416
    s_addc_u32 s13, s5, 0
    s_mov_b32 s14, 27648
    s_mov_b32 s15, 0x00020000
    v_and_b32 v5, 7, v0
    v_lshlrev_b32 v5, 5, v5
    v_bfe_u32 v4, v0, 4, 1
    v_lshl_add_u32 v5, v4, 4, v5
    v_lshrrev_b32 v4, 5, v0
    v_lshl_add_u32 v5, v4, 8, v5
    s_mul_i32 s26, s24, 7168
    v_add_u32 v5, s26, v5
    v_lshrrev_b32 v4, 4, v0
    v_mul_u32_u24 v4, 10240, v4
    v_and_b32 v6, 15, v0
    v_lshl_add_u32 v4, v6, 1, v4
    s_mul_i32 s27, s24, 573440
    s_lshl_b32 s28, s35, 5
    s_add_u32 s27, s27, s28
    v_add_u32 v4, s27, v4
    s_waitcnt lgkmcnt(0)
    buffer_load_dwordx4 v[16:19], v5, s[12:15], 0 offen offset:0 sc1
    buffer_load_dwordx4 v[20:23], v5, s[12:15], 0 offen offset:512 sc1
    buffer_load_dwordx4 v[24:27], v5, s[12:15], 0 offen offset:1024 sc1
    buffer_load_dwordx4 v[28:31], v5, s[12:15], 0 offen offset:1536 sc1
    buffer_load_dwordx4 v[32:35], v5, s[12:15], 0 offen offset:2048 sc1
    buffer_load_dwordx4 v[36:39], v5, s[12:15], 0 offen offset:2560 sc1
    buffer_load_dwordx4 v[40:43], v5, s[12:15], 0 offen offset:3072 sc1
    buffer_load_dwordx4 v[44:47], v5, s[12:15], 0 offen offset:3584 sc1
    v_add_u32 v5, 4096, v5
    buffer_load_dwordx4 v[48:51], v5, s[12:15], 0 offen offset:0 sc1
    buffer_load_dwordx4 v[52:55], v5, s[12:15], 0 offen offset:512 sc1
    buffer_load_dwordx4 v[56:59], v5, s[12:15], 0 offen offset:1024 sc1
    buffer_load_dwordx4 v[60:63], v5, s[12:15], 0 offen offset:1536 sc1
    buffer_load_dwordx4 v[64:67], v5, s[12:15], 0 offen offset:2048 sc1
    buffer_load_dwordx4 v[68:71], v5, s[12:15], 0 offen offset:2560 sc1
    buffer_load_ushort v72, v4, s[8:11], 0 offen offset:0
    buffer_load_ushort v73, v4, s[8:11], 0 offen offset:1280
    buffer_load_ushort v74, v4, s[8:11], 0 offen offset:2560
    v_add_u32 v4, 3840, v4
    buffer_load_ushort v75, v4, s[8:11], 0 offen offset:0
    buffer_load_ushort v76, v4, s[8:11], 0 offen offset:1280
    buffer_load_ushort v77, v4, s[8:11], 0 offen offset:2560
    v_add_u32 v4, 3840, v4
    buffer_load_ushort v78, v4, s[8:11], 0 offen offset:0
    buffer_load_ushort v79, v4, s[8:11], 0 offen offset:1280
    v_add_u32 v4, 33280, v4
    buffer_load_ushort v80, v4, s[8:11], 0 offen offset:0
    buffer_load_ushort v81, v4, s[8:11], 0 offen offset:1280
    buffer_load_ushort v82, v4, s[8:11], 0 offen offset:2560
    v_add_u32 v4, 3840, v4
    buffer_load_ushort v83, v4, s[8:11], 0 offen offset:0
    buffer_load_ushort v84, v4, s[8:11], 0 offen offset:1280
    buffer_load_ushort v85, v4, s[8:11], 0 offen offset:2560
    v_add_u32 v4, 3840, v4
    buffer_load_ushort v86, v4, s[8:11], 0 offen offset:0
    buffer_load_ushort v87, v4, s[8:11], 0 offen offset:1280
    v_add_u32 v4, 33280, v4
    buffer_load_ushort v88, v4, s[8:11], 0 offen offset:0
    buffer_load_ushort v89, v4, s[8:11], 0 offen offset:1280
    buffer_load_ushort v90, v4, s[8:11], 0 offen offset:2560
    v_add_u32 v4, 3840, v4
    buffer_load_ushort v91, v4, s[8:11], 0 offen offset:0
    buffer_load_ushort v92, v4, s[8:11], 0 offen offset:1280
    buffer_load_ushort v93, v4, s[8:11], 0 offen offset:2560
    v_add_u32 v4, 3840, v4
    buffer_load_ushort v94, v4, s[8:11], 0 offen offset:0
    buffer_load_ushort v95, v4, s[8:11], 0 offen offset:1280
    v_add_u32 v4, 33280, v4
    buffer_load_ushort v96, v4, s[8:11], 0 offen offset:0
    buffer_load_ushort v97, v4, s[8:11], 0 offen offset:1280
    buffer_load_ushort v98, v4, s[8:11], 0 offen offset:2560
    v_add_u32 v4, 3840, v4
    buffer_load_ushort v99, v4, s[8:11], 0 offen offset:0
    buffer_load_ushort v100, v4, s[8:11], 0 offen offset:1280
    buffer_load_ushort v101, v4, s[8:11], 0 offen offset:2560
    v_add_u32 v4, 3840, v4
    buffer_load_ushort v102, v4, s[8:11], 0 offen offset:0
    buffer_load_ushort v103, v4, s[8:11], 0 offen offset:1280
    v_add_u32 v4, 33280, v4
    buffer_load_ushort v104, v4, s[8:11], 0 offen offset:0
    buffer_load_ushort v105, v4, s[8:11], 0 offen offset:1280
    buffer_load_ushort v106, v4, s[8:11], 0 offen offset:2560
    v_add_u32 v4, 3840, v4
    buffer_load_ushort v107, v4, s[8:11], 0 offen offset:0
    buffer_load_ushort v108, v4, s[8:11], 0 offen offset:1280
    buffer_load_ushort v109, v4, s[8:11], 0 offen offset:2560
    v_add_u32 v4, 3840, v4
    buffer_load_ushort v110, v4, s[8:11], 0 offen offset:0
    buffer_load_ushort v111, v4, s[8:11], 0 offen offset:1280
    v_add_u32 v4, 33280, v4
    buffer_load_ushort v112, v4, s[8:11], 0 offen offset:0
    buffer_load_ushort v113, v4, s[8:11], 0 offen offset:1280
    buffer_load_ushort v114, v4, s[8:11], 0 offen offset:2560
    v_add_u32 v4, 3840, v4
    buffer_load_ushort v115, v4, s[8:11], 0 offen offset:0
    buffer_load_ushort v116, v4, s[8:11], 0 offen offset:1280
    buffer_load_ushort v117, v4, s[8:11], 0 offen offset:2560
    v_add_u32 v4, 3840, v4
    buffer_load_ushort v118, v4, s[8:11], 0 offen offset:0
    buffer_load_ushort v119, v4, s[8:11], 0 offen offset:1280
    v_add_u32 v4, 33280, v4
    buffer_load_ushort v120, v4, s[8:11], 0 offen offset:0
    buffer_load_ushort v121, v4, s[8:11], 0 offen offset:1280
    buffer_load_ushort v122, v4, s[8:11], 0 offen offset:2560
    v_add_u32 v4, 3840, v4
    buffer_load_ushort v123, v4, s[8:11], 0 offen offset:0
    buffer_load_ushort v124, v4, s[8:11], 0 offen offset:1280
    buffer_load_ushort v125, v4, s[8:11], 0 offen offset:2560
    v_add_u32 v4, 3840, v4
    buffer_load_ushort v126, v4, s[8:11], 0 offen offset:0
    buffer_load_ushort v127, v4, s[8:11], 0 offen offset:1280
    v_add_u32 v4, 33280, v4
    buffer_load_ushort v128, v4, s[8:11], 0 offen offset:0
    buffer_load_ushort v129, v4, s[8:11], 0 offen offset:1280
    buffer_load_ushort v130, v4, s[8:11], 0 offen offset:2560
    v_add_u32 v4, 3840, v4
    buffer_load_ushort v131, v4, s[8:11], 0 offen offset:0
    buffer_load_ushort v132, v4, s[8:11], 0 offen offset:1280
    buffer_load_ushort v133, v4, s[8:11], 0 offen offset:2560
    v_add_u32 v4, 3840, v4
    buffer_load_ushort v134, v4, s[8:11], 0 offen offset:0
    buffer_load_ushort v135, v4, s[8:11], 0 offen offset:1280
    v_add_u32 v4, 33280, v4
    buffer_load_ushort v136, v4, s[8:11], 0 offen offset:0
    buffer_load_ushort v137, v4, s[8:11], 0 offen offset:1280
    buffer_load_ushort v138, v4, s[8:11], 0 offen offset:2560
    v_add_u32 v4, 3840, v4
    buffer_load_ushort v139, v4, s[8:11], 0 offen offset:0
    buffer_load_ushort v140, v4, s[8:11], 0 offen offset:1280
    buffer_load_ushort v141, v4, s[8:11], 0 offen offset:2560
    v_add_u32 v4, 3840, v4
    buffer_load_ushort v142, v4, s[8:11], 0 offen offset:0
    buffer_load_ushort v143, v4, s[8:11], 0 offen offset:1280
    v_add_u32 v4, 33280, v4
    buffer_load_ushort v144, v4, s[8:11], 0 offen offset:0
    buffer_load_ushort v145, v4, s[8:11], 0 offen offset:1280
    buffer_load_ushort v146, v4, s[8:11], 0 offen offset:2560
    v_add_u32 v4, 3840, v4
    buffer_load_ushort v147, v4, s[8:11], 0 offen offset:0
    buffer_load_ushort v148, v4, s[8:11], 0 offen offset:1280
    buffer_load_ushort v149, v4, s[8:11], 0 offen offset:2560
    v_add_u32 v4, 3840, v4
    buffer_load_ushort v150, v4, s[8:11], 0 offen offset:0
    buffer_load_ushort v151, v4, s[8:11], 0 offen offset:1280
    v_add_u32 v4, 33280, v4
    buffer_load_ushort v152, v4, s[8:11], 0 offen offset:0
    buffer_load_ushort v153, v4, s[8:11], 0 offen offset:1280
    buffer_load_ushort v154, v4, s[8:11], 0 offen offset:2560
    v_add_u32 v4, 3840, v4
    buffer_load_ushort v155, v4, s[8:11], 0 offen offset:0
    buffer_load_ushort v156, v4, s[8:11], 0 offen offset:1280
    buffer_load_ushort v157, v4, s[8:11], 0 offen offset:2560
    v_add_u32 v4, 3840, v4
    buffer_load_ushort v158, v4, s[8:11], 0 offen offset:0
    buffer_load_ushort v159, v4, s[8:11], 0 offen offset:1280
    v_add_u32 v4, 33280, v4
    buffer_load_ushort v160, v4, s[8:11], 0 offen offset:0
    buffer_load_ushort v161, v4, s[8:11], 0 offen offset:1280
    buffer_load_ushort v162, v4, s[8:11], 0 offen offset:2560
    v_add_u32 v4, 3840, v4
    buffer_load_ushort v163, v4, s[8:11], 0 offen offset:0
    buffer_load_ushort v164, v4, s[8:11], 0 offen offset:1280
    buffer_load_ushort v165, v4, s[8:11], 0 offen offset:2560
    v_add_u32 v4, 3840, v4
    buffer_load_ushort v166, v4, s[8:11], 0 offen offset:0
    buffer_load_ushort v167, v4, s[8:11], 0 offen offset:1280
    v_add_u32 v4, 33280, v4
    buffer_load_ushort v168, v4, s[8:11], 0 offen offset:0
    buffer_load_ushort v169, v4, s[8:11], 0 offen offset:1280
    buffer_load_ushort v170, v4, s[8:11], 0 offen offset:2560
    v_add_u32 v4, 3840, v4
    buffer_load_ushort v171, v4, s[8:11], 0 offen offset:0
    buffer_load_ushort v172, v4, s[8:11], 0 offen offset:1280
    buffer_load_ushort v173, v4, s[8:11], 0 offen offset:2560
    v_add_u32 v4, 3840, v4
    buffer_load_ushort v174, v4, s[8:11], 0 offen offset:0
    buffer_load_ushort v175, v4, s[8:11], 0 offen offset:1280
    v_add_u32 v4, 33280, v4
    buffer_load_ushort v176, v4, s[8:11], 0 offen offset:0
    buffer_load_ushort v177, v4, s[8:11], 0 offen offset:1280
    buffer_load_ushort v178, v4, s[8:11], 0 offen offset:2560
    v_add_u32 v4, 3840, v4
    buffer_load_ushort v179, v4, s[8:11], 0 offen offset:0
    buffer_load_ushort v180, v4, s[8:11], 0 offen offset:1280
    buffer_load_ushort v181, v4, s[8:11], 0 offen offset:2560
    v_add_u32 v4, 3840, v4
    buffer_load_ushort v182, v4, s[8:11], 0 offen offset:0
    buffer_load_ushort v183, v4, s[8:11], 0 offen offset:1280
    v_add_u32 v4, 33280, v4
    s_waitcnt vmcnt(0)
    v_lshl_or_b32 v72, v73, 16, v72
    v_lshl_or_b32 v73, v75, 16, v74
    v_lshl_or_b32 v74, v77, 16, v76
    v_lshl_or_b32 v75, v79, 16, v78
    s_nop 1
    v_mfma_f32_16x16x32_bf16 v[8:11], v[16:19], v[72:75], 0
    v_lshl_or_b32 v80, v81, 16, v80
    v_lshl_or_b32 v81, v83, 16, v82
    v_lshl_or_b32 v82, v85, 16, v84
    v_lshl_or_b32 v83, v87, 16, v86
    s_nop 1
    v_mfma_f32_16x16x32_bf16 v[8:11], v[20:23], v[80:83], v[8:11]
    v_lshl_or_b32 v88, v89, 16, v88
    v_lshl_or_b32 v89, v91, 16, v90
    v_lshl_or_b32 v90, v93, 16, v92
    v_lshl_or_b32 v91, v95, 16, v94
    s_nop 1
    v_mfma_f32_16x16x32_bf16 v[8:11], v[24:27], v[88:91], v[8:11]
    v_lshl_or_b32 v96, v97, 16, v96
    v_lshl_or_b32 v97, v99, 16, v98
    v_lshl_or_b32 v98, v101, 16, v100
    v_lshl_or_b32 v99, v103, 16, v102
    s_nop 1
    v_mfma_f32_16x16x32_bf16 v[8:11], v[28:31], v[96:99], v[8:11]
    v_lshl_or_b32 v104, v105, 16, v104
    v_lshl_or_b32 v105, v107, 16, v106
    v_lshl_or_b32 v106, v109, 16, v108
    v_lshl_or_b32 v107, v111, 16, v110
    s_nop 1
    v_mfma_f32_16x16x32_bf16 v[8:11], v[32:35], v[104:107], v[8:11]
    v_lshl_or_b32 v112, v113, 16, v112
    v_lshl_or_b32 v113, v115, 16, v114
    v_lshl_or_b32 v114, v117, 16, v116
    v_lshl_or_b32 v115, v119, 16, v118
    s_nop 1
    v_mfma_f32_16x16x32_bf16 v[8:11], v[36:39], v[112:115], v[8:11]
    v_lshl_or_b32 v120, v121, 16, v120
    v_lshl_or_b32 v121, v123, 16, v122
    v_lshl_or_b32 v122, v125, 16, v124
    v_lshl_or_b32 v123, v127, 16, v126
    s_nop 1
    v_mfma_f32_16x16x32_bf16 v[8:11], v[40:43], v[120:123], v[8:11]
    v_lshl_or_b32 v128, v129, 16, v128
    v_lshl_or_b32 v129, v131, 16, v130
    v_lshl_or_b32 v130, v133, 16, v132
    v_lshl_or_b32 v131, v135, 16, v134
    s_nop 1
    v_mfma_f32_16x16x32_bf16 v[8:11], v[44:47], v[128:131], v[8:11]
    v_lshl_or_b32 v136, v137, 16, v136
    v_lshl_or_b32 v137, v139, 16, v138
    v_lshl_or_b32 v138, v141, 16, v140
    v_lshl_or_b32 v139, v143, 16, v142
    s_nop 1
    v_mfma_f32_16x16x32_bf16 v[8:11], v[48:51], v[136:139], v[8:11]
    v_lshl_or_b32 v144, v145, 16, v144
    v_lshl_or_b32 v145, v147, 16, v146
    v_lshl_or_b32 v146, v149, 16, v148
    v_lshl_or_b32 v147, v151, 16, v150
    s_nop 1
    v_mfma_f32_16x16x32_bf16 v[8:11], v[52:55], v[144:147], v[8:11]
    v_lshl_or_b32 v152, v153, 16, v152
    v_lshl_or_b32 v153, v155, 16, v154
    v_lshl_or_b32 v154, v157, 16, v156
    v_lshl_or_b32 v155, v159, 16, v158
    s_nop 1
    v_mfma_f32_16x16x32_bf16 v[8:11], v[56:59], v[152:155], v[8:11]
    v_lshl_or_b32 v160, v161, 16, v160
    v_lshl_or_b32 v161, v163, 16, v162
    v_lshl_or_b32 v162, v165, 16, v164
    v_lshl_or_b32 v163, v167, 16, v166
    s_nop 1
    v_mfma_f32_16x16x32_bf16 v[8:11], v[60:63], v[160:163], v[8:11]
    v_lshl_or_b32 v168, v169, 16, v168
    v_lshl_or_b32 v169, v171, 16, v170
    v_lshl_or_b32 v170, v173, 16, v172
    v_lshl_or_b32 v171, v175, 16, v174
    s_nop 1
    v_mfma_f32_16x16x32_bf16 v[8:11], v[64:67], v[168:171], v[8:11]
    v_lshl_or_b32 v176, v177, 16, v176
    v_lshl_or_b32 v177, v179, 16, v178
    v_lshl_or_b32 v178, v181, 16, v180
    v_lshl_or_b32 v179, v183, 16, v182
    s_nop 1
    v_mfma_f32_16x16x32_bf16 v[8:11], v[68:71], v[176:179], v[8:11]
    v_lshlrev_b32 v1, 4, v0
    s_lshl_b32 s26, s24, 10
    v_add_u32 v2, s26, v1
    s_nop 4
    ds_write_b128 v2, v[8:11] offset:0
    s_waitcnt lgkmcnt(0)
    s_barrier
    s_cmp_lg_u32 s24, 0
    s_cbranch_scc1 L_recuxd_222
    ds_read_b128 v[100:103], v1 offset:1024
    ds_read_b128 v[104:107], v1 offset:2048
    ds_read_b128 v[108:111], v1 offset:3072
    s_waitcnt lgkmcnt(0)
    v_add_f32 v8, v8, v100
    v_add_f32 v9, v9, v101
    v_add_f32 v10, v10, v102
    v_add_f32 v11, v11, v103
    v_add_f32 v8, v8, v104
    v_add_f32 v9, v9, v105
    v_add_f32 v10, v10, v106
    v_add_f32 v11, v11, v107
    v_add_f32 v8, v8, v108
    v_add_f32 v9, v9, v109
    v_add_f32 v10, v10, v110
    v_add_f32 v11, v11, v111
    s_mov_b32 exec_hi, 0
    v_cmp_lt_u32 vcc, 15, v0
    s_lshl_b32 s26, s35, 10
    s_add_u32 s26, s26, 0
    s_lshl_b32 s27, s35, 5
    s_add_u32 s27, s27, 2621440
    v_and_b32 v2, 7, v0
    v_lshlrev_b32 v2, 1, v2
    v_bfe_u32 v3, v0, 3, 1
    v_lshl_add_u32 v2, v3, 9, v2
    v_mov_b32 v3, s44
    v_mov_b32 v4, s48
    v_cndmask_b32 v12, v3, v4, vcc
    v_mov_b32 v3, s52
    v_mov_b32 v4, s56
    v_cndmask_b32 v16, v3, v4, vcc
    v_lshrrev_b32 v3, 5, v12
    v_mul_u32_u24 v3, 40960, v3
    v_and_b32 v4, 31, v12
    v_lshl_add_u32 v3, v4, 4, v3
    v_add_u32 v3, v3, v2
    buffer_load_ushort v20, v3, s[4:7], s26 offen sc1
    v_mul_u32_u24 v12, 1280, v12
    v_lshl_add_u32 v12, v6, 1, v12
    v_mul_f32 v3, 0xbfb8aa3b, v16
    v_exp_f32 v3, v3
    s_nop 0
    v_add_f32 v3, 1.0, v3
    v_rcp_f32 v16, v3
    s_nop 0
    v_cvt_pk_bf16_f32 v16, v16, v16
    v_and_b32 v16, 0xffff0000, v16
    v_cvt_pk_bf16_f32 v8, v8, v8
    v_and_b32 v8, 0xffff0000, v8
    v_mul_f32 v8, v8, v16
    v_cvt_pk_bf16_f32 v8, v8, v8
    v_and_b32 v8, 0xffff0000, v8
    v_mov_b32 v3, s45
    v_mov_b32 v4, s49
    v_cndmask_b32 v13, v3, v4, vcc
    v_mov_b32 v3, s53
    v_mov_b32 v4, s57
    v_cndmask_b32 v17, v3, v4, vcc
    v_lshrrev_b32 v3, 5, v13
    v_mul_u32_u24 v3, 40960, v3
    v_and_b32 v4, 31, v13
    v_lshl_add_u32 v3, v4, 4, v3
    v_add_u32 v3, v3, v2
    buffer_load_ushort v21, v3, s[4:7], s26 offen sc1
    v_mul_u32_u24 v13, 1280, v13
    v_lshl_add_u32 v13, v6, 1, v13
    v_mul_f32 v3, 0xbfb8aa3b, v17
    v_exp_f32 v3, v3
    s_nop 0
    v_add_f32 v3, 1.0, v3
    v_rcp_f32 v17, v3
    s_nop 0
    v_cvt_pk_bf16_f32 v17, v17, v17
    v_and_b32 v17, 0xffff0000, v17
    v_cvt_pk_bf16_f32 v9, v9, v9
    v_and_b32 v9, 0xffff0000, v9
    v_mul_f32 v9, v9, v17
    v_cvt_pk_bf16_f32 v9, v9, v9
    v_and_b32 v9, 0xffff0000, v9
    v_mov_b32 v3, s46
    v_mov_b32 v4, s50
    v_cndmask_b32 v14, v3, v4, vcc
    v_mov_b32 v3, s54
    v_mov_b32 v4, s58
    v_cndmask_b32 v18, v3, v4, vcc
    v_lshrrev_b32 v3, 5, v14
    v_mul_u32_u24 v3, 40960, v3
    v_and_b32 v4, 31, v14
    v_lshl_add_u32 v3, v4, 4, v3
    v_add_u32 v3, v3, v2
    buffer_load_ushort v22, v3, s[4:7], s26 offen sc1
    v_mul_u32_u24 v14, 1280, v14
    v_lshl_add_u32 v14, v6, 1, v14
    v_mul_f32 v3, 0xbfb8aa3b, v18
    v_exp_f32 v3, v3
    s_nop 0
    v_add_f32 v3, 1.0, v3
    v_rcp_f32 v18, v3
    s_nop 0
    v_cvt_pk_bf16_f32 v18, v18, v18
    v_and_b32 v18, 0xffff0000, v18
    v_cvt_pk_bf16_f32 v10, v10, v10
    v_and_b32 v10, 0xffff0000, v10
    v_mul_f32 v10, v10, v18
    v_cvt_pk_bf16_f32 v10, v10, v10
    v_and_b32 v10, 0xffff0000, v10
    v_mov_b32 v3, s47
    v_mov_b32 v4, s51
    v_cndmask_b32 v15, v3, v4, vcc
    v_mov_b32 v3, s55
    v_mov_b32 v4, s59
    v_cndmask_b32 v19, v3, v4, vcc
    v_lshrrev_b32 v3, 5, v15
    v_mul_u32_u24 v3, 40960, v3
    v_and_b32 v4, 31, v15
    v_lshl_add_u32 v3, v4, 4, v3
    v_add_u32 v3, v3, v2
    buffer_load_ushort v23, v3, s[4:7], s26 offen sc1
    v_mul_u32_u24 v15, 1280, v15
    v_lshl_add_u32 v15, v6, 1, v15
    v_mul_f32 v3, 0xbfb8aa3b, v19
    v_exp_f32 v3, v3
    s_nop 0
    v_add_f32 v3, 1.0, v3
    v_rcp_f32 v19, v3
    s_nop 0
    v_cvt_pk_bf16_f32 v19, v19, v19
    v_and_b32 v19, 0xffff0000, v19
    v_cvt_pk_bf16_f32 v11, v11, v11
    v_and_b32 v11, 0xffff0000, v11
    v_mul_f32 v11, v11, v19
    v_cvt_pk_bf16_f32 v11, v11, v11
    v_and_b32 v11, 0xffff0000, v11
    s_waitcnt vmcnt(0)
    v_lshlrev_b32 v20, 16, v20
    v_add_f32 v8, v8, v20
    v_cvt_pk_bf16_f32 v8, v8, v8
    v_and_b32 v8, 0xffff0000, v8
    v_mul_f32 v3, 0xbfb8aa3b, v8
    v_exp_f32 v3, v3
    s_nop 0
    v_add_f32 v3, 1.0, v3
    v_rcp_f32 v3, v3
    s_nop 0
    v_mul_f32 v8, v8, v3
    v_cvt_pk_bf16_f32 v8, v8, v8
    buffer_store_short v8, v12, s[4:7], s27 offen sc1
    v_lshlrev_b32 v21, 16, v21
    v_add_f32 v9, v9, v21
    v_cvt_pk_bf16_f32 v9, v9, v9
    v_and_b32 v9, 0xffff0000, v9
    v_mul_f32 v3, 0xbfb8aa3b, v9
    v_exp_f32 v3, v3
    s_nop 0
    v_add_f32 v3, 1.0, v3
    v_rcp_f32 v3, v3
    s_nop 0
    v_mul_f32 v9, v9, v3
    v_cvt_pk_bf16_f32 v9, v9, v9
    buffer_store_short v9, v13, s[4:7], s27 offen sc1
    v_lshlrev_b32 v22, 16, v22
    v_add_f32 v10, v10, v22
    v_cvt_pk_bf16_f32 v10, v10, v10
    v_and_b32 v10, 0xffff0000, v10
    v_mul_f32 v3, 0xbfb8aa3b, v10
    v_exp_f32 v3, v3
    s_nop 0
    v_add_f32 v3, 1.0, v3
    v_rcp_f32 v3, v3
    s_nop 0
    v_mul_f32 v10, v10, v3
    v_cvt_pk_bf16_f32 v10, v10, v10
    buffer_store_short v10, v14, s[4:7], s27 offen sc1
    v_lshlrev_b32 v23, 16, v23
    v_add_f32 v11, v11, v23
    v_cvt_pk_bf16_f32 v11, v11, v11
    v_and_b32 v11, 0xffff0000, v11
    v_mul_f32 v3, 0xbfb8aa3b, v11
    v_exp_f32 v3, v3
    s_nop 0
    v_add_f32 v3, 1.0, v3
    v_rcp_f32 v3, v3
    s_nop 0
    v_mul_f32 v11, v11, v3
    v_cvt_pk_bf16_f32 v11, v11, v11
    buffer_store_short v11, v15, s[4:7], s27 offen sc1
    s_mov_b32 exec_hi, -1
    s_waitcnt vmcnt(0)
    v_mov_b32 v4, 0
    v_mov_b32 v5, 1
    s_mov_b64 exec, 1
    buffer_atomic_add v5, v4, s[20:23], 0 offen offset:136 sc1
    s_mov_b64 exec, -1
L_recuxd_222:
L_recuwo_213:
    s_load_dwordx2 s[8:9], s[0:1], 40
    s_mov_b32 s10, 0x500000
    s_mov_b32 s11, 0x00020000
    s_load_dwordx2 s[12:13], s[0:1], 0
    s_mov_b32 s14, 0x280000
    s_mov_b32 s15, 0x00020000
    s_load_dwordx2 s[16:17], s[0:1], 96
    s_mov_b32 s18, 0x280000
    s_mov_b32 s19, 0x00020000
    s_mul_i32 s26, s25, 52429
    s_lshr_b32 s26, s26, 20
    s_mul_i32 s27, s26, 20
    s_sub_u32 s32, s25, s27
    s_and_b32 s33, s26, 1
    s_lshr_b32 s34, s26, 1
    v_lshrrev_b32 v1, 2, v0
    v_mul_u32_u24 v1, 1280, v1
    v_and_b32 v2, 3, v0
    v_lshl_add_u32 v1, v2, 4, v1
    v_lshrrev_b32 v3, 2, v0
    v_lshlrev_b32 v3, 6, v3
    v_lshl_add_u32 v3, v2, 4, v3
    s_mul_i32 s27, s24, 40960
    v_add_u32 v3, s27, v3
    s_mul_i32 s26, s24, 1310720
    s_lshl_b32 s28, s32, 6
    s_add_u32 s26, s26, s28
    s_waitcnt lgkmcnt(0)
    s_mov_b32 m0, s27
    s_nop 0
    buffer_load_dwordx4 v1, s[8:11], s26 offen lds
    s_add_u32 s26, s26, 20480
    s_add_u32 m0, m0, 1024
    s_nop 0
    buffer_load_dwordx4 v1, s[8:11], s26 offen lds
    s_add_u32 s26, s26, 20480
    s_add_u32 m0, m0, 1024
    s_nop 0
    buffer_load_dwordx4 v1, s[8:11], s26 offen lds
    s_add_u32 s26, s26, 20480
    s_add_u32 m0, m0, 1024
    s_nop 0
    buffer_load_dwordx4 v1, s[8:11], s26 offen lds
    s_add_u32 s26, s26, 20480
    s_add_u32 m0, m0, 1024
    s_nop 0
    buffer_load_dwordx4 v1, s[8:11], s26 offen lds
    s_add_u32 s26, s26, 20480
    s_add_u32 m0, m0, 1024
    s_nop 0
    buffer_load_dwordx4 v1, s[8:11], s26 offen lds
    s_add_u32 s26, s26, 20480
    s_add_u32 m0, m0, 1024
    s_nop 0
    buffer_load_dwordx4 v1, s[8:11], s26 offen lds
    s_add_u32 s26, s26, 20480
    s_add_u32 m0, m0, 1024
    s_nop 0
    buffer_load_dwordx4 v1, s[8:11], s26 offen lds
    s_add_u32 s26, s26, 20480
    s_add_u32 m0, m0, 1024
    s_nop 0
    buffer_load_dwordx4 v1, s[8:11], s26 offen lds
    s_add_u32 s26, s26, 20480
    s_add_u32 m0, m0, 1024
    s_nop 0
    buffer_load_dwordx4 v1, s[8:11], s26 offen lds
    s_add_u32 s26, s26, 20480
    s_add_u32 m0, m0, 1024
    s_nop 0
    buffer_load_dwordx4 v1, s[8:11], s26 offen lds
    s_add_u32 s26, s26, 20480
    s_add_u32 m0, m0, 1024
    s_nop 0
    buffer_load_dwordx4 v1, s[8:11], s26 offen lds
    s_add_u32 s26, s26, 20480
    s_add_u32 m0, m0, 1024
    s_nop 0
    buffer_load_dwordx4 v1, s[8:11], s26 offen lds
    s_add_u32 s26, s26, 20480
    s_add_u32 m0, m0, 1024
    s_nop 0
    buffer_load_dwordx4 v1, s[8:11], s26 offen lds
    s_add_u32 s26, s26, 20480
    s_add_u32 m0, m0, 1024
    s_nop 0
    buffer_load_dwordx4 v1, s[8:11], s26 offen lds
    s_add_u32 s26, s26, 20480
    s_add_u32 m0, m0, 1024
    s_nop 0
    buffer_load_dwordx4 v1, s[8:11], s26 offen lds
    s_add_u32 s26, s26, 20480
    s_add_u32 m0, m0, 1024
    s_nop 0
    buffer_load_dwordx4 v1, s[8:11], s26 offen lds
    s_add_u32 s26, s26, 20480
    s_add_u32 m0, m0, 1024
    s_nop 0
    buffer_load_dwordx4 v1, s[8:11], s26 offen lds
    s_add_u32 s26, s26, 20480
    s_add_u32 m0, m0, 1024
    s_nop 0
    buffer_load_dwordx4 v1, s[8:11], s26 offen lds
    s_add_u32 s26, s26, 20480
    s_add_u32 m0, m0, 1024
    s_nop 0
    buffer_load_dwordx4 v1, s[8:11], s26 offen lds
    s_add_u32 s26, s26, 20480
    s_add_u32 m0, m0, 1024
    s_nop 0
    buffer_load_dwordx4 v1, s[8:11], s26 offen lds
    s_add_u32 s26, s26, 20480
    s_add_u32 m0, m0, 1024
    s_nop 0
    buffer_load_dwordx4 v1, s[8:11], s26 offen lds
    s_add_u32 s26, s26, 20480
    s_add_u32 m0, m0, 1024
    s_nop 0
    buffer_load_dwordx4 v1, s[8:11], s26 offen lds
    s_add_u32 s26, s26, 20480
    s_add_u32 m0, m0, 1024
    s_nop 0
    buffer_load_dwordx4 v1, s[8:11], s26 offen lds
    s_add_u32 s26, s26, 20480
    s_add_u32 m0, m0, 1024
    s_nop 0
    buffer_load_dwordx4 v1, s[8:11], s26 offen lds
    s_add_u32 s26, s26, 20480
    s_add_u32 m0, m0, 1024
    s_nop 0
    buffer_load_dwordx4 v1, s[8:11], s26 offen lds
    s_add_u32 s26, s26, 20480
    s_add_u32 m0, m0, 1024
    s_nop 0
    buffer_load_dwordx4 v1, s[8:11], s26 offen lds
    s_add_u32 s26, s26, 20480
    s_add_u32 m0, m0, 1024
    s_nop 0
    buffer_load_dwordx4 v1, s[8:11], s26 offen lds
    s_add_u32 s26, s26, 20480
    s_add_u32 m0, m0, 1024
    s_nop 0
    buffer_load_dwordx4 v1, s[8:11], s26 offen lds
    s_add_u32 s26, s26, 20480
    s_add_u32 m0, m0, 1024
    s_nop 0
    buffer_load_dwordx4 v1, s[8:11], s26 offen lds
    s_add_u32 s26, s26, 20480
    s_add_u32 m0, m0, 1024
    s_nop 0
    buffer_load_dwordx4 v1, s[8:11], s26 offen lds
    s_add_u32 s26, s26, 20480
    s_add_u32 m0, m0, 1024
    s_nop 0
    buffer_load_dwordx4 v1, s[8:11], s26 offen lds
    s_add_u32 s26, s26, 20480
    s_add_u32 m0, m0, 1024
    s_waitcnt vmcnt(31)
    ds_read_b64_tr_b16 a[0:1], v3 offset:0
    ds_read_b64_tr_b16 a[4:5], v3 offset:8
    s_waitcnt vmcnt(30)
    ds_read_b64_tr_b16 a[2:3], v3 offset:1024
    ds_read_b64_tr_b16 a[6:7], v3 offset:1032
    s_waitcnt vmcnt(29)
    ds_read_b64_tr_b16 a[8:9], v3 offset:2048
    ds_read_b64_tr_b16 a[12:13], v3 offset:2056
    s_waitcnt vmcnt(28)
    ds_read_b64_tr_b16 a[10:11], v3 offset:3072
    ds_read_b64_tr_b16 a[14:15], v3 offset:3080
    s_waitcnt vmcnt(27)
    ds_read_b64_tr_b16 a[16:17], v3 offset:4096
    ds_read_b64_tr_b16 a[20:21], v3 offset:4104
    s_waitcnt vmcnt(26)
    ds_read_b64_tr_b16 a[18:19], v3 offset:5120
    ds_read_b64_tr_b16 a[22:23], v3 offset:5128
    s_waitcnt vmcnt(25)
    ds_read_b64_tr_b16 a[24:25], v3 offset:6144
    ds_read_b64_tr_b16 a[28:29], v3 offset:6152
    s_waitcnt vmcnt(24)
    ds_read_b64_tr_b16 a[26:27], v3 offset:7168
    ds_read_b64_tr_b16 a[30:31], v3 offset:7176
    s_waitcnt vmcnt(23)
    ds_read_b64_tr_b16 a[32:33], v3 offset:8192
    ds_read_b64_tr_b16 a[36:37], v3 offset:8200
    s_waitcnt vmcnt(22)
    ds_read_b64_tr_b16 a[34:35], v3 offset:9216
    ds_read_b64_tr_b16 a[38:39], v3 offset:9224
    s_waitcnt vmcnt(21)
    ds_read_b64_tr_b16 a[40:41], v3 offset:10240
    ds_read_b64_tr_b16 a[44:45], v3 offset:10248
    s_waitcnt vmcnt(20)
    ds_read_b64_tr_b16 a[42:43], v3 offset:11264
    ds_read_b64_tr_b16 a[46:47], v3 offset:11272
    s_waitcnt vmcnt(19)
    ds_read_b64_tr_b16 a[48:49], v3 offset:12288
    ds_read_b64_tr_b16 a[52:53], v3 offset:12296
    s_waitcnt vmcnt(18)
    ds_read_b64_tr_b16 a[50:51], v3 offset:13312
    ds_read_b64_tr_b16 a[54:55], v3 offset:13320
    s_waitcnt vmcnt(17)
    ds_read_b64_tr_b16 a[56:57], v3 offset:14336
    ds_read_b64_tr_b16 a[60:61], v3 offset:14344
    s_waitcnt vmcnt(16)
    ds_read_b64_tr_b16 a[58:59], v3 offset:15360
    ds_read_b64_tr_b16 a[62:63], v3 offset:15368
    s_waitcnt vmcnt(15)
    ds_read_b64_tr_b16 a[64:65], v3 offset:16384
    ds_read_b64_tr_b16 a[68:69], v3 offset:16392
    s_waitcnt vmcnt(14)
    ds_read_b64_tr_b16 a[66:67], v3 offset:17408
    ds_read_b64_tr_b16 a[70:71], v3 offset:17416
    s_waitcnt vmcnt(13)
    ds_read_b64_tr_b16 a[72:73], v3 offset:18432
    ds_read_b64_tr_b16 a[76:77], v3 offset:18440
    s_waitcnt vmcnt(12)
    ds_read_b64_tr_b16 a[74:75], v3 offset:19456
    ds_read_b64_tr_b16 a[78:79], v3 offset:19464
    s_waitcnt vmcnt(11)
    ds_read_b64_tr_b16 a[80:81], v3 offset:20480
    ds_read_b64_tr_b16 a[84:85], v3 offset:20488
    s_waitcnt vmcnt(10)
    ds_read_b64_tr_b16 a[82:83], v3 offset:21504
    ds_read_b64_tr_b16 a[86:87], v3 offset:21512
    s_waitcnt vmcnt(9)
    ds_read_b64_tr_b16 a[88:89], v3 offset:22528
    ds_read_b64_tr_b16 a[92:93], v3 offset:22536
    s_waitcnt vmcnt(8)
    ds_read_b64_tr_b16 a[90:91], v3 offset:23552
    ds_read_b64_tr_b16 a[94:95], v3 offset:23560
    s_waitcnt vmcnt(7)
    ds_read_b64_tr_b16 a[96:97], v3 offset:24576
    ds_read_b64_tr_b16 a[100:101], v3 offset:24584
    s_waitcnt vmcnt(6)
    ds_read_b64_tr_b16 a[98:99], v3 offset:25600
    ds_read_b64_tr_b16 a[102:103], v3 offset:25608
    s_waitcnt vmcnt(5)
    ds_read_b64_tr_b16 a[104:105], v3 offset:26624
    ds_read_b64_tr_b16 a[108:109], v3 offset:26632
    s_waitcnt vmcnt(4)
    ds_read_b64_tr_b16 a[106:107], v3 offset:27648
    ds_read_b64_tr_b16 a[110:111], v3 offset:27656
    s_waitcnt vmcnt(3)
    ds_read_b64_tr_b16 a[112:113], v3 offset:28672
    ds_read_b64_tr_b16 a[116:117], v3 offset:28680
    s_waitcnt vmcnt(2)
    ds_read_b64_tr_b16 a[114:115], v3 offset:29696
    ds_read_b64_tr_b16 a[118:119], v3 offset:29704
    s_waitcnt vmcnt(1)
    ds_read_b64_tr_b16 a[120:121], v3 offset:30720
    ds_read_b64_tr_b16 a[124:125], v3 offset:30728
    s_waitcnt vmcnt(0)
    ds_read_b64_tr_b16 a[122:123], v3 offset:31744
    ds_read_b64_tr_b16 a[126:127], v3 offset:31752
    s_waitcnt lgkmcnt(0)
    s_mov_b32 m0, s27
    s_nop 0
    buffer_load_dwordx4 v1, s[8:11], s26 offen lds
    s_add_u32 s26, s26, 20480
    s_add_u32 m0, m0, 1024
    s_nop 0
    buffer_load_dwordx4 v1, s[8:11], s26 offen lds
    s_add_u32 s26, s26, 20480
    s_add_u32 m0, m0, 1024
    s_nop 0
    buffer_load_dwordx4 v1, s[8:11], s26 offen lds
    s_add_u32 s26, s26, 20480
    s_add_u32 m0, m0, 1024
    s_nop 0
    buffer_load_dwordx4 v1, s[8:11], s26 offen lds
    s_add_u32 s26, s26, 20480
    s_add_u32 m0, m0, 1024
    s_nop 0
    buffer_load_dwordx4 v1, s[8:11], s26 offen lds
    s_add_u32 s26, s26, 20480
    s_add_u32 m0, m0, 1024
    s_nop 0
    buffer_load_dwordx4 v1, s[8:11], s26 offen lds
    s_add_u32 s26, s26, 20480
    s_add_u32 m0, m0, 1024
    s_nop 0
    buffer_load_dwordx4 v1, s[8:11], s26 offen lds
    s_add_u32 s26, s26, 20480
    s_add_u32 m0, m0, 1024
    s_nop 0
    buffer_load_dwordx4 v1, s[8:11], s26 offen lds
    s_add_u32 s26, s26, 20480
    s_add_u32 m0, m0, 1024
    s_nop 0
    buffer_load_dwordx4 v1, s[8:11], s26 offen lds
    s_add_u32 s26, s26, 20480
    s_add_u32 m0, m0, 1024
    s_nop 0
    buffer_load_dwordx4 v1, s[8:11], s26 offen lds
    s_add_u32 s26, s26, 20480
    s_add_u32 m0, m0, 1024
    s_nop 0
    buffer_load_dwordx4 v1, s[8:11], s26 offen lds
    s_add_u32 s26, s26, 20480
    s_add_u32 m0, m0, 1024
    s_nop 0
    buffer_load_dwordx4 v1, s[8:11], s26 offen lds
    s_add_u32 s26, s26, 20480
    s_add_u32 m0, m0, 1024
    s_nop 0
    buffer_load_dwordx4 v1, s[8:11], s26 offen lds
    s_add_u32 s26, s26, 20480
    s_add_u32 m0, m0, 1024
    s_nop 0
    buffer_load_dwordx4 v1, s[8:11], s26 offen lds
    s_add_u32 s26, s26, 20480
    s_add_u32 m0, m0, 1024
    s_nop 0
    buffer_load_dwordx4 v1, s[8:11], s26 offen lds
    s_add_u32 s26, s26, 20480
    s_add_u32 m0, m0, 1024
    s_nop 0
    buffer_load_dwordx4 v1, s[8:11], s26 offen lds
    s_add_u32 s26, s26, 20480
    s_add_u32 m0, m0, 1024
    s_nop 0
    buffer_load_dwordx4 v1, s[8:11], s26 offen lds
    s_add_u32 s26, s26, 20480
    s_add_u32 m0, m0, 1024
    s_nop 0
    buffer_load_dwordx4 v1, s[8:11], s26 offen lds
    s_add_u32 s26, s26, 20480
    s_add_u32 m0, m0, 1024
    s_nop 0
    buffer_load_dwordx4 v1, s[8:11], s26 offen lds
    s_add_u32 s26, s26, 20480
    s_add_u32 m0, m0, 1024
    s_nop 0
    buffer_load_dwordx4 v1, s[8:11], s26 offen lds
    s_add_u32 s26, s26, 20480
    s_add_u32 m0, m0, 1024
    s_nop 0
    buffer_load_dwordx4 v1, s[8:11], s26 offen lds
    s_add_u32 s26, s26, 20480
    s_add_u32 m0, m0, 1024
    s_nop 0
    buffer_load_dwordx4 v1, s[8:11], s26 offen lds
    s_add_u32 s26, s26, 20480
    s_add_u32 m0, m0, 1024
    s_nop 0
    buffer_load_dwordx4 v1, s[8:11], s26 offen lds
    s_add_u32 s26, s26, 20480
    s_add_u32 m0, m0, 1024
    s_nop 0
    buffer_load_dwordx4 v1, s[8:11], s26 offen lds
    s_add_u32 s26, s26, 20480
    s_add_u32 m0, m0, 1024
    s_nop 0
    buffer_load_dwordx4 v1, s[8:11], s26 offen lds
    s_add_u32 s26, s26, 20480
    s_add_u32 m0, m0, 1024
    s_nop 0
    buffer_load_dwordx4 v1, s[8:11], s26 offen lds
    s_add_u32 s26, s26, 20480
    s_add_u32 m0, m0, 1024
    s_nop 0
    buffer_load_dwordx4 v1, s[8:11], s26 offen lds
    s_add_u32 s26, s26, 20480
    s_add_u32 m0, m0, 1024
    s_nop 0
    buffer_load_dwordx4 v1, s[8:11], s26 offen lds
    s_add_u32 s26, s26, 20480
    s_add_u32 m0, m0, 1024
    s_nop 0
    buffer_load_dwordx4 v1, s[8:11], s26 offen lds
    s_add_u32 s26, s26, 20480
    s_add_u32 m0, m0, 1024
    s_nop 0
    buffer_load_dwordx4 v1, s[8:11], s26 offen lds
    s_add_u32 s26, s26, 20480
    s_add_u32 m0, m0, 1024
    s_nop 0
    buffer_load_dwordx4 v1, s[8:11], s26 offen lds
    s_add_u32 s26, s26, 20480
    s_add_u32 m0, m0, 1024
    s_nop 0
    buffer_load_dwordx4 v1, s[8:11], s26 offen lds
    s_add_u32 s26, s26, 20480
    s_add_u32 m0, m0, 1024
    s_waitcnt vmcnt(31)
    ds_read_b64_tr_b16 a[128:129], v3 offset:0
    ds_read_b64_tr_b16 a[132:133], v3 offset:8
    s_waitcnt vmcnt(30)
    ds_read_b64_tr_b16 a[130:131], v3 offset:1024
    ds_read_b64_tr_b16 a[134:135], v3 offset:1032
    s_waitcnt vmcnt(29)
    ds_read_b64_tr_b16 a[136:137], v3 offset:2048
    ds_read_b64_tr_b16 a[140:141], v3 offset:2056
    s_waitcnt vmcnt(28)
    ds_read_b64_tr_b16 a[138:139], v3 offset:3072
    ds_read_b64_tr_b16 a[142:143], v3 offset:3080
    s_waitcnt vmcnt(27)
    ds_read_b64_tr_b16 a[144:145], v3 offset:4096
    ds_read_b64_tr_b16 a[148:149], v3 offset:4104
    s_waitcnt vmcnt(26)
    ds_read_b64_tr_b16 a[146:147], v3 offset:5120
    ds_read_b64_tr_b16 a[150:151], v3 offset:5128
    s_waitcnt vmcnt(25)
    ds_read_b64_tr_b16 a[152:153], v3 offset:6144
    ds_read_b64_tr_b16 a[156:157], v3 offset:6152
    s_waitcnt vmcnt(24)
    ds_read_b64_tr_b16 a[154:155], v3 offset:7168
    ds_read_b64_tr_b16 a[158:159], v3 offset:7176
    s_waitcnt vmcnt(23)
    ds_read_b64_tr_b16 a[160:161], v3 offset:8192
    ds_read_b64_tr_b16 a[164:165], v3 offset:8200
    s_waitcnt vmcnt(22)
    ds_read_b64_tr_b16 a[162:163], v3 offset:9216
    ds_read_b64_tr_b16 a[166:167], v3 offset:9224
    s_waitcnt vmcnt(21)
    ds_read_b64_tr_b16 a[168:169], v3 offset:10240
    ds_read_b64_tr_b16 a[172:173], v3 offset:10248
    s_waitcnt vmcnt(20)
    ds_read_b64_tr_b16 a[170:171], v3 offset:11264
    ds_read_b64_tr_b16 a[174:175], v3 offset:11272
    s_waitcnt vmcnt(19)
    ds_read_b64_tr_b16 a[176:177], v3 offset:12288
    ds_read_b64_tr_b16 a[180:181], v3 offset:12296
    s_waitcnt vmcnt(18)
    ds_read_b64_tr_b16 a[178:179], v3 offset:13312
    ds_read_b64_tr_b16 a[182:183], v3 offset:13320
    s_waitcnt vmcnt(17)
    ds_read_b64_tr_b16 a[184:185], v3 offset:14336
    ds_read_b64_tr_b16 a[188:189], v3 offset:14344
    s_waitcnt vmcnt(16)
    ds_read_b64_tr_b16 a[186:187], v3 offset:15360
    ds_read_b64_tr_b16 a[190:191], v3 offset:15368
    s_waitcnt vmcnt(15)
    ds_read_b64_tr_b16 a[192:193], v3 offset:16384
    ds_read_b64_tr_b16 a[196:197], v3 offset:16392
    s_waitcnt vmcnt(14)
    ds_read_b64_tr_b16 a[194:195], v3 offset:17408
    ds_read_b64_tr_b16 a[198:199], v3 offset:17416
    s_waitcnt vmcnt(13)
    ds_read_b64_tr_b16 a[200:201], v3 offset:18432
    ds_read_b64_tr_b16 a[204:205], v3 offset:18440
    s_waitcnt vmcnt(12)
    ds_read_b64_tr_b16 a[202:203], v3 offset:19456
    ds_read_b64_tr_b16 a[206:207], v3 offset:19464
    s_waitcnt vmcnt(11)
    ds_read_b64_tr_b16 a[208:209], v3 offset:20480
    ds_read_b64_tr_b16 a[212:213], v3 offset:20488
    s_waitcnt vmcnt(10)
    ds_read_b64_tr_b16 a[210:211], v3 offset:21504
    ds_read_b64_tr_b16 a[214:215], v3 offset:21512
    s_waitcnt vmcnt(9)
    ds_read_b64_tr_b16 a[216:217], v3 offset:22528
    ds_read_b64_tr_b16 a[220:221], v3 offset:22536
    s_waitcnt vmcnt(8)
    ds_read_b64_tr_b16 a[218:219], v3 offset:23552
    ds_read_b64_tr_b16 a[222:223], v3 offset:23560
    s_waitcnt vmcnt(7)
    ds_read_b64_tr_b16 a[224:225], v3 offset:24576
    ds_read_b64_tr_b16 a[228:229], v3 offset:24584
    s_waitcnt vmcnt(6)
    ds_read_b64_tr_b16 a[226:227], v3 offset:25600
    ds_read_b64_tr_b16 a[230:231], v3 offset:25608
    s_waitcnt vmcnt(5)
    ds_read_b64_tr_b16 a[232:233], v3 offset:26624
    ds_read_b64_tr_b16 a[236:237], v3 offset:26632
    s_waitcnt vmcnt(4)
    ds_read_b64_tr_b16 a[234:235], v3 offset:27648
    ds_read_b64_tr_b16 a[238:239], v3 offset:27656
    s_waitcnt vmcnt(3)
    ds_read_b64_tr_b16 a[240:241], v3 offset:28672
    ds_read_b64_tr_b16 a[244:245], v3 offset:28680
    s_waitcnt vmcnt(2)
    ds_read_b64_tr_b16 a[242:243], v3 offset:29696
    ds_read_b64_tr_b16 a[246:247], v3 offset:29704
    s_waitcnt vmcnt(1)
    ds_read_b64_tr_b16 a[248:249], v3 offset:30720
    ds_read_b64_tr_b16 a[252:253], v3 offset:30728
    s_waitcnt vmcnt(0)
    ds_read_b64_tr_b16 a[250:251], v3 offset:31744
    ds_read_b64_tr_b16 a[254:255], v3 offset:31752
    s_waitcnt lgkmcnt(0)
    s_barrier
    v_mov_b32 v5, 0
    s_mov_b32 s27, 0
L_recuwm2_223:
    buffer_load_dword v6, v5, s[20:23], 0 offen offset:136 sc1
    s_waitcnt vmcnt(0)
    v_cmp_gt_u32 vcc, 40, v6
    s_cbranch_vccz L_recuwm2ok_224
    s_add_u32 s27, s27, 1
    s_cmp_lt_u32 s27, 400000
    s_cbranch_scc0 L_exit_recurrent_scan__memory_aug_recurrent_mem_tr__moe_arch_mod__prompt_kernel
    s_sleep 2
    s_branch L_recuwm2_223
L_recuwm2ok_224:
    v_lshlrev_b32 v1, 4, v0
    v_bfe_u32 v2, v0, 1, 3
    v_lshlrev_b32 v2, 7, v2
    v_and_b32 v3, 1, v0
    v_lshl_add_u32 v2, v3, 3, v2
    s_lshl_b32 s35, s24, 10
    s_lshl_b32 s26, s33, 2
    s_add_u32 s35, s35, s26
    s_add_u32 s35, s35, 5414912
    s_lshl_b32 s36, s34, 18
    s_lshl_b32 s26, s33, 17
    s_add_u32 s36, s36, s26
    s_lshl_b32 s26, s24, 15
    s_add_u32 s36, s36, s26
    s_add_u32 s36, s36, 67108864
    v_and_b32 v3, 15, v0
    v_mul_u32_u24 v3, 1280, v3
    v_lshrrev_b32 v4, 4, v0
    v_lshl_add_u32 v3, v4, 4, v3
    s_lshl_b32 s37, s34, 1
    s_add_u32 s37, s37, s33
    s_mul_i32 s37, s37, 20480
    s_lshl_b32 s26, s32, 6
    s_add_u32 s37, s37, s26
    s_mov_b32 s38, 0
    s_lshl_b32 s39, s24, 11
L_recuwl_226:
    s_mov_b32 s27, 0
L_recuwo_227:
    buffer_load_dword v6, v2, s[4:7], s35 offen sc1
    s_waitcnt vmcnt(0)
    v_cmp_ge_u32 vcc, s34, v6
    s_cbranch_vccz L_recuwook_228
    s_add_u32 s27, s27, 1
    s_cmp_lt_u32 s27, 400000
    s_cbranch_scc0 L_exit_recurrent_scan__memory_aug_recurrent_mem_tr__moe_arch_mod__prompt_kernel
    s_sleep 2
    s_branch L_recuwo_227
L_recuwook_228:
    s_add_u32 s27, s37, 2621440
    buffer_load_dwordx4 v[16:19], v3, s[12:15], s37 offen
    buffer_load_dwordx4 v[20:23], v3, s[4:7], s27 offen
    s_mov_b32 s26, s36
    buffer_load_dwordx4 v[64:67], v1, s[4:7], s26 offen offset:0
    buffer_load_dwordx4 v[68:71], v1, s[4:7], s26 offen offset:1024
    buffer_load_dwordx4 v[72:75], v1, s[4:7], s26 offen offset:2048
    buffer_load_dwordx4 v[76:79], v1, s[4:7], s26 offen offset:3072
    s_add_u32 s26, s26, 4096
    buffer_load_dwordx4 v[80:83], v1, s[4:7], s26 offen offset:0
    buffer_load_dwordx4 v[84:87], v1, s[4:7], s26 offen offset:1024
    buffer_load_dwordx4 v[88:91], v1, s[4:7], s26 offen offset:2048
    buffer_load_dwordx4 v[92:95], v1, s[4:7], s26 offen offset:3072
    s_add_u32 s26, s26, 4096
    buffer_load_dwordx4 v[96:99], v1, s[4:7], s26 offen offset:0
    buffer_load_dwordx4 v[100:103], v1, s[4:7], s26 offen offset:1024
    buffer_load_dwordx4 v[104:107], v1, s[4:7], s26 offen offset:2048
    buffer_load_dwordx4 v[108:111], v1, s[4:7], s26 offen offset:3072
    s_add_u32 s26, s26, 4096
    buffer_load_dwordx4 v[112:115], v1, s[4:7], s26 offen offset:0
    buffer_load_dwordx4 v[116:119], v1, s[4:7], s26 offen offset:1024
    buffer_load_dwordx4 v[120:123], v1, s[4:7], s26 offen offset:2048
    buffer_load_dwordx4 v[124:127], v1, s[4:7], s26 offen offset:3072
    s_add_u32 s26, s26, 4096
    buffer_load_dwordx4 v[128:131], v1, s[4:7], s26 offen offset:0
    buffer_load_dwordx4 v[132:135], v1, s[4:7], s26 offen offset:1024
    buffer_load_dwordx4 v[136:139], v1, s[4:7], s26 offen offset:2048
    buffer_load_dwordx4 v[140:143], v1, s[4:7], s26 offen offset:3072
    s_add_u32 s26, s26, 4096
    buffer_load_dwordx4 v[144:147], v1, s[4:7], s26 offen offset:0
    buffer_load_dwordx4 v[148:151], v1, s[4:7], s26 offen offset:1024
    buffer_load_dwordx4 v[152:155], v1, s[4:7], s26 offen offset:2048
    buffer_load_dwordx4 v[156:159], v1, s[4:7], s26 offen offset:3072
    s_add_u32 s26, s26, 4096
    buffer_load_dwordx4 v[160:163], v1, s[4:7], s26 offen offset:0
    buffer_load_dwordx4 v[164:167], v1, s[4:7], s26 offen offset:1024
    buffer_load_dwordx4 v[168:171], v1, s[4:7], s26 offen offset:2048
    buffer_load_dwordx4 v[172:175], v1, s[4:7], s26 offen offset:3072
    s_add_u32 s26, s26, 4096
    buffer_load_dwordx4 v[176:179], v1, s[4:7], s26 offen offset:0
    buffer_load_dwordx4 v[180:183], v1, s[4:7], s26 offen offset:1024
    buffer_load_dwordx4 v[184:187], v1, s[4:7], s26 offen offset:2048
    buffer_load_dwordx4 v[188:191], v1, s[4:7], s26 offen offset:3072
    s_add_u32 s26, s26, 4096
    s_waitcnt vmcnt(31)
    v_mfma_f32_16x16x32_bf16 v[8:11], a[0:3], v[64:67], 0
    v_mfma_f32_16x16x32_bf16 v[12:15], a[4:7], v[64:67], 0
    s_waitcnt vmcnt(30)
    v_mfma_f32_16x16x32_bf16 v[8:11], a[8:11], v[68:71], v[8:11]
    v_mfma_f32_16x16x32_bf16 v[12:15], a[12:15], v[68:71], v[12:15]
    s_waitcnt vmcnt(29)
    v_mfma_f32_16x16x32_bf16 v[8:11], a[16:19], v[72:75], v[8:11]
    v_mfma_f32_16x16x32_bf16 v[12:15], a[20:23], v[72:75], v[12:15]
    s_waitcnt vmcnt(28)
    v_mfma_f32_16x16x32_bf16 v[8:11], a[24:27], v[76:79], v[8:11]
    v_mfma_f32_16x16x32_bf16 v[12:15], a[28:31], v[76:79], v[12:15]
    s_waitcnt vmcnt(27)
    v_mfma_f32_16x16x32_bf16 v[8:11], a[32:35], v[80:83], v[8:11]
    v_mfma_f32_16x16x32_bf16 v[12:15], a[36:39], v[80:83], v[12:15]
    s_waitcnt vmcnt(26)
    v_mfma_f32_16x16x32_bf16 v[8:11], a[40:43], v[84:87], v[8:11]
    v_mfma_f32_16x16x32_bf16 v[12:15], a[44:47], v[84:87], v[12:15]
    s_waitcnt vmcnt(25)
    v_mfma_f32_16x16x32_bf16 v[8:11], a[48:51], v[88:91], v[8:11]
    v_mfma_f32_16x16x32_bf16 v[12:15], a[52:55], v[88:91], v[12:15]
    s_waitcnt vmcnt(24)
    v_mfma_f32_16x16x32_bf16 v[8:11], a[56:59], v[92:95], v[8:11]
    v_mfma_f32_16x16x32_bf16 v[12:15], a[60:63], v[92:95], v[12:15]
    s_waitcnt vmcnt(23)
    v_mfma_f32_16x16x32_bf16 v[8:11], a[64:67], v[96:99], v[8:11]
    v_mfma_f32_16x16x32_bf16 v[12:15], a[68:71], v[96:99], v[12:15]
    s_waitcnt vmcnt(22)
    v_mfma_f32_16x16x32_bf16 v[8:11], a[72:75], v[100:103], v[8:11]
    v_mfma_f32_16x16x32_bf16 v[12:15], a[76:79], v[100:103], v[12:15]
    s_waitcnt vmcnt(21)
    v_mfma_f32_16x16x32_bf16 v[8:11], a[80:83], v[104:107], v[8:11]
    v_mfma_f32_16x16x32_bf16 v[12:15], a[84:87], v[104:107], v[12:15]
    s_waitcnt vmcnt(20)
    v_mfma_f32_16x16x32_bf16 v[8:11], a[88:91], v[108:111], v[8:11]
    v_mfma_f32_16x16x32_bf16 v[12:15], a[92:95], v[108:111], v[12:15]
    s_waitcnt vmcnt(19)
    v_mfma_f32_16x16x32_bf16 v[8:11], a[96:99], v[112:115], v[8:11]
    v_mfma_f32_16x16x32_bf16 v[12:15], a[100:103], v[112:115], v[12:15]
    s_waitcnt vmcnt(18)
    v_mfma_f32_16x16x32_bf16 v[8:11], a[104:107], v[116:119], v[8:11]
    v_mfma_f32_16x16x32_bf16 v[12:15], a[108:111], v[116:119], v[12:15]
    s_waitcnt vmcnt(17)
    v_mfma_f32_16x16x32_bf16 v[8:11], a[112:115], v[120:123], v[8:11]
    v_mfma_f32_16x16x32_bf16 v[12:15], a[116:119], v[120:123], v[12:15]
    s_waitcnt vmcnt(16)
    v_mfma_f32_16x16x32_bf16 v[8:11], a[120:123], v[124:127], v[8:11]
    v_mfma_f32_16x16x32_bf16 v[12:15], a[124:127], v[124:127], v[12:15]
    s_waitcnt vmcnt(15)
    v_mfma_f32_16x16x32_bf16 v[8:11], a[128:131], v[128:131], v[8:11]
    v_mfma_f32_16x16x32_bf16 v[12:15], a[132:135], v[128:131], v[12:15]
    s_waitcnt vmcnt(14)
    v_mfma_f32_16x16x32_bf16 v[8:11], a[136:139], v[132:135], v[8:11]
    v_mfma_f32_16x16x32_bf16 v[12:15], a[140:143], v[132:135], v[12:15]
    s_waitcnt vmcnt(13)
    v_mfma_f32_16x16x32_bf16 v[8:11], a[144:147], v[136:139], v[8:11]
    v_mfma_f32_16x16x32_bf16 v[12:15], a[148:151], v[136:139], v[12:15]
    s_waitcnt vmcnt(12)
    v_mfma_f32_16x16x32_bf16 v[8:11], a[152:155], v[140:143], v[8:11]
    v_mfma_f32_16x16x32_bf16 v[12:15], a[156:159], v[140:143], v[12:15]
    s_waitcnt vmcnt(11)
    v_mfma_f32_16x16x32_bf16 v[8:11], a[160:163], v[144:147], v[8:11]
    v_mfma_f32_16x16x32_bf16 v[12:15], a[164:167], v[144:147], v[12:15]
    s_waitcnt vmcnt(10)
    v_mfma_f32_16x16x32_bf16 v[8:11], a[168:171], v[148:151], v[8:11]
    v_mfma_f32_16x16x32_bf16 v[12:15], a[172:175], v[148:151], v[12:15]
    s_waitcnt vmcnt(9)
    v_mfma_f32_16x16x32_bf16 v[8:11], a[176:179], v[152:155], v[8:11]
    v_mfma_f32_16x16x32_bf16 v[12:15], a[180:183], v[152:155], v[12:15]
    s_waitcnt vmcnt(8)
    v_mfma_f32_16x16x32_bf16 v[8:11], a[184:187], v[156:159], v[8:11]
    v_mfma_f32_16x16x32_bf16 v[12:15], a[188:191], v[156:159], v[12:15]
    s_waitcnt vmcnt(7)
    v_mfma_f32_16x16x32_bf16 v[8:11], a[192:195], v[160:163], v[8:11]
    v_mfma_f32_16x16x32_bf16 v[12:15], a[196:199], v[160:163], v[12:15]
    s_waitcnt vmcnt(6)
    v_mfma_f32_16x16x32_bf16 v[8:11], a[200:203], v[164:167], v[8:11]
    v_mfma_f32_16x16x32_bf16 v[12:15], a[204:207], v[164:167], v[12:15]
    s_waitcnt vmcnt(5)
    v_mfma_f32_16x16x32_bf16 v[8:11], a[208:211], v[168:171], v[8:11]
    v_mfma_f32_16x16x32_bf16 v[12:15], a[212:215], v[168:171], v[12:15]
    s_waitcnt vmcnt(4)
    v_mfma_f32_16x16x32_bf16 v[8:11], a[216:219], v[172:175], v[8:11]
    v_mfma_f32_16x16x32_bf16 v[12:15], a[220:223], v[172:175], v[12:15]
    s_waitcnt vmcnt(3)
    v_mfma_f32_16x16x32_bf16 v[8:11], a[224:227], v[176:179], v[8:11]
    v_mfma_f32_16x16x32_bf16 v[12:15], a[228:231], v[176:179], v[12:15]
    s_waitcnt vmcnt(2)
    v_mfma_f32_16x16x32_bf16 v[8:11], a[232:235], v[180:183], v[8:11]
    v_mfma_f32_16x16x32_bf16 v[12:15], a[236:239], v[180:183], v[12:15]
    s_waitcnt vmcnt(1)
    v_mfma_f32_16x16x32_bf16 v[8:11], a[240:243], v[184:187], v[8:11]
    v_mfma_f32_16x16x32_bf16 v[12:15], a[244:247], v[184:187], v[12:15]
    s_waitcnt vmcnt(0)
    v_mfma_f32_16x16x32_bf16 v[8:11], a[248:251], v[188:191], v[8:11]
    v_mfma_f32_16x16x32_bf16 v[12:15], a[252:255], v[188:191], v[12:15]
    s_add_u32 s26, s38, s39
    v_add_u32 v4, s26, v1
    v_add_u32 v5, s38, v1
    s_nop 0
    ds_write_b128 v4, v[8:11]
    s_nop 2
    ds_write_b128 v4, v[12:15] offset:1024
    s_waitcnt lgkmcnt(0)
    s_barrier
    s_cmp_lg_u32 s24, 0
    s_cbranch_scc1 L_recunx_230
    ds_read_b128 v[24:27], v5 offset:2048
    ds_read_b128 v[28:31], v5 offset:3072
    ds_read_b128 v[32:35], v5 offset:4096
    ds_read_b128 v[36:39], v5 offset:5120
    ds_read_b128 v[40:43], v5 offset:6144
    ds_read_b128 v[44:47], v5 offset:7168
    s_waitcnt lgkmcnt(0)
    v_add_f32 v8, v8, v24
    v_add_f32 v9, v9, v25
    v_add_f32 v10, v10, v26
    v_add_f32 v11, v11, v27
    v_add_f32 v12, v12, v28
    v_add_f32 v13, v13, v29
    v_add_f32 v14, v14, v30
    v_add_f32 v15, v15, v31
    v_add_f32 v8, v8, v32
    v_add_f32 v9, v9, v33
    v_add_f32 v10, v10, v34
    v_add_f32 v11, v11, v35
    v_add_f32 v12, v12, v36
    v_add_f32 v13, v13, v37
    v_add_f32 v14, v14, v38
    v_add_f32 v15, v15, v39
    v_add_f32 v8, v8, v40
    v_add_f32 v9, v9, v41
    v_add_f32 v10, v10, v42
    v_add_f32 v11, v11, v43
    v_add_f32 v12, v12, v44
    v_add_f32 v13, v13, v45
    v_add_f32 v14, v14, v46
    v_add_f32 v15, v15, v47
    v_cvt_pk_bf16_f32 v24, v8, v9
    v_cvt_pk_bf16_f32 v25, v10, v11
    v_cvt_pk_bf16_f32 v26, v12, v13
    v_cvt_pk_bf16_f32 v27, v14, v15
    v_lshlrev_b32 v36, 16, v24
    v_and_b32 v37, 0xffff0000, v24
    v_lshlrev_b32 v44, 16, v20
    v_and_b32 v45, 0xffff0000, v20
    v_lshlrev_b32 v38, 16, v25
    v_and_b32 v39, 0xffff0000, v25
    v_lshlrev_b32 v46, 16, v21
    v_and_b32 v47, 0xffff0000, v21
    v_lshlrev_b32 v40, 16, v26
    v_and_b32 v41, 0xffff0000, v26
    v_lshlrev_b32 v48, 16, v22
    v_and_b32 v49, 0xffff0000, v22
    v_lshlrev_b32 v42, 16, v27
    v_and_b32 v43, 0xffff0000, v27
    v_lshlrev_b32 v50, 16, v23
    v_and_b32 v51, 0xffff0000, v23
    v_pk_mul_f32 v[36:37], v[36:37], v[44:45]
    v_pk_mul_f32 v[38:39], v[38:39], v[46:47]
    v_pk_mul_f32 v[40:41], v[40:41], v[48:49]
    v_pk_mul_f32 v[42:43], v[42:43], v[50:51]
    v_cvt_pk_bf16_f32 v24, v36, v37
    v_cvt_pk_bf16_f32 v25, v38, v39
    v_cvt_pk_bf16_f32 v26, v40, v41
    v_cvt_pk_bf16_f32 v27, v42, v43
    v_lshlrev_b32 v36, 16, v24
    v_and_b32 v37, 0xffff0000, v24
    v_lshlrev_b32 v44, 16, v16
    v_and_b32 v45, 0xffff0000, v16
    v_lshlrev_b32 v38, 16, v25
    v_and_b32 v39, 0xffff0000, v25
    v_lshlrev_b32 v46, 16, v17
    v_and_b32 v47, 0xffff0000, v17
    v_lshlrev_b32 v40, 16, v26
    v_and_b32 v41, 0xffff0000, v26
    v_lshlrev_b32 v48, 16, v18
    v_and_b32 v49, 0xffff0000, v18
    v_lshlrev_b32 v42, 16, v27
    v_and_b32 v43, 0xffff0000, v27
    v_lshlrev_b32 v50, 16, v19
    v_and_b32 v51, 0xffff0000, v19
    v_pk_add_f32 v[36:37], v[36:37], v[44:45]
    v_pk_add_f32 v[38:39], v[38:39], v[46:47]
    v_pk_add_f32 v[40:41], v[40:41], v[48:49]
    v_pk_add_f32 v[42:43], v[42:43], v[50:51]
    v_cvt_pk_bf16_f32 v24, v36, v37
    v_cvt_pk_bf16_f32 v25, v38, v39
    v_cvt_pk_bf16_f32 v26, v40, v41
    v_cvt_pk_bf16_f32 v27, v42, v43
    buffer_store_dwordx4 v[24:27], v3, s[16:19], s37 offen
L_recunx_230:
    s_xor_b32 s38, s38, 8192
    s_add_u32 s36, s36, 1048576
    s_add_u32 s37, s37, 163840
    s_add_u32 s34, s34, 4
    s_cmp_lt_u32 s34, 64
    s_cbranch_scc1 L_recuwl_226
    s_waitcnt vmcnt(0)
    s_branch L_exit_recurrent_scan__memory_aug_recurrent_mem_tr__moe_arch_mod__prompt_kernel
L_recuat_212:
    s_sub_u32 s42, s25, 160
    v_lshlrev_b32 v1, 4, v0
    v_lshlrev_b32 v2, 3, v0
    v_bfe_u32 v3, v0, 2, 1
    v_lshlrev_b32 v3, 7, v3
    v_and_b32 v4, 3, v0
    v_lshl_add_u32 v3, v4, 2, v3
    s_and_b32 s26, s24, 1
    s_lshr_b32 s27, s24, 1
    s_lshl_b32 s34, s42, 13
    s_lshl_b32 s40, s26, 12
    s_add_u32 s40, s40, 16777216
    s_lshl_b32 s41, s27, 12
    s_add_u32 s41, s41, 50331648
    s_lshl_b32 s35, s42, 12
    s_add_u32 s35, s35, 83886080
    s_lshl_b32 s36, s42, 11
    s_lshl_b32 s28, s27, 10
    s_add_u32 s36, s36, s28
    s_add_u32 s36, s36, 92274688
    s_lshl_b32 s37, s26, 17
    s_lshl_b32 s28, s42, 12
    s_add_u32 s37, s37, s28
    s_lshl_b32 s28, s27, 11
    s_add_u32 s37, s37, s28
    s_add_u32 s37, s37, 67108864
    s_lshl_b32 s38, s42, 7
    s_lshl_b32 s28, s24, 2
    s_add_u32 s38, s38, s28
    s_add_u32 s38, s38, 5414912
    s_lshl_b32 s39, s42, 8
    s_add_u32 s39, s39, 5406720
    s_mov_b32 s32, 0
    s_mov_b32 s33, 0
    s_lshl_b32 s26, s26, 4
    v_and_b32 v4, 15, v0
    v_add_u32 v4, s26, v4
    v_lshrrev_b32 v5, 4, v0
    v_lshlrev_b32 v5, 2, v5
    v_sub_u32 v4, v4, v5
    v_cmp_le_i32 s[60:61], 0, v4
    v_cmp_le_i32 s[62:63], 1, v4
    v_cmp_le_i32 s[64:65], 2, v4
    v_cmp_le_i32 s[66:67], 3, v4
    v_cmp_le_i32 s[68:69], 16, v4
    v_cmp_le_i32 s[70:71], 17, v4
    v_cmp_le_i32 s[72:73], 18, v4
    v_cmp_le_i32 s[74:75], 19, v4
    v_bfe_u32 v5, v0, 2, 1
    v_lshlrev_b32 v5, 7, v5
    v_bfe_u32 v6, v0, 3, 2
    v_min_u32 v6, 2, v6
    v_lshl_add_u32 v5, v6, 13, v5
    v_and_b32 v6, 3, v0
    v_lshl_add_u32 v5, v6, 2, v5
    s_lshl_b32 s26, s42, 8
    s_add_u32 s26, s26, 5382144
    s_mov_b32 s27, 0
L_recuwg_231:
    buffer_load_dword v6, v5, s[4:7], s26 offen sc1
    s_waitcnt vmcnt(0)
    v_cmp_gt_u32 vcc, 32, v6
    s_cbranch_vccz L_recuwgok_232
    s_add_u32 s27, s27, 1
    s_cmp_lt_u32 s27, 400000
    s_cbranch_scc0 L_exit_recurrent_scan__memory_aug_recurrent_mem_tr__moe_arch_mod__prompt_kernel
    s_sleep 2
    s_branch L_recuwg_231
L_recuwgok_232:
    v_mov_b32 v58, 0xf149f2ca
    v_mov_b32 v57, 0
    v_mov_b32 v36, 0
    s_add_u32 s26, s34, s40
    s_add_u32 s27, s34, 33554432
    s_add_u32 s28, s27, 4096
    s_add_u32 s29, s34, s41
    buffer_load_dwordx4 v[64:67], v1, s[4:7], s26 offen offset:0
    buffer_load_dwordx4 v[68:71], v1, s[4:7], s26 offen offset:1024
    buffer_load_dwordx4 v[72:75], v1, s[4:7], s26 offen offset:2048
    buffer_load_dwordx4 v[76:79], v1, s[4:7], s26 offen offset:3072
    buffer_load_dwordx4 v[80:83], v1, s[4:7], s27 offen offset:0
    buffer_load_dwordx4 v[84:87], v1, s[4:7], s27 offen offset:1024
    buffer_load_dwordx4 v[88:91], v1, s[4:7], s27 offen offset:2048
    buffer_load_dwordx4 v[92:95], v1, s[4:7], s27 offen offset:3072
    buffer_load_dwordx4 v[96:99], v1, s[4:7], s28 offen offset:0
    buffer_load_dwordx4 v[100:103], v1, s[4:7], s28 offen offset:1024
    buffer_load_dwordx4 v[104:107], v1, s[4:7], s28 offen offset:2048
    buffer_load_dwordx4 v[108:111], v1, s[4:7], s28 offen offset:3072
    buffer_load_dwordx4 v[112:115], v1, s[4:7], s29 offen offset:0
    buffer_load_dwordx4 v[116:119], v1, s[4:7], s29 offen offset:1024
    buffer_load_dwordx4 v[120:123], v1, s[4:7], s29 offen offset:2048
    buffer_load_dwordx4 v[124:127], v1, s[4:7], s29 offen offset:3072
    s_add_u32 s34, s34, 262144
    s_mov_b32 s44, 0x3db504f3
    s_mov_b32 s45, s44
    s_mov_b32 s46, 0x3fb8aa3b
    s_mov_b32 s47, s46
    s_waitcnt vmcnt(0)
L_recual_234:
    s_cmp_gt_u32 s33, s32
    s_cbranch_scc1 L_recusk_235
    s_mov_b32 s27, 0
L_recuwp_238:
    buffer_load_dword v6, v3, s[4:7], s39 offen sc1
    s_waitcnt vmcnt(0)
    v_cmp_ge_u32 vcc, s32, v6
    s_cbranch_vccz L_recuwpok_239
    s_add_u32 s27, s27, 1
    s_cmp_lt_u32 s27, 400000
    s_cbranch_scc0 L_exit_recurrent_scan__memory_aug_recurrent_mem_tr__moe_arch_mod__prompt_kernel
    s_sleep 2
    s_branch L_recuwp_238
L_recuwpok_239:
    v_min_u32_dpp v6, v6, v6 quad_perm:[1,0,3,2] row_mask:0xf bank_mask:0xf
    s_nop 1
    v_min_u32_dpp v6, v6, v6 quad_perm:[2,3,0,1] row_mask:0xf bank_mask:0xf
    s_nop 1
    v_min_u32_dpp v6, v6, v6 row_half_mirror row_mask:0xf bank_mask:0xf
    s_nop 0
    v_readfirstlane_b32 s33, v6
L_recusk_235:
    buffer_load_dwordx4 v[16:19], v1, s[4:7], s35 offen offset:0
    buffer_load_dwordx4 v[20:23], v1, s[4:7], s35 offen offset:1024
    buffer_load_dwordx4 v[24:27], v1, s[4:7], s35 offen offset:2048
    buffer_load_dwordx4 v[28:31], v1, s[4:7], s35 offen offset:3072
    buffer_load_dwordx2 v[32:33], v2, s[4:7], s36 offen offset:0
    buffer_load_dwordx2 v[34:35], v2, s[4:7], s36 offen offset:512
    s_add_u32 s35, s35, 131072
    s_add_u32 s36, s36, 65536
    s_add_u32 s26, s34, s40
    s_add_u32 s27, s34, 33554432
    s_add_u32 s28, s27, 4096
    s_add_u32 s29, s34, s41
    buffer_load_dwordx4 v[128:131], v1, s[4:7], s26 offen offset:0
    buffer_load_dwordx4 v[132:135], v1, s[4:7], s26 offen offset:1024
    buffer_load_dwordx4 v[136:139], v1, s[4:7], s26 offen offset:2048
    buffer_load_dwordx4 v[140:143], v1, s[4:7], s26 offen offset:3072
    buffer_load_dwordx4 v[144:147], v1, s[4:7], s27 offen offset:0
    buffer_load_dwordx4 v[148:151], v1, s[4:7], s27 offen offset:1024
    buffer_load_dwordx4 v[152:155], v1, s[4:7], s27 offen offset:2048
    buffer_load_dwordx4 v[156:159], v1, s[4:7], s27 offen offset:3072
    buffer_load_dwordx4 v[160:163], v1, s[4:7], s28 offen offset:0
    buffer_load_dwordx4 v[164:167], v1, s[4:7], s28 offen offset:1024
    buffer_load_dwordx4 v[168:171], v1, s[4:7], s28 offen offset:2048
    buffer_load_dwordx4 v[172:175], v1, s[4:7], s28 offen offset:3072
    buffer_load_dwordx4 v[176:179], v1, s[4:7], s29 offen offset:0
    buffer_load_dwordx4 v[180:183], v1, s[4:7], s29 offen offset:1024
    buffer_load_dwordx4 v[184:187], v1, s[4:7], s29 offen offset:2048
    buffer_load_dwordx4 v[188:191], v1, s[4:7], s29 offen offset:3072
    s_add_u32 s34, s34, 262144
    s_waitcnt vmcnt(25)
    v_mfma_f32_16x16x32_bf16 v[44:47], v[80:83], v[64:67], 0
    v_mfma_f32_16x16x32_bf16 v[48:51], v[96:99], v[64:67], 0
    v_mfma_f32_16x16x32_bf16 v[44:47], v[84:87], v[68:71], v[44:47]
    v_mfma_f32_16x16x32_bf16 v[48:51], v[100:103], v[68:71], v[48:51]
    v_mfma_f32_16x16x32_bf16 v[44:47], v[88:91], v[72:75], v[44:47]
    v_mfma_f32_16x16x32_bf16 v[48:51], v[104:107], v[72:75], v[48:51]
    v_mfma_f32_16x16x32_bf16 v[44:47], v[92:95], v[76:79], v[44:47]
    v_mfma_f32_16x16x32_bf16 v[48:51], v[108:111], v[76:79], v[48:51]
    s_nop 3
    v_cvt_pk_bf16_f32 v8, v44, v45
    v_cvt_pk_bf16_f32 v9, v46, v47
    s_nop 1
    v_cvt_pk_bf16_f32 v10, v48, v49
    v_cvt_pk_bf16_f32 v11, v50, v51
    v_lshlrev_b32 v44, 16, v8
    v_and_b32 v45, 0xffff0000, v8
    v_lshlrev_b32 v46, 16, v9
    v_and_b32 v47, 0xffff0000, v9
    v_lshlrev_b32 v48, 16, v10
    v_and_b32 v49, 0xffff0000, v10
    v_lshlrev_b32 v50, 16, v11
    v_and_b32 v51, 0xffff0000, v11
    v_pk_mul_f32 v[44:45], v[44:45], s[44:45]
    v_pk_mul_f32 v[46:47], v[46:47], s[44:45]
    v_pk_mul_f32 v[48:49], v[48:49], s[44:45]
    v_pk_mul_f32 v[50:51], v[50:51], s[44:45]
    v_cvt_pk_bf16_f32 v8, v44, v45
    v_cvt_pk_bf16_f32 v9, v46, v47
    v_cvt_pk_bf16_f32 v10, v48, v49
    v_cvt_pk_bf16_f32 v11, v50, v51
    v_lshlrev_b32 v44, 16, v8
    v_and_b32 v45, 0xffff0000, v8
    v_lshlrev_b32 v46, 16, v9
    v_and_b32 v47, 0xffff0000, v9
    v_lshlrev_b32 v48, 16, v10
    v_and_b32 v49, 0xffff0000, v10
    v_lshlrev_b32 v50, 16, v11
    v_and_b32 v51, 0xffff0000, v11
    v_cndmask_b32 v44, v58, v44, s[60:61]
    v_cndmask_b32 v45, v58, v45, s[62:63]
    v_cndmask_b32 v46, v58, v46, s[64:65]
    v_cndmask_b32 v47, v58, v47, s[66:67]
    v_cndmask_b32 v48, v58, v48, s[68:69]
    v_cndmask_b32 v49, v58, v49, s[70:71]
    v_cndmask_b32 v50, v58, v50, s[72:73]
    v_cndmask_b32 v51, v58, v51, s[74:75]
    v_max3_f32 v13, v44, v45, v46
    v_max3_f32 v14, v47, v48, v49
    v_max3_f32 v13, v13, v50, v51
    v_max_f32 v13, v13, v14
L_reculb63_237:
    s_waitcnt vmcnt(16)
    v_mfma_f32_16x16x32_bf16 v[40:43], v[16:19], v[64:67], 0
    v_mfma_f32_16x16x32_bf16 v[40:43], v[20:23], v[68:71], v[40:43]
    v_mfma_f32_16x16x32_bf16 v[40:43], v[24:27], v[72:75], v[40:43]
    v_mfma_f32_16x16x32_bf16 v[40:43], v[28:31], v[76:79], v[40:43]
    v_mov_b32 v6, s32
    v_mov_b32 v7, 0
    buffer_store_dword v6, v7, s[4:7], s38 offen sc1
    s_nop 4
    v_cvt_pk_bf16_f32 v8, v42, v43
    v_lshlrev_b32 v42, 16, v8
    v_and_b32 v43, 0xffff0000, v8
    v_pk_mul_f32 v[42:43], v[42:43], s[44:45]
    v_cvt_pk_bf16_f32 v8, v42, v43
    v_lshlrev_b32 v42, 16, v8
    v_and_b32 v43, 0xffff0000, v8
    v_max3_f32 v6, v13, v42, v43
    v_mov_b32 v59, v6
    s_nop 1
    v_permlane32_swap_b32 v59, v6
    v_max_f32 v6, v6, v59
    v_mov_b32 v59, v6
    s_nop 1
    v_permlane16_swap_b32 v59, v6
    v_max_f32 v6, v6, v59
    v_pk_add_f32 v[42:43], v[42:43], v[6:7] op_sel_hi:[1,0] neg_lo:[0,1] neg_hi:[0,1]
    v_pk_add_f32 v[44:45], v[44:45], v[6:7] op_sel_hi:[1,0] neg_lo:[0,1] neg_hi:[0,1]
    v_pk_add_f32 v[46:47], v[46:47], v[6:7] op_sel_hi:[1,0] neg_lo:[0,1] neg_hi:[0,1]
    v_pk_add_f32 v[48:49], v[48:49], v[6:7] op_sel_hi:[1,0] neg_lo:[0,1] neg_hi:[0,1]
    v_pk_add_f32 v[50:51], v[50:51], v[6:7] op_sel_hi:[1,0] neg_lo:[0,1] neg_hi:[0,1]
    v_pk_mul_f32 v[42:43], v[42:43], s[46:47]
    v_pk_mul_f32 v[44:45], v[44:45], s[46:47]
    v_pk_mul_f32 v[46:47], v[46:47], s[46:47]
    v_pk_mul_f32 v[48:49], v[48:49], s[46:47]
    v_pk_mul_f32 v[50:51], v[50:51], s[46:47]
    v_exp_f32 v42, v42
    v_exp_f32 v43, v43
    v_exp_f32 v44, v44
    v_exp_f32 v45, v45
    v_exp_f32 v46, v46
    v_exp_f32 v47, v47
    v_exp_f32 v48, v48
    v_exp_f32 v49, v49
    v_exp_f32 v50, v50
    v_exp_f32 v51, v51
    v_pk_add_f32 v[8:9], v[42:43], v[44:45]
    v_pk_add_f32 v[10:11], v[46:47], v[48:49]
    v_pk_add_f32 v[8:9], v[8:9], v[50:51]
    v_pk_add_f32 v[8:9], v[8:9], v[10:11]
    v_add_f32 v6, v8, v9
    v_mov_b32 v59, v6
    s_nop 1
    v_permlane32_swap_b32 v59, v6
    v_add_f32 v6, v6, v59
    v_mov_b32 v59, v6
    s_nop 1
    v_permlane16_swap_b32 v59, v6
    v_add_f32 v6, v6, v59
    v_rcp_f32 v6, v6
    s_nop 0
    v_pk_mul_f32 v[42:43], v[42:43], v[6:7] op_sel_hi:[1,0]
    v_pk_mul_f32 v[44:45], v[44:45], v[6:7] op_sel_hi:[1,0]
    v_pk_mul_f32 v[46:47], v[46:47], v[6:7] op_sel_hi:[1,0]
    v_pk_mul_f32 v[48:49], v[48:49], v[6:7] op_sel_hi:[1,0]
    v_pk_mul_f32 v[50:51], v[50:51], v[6:7] op_sel_hi:[1,0]
    v_cvt_pk_bf16_f32 v52, v44, v45
    v_cvt_pk_bf16_f32 v53, v46, v47
    v_cvt_pk_bf16_f32 v54, v48, v49
    v_cvt_pk_bf16_f32 v55, v50, v51
    v_cvt_pk_bf16_f32 v56, v42, v43
    v_cvt_pk_bf16_f32 v37, v42, v43
    v_mfma_f32_16x16x32_bf16 v[192:195], v[112:115], v[52:55], 0
    v_mfma_f32_16x16x32_bf16 v[196:199], v[116:119], v[52:55], 0
    v_mfma_f32_16x16x32_bf16 v[200:203], v[120:123], v[52:55], 0
    v_mfma_f32_16x16x32_bf16 v[204:207], v[124:127], v[52:55], 0
    v_mfma_f32_16x16x16_bf16 v[192:195], v[32:33], v[56:57], v[192:195]
    v_mfma_f32_16x16x16_bf16 v[196:199], v[32:33], v[36:37], v[196:199]
    v_mfma_f32_16x16x16_bf16 v[200:203], v[34:35], v[56:57], v[200:203]
    v_mfma_f32_16x16x16_bf16 v[204:207], v[34:35], v[36:37], v[204:207]
    v_cvt_pk_bf16_f32 v208, v192, v193
    v_cvt_pk_bf16_f32 v209, v194, v195
    v_cvt_pk_bf16_f32 v210, v196, v197
    v_cvt_pk_bf16_f32 v211, v198, v199
    v_cvt_pk_bf16_f32 v212, v200, v201
    v_cvt_pk_bf16_f32 v213, v202, v203
    s_nop 1
    v_cvt_pk_bf16_f32 v214, v204, v205
    v_cvt_pk_bf16_f32 v215, v206, v207
    buffer_store_dwordx4 v[208:211], v1, s[4:7], s37 offen sc1
    buffer_store_dwordx4 v[212:215], v1, s[4:7], s37 offen offset:1024 sc1
    s_add_u32 s37, s37, 262144
    s_add_u32 s32, s32, 1
    s_cmp_lt_u32 s32, 63
    s_cbranch_scc1 L_reculp63_242
    buffer_load_dwordx4 v[16:19], v1, s[4:7], s35 offen offset:0 sc1
    buffer_load_dwordx4 v[20:23], v1, s[4:7], s35 offen offset:1024 sc1
    buffer_load_dwordx4 v[24:27], v1, s[4:7], s35 offen offset:2048 sc1
    buffer_load_dwordx4 v[28:31], v1, s[4:7], s35 offen offset:3072 sc1
    buffer_load_dwordx2 v[32:33], v2, s[4:7], s36 offen offset:0 sc1
    buffer_load_dwordx2 v[34:35], v2, s[4:7], s36 offen offset:512 sc1
    s_cmp_eq_u32 s32, 63
    s_cbranch_scc1 L_recunq_244
    s_add_u32 s26, s34, s40
    s_add_u32 s27, s34, 33554432
    s_add_u32 s28, s27, 4096
    s_add_u32 s29, s34, s41
    buffer_load_dwordx4 v[64:67], v1, s[4:7], s26 offen offset:0
    buffer_load_dwordx4 v[68:71], v1, s[4:7], s26 offen offset:1024
    buffer_load_dwordx4 v[72:75], v1, s[4:7], s26 offen offset:2048
    buffer_load_dwordx4 v[76:79], v1, s[4:7], s26 offen offset:3072
    buffer_load_dwordx4 v[80:83], v1, s[4:7], s27 offen offset:0
    buffer_load_dwordx4 v[84:87], v1, s[4:7], s27 offen offset:1024
    buffer_load_dwordx4 v[88:91], v1, s[4:7], s27 offen offset:2048
    buffer_load_dwordx4 v[92:95], v1, s[4:7], s27 offen offset:3072
    buffer_load_dwordx4 v[96:99], v1, s[4:7], s28 offen offset:0
    buffer_load_dwordx4 v[100:103], v1, s[4:7], s28 offen offset:1024
    buffer_load_dwordx4 v[104:107], v1, s[4:7], s28 offen offset:2048
    buffer_load_dwordx4 v[108:111], v1, s[4:7], s28 offen offset:3072
    buffer_load_dwordx4 v[112:115], v1, s[4:7], s29 offen offset:0
    buffer_load_dwordx4 v[116:119], v1, s[4:7], s29 offen offset:1024
    buffer_load_dwordx4 v[120:123], v1, s[4:7], s29 offen offset:2048
    buffer_load_dwordx4 v[124:127], v1, s[4:7], s29 offen offset:3072
    s_add_u32 s34, s34, 262144
L_recunq_244:
    s_waitcnt vmcnt(9)
    v_mfma_f32_16x16x32_bf16 v[44:47], v[144:147], v[128:131], 0
    v_mfma_f32_16x16x32_bf16 v[48:51], v[160:163], v[128:131], 0
    v_mfma_f32_16x16x32_bf16 v[44:47], v[148:151], v[132:135], v[44:47]
    v_mfma_f32_16x16x32_bf16 v[48:51], v[164:167], v[132:135], v[48:51]
    v_mfma_f32_16x16x32_bf16 v[44:47], v[152:155], v[136:139], v[44:47]
    v_mfma_f32_16x16x32_bf16 v[48:51], v[168:171], v[136:139], v[48:51]
    v_mfma_f32_16x16x32_bf16 v[44:47], v[156:159], v[140:143], v[44:47]
    v_mfma_f32_16x16x32_bf16 v[48:51], v[172:175], v[140:143], v[48:51]
    s_nop 3
    v_cvt_pk_bf16_f32 v8, v44, v45
    v_cvt_pk_bf16_f32 v9, v46, v47
    s_nop 1
    v_cvt_pk_bf16_f32 v10, v48, v49
    v_cvt_pk_bf16_f32 v11, v50, v51
    v_lshlrev_b32 v44, 16, v8
    v_and_b32 v45, 0xffff0000, v8
    v_lshlrev_b32 v46, 16, v9
    v_and_b32 v47, 0xffff0000, v9
    v_lshlrev_b32 v48, 16, v10
    v_and_b32 v49, 0xffff0000, v10
    v_lshlrev_b32 v50, 16, v11
    v_and_b32 v51, 0xffff0000, v11
    v_pk_mul_f32 v[44:45], v[44:45], s[44:45]
    v_pk_mul_f32 v[46:47], v[46:47], s[44:45]
    v_pk_mul_f32 v[48:49], v[48:49], s[44:45]
    v_pk_mul_f32 v[50:51], v[50:51], s[44:45]
    v_cvt_pk_bf16_f32 v8, v44, v45
    v_cvt_pk_bf16_f32 v9, v46, v47
    v_cvt_pk_bf16_f32 v10, v48, v49
    v_cvt_pk_bf16_f32 v11, v50, v51
    v_lshlrev_b32 v44, 16, v8
    v_and_b32 v45, 0xffff0000, v8
    v_lshlrev_b32 v46, 16, v9
    v_and_b32 v47, 0xffff0000, v9
    v_lshlrev_b32 v48, 16, v10
    v_and_b32 v49, 0xffff0000, v10
    v_lshlrev_b32 v50, 16, v11
    v_and_b32 v51, 0xffff0000, v11
    v_cndmask_b32 v44, v58, v44, s[60:61]
    v_cndmask_b32 v45, v58, v45, s[62:63]
    v_cndmask_b32 v46, v58, v46, s[64:65]
    v_cndmask_b32 v47, v58, v47, s[66:67]
    v_cndmask_b32 v48, v58, v48, s[68:69]
    v_cndmask_b32 v49, v58, v49, s[70:71]
    v_cndmask_b32 v50, v58, v50, s[72:73]
    v_cndmask_b32 v51, v58, v51, s[74:75]
    v_max3_f32 v13, v44, v45, v46
    v_max3_f32 v14, v47, v48, v49
    v_max3_f32 v13, v13, v50, v51
    v_max_f32 v13, v13, v14
    s_mov_b32 s27, 0
    s_branch L_recuwlp_247
L_recuwl_245:
    buffer_load_dwordx4 v[16:19], v1, s[4:7], s35 offen offset:0 sc1
    buffer_load_dwordx4 v[20:23], v1, s[4:7], s35 offen offset:1024 sc1
    buffer_load_dwordx4 v[24:27], v1, s[4:7], s35 offen offset:2048 sc1
    buffer_load_dwordx4 v[28:31], v1, s[4:7], s35 offen offset:3072 sc1
    buffer_load_dwordx2 v[32:33], v2, s[4:7], s36 offen offset:0 sc1
    buffer_load_dwordx2 v[34:35], v2, s[4:7], s36 offen offset:512 sc1
L_recuwlp_247:
    s_waitcnt vmcnt(0)
    v_max3_u32 v6, v16, v20, v24
    v_max3_u32 v6, v6, v28, v32
    v_max_u32 v6, v6, v34
    v_cmp_eq_u32 vcc, -1, v6
    s_cbranch_vccz L_recuwlok_246
    s_add_u32 s27, s27, 1
    s_cmp_lt_u32 s27, 400000
    s_cbranch_scc0 L_exit_recurrent_scan__memory_aug_recurrent_mem_tr__moe_arch_mod__prompt_kernel
    s_sleep 2
    s_branch L_recuwl_245
L_recuwlok_246:
    s_add_u32 s35, s35, 131072
    s_add_u32 s36, s36, 65536
    s_branch L_reculb63_243
L_reculp63_242:
    s_cmp_gt_u32 s33, s32
    s_cbranch_scc1 L_recusk_241
    s_mov_b32 s27, 0
L_recuwp_248:
    buffer_load_dword v6, v3, s[4:7], s39 offen sc1
    s_waitcnt vmcnt(0)
    v_cmp_ge_u32 vcc, s32, v6
    s_cbranch_vccz L_recuwpok_249
    s_add_u32 s27, s27, 1
    s_cmp_lt_u32 s27, 400000
    s_cbranch_scc0 L_exit_recurrent_scan__memory_aug_recurrent_mem_tr__moe_arch_mod__prompt_kernel
    s_sleep 2
    s_branch L_recuwp_248
L_recuwpok_249:
    v_min_u32_dpp v6, v6, v6 quad_perm:[1,0,3,2] row_mask:0xf bank_mask:0xf
    s_nop 1
    v_min_u32_dpp v6, v6, v6 quad_perm:[2,3,0,1] row_mask:0xf bank_mask:0xf
    s_nop 1
    v_min_u32_dpp v6, v6, v6 row_half_mirror row_mask:0xf bank_mask:0xf
    s_nop 0
    v_readfirstlane_b32 s33, v6
L_recusk_241:
    buffer_load_dwordx4 v[16:19], v1, s[4:7], s35 offen offset:0
    buffer_load_dwordx4 v[20:23], v1, s[4:7], s35 offen offset:1024
    buffer_load_dwordx4 v[24:27], v1, s[4:7], s35 offen offset:2048
    buffer_load_dwordx4 v[28:31], v1, s[4:7], s35 offen offset:3072
    buffer_load_dwordx2 v[32:33], v2, s[4:7], s36 offen offset:0
    buffer_load_dwordx2 v[34:35], v2, s[4:7], s36 offen offset:512
    s_add_u32 s35, s35, 131072
    s_add_u32 s36, s36, 65536
    s_add_u32 s26, s34, s40
    s_add_u32 s27, s34, 33554432
    s_add_u32 s28, s27, 4096
    s_add_u32 s29, s34, s41
    buffer_load_dwordx4 v[64:67], v1, s[4:7], s26 offen offset:0
    buffer_load_dwordx4 v[68:71], v1, s[4:7], s26 offen offset:1024
    buffer_load_dwordx4 v[72:75], v1, s[4:7], s26 offen offset:2048
    buffer_load_dwordx4 v[76:79], v1, s[4:7], s26 offen offset:3072
    buffer_load_dwordx4 v[80:83], v1, s[4:7], s27 offen offset:0
    buffer_load_dwordx4 v[84:87], v1, s[4:7], s27 offen offset:1024
    buffer_load_dwordx4 v[88:91], v1, s[4:7], s27 offen offset:2048
    buffer_load_dwordx4 v[92:95], v1, s[4:7], s27 offen offset:3072
    buffer_load_dwordx4 v[96:99], v1, s[4:7], s28 offen offset:0
    buffer_load_dwordx4 v[100:103], v1, s[4:7], s28 offen offset:1024
    buffer_load_dwordx4 v[104:107], v1, s[4:7], s28 offen offset:2048
    buffer_load_dwordx4 v[108:111], v1, s[4:7], s28 offen offset:3072
    buffer_load_dwordx4 v[112:115], v1, s[4:7], s29 offen offset:0
    buffer_load_dwordx4 v[116:119], v1, s[4:7], s29 offen offset:1024
    buffer_load_dwordx4 v[120:123], v1, s[4:7], s29 offen offset:2048
    buffer_load_dwordx4 v[124:127], v1, s[4:7], s29 offen offset:3072
    s_add_u32 s34, s34, 262144
    s_waitcnt vmcnt(25)
    v_mfma_f32_16x16x32_bf16 v[44:47], v[144:147], v[128:131], 0
    v_mfma_f32_16x16x32_bf16 v[48:51], v[160:163], v[128:131], 0
    v_mfma_f32_16x16x32_bf16 v[44:47], v[148:151], v[132:135], v[44:47]
    v_mfma_f32_16x16x32_bf16 v[48:51], v[164:167], v[132:135], v[48:51]
    v_mfma_f32_16x16x32_bf16 v[44:47], v[152:155], v[136:139], v[44:47]
    v_mfma_f32_16x16x32_bf16 v[48:51], v[168:171], v[136:139], v[48:51]
    v_mfma_f32_16x16x32_bf16 v[44:47], v[156:159], v[140:143], v[44:47]
    v_mfma_f32_16x16x32_bf16 v[48:51], v[172:175], v[140:143], v[48:51]
    s_nop 3
    v_cvt_pk_bf16_f32 v8, v44, v45
    v_cvt_pk_bf16_f32 v9, v46, v47
    s_nop 1
    v_cvt_pk_bf16_f32 v10, v48, v49
    v_cvt_pk_bf16_f32 v11, v50, v51
    v_lshlrev_b32 v44, 16, v8
    v_and_b32 v45, 0xffff0000, v8
    v_lshlrev_b32 v46, 16, v9
    v_and_b32 v47, 0xffff0000, v9
    v_lshlrev_b32 v48, 16, v10
    v_and_b32 v49, 0xffff0000, v10
    v_lshlrev_b32 v50, 16, v11
    v_and_b32 v51, 0xffff0000, v11
    v_pk_mul_f32 v[44:45], v[44:45], s[44:45]
    v_pk_mul_f32 v[46:47], v[46:47], s[44:45]
    v_pk_mul_f32 v[48:49], v[48:49], s[44:45]
    v_pk_mul_f32 v[50:51], v[50:51], s[44:45]
    v_cvt_pk_bf16_f32 v8, v44, v45
    v_cvt_pk_bf16_f32 v9, v46, v47
    v_cvt_pk_bf16_f32 v10, v48, v49
    v_cvt_pk_bf16_f32 v11, v50, v51
    v_lshlrev_b32 v44, 16, v8
    v_and_b32 v45, 0xffff0000, v8
    v_lshlrev_b32 v46, 16, v9
    v_and_b32 v47, 0xffff0000, v9
    v_lshlrev_b32 v48, 16, v10
    v_and_b32 v49, 0xffff0000, v10
    v_lshlrev_b32 v50, 16, v11
    v_and_b32 v51, 0xffff0000, v11
    v_cndmask_b32 v44, v58, v44, s[60:61]
    v_cndmask_b32 v45, v58, v45, s[62:63]
    v_cndmask_b32 v46, v58, v46, s[64:65]
    v_cndmask_b32 v47, v58, v47, s[66:67]
    v_cndmask_b32 v48, v58, v48, s[68:69]
    v_cndmask_b32 v49, v58, v49, s[70:71]
    v_cndmask_b32 v50, v58, v50, s[72:73]
    v_cndmask_b32 v51, v58, v51, s[74:75]
    v_max3_f32 v13, v44, v45, v46
    v_max3_f32 v14, v47, v48, v49
    v_max3_f32 v13, v13, v50, v51
    v_max_f32 v13, v13, v14
L_reculb63_243:
    s_waitcnt vmcnt(16)
    v_mfma_f32_16x16x32_bf16 v[40:43], v[16:19], v[128:131], 0
    v_mfma_f32_16x16x32_bf16 v[40:43], v[20:23], v[132:135], v[40:43]
    v_mfma_f32_16x16x32_bf16 v[40:43], v[24:27], v[136:139], v[40:43]
    v_mfma_f32_16x16x32_bf16 v[40:43], v[28:31], v[140:143], v[40:43]
    v_mov_b32 v6, s32
    v_mov_b32 v7, 0
    buffer_store_dword v6, v7, s[4:7], s38 offen sc1
    s_nop 4
    v_cvt_pk_bf16_f32 v8, v42, v43
    v_lshlrev_b32 v42, 16, v8
    v_and_b32 v43, 0xffff0000, v8
    v_pk_mul_f32 v[42:43], v[42:43], s[44:45]
    v_cvt_pk_bf16_f32 v8, v42, v43
    v_lshlrev_b32 v42, 16, v8
    v_and_b32 v43, 0xffff0000, v8
    v_max3_f32 v6, v13, v42, v43
    v_mov_b32 v59, v6
    s_nop 1
    v_permlane32_swap_b32 v59, v6
    v_max_f32 v6, v6, v59
    v_mov_b32 v59, v6
    s_nop 1
    v_permlane16_swap_b32 v59, v6
    v_max_f32 v6, v6, v59
    v_pk_add_f32 v[42:43], v[42:43], v[6:7] op_sel_hi:[1,0] neg_lo:[0,1] neg_hi:[0,1]
    v_pk_add_f32 v[44:45], v[44:45], v[6:7] op_sel_hi:[1,0] neg_lo:[0,1] neg_hi:[0,1]
    v_pk_add_f32 v[46:47], v[46:47], v[6:7] op_sel_hi:[1,0] neg_lo:[0,1] neg_hi:[0,1]
    v_pk_add_f32 v[48:49], v[48:49], v[6:7] op_sel_hi:[1,0] neg_lo:[0,1] neg_hi:[0,1]
    v_pk_add_f32 v[50:51], v[50:51], v[6:7] op_sel_hi:[1,0] neg_lo:[0,1] neg_hi:[0,1]
    v_pk_mul_f32 v[42:43], v[42:43], s[46:47]
    v_pk_mul_f32 v[44:45], v[44:45], s[46:47]
    v_pk_mul_f32 v[46:47], v[46:47], s[46:47]
    v_pk_mul_f32 v[48:49], v[48:49], s[46:47]
    v_pk_mul_f32 v[50:51], v[50:51], s[46:47]
    v_exp_f32 v42, v42
    v_exp_f32 v43, v43
    v_exp_f32 v44, v44
    v_exp_f32 v45, v45
    v_exp_f32 v46, v46
    v_exp_f32 v47, v47
    v_exp_f32 v48, v48
    v_exp_f32 v49, v49
    v_exp_f32 v50, v50
    v_exp_f32 v51, v51
    v_pk_add_f32 v[8:9], v[42:43], v[44:45]
    v_pk_add_f32 v[10:11], v[46:47], v[48:49]
    v_pk_add_f32 v[8:9], v[8:9], v[50:51]
    v_pk_add_f32 v[8:9], v[8:9], v[10:11]
    v_add_f32 v6, v8, v9
    v_mov_b32 v59, v6
    s_nop 1
    v_permlane32_swap_b32 v59, v6
    v_add_f32 v6, v6, v59
    v_mov_b32 v59, v6
    s_nop 1
    v_permlane16_swap_b32 v59, v6
    v_add_f32 v6, v6, v59
    v_rcp_f32 v6, v6
    s_nop 0
    v_pk_mul_f32 v[42:43], v[42:43], v[6:7] op_sel_hi:[1,0]
    v_pk_mul_f32 v[44:45], v[44:45], v[6:7] op_sel_hi:[1,0]
    v_pk_mul_f32 v[46:47], v[46:47], v[6:7] op_sel_hi:[1,0]
    v_pk_mul_f32 v[48:49], v[48:49], v[6:7] op_sel_hi:[1,0]
    v_pk_mul_f32 v[50:51], v[50:51], v[6:7] op_sel_hi:[1,0]
    v_cvt_pk_bf16_f32 v52, v44, v45
    v_cvt_pk_bf16_f32 v53, v46, v47
    v_cvt_pk_bf16_f32 v54, v48, v49
    v_cvt_pk_bf16_f32 v55, v50, v51
    v_cvt_pk_bf16_f32 v56, v42, v43
    v_cvt_pk_bf16_f32 v37, v42, v43
    v_mfma_f32_16x16x32_bf16 v[192:195], v[176:179], v[52:55], 0
    v_mfma_f32_16x16x32_bf16 v[196:199], v[180:183], v[52:55], 0
    v_mfma_f32_16x16x32_bf16 v[200:203], v[184:187], v[52:55], 0
    v_mfma_f32_16x16x32_bf16 v[204:207], v[188:191], v[52:55], 0
    v_mfma_f32_16x16x16_bf16 v[192:195], v[32:33], v[56:57], v[192:195]
    v_mfma_f32_16x16x16_bf16 v[196:199], v[32:33], v[36:37], v[196:199]
    v_mfma_f32_16x16x16_bf16 v[200:203], v[34:35], v[56:57], v[200:203]
    v_mfma_f32_16x16x16_bf16 v[204:207], v[34:35], v[36:37], v[204:207]
    v_cvt_pk_bf16_f32 v208, v192, v193
    v_cvt_pk_bf16_f32 v209, v194, v195
    v_cvt_pk_bf16_f32 v210, v196, v197
    v_cvt_pk_bf16_f32 v211, v198, v199
    v_cvt_pk_bf16_f32 v212, v200, v201
    v_cvt_pk_bf16_f32 v213, v202, v203
    s_nop 1
    v_cvt_pk_bf16_f32 v214, v204, v205
    v_cvt_pk_bf16_f32 v215, v206, v207
    buffer_store_dwordx4 v[208:211], v1, s[4:7], s37 offen sc1
    buffer_store_dwordx4 v[212:215], v1, s[4:7], s37 offen offset:1024 sc1
    s_add_u32 s37, s37, 262144
    s_add_u32 s32, s32, 1
    s_cmp_lt_u32 s32, 64
    s_cbranch_scc1 L_recual_234
    s_waitcnt vmcnt(0)
    v_mov_b32 v6, s32
    v_mov_b32 v7, 0
    buffer_store_dword v6, v7, s[4:7], s38 offen sc1
    s_waitcnt vmcnt(0)
    s_branch L_exit_recurrent_scan__memory_aug_recurrent_mem_tr__moe_arch_mod__prompt_kernel
L_gen_recurrent_scan__memory_aug_recurrent_mem_tr__moe_arch_mod__prompt_kernel:
    s_waitcnt vmcnt(0) lgkmcnt(0)
    s_barrier
    v_mov_b32 v1, 0
    s_cmp_lg_u32 s24, 0
    s_cbranch_scc1 L_recugw_251
    s_mov_b64 exec, 1
    v_mov_b32 v2, 1
    buffer_atomic_add v2, v1, s[20:23], 0 offen offset:128 sc0 sc1
    s_waitcnt vmcnt(0)
    ds_write_b32 v1, v2
    s_waitcnt lgkmcnt(0)
    s_mov_b64 exec, -1
L_recugw_251:
    s_barrier
    ds_read_b32 v2, v1
    s_waitcnt lgkmcnt(0)
    v_readfirstlane_b32 s25, v2
    s_mov_b32 s76, 2
    s_mov_b32 s77, 3
    v_mbcnt_lo_u32_b32 v0, -1, 0
    v_mbcnt_hi_u32_b32 v0, -1, v0
    s_barrier
    v_mov_b32 v5, 0
    s_mov_b32 s27, 0
L_recuwgt_252:
    buffer_load_dword v6, v5, s[20:23], 0 offen offset:128 sc1
    s_waitcnt vmcnt(0)
    v_cmp_gt_u32 vcc, 0x100, v6
    s_cbranch_vccz L_recuwgtok_253
    s_add_u32 s27, s27, 1
    s_cmp_lt_u32 s27, 400000
    s_cbranch_scc0 L_exit_recurrent_scan__memory_aug_recurrent_mem_tr__moe_arch_mod__prompt_kernel
    s_sleep 2
    s_branch L_recuwgt_252
L_recuwgtok_253:
    s_cmp_lt_u32 s25, 256
    s_cbranch_scc1 L_recudsp_1
L_exit_recurrent_scan__memory_aug_recurrent_mem_tr__moe_arch_mod__prompt_kernel:
    s_endpgm
.section .rodata,"a"
.p2align 6
.amdhsa_kernel recurrent_scan__memory_aug_recurrent_mem_tr__moe_arch_mod__prompt_kernel
  .amdhsa_next_free_vgpr 512
  .amdhsa_next_free_sgpr 102
  .amdhsa_accum_offset 256
  .amdhsa_group_segment_fixed_size 0
  .amdhsa_kernarg_size 120
  .amdhsa_user_sgpr_count 2
  .amdhsa_user_sgpr_kernarg_segment_ptr 1
  .amdhsa_system_sgpr_workgroup_id_x 1
  .amdhsa_float_denorm_mode_32 3
.end_amdhsa_kernel
.text
```
